```python
import torch

def _softmax(x, axis=-1):
    return torch.softmax(x, dim=axis)
def _gelu(x):
    return torch.nn.functional.gelu(x, approximate="tanh")
def _silu(x):
    return torch.nn.functional.silu(x)
def _sigmoid(x):
    return torch.sigmoid(x)
def _layernorm(x, axis=-1, eps=1e-5):
    m = x.mean(dim=axis, keepdim=True)
    v = x.var(dim=axis, keepdim=True, unbiased=False)
    return (x - m) / torch.sqrt(v + eps)
def _scatter_add(tgt, idx, src, axis=0):
    return tgt.clone().index_add_(axis, idx, src)
def _segment_sum(src, seg, n):
    out = torch.zeros((n,) + src.shape[1:], dtype=src.dtype)
    return out.index_add_(0, seg, src)
def _pad(x, pw):
    flat = tuple(v for pair in reversed(pw) for v in pair)
    return torch.nn.functional.pad(x, flat)

kernel_name = 'sequential_preLN__compressed_kv_cla__mixer_token_mlp__prompt'

def setup_inputs():

    _w = (lambda a: (lambda t: t.to(torch.bfloat16) if t.is_floating_point() else t)(torch.as_tensor(a)))
    def _A_setup():
        B, H, Sq, Sk, D, M = 1, 32, 2048, 2048, 128, 640
        Dc = 4 * D
        return {
            "x": _w((lambda *s: torch.randn(*s, dtype=torch.bfloat16) * 0.05)(B, Sq, M)),
            "c_kv": _w((lambda *s: torch.randn(*s, dtype=torch.bfloat16) * 0.2)(B, Sk, Dc)),
            "w_q": _w((lambda *s: torch.randn(*s, dtype=torch.bfloat16) * 3.2)(M, H, D) * (M ** -0.5)),
            "w_uk": _w((lambda *s: torch.randn(*s, dtype=torch.bfloat16) * 6.4)(Dc, H, D) * (Dc ** -0.5)),
            "w_uv": _w((lambda *s: torch.randn(*s, dtype=torch.bfloat16) * 0.2)(Dc, H, D) * (Dc ** -0.5)),
            "w_o": _w((lambda *s: torch.randn(*s, dtype=torch.bfloat16) * 0.2)(H, D, M) * ((H * D) ** -0.5)),
        }
    _A_in = _A_setup()

    def _B_setup():
        B, S, D, F = 1, 2048, 640, 1728
        return {
            "x": _w((lambda *s: torch.randn(*s, dtype=torch.bfloat16) * 0.05)(B, S, D)),
            "w1": _w((lambda *s: torch.randn(*s, dtype=torch.bfloat16) * 0.4)(S, F) * (S ** -0.5)),
            "b1": _w((lambda *s: torch.randn(*s, dtype=torch.bfloat16) * 3.2)(F) * 0.02),
            "w2": _w((lambda *s: torch.randn(*s, dtype=torch.bfloat16) * 0.2)(F, S) * (F ** -0.5)),
            "b2": _w((lambda *s: torch.randn(*s, dtype=torch.bfloat16) * 0.8)(S) * 0.02),
        }
    _B_in = _B_setup()

    return {
        "A_x": _A_in["x"],
        "A_c_kv": _A_in["c_kv"],
        "A_w_q": _A_in["w_q"],
        "A_w_uk": _A_in["w_uk"],
        "A_w_uv": _A_in["w_uv"],
        "A_w_o": _A_in["w_o"],
        "B_x": _B_in["x"],
        "B_w1": _B_in["w1"],
        "B_b1": _B_in["b1"],
        "B_w2": _B_in["w2"],
        "B_b2": _B_in["b2"],
    }

def reference(A_x, A_c_kv, A_w_q, A_w_uk, A_w_uv, A_w_o, B_x, B_w1, B_b1, B_w2, B_b2):
    def _A_ref(x, c_kv, w_q, w_uk, w_uv, w_o):
        B, Sq, M = x.shape[0], x.shape[1], x.shape[2]
        Sk = c_kv.shape[1]
        H, D = w_q.shape[1], w_q.shape[2]
        q = torch.einsum("bqm,mhd->bhqd", x, w_q)
        k = torch.einsum("bkc,chd->bhkd", c_kv, w_uk)
        v = torch.einsum("bkc,chd->bhkd", c_kv, w_uv)
        scores = torch.einsum("bhqd,bhkd->bhqk", q, k) * (D ** -0.5)
        off = Sk - Sq
        qi = torch.arange(Sq)[:, None]
        kj = torch.arange(Sk)[None, :]
        cmask = kj <= (qi + off)
        scores = torch.where(cmask[None, None], scores, -1e9)
        p = _softmax(scores, axis=-1)
        ctx = torch.einsum("bhqk,bhkd->bhqd", p, v)
        return torch.einsum("bhqd,hdm->bqm", ctx, w_o)

    def _B_ref(x, w1, b1, w2, b2):
        B, S, D = x.shape
        h = _layernorm(x, axis=-1)
        u = torch.einsum("bsd,sf->bdf", h, w1) + b1
        u = _gelu(u)
        y = torch.einsum("bdf,fs->bds", u, w2) + b2
        return (lambda x, *d: x.permute(*d))(y, 0, 2, 1)

    x = A_x
    h = x + _A_ref(_layernorm(x, axis=-1), A_c_kv, A_w_q, A_w_uk, A_w_uv, A_w_o)
    h2 = h + _B_ref(_layernorm(h, axis=-1), B_w1, B_b1, B_w2, B_b2)
    return h2
```

```asm
; @launch kernel=kv_kernel grid=(256,1,1) block=(256,1,1) lds=147456
; @launch kernel=attn_kernel grid=(256,1,1) block=(512,1,1) lds=163840
; @launch kernel=oproj_kernel grid=(256,1,1) block=(512,1,1) lds=147456
; @launch kernel=ln2_kernel grid=(256,1,1) block=(256,1,1) lds=0
; @launch kernel=mlp1_kernel grid=(216,1,1) block=(512,1,1) lds=147456
; @launch kernel=mlp2_kernel grid=(256,1,1) block=(512,1,1) lds=147456
.amdgcn_target "amdgcn-amd-amdhsa--gfx950"
.text
.globl kv_kernel
.p2align 8
.type kv_kernel,@function
kv_kernel:
    s_cmp_ge_u32 s2, 256
    s_cbranch_scc1 Lkv_end
    s_load_dwordx4 s[4:7], s[0:1], 0
    s_load_dwordx4 s[8:11], s[0:1], 24
    s_load_dwordx2 s[12:13], s[0:1], 104
    s_load_dwordx2 s[14:15], s[0:1], 16
    v_lshrrev_b32 v1, 6, v0
    s_nop 0
    v_readfirstlane_b32 s40, v1
    s_and_b32 s41, s2, 7
    s_lshr_b32 s42, s2, 3
    s_and_b32 s43, s42, 7
    s_lshr_b32 s42, s42, 3
    s_lshl_b32 s41, s41, 2
    s_add_u32 s41, s41, s42
    s_lshr_b32 s45, s40, 1
    s_and_b32 s46, s40, 1
    s_lshl_b32 s64, s43, 18
    s_lshl_b32 s65, s41, 8
    s_mul_i32 s44, s43, 1
    s_mul_i32 s42, s42, 0
    s_add_u32 s44, s44, s42
    v_and_b32 v1, 63, v0
    s_mul_i32 s48, s40, 8192
    s_lshr_b32 s52, s48, 4
    v_add_u32 v2, s52, v1
    v_lshrrev_b32 v3, 3, v2
    v_and_b32 v4, 7, v2
    v_lshrrev_b32 v5, 1, v3
    v_and_b32 v5, 7, v5
    v_xor_b32 v4, v4, v5
    s_mov_b32 s53, 1024
    v_mul_lo_u32 v3, v3, s53
    v_lshl_add_u32 v8, v4, 4, v3
    v_add_u32 v2, s52, v1
    v_add_u32 v2, 64, v2
    v_lshrrev_b32 v3, 3, v2
    v_and_b32 v4, 7, v2
    v_lshrrev_b32 v5, 1, v3
    v_and_b32 v5, 7, v5
    v_xor_b32 v4, v4, v5
    s_mov_b32 s53, 1024
    v_mul_lo_u32 v3, v3, s53
    v_lshl_add_u32 v9, v4, 4, v3
    v_add_u32 v2, s52, v1
    v_add_u32 v2, 128, v2
    v_lshrrev_b32 v3, 3, v2
    v_and_b32 v4, 7, v2
    v_lshrrev_b32 v5, 1, v3
    v_and_b32 v5, 7, v5
    v_xor_b32 v4, v4, v5
    s_mov_b32 s53, 1024
    v_mul_lo_u32 v3, v3, s53
    v_lshl_add_u32 v10, v4, 4, v3
    v_add_u32 v2, s52, v1
    v_add_u32 v2, 192, v2
    v_lshrrev_b32 v3, 3, v2
    v_and_b32 v4, 7, v2
    v_lshrrev_b32 v5, 1, v3
    v_and_b32 v5, 7, v5
    v_xor_b32 v4, v4, v5
    s_mov_b32 s53, 1024
    v_mul_lo_u32 v3, v3, s53
    v_lshl_add_u32 v11, v4, 4, v3
    v_add_u32 v2, s52, v1
    v_add_u32 v2, 256, v2
    v_lshrrev_b32 v3, 3, v2
    v_and_b32 v4, 7, v2
    v_lshrrev_b32 v5, 1, v3
    v_and_b32 v5, 7, v5
    v_xor_b32 v4, v4, v5
    s_mov_b32 s53, 1024
    v_mul_lo_u32 v3, v3, s53
    v_lshl_add_u32 v12, v4, 4, v3
    v_add_u32 v2, s52, v1
    v_add_u32 v2, 320, v2
    v_lshrrev_b32 v3, 3, v2
    v_and_b32 v4, 7, v2
    v_lshrrev_b32 v5, 1, v3
    v_and_b32 v5, 7, v5
    v_xor_b32 v4, v4, v5
    s_mov_b32 s53, 1024
    v_mul_lo_u32 v3, v3, s53
    v_lshl_add_u32 v13, v4, 4, v3
    v_add_u32 v2, s52, v1
    v_add_u32 v2, 384, v2
    v_lshrrev_b32 v3, 3, v2
    v_and_b32 v4, 7, v2
    v_lshrrev_b32 v5, 1, v3
    v_and_b32 v5, 7, v5
    v_xor_b32 v4, v4, v5
    s_mov_b32 s53, 1024
    v_mul_lo_u32 v3, v3, s53
    v_lshl_add_u32 v14, v4, 4, v3
    v_add_u32 v2, s52, v1
    v_add_u32 v2, 448, v2
    v_lshrrev_b32 v3, 3, v2
    v_and_b32 v4, 7, v2
    v_lshrrev_b32 v5, 1, v3
    v_and_b32 v5, 7, v5
    v_xor_b32 v4, v4, v5
    s_mov_b32 s53, 1024
    v_mul_lo_u32 v3, v3, s53
    v_lshl_add_u32 v15, v4, 4, v3
    s_mul_i32 s50, s40, 4096
    s_lshr_b32 s52, s50, 4
    v_add_u32 v2, s52, v1
    v_lshrrev_b32 v3, 4, v2
    v_and_b32 v4, 15, v2
    v_and_b32 v5, 3, v3
    v_lshlrev_b32 v5, 2, v5
    v_xor_b32 v4, v4, v5
    s_mov_b32 s53, 8192
    v_mul_lo_u32 v3, v3, s53
    v_lshl_add_u32 v16, v4, 4, v3
    v_add_u32 v2, s52, v1
    v_add_u32 v2, 64, v2
    v_lshrrev_b32 v3, 4, v2
    v_and_b32 v4, 15, v2
    v_and_b32 v5, 3, v3
    v_lshlrev_b32 v5, 2, v5
    v_xor_b32 v4, v4, v5
    s_mov_b32 s53, 8192
    v_mul_lo_u32 v3, v3, s53
    v_lshl_add_u32 v17, v4, 4, v3
    v_add_u32 v2, s52, v1
    v_add_u32 v2, 128, v2
    v_lshrrev_b32 v3, 4, v2
    v_and_b32 v4, 15, v2
    v_and_b32 v5, 3, v3
    v_lshlrev_b32 v5, 2, v5
    v_xor_b32 v4, v4, v5
    s_mov_b32 s53, 8192
    v_mul_lo_u32 v3, v3, s53
    v_lshl_add_u32 v18, v4, 4, v3
    v_add_u32 v2, s52, v1
    v_add_u32 v2, 192, v2
    v_lshrrev_b32 v3, 4, v2
    v_and_b32 v4, 15, v2
    v_and_b32 v5, 3, v3
    v_lshlrev_b32 v5, 2, v5
    v_xor_b32 v4, v4, v5
    s_mov_b32 s53, 8192
    v_mul_lo_u32 v3, v3, s53
    v_lshl_add_u32 v19, v4, 4, v3
    s_waitcnt lgkmcnt(0)
    s_mov_b32 s16, s6
    s_mov_b32 s17, s7
    s_mov_b32 s18, 2097152
    s_mov_b32 s19, 0x00020000
    s_mov_b32 s20, s8
    s_mov_b32 s21, s9
    s_mov_b32 s22, 4194304
    s_mov_b32 s23, 0x00020000
    s_add_u32 m0, s48, 0
    s_and_b32 s44, s44, 7
    s_lshl_b32 s49, s44, 7
    s_add_u32 s49, s49, s64
    s_lshl_b32 s51, s44, 19
    s_add_u32 s51, s51, s65
    s_add_u32 s44, s44, 1
    buffer_load_dwordx4 v8, s[16:19], s49 offen lds
    s_add_u32 m0, s48, 1024
    s_nop 0
    buffer_load_dwordx4 v9, s[16:19], s49 offen lds
    s_add_u32 m0, s48, 2048
    s_nop 0
    buffer_load_dwordx4 v10, s[16:19], s49 offen lds
    s_add_u32 m0, s48, 3072
    s_nop 0
    buffer_load_dwordx4 v11, s[16:19], s49 offen lds
    s_add_u32 m0, s48, 4096
    s_nop 0
    buffer_load_dwordx4 v12, s[16:19], s49 offen lds
    s_add_u32 m0, s48, 5120
    s_nop 0
    buffer_load_dwordx4 v13, s[16:19], s49 offen lds
    s_add_u32 m0, s48, 6144
    s_nop 0
    buffer_load_dwordx4 v14, s[16:19], s49 offen lds
    s_add_u32 m0, s48, 7168
    s_nop 0
    buffer_load_dwordx4 v15, s[16:19], s49 offen lds
    s_add_u32 m0, s50, 32768
    s_nop 0
    buffer_load_dwordx4 v16, s[20:23], s51 offen lds
    s_add_u32 m0, s50, 33792
    s_nop 0
    buffer_load_dwordx4 v17, s[20:23], s51 offen lds
    s_add_u32 m0, s50, 34816
    s_nop 0
    buffer_load_dwordx4 v18, s[20:23], s51 offen lds
    s_add_u32 m0, s50, 35840
    s_nop 0
    buffer_load_dwordx4 v19, s[20:23], s51 offen lds
    s_mov_b32 s28, s4
    s_mov_b32 s29, s5
    s_mov_b32 s30, 2621440
    s_mov_b32 s31, 0x00020000
    v_and_b32 v178, 63, v0
    v_lshlrev_b32 v150, 2, v178
    v_lshlrev_b32 v176, 4, v178
    v_and_b32 v181, 0x270, v176
    v_and_b32 v2, 0x80, v176
    v_lshl_add_u32 v181, v2, 1, v181
    v_and_b32 v2, 0x100, v176
    v_lshrrev_b32 v2, 1, v2
    v_add_u32 v181, v2, v181
    s_lshl_b32 s47, s2, 3
    s_lshl_b32 s60, s40, 1
    s_add_u32 s47, s47, s60
    s_mul_i32 s47, s47, 1280
    s_add_u32 m0, s48, 49152
    s_and_b32 s44, s44, 7
    s_lshl_b32 s49, s44, 7
    s_add_u32 s49, s49, s64
    s_lshl_b32 s51, s44, 19
    s_add_u32 s51, s51, s65
    s_add_u32 s44, s44, 1
    buffer_load_dwordx4 v8, s[16:19], s49 offen lds
    s_add_u32 m0, s48, 50176
    s_nop 0
    buffer_load_dwordx4 v9, s[16:19], s49 offen lds
    s_add_u32 m0, s48, 51200
    s_nop 0
    buffer_load_dwordx4 v10, s[16:19], s49 offen lds
    s_add_u32 m0, s48, 52224
    s_nop 0
    buffer_load_dwordx4 v11, s[16:19], s49 offen lds
    s_add_u32 m0, s48, 53248
    s_nop 0
    buffer_load_dwordx4 v12, s[16:19], s49 offen lds
    s_add_u32 m0, s48, 54272
    s_nop 0
    buffer_load_dwordx4 v13, s[16:19], s49 offen lds
    s_add_u32 m0, s48, 55296
    s_nop 0
    buffer_load_dwordx4 v14, s[16:19], s49 offen lds
    s_add_u32 m0, s48, 56320
    s_nop 0
    buffer_load_dwordx4 v15, s[16:19], s49 offen lds
    s_add_u32 m0, s50, 81920
    s_nop 0
    buffer_load_dwordx4 v16, s[20:23], s51 offen lds
    s_add_u32 m0, s50, 82944
    s_nop 0
    buffer_load_dwordx4 v17, s[20:23], s51 offen lds
    s_add_u32 m0, s50, 83968
    s_nop 0
    buffer_load_dwordx4 v18, s[20:23], s51 offen lds
    s_add_u32 m0, s50, 84992
    s_nop 0
    buffer_load_dwordx4 v19, s[20:23], s51 offen lds
    buffer_load_dword v128, v150, s[28:31], s47 offen offset:0
    buffer_load_dword v129, v150, s[28:31], s47 offen offset:256
    buffer_load_dword v130, v150, s[28:31], s47 offen offset:512
    buffer_load_dword v131, v150, s[28:31], s47 offen offset:768
    buffer_load_dword v132, v150, s[28:31], s47 offen offset:1024
    buffer_load_dword v133, v150, s[28:31], s47 offen offset:1280
    buffer_load_dword v134, v150, s[28:31], s47 offen offset:1536
    buffer_load_dword v135, v150, s[28:31], s47 offen offset:1792
    buffer_load_dword v136, v150, s[28:31], s47 offen offset:2048
    buffer_load_dword v137, v150, s[28:31], s47 offen offset:2304
    s_mov_b32 s32, s12
    s_mov_b32 s33, s13
    s_mov_b32 s34, 2621440
    s_mov_b32 s35, 0x00020000
    s_mov_b32 s36, s10
    s_mov_b32 s37, s11
    s_mov_b32 s38, 4194304
    s_mov_b32 s39, 0x00020000
    s_mov_b32 s56, s14
    s_mov_b32 s57, s15
    s_mov_b32 s58, 5242880
    s_mov_b32 s59, 0x00020000
    s_add_u32 s24, s12, 4194304
    s_addc_u32 s25, s13, 0
    s_mov_b32 s26, 37748736
    s_mov_b32 s27, 0x00020000
    s_lshl_b32 s54, s2, 2
    s_add_u32 s54, s54, s40
    s_lshl_b32 s60, s41, 19
    s_lshl_b32 s61, s43, 16
    s_add_u32 s60, s60, s61
    s_lshl_b32 s61, s45, 15
    s_add_u32 s60, s60, s61
    s_lshl_b32 s61, s46, 12
    s_add_u32 s61, s61, s60
    s_lshl_b32 s62, s46, 13
    s_add_u32 s62, s62, s60
    s_add_u32 s62, s62, 20971520
    v_and_b32 v2, 63, v0
    v_and_b32 v3, 31, v2
    v_lshrrev_b32 v4, 5, v2
    v_lshrrev_b32 v5, 1, v3
    v_and_b32 v5, 7, v5
    s_mul_i32 s52, s45, 128
    v_add_u32 v3, s52, v3
    v_mul_u32_u24 v3, 128, v3
    v_add_u32 v3, 0, v3
    v_add_u32 v6, 0, v4
    v_xor_b32 v6, v6, v5
    v_lshl_add_u32 v20, v6, 4, v3
    v_add_u32 v6, 2, v4
    v_xor_b32 v6, v6, v5
    v_lshl_add_u32 v21, v6, 4, v3
    v_add_u32 v6, 4, v4
    v_xor_b32 v6, v6, v5
    v_lshl_add_u32 v22, v6, 4, v3
    v_add_u32 v6, 6, v4
    v_xor_b32 v6, v6, v5
    v_lshl_add_u32 v23, v6, 4, v3
    v_bfe_u32 v3, v2, 2, 2
    v_lshrrev_b32 v4, 5, v2
    v_mad_u32_u24 v4, v4, 8, v3
    v_mul_u32_u24 v5, 256, v4
    v_and_b32 v6, 3, v2
    v_lshl_add_u32 v5, v6, 3, v5
    v_bfe_u32 v6, v2, 4, 1
    v_lshl_add_u32 v5, v6, 5, v5
    v_add_u32 v5, 32768, v5
    v_mov_b32 v6, v3
    s_mul_i32 s52, s46, 2
    s_add_u32 s52, s52, 0
    v_xor_b32 v3, s52, v6
    v_mad_u32_u24 v28, v3, 64, v5
    s_mul_i32 s52, s46, 2
    s_add_u32 s52, s52, 1
    v_xor_b32 v3, s52, v6
    v_mad_u32_u24 v29, v3, 64, v5
    s_waitcnt vmcnt(22)
    s_barrier
    v_add_u32 v24, 0, v20
    v_add_u32 v25, 0, v21
    v_add_u32 v26, 0, v22
    v_add_u32 v27, 0, v23
    v_add_u32 v30, 0, v28
    v_add_u32 v31, 0, v29
    ds_read_b128 v[32:35], v24 offset:0
    ds_read_b128 v[36:39], v24 offset:4096
    ds_read_b128 v[40:43], v24 offset:8192
    ds_read_b128 v[44:47], v24 offset:12288
    ds_read_b64_tr_b16 v[48:49], v30 offset:0
    ds_read_b64_tr_b16 v[50:51], v30 offset:1024
    ds_read_b64_tr_b16 v[52:53], v31 offset:0
    ds_read_b64_tr_b16 v[54:55], v31 offset:1024
    ds_read_b128 v[56:59], v25 offset:0
    ds_read_b128 v[60:63], v25 offset:4096
    ds_read_b128 v[64:67], v25 offset:8192
    ds_read_b128 v[68:71], v25 offset:12288
    ds_read_b64_tr_b16 v[72:73], v30 offset:4096
    ds_read_b64_tr_b16 v[74:75], v30 offset:5120
    ds_read_b64_tr_b16 v[76:77], v31 offset:4096
    ds_read_b64_tr_b16 v[78:79], v31 offset:5120
    s_waitcnt lgkmcnt(0)
    v_mfma_f32_32x32x16_bf16 a[0:15], v[48:51], v[32:35], 0
    ds_read_b128 v[80:83], v26 offset:0
    ds_read_b128 v[84:87], v26 offset:4096
    ds_read_b128 v[88:91], v26 offset:8192
    v_mfma_f32_32x32x16_bf16 a[16:31], v[52:55], v[32:35], 0
    ds_read_b128 v[92:95], v26 offset:12288
    ds_read_b64_tr_b16 v[96:97], v30 offset:8192
    ds_read_b64_tr_b16 v[98:99], v30 offset:9216
    s_add_u32 m0, s48, 98304
    s_and_b32 s44, s44, 7
    s_lshl_b32 s49, s44, 7
    s_add_u32 s49, s49, s64
    s_lshl_b32 s51, s44, 19
    s_add_u32 s51, s51, s65
    s_add_u32 s44, s44, 1
    buffer_load_dwordx4 v8, s[16:19], s49 offen lds
    v_mfma_f32_32x32x16_bf16 a[32:47], v[48:51], v[36:39], 0
    ds_read_b64_tr_b16 v[100:101], v31 offset:8192
    ds_read_b64_tr_b16 v[102:103], v31 offset:9216
    ds_read_b128 v[104:107], v27 offset:0
    v_mfma_f32_32x32x16_bf16 a[48:63], v[52:55], v[36:39], 0
    ds_read_b128 v[108:111], v27 offset:4096
    ds_read_b128 v[112:115], v27 offset:8192
    ds_read_b128 v[116:119], v27 offset:12288
    s_add_u32 m0, s48, 99328
    s_nop 0
    buffer_load_dwordx4 v9, s[16:19], s49 offen lds
    v_mfma_f32_32x32x16_bf16 a[64:79], v[48:51], v[40:43], 0
    ds_read_b64_tr_b16 v[120:121], v30 offset:12288
    ds_read_b64_tr_b16 v[122:123], v30 offset:13312
    ds_read_b64_tr_b16 v[124:125], v31 offset:12288
    v_mfma_f32_32x32x16_bf16 a[80:95], v[52:55], v[40:43], 0
    ds_read_b64_tr_b16 v[126:127], v31 offset:13312
    s_add_u32 m0, s48, 100352
    s_nop 0
    buffer_load_dwordx4 v10, s[16:19], s49 offen lds
    v_mfma_f32_32x32x16_bf16 a[96:111], v[48:51], v[44:47], 0
    v_mfma_f32_32x32x16_bf16 a[112:127], v[52:55], v[44:47], 0
    s_add_u32 m0, s48, 101376
    s_nop 0
    buffer_load_dwordx4 v11, s[16:19], s49 offen lds
    v_mfma_f32_32x32x16_bf16 a[0:15], v[72:75], v[56:59], a[0:15]
    v_mfma_f32_32x32x16_bf16 a[16:31], v[76:79], v[56:59], a[16:31]
    s_add_u32 m0, s48, 102400
    s_nop 0
    buffer_load_dwordx4 v12, s[16:19], s49 offen lds
    v_mfma_f32_32x32x16_bf16 a[32:47], v[72:75], v[60:63], a[32:47]
    v_mfma_f32_32x32x16_bf16 a[48:63], v[76:79], v[60:63], a[48:63]
    s_add_u32 m0, s48, 103424
    s_nop 0
    buffer_load_dwordx4 v13, s[16:19], s49 offen lds
    v_mfma_f32_32x32x16_bf16 a[64:79], v[72:75], v[64:67], a[64:79]
    v_mfma_f32_32x32x16_bf16 a[80:95], v[76:79], v[64:67], a[80:95]
    s_add_u32 m0, s48, 104448
    s_nop 0
    buffer_load_dwordx4 v14, s[16:19], s49 offen lds
    v_mfma_f32_32x32x16_bf16 a[96:111], v[72:75], v[68:71], a[96:111]
    v_mfma_f32_32x32x16_bf16 a[112:127], v[76:79], v[68:71], a[112:127]
    s_add_u32 m0, s48, 105472
    s_nop 0
    buffer_load_dwordx4 v15, s[16:19], s49 offen lds
    s_waitcnt lgkmcnt(0)
    s_waitcnt vmcnt(18)
    s_barrier
    v_mfma_f32_32x32x16_bf16 a[0:15], v[96:99], v[80:83], a[0:15]
    v_add_u32 v24, 49152, v20
    v_add_u32 v25, 49152, v21
    v_add_u32 v26, 49152, v22
    s_add_u32 m0, s50, 131072
    s_nop 0
    buffer_load_dwordx4 v16, s[20:23], s51 offen lds
    v_mfma_f32_32x32x16_bf16 a[16:31], v[100:103], v[80:83], a[16:31]
    v_add_u32 v27, 49152, v23
    v_add_u32 v30, 49152, v28
    v_add_u32 v31, 49152, v29
    s_add_u32 m0, s50, 132096
    s_nop 0
    buffer_load_dwordx4 v17, s[20:23], s51 offen lds
    v_mfma_f32_32x32x16_bf16 a[32:47], v[96:99], v[84:87], a[32:47]
    ds_read_b128 v[32:35], v24 offset:0
    ds_read_b128 v[36:39], v24 offset:4096
    ds_read_b128 v[40:43], v24 offset:8192
    s_add_u32 m0, s50, 133120
    s_nop 0
    buffer_load_dwordx4 v18, s[20:23], s51 offen lds
    v_mfma_f32_32x32x16_bf16 a[48:63], v[100:103], v[84:87], a[48:63]
    ds_read_b128 v[44:47], v24 offset:12288
    ds_read_b64_tr_b16 v[48:49], v30 offset:0
    ds_read_b64_tr_b16 v[50:51], v30 offset:1024
    v_mfma_f32_32x32x16_bf16 a[64:79], v[96:99], v[88:91], a[64:79]
    ds_read_b64_tr_b16 v[52:53], v31 offset:0
    ds_read_b64_tr_b16 v[54:55], v31 offset:1024
    ds_read_b128 v[56:59], v25 offset:0
    s_add_u32 m0, s50, 134144
    s_nop 0
    buffer_load_dwordx4 v19, s[20:23], s51 offen lds
    v_mfma_f32_32x32x16_bf16 a[80:95], v[100:103], v[88:91], a[80:95]
    ds_read_b128 v[60:63], v25 offset:4096
    ds_read_b128 v[64:67], v25 offset:8192
    ds_read_b128 v[68:71], v25 offset:12288
    s_add_u32 m0, s48, 0
    s_and_b32 s44, s44, 7
    s_lshl_b32 s49, s44, 7
    s_add_u32 s49, s49, s64
    s_lshl_b32 s51, s44, 19
    s_add_u32 s51, s51, s65
    s_add_u32 s44, s44, 1
    buffer_load_dwordx4 v8, s[16:19], s49 offen lds
    v_mfma_f32_32x32x16_bf16 a[96:111], v[96:99], v[92:95], a[96:111]
    ds_read_b64_tr_b16 v[72:73], v30 offset:4096
    ds_read_b64_tr_b16 v[74:75], v30 offset:5120
    ds_read_b64_tr_b16 v[76:77], v31 offset:4096
    s_add_u32 m0, s48, 1024
    s_nop 0
    buffer_load_dwordx4 v9, s[16:19], s49 offen lds
    v_mfma_f32_32x32x16_bf16 a[112:127], v[100:103], v[92:95], a[112:127]
    ds_read_b64_tr_b16 v[78:79], v31 offset:5120
    v_mfma_f32_32x32x16_bf16 a[0:15], v[120:123], v[104:107], a[0:15]
    s_add_u32 m0, s48, 2048
    s_nop 0
    buffer_load_dwordx4 v10, s[16:19], s49 offen lds
    v_mfma_f32_32x32x16_bf16 a[16:31], v[124:127], v[104:107], a[16:31]
    s_add_u32 m0, s48, 3072
    s_nop 0
    buffer_load_dwordx4 v11, s[16:19], s49 offen lds
    v_mfma_f32_32x32x16_bf16 a[32:47], v[120:123], v[108:111], a[32:47]
    s_add_u32 m0, s48, 4096
    s_nop 0
    buffer_load_dwordx4 v12, s[16:19], s49 offen lds
    v_mfma_f32_32x32x16_bf16 a[48:63], v[124:127], v[108:111], a[48:63]
    v_mfma_f32_32x32x16_bf16 a[64:79], v[120:123], v[112:115], a[64:79]
    s_add_u32 m0, s48, 5120
    s_nop 0
    buffer_load_dwordx4 v13, s[16:19], s49 offen lds
    v_mfma_f32_32x32x16_bf16 a[80:95], v[124:127], v[112:115], a[80:95]
    s_add_u32 m0, s48, 6144
    s_nop 0
    buffer_load_dwordx4 v14, s[16:19], s49 offen lds
    v_mfma_f32_32x32x16_bf16 a[96:111], v[120:123], v[116:119], a[96:111]
    s_add_u32 m0, s48, 7168
    s_nop 0
    buffer_load_dwordx4 v15, s[16:19], s49 offen lds
    v_mfma_f32_32x32x16_bf16 a[112:127], v[124:127], v[116:119], a[112:127]
    s_waitcnt lgkmcnt(0)
    v_mfma_f32_32x32x16_bf16 a[0:15], v[48:51], v[32:35], a[0:15]
    ds_read_b128 v[80:83], v26 offset:0
    ds_read_b128 v[84:87], v26 offset:4096
    ds_read_b128 v[88:91], v26 offset:8192
    v_mfma_f32_32x32x16_bf16 a[16:31], v[52:55], v[32:35], a[16:31]
    ds_read_b128 v[92:95], v26 offset:12288
    ds_read_b64_tr_b16 v[96:97], v30 offset:8192
    ds_read_b64_tr_b16 v[98:99], v30 offset:9216
    v_mfma_f32_32x32x16_bf16 a[32:47], v[48:51], v[36:39], a[32:47]
    ds_read_b64_tr_b16 v[100:101], v31 offset:8192
    ds_read_b64_tr_b16 v[102:103], v31 offset:9216
    ds_read_b128 v[104:107], v27 offset:0
    s_add_u32 m0, s50, 32768
    s_nop 0
    buffer_load_dwordx4 v16, s[20:23], s51 offen lds
    v_mfma_f32_32x32x16_bf16 a[48:63], v[52:55], v[36:39], a[48:63]
    ds_read_b128 v[108:111], v27 offset:4096
    ds_read_b128 v[112:115], v27 offset:8192
    ds_read_b128 v[116:119], v27 offset:12288
    v_mfma_f32_32x32x16_bf16 a[64:79], v[48:51], v[40:43], a[64:79]
    ds_read_b64_tr_b16 v[120:121], v30 offset:12288
    ds_read_b64_tr_b16 v[122:123], v30 offset:13312
    ds_read_b64_tr_b16 v[124:125], v31 offset:12288
    v_mfma_f32_32x32x16_bf16 a[80:95], v[52:55], v[40:43], a[80:95]
    ds_read_b64_tr_b16 v[126:127], v31 offset:13312
    v_mfma_f32_32x32x16_bf16 a[96:111], v[48:51], v[44:47], a[96:111]
    s_add_u32 m0, s50, 33792
    s_nop 0
    buffer_load_dwordx4 v17, s[20:23], s51 offen lds
    v_mfma_f32_32x32x16_bf16 a[112:127], v[52:55], v[44:47], a[112:127]
    v_mfma_f32_32x32x16_bf16 a[0:15], v[72:75], v[56:59], a[0:15]
    v_mfma_f32_32x32x16_bf16 a[16:31], v[76:79], v[56:59], a[16:31]
    v_mfma_f32_32x32x16_bf16 a[32:47], v[72:75], v[60:63], a[32:47]
    s_add_u32 m0, s50, 34816
    s_nop 0
    buffer_load_dwordx4 v18, s[20:23], s51 offen lds
    v_mfma_f32_32x32x16_bf16 a[48:63], v[76:79], v[60:63], a[48:63]
    v_mfma_f32_32x32x16_bf16 a[64:79], v[72:75], v[64:67], a[64:79]
    v_mfma_f32_32x32x16_bf16 a[80:95], v[76:79], v[64:67], a[80:95]
    v_mfma_f32_32x32x16_bf16 a[96:111], v[72:75], v[68:71], a[96:111]
    s_add_u32 m0, s50, 35840
    s_nop 0
    buffer_load_dwordx4 v19, s[20:23], s51 offen lds
    v_mfma_f32_32x32x16_bf16 a[112:127], v[76:79], v[68:71], a[112:127]
    s_waitcnt lgkmcnt(0)
    s_waitcnt vmcnt(12)
    s_barrier
    v_mfma_f32_32x32x16_bf16 a[0:15], v[96:99], v[80:83], a[0:15]
    v_add_u32 v24, 98304, v20
    v_add_u32 v25, 98304, v21
    v_add_u32 v26, 98304, v22
    v_mfma_f32_32x32x16_bf16 a[16:31], v[100:103], v[80:83], a[16:31]
    v_add_u32 v27, 98304, v23
    v_add_u32 v30, 98304, v28
    v_add_u32 v31, 98304, v29
    s_add_u32 m0, s48, 49152
    s_and_b32 s44, s44, 7
    s_lshl_b32 s49, s44, 7
    s_add_u32 s49, s49, s64
    s_lshl_b32 s51, s44, 19
    s_add_u32 s51, s51, s65
    s_add_u32 s44, s44, 1
    buffer_load_dwordx4 v8, s[16:19], s49 offen lds
    v_mfma_f32_32x32x16_bf16 a[32:47], v[96:99], v[84:87], a[32:47]
    ds_read_b128 v[32:35], v24 offset:0
    ds_read_b128 v[36:39], v24 offset:4096
    ds_read_b128 v[40:43], v24 offset:8192
    v_mfma_f32_32x32x16_bf16 a[48:63], v[100:103], v[84:87], a[48:63]
    ds_read_b128 v[44:47], v24 offset:12288
    ds_read_b64_tr_b16 v[48:49], v30 offset:0
    ds_read_b64_tr_b16 v[50:51], v30 offset:1024
    s_add_u32 m0, s48, 50176
    s_nop 0
    buffer_load_dwordx4 v9, s[16:19], s49 offen lds
    v_mfma_f32_32x32x16_bf16 a[64:79], v[96:99], v[88:91], a[64:79]
    ds_read_b64_tr_b16 v[52:53], v31 offset:0
    ds_read_b64_tr_b16 v[54:55], v31 offset:1024
    ds_read_b128 v[56:59], v25 offset:0
    v_lshlrev_b32 v138, 16, v128
    v_and_b32 v139, 0xffff0000, v128
    v_lshlrev_b32 v140, 16, v129
    v_mfma_f32_32x32x16_bf16 a[80:95], v[100:103], v[88:91], a[80:95]
    ds_read_b128 v[60:63], v25 offset:4096
    ds_read_b128 v[64:67], v25 offset:8192
    ds_read_b128 v[68:71], v25 offset:12288
    s_add_u32 m0, s48, 51200
    s_nop 0
    buffer_load_dwordx4 v10, s[16:19], s49 offen lds
    v_and_b32 v141, 0xffff0000, v129
    v_lshlrev_b32 v142, 16, v130
    v_and_b32 v143, 0xffff0000, v130
    v_mfma_f32_32x32x16_bf16 a[96:111], v[96:99], v[92:95], a[96:111]
    ds_read_b64_tr_b16 v[72:73], v30 offset:4096
    ds_read_b64_tr_b16 v[74:75], v30 offset:5120
    ds_read_b64_tr_b16 v[76:77], v31 offset:4096
    v_lshlrev_b32 v144, 16, v131
    v_and_b32 v145, 0xffff0000, v131
    v_mfma_f32_32x32x16_bf16 a[112:127], v[100:103], v[92:95], a[112:127]
    ds_read_b64_tr_b16 v[78:79], v31 offset:5120
    s_add_u32 m0, s48, 52224
    s_nop 0
    buffer_load_dwordx4 v11, s[16:19], s49 offen lds
    v_lshlrev_b32 v146, 16, v132
    v_and_b32 v147, 0xffff0000, v132
    v_add_f32 v148, v138, v139
    v_mfma_f32_32x32x16_bf16 a[0:15], v[120:123], v[104:107], a[0:15]
    v_add_f32 v148, v148, v140
    v_add_f32 v148, v148, v141
    v_add_f32 v148, v148, v142
    v_mfma_f32_32x32x16_bf16 a[16:31], v[124:127], v[104:107], a[16:31]
    s_add_u32 m0, s48, 53248
    s_nop 0
    buffer_load_dwordx4 v12, s[16:19], s49 offen lds
    v_add_f32 v148, v148, v143
    v_add_f32 v148, v148, v144
    v_mfma_f32_32x32x16_bf16 a[32:47], v[120:123], v[108:111], a[32:47]
    v_add_f32 v148, v148, v145
    v_add_f32 v148, v148, v146
    v_add_f32 v148, v148, v147
    v_mfma_f32_32x32x16_bf16 a[48:63], v[124:127], v[108:111], a[48:63]
    s_add_u32 m0, s48, 54272
    s_nop 0
    buffer_load_dwordx4 v13, s[16:19], s49 offen lds
    s_nop 1
    v_add_f32_dpp v148, v148, v148 quad_perm:[1,0,3,2] row_mask:0xf bank_mask:0xf
    s_nop 1
    v_mfma_f32_32x32x16_bf16 a[64:79], v[120:123], v[112:115], a[64:79]
    v_add_f32_dpp v148, v148, v148 quad_perm:[2,3,0,1] row_mask:0xf bank_mask:0xf
    s_nop 1
    v_mfma_f32_32x32x16_bf16 a[80:95], v[124:127], v[112:115], a[80:95]
    s_add_u32 m0, s48, 55296
    s_nop 0
    buffer_load_dwordx4 v14, s[16:19], s49 offen lds
    v_add_f32_dpp v148, v148, v148 row_half_mirror row_mask:0xf bank_mask:0xf
    s_nop 1
    v_add_f32_dpp v148, v148, v148 row_mirror row_mask:0xf bank_mask:0xf
    v_mfma_f32_32x32x16_bf16 a[96:111], v[120:123], v[116:119], a[96:111]
    s_nop 1
    v_add_f32_dpp v148, v148, v148 row_bcast:15 row_mask:0xa bank_mask:0xf
    s_nop 1
    v_mfma_f32_32x32x16_bf16 a[112:127], v[124:127], v[116:119], a[112:127]
    s_add_u32 m0, s48, 56320
    s_nop 0
    buffer_load_dwordx4 v15, s[16:19], s49 offen lds
    v_add_f32_dpp v148, v148, v148 row_bcast:31 row_mask:0xc bank_mask:0xf
    s_nop 1
    s_waitcnt lgkmcnt(0)
    v_mfma_f32_32x32x16_bf16 a[0:15], v[48:51], v[32:35], a[0:15]
    ds_read_b128 v[80:83], v26 offset:0
    ds_read_b128 v[84:87], v26 offset:4096
    ds_read_b128 v[88:91], v26 offset:8192
    v_mfma_f32_32x32x16_bf16 a[16:31], v[52:55], v[32:35], a[16:31]
    ds_read_b128 v[92:95], v26 offset:12288
    ds_read_b64_tr_b16 v[96:97], v30 offset:8192
    ds_read_b64_tr_b16 v[98:99], v30 offset:9216
    v_mfma_f32_32x32x16_bf16 a[32:47], v[48:51], v[36:39], a[32:47]
    ds_read_b64_tr_b16 v[100:101], v31 offset:8192
    ds_read_b64_tr_b16 v[102:103], v31 offset:9216
    ds_read_b128 v[104:107], v27 offset:0
    s_add_u32 m0, s50, 81920
    s_nop 0
    buffer_load_dwordx4 v16, s[20:23], s51 offen lds
    v_mfma_f32_32x32x16_bf16 a[48:63], v[52:55], v[36:39], a[48:63]
    ds_read_b128 v[108:111], v27 offset:4096
    ds_read_b128 v[112:115], v27 offset:8192
    ds_read_b128 v[116:119], v27 offset:12288
    v_mfma_f32_32x32x16_bf16 a[64:79], v[48:51], v[40:43], a[64:79]
    ds_read_b64_tr_b16 v[120:121], v30 offset:12288
    ds_read_b64_tr_b16 v[122:123], v30 offset:13312
    ds_read_b64_tr_b16 v[124:125], v31 offset:12288
    v_readlane_b32 s60, v148, 63
    s_nop 1
    v_mov_b32 v148, s60
    v_mfma_f32_32x32x16_bf16 a[80:95], v[52:55], v[40:43], a[80:95]
    ds_read_b64_tr_b16 v[126:127], v31 offset:13312
    v_mul_f32 v148, 0.0015625, v148
    v_sub_f32 v138, v138, v148
    v_sub_f32 v139, v139, v148
    v_mfma_f32_32x32x16_bf16 a[96:111], v[48:51], v[44:47], a[96:111]
    s_add_u32 m0, s50, 82944
    s_nop 0
    buffer_load_dwordx4 v17, s[20:23], s51 offen lds
    v_sub_f32 v140, v140, v148
    v_sub_f32 v141, v141, v148
    v_mfma_f32_32x32x16_bf16 a[112:127], v[52:55], v[44:47], a[112:127]
    v_sub_f32 v142, v142, v148
    v_sub_f32 v143, v143, v148
    v_sub_f32 v144, v144, v148
    v_mfma_f32_32x32x16_bf16 a[0:15], v[72:75], v[56:59], a[0:15]
    v_sub_f32 v145, v145, v148
    v_sub_f32 v146, v146, v148
    v_sub_f32 v147, v147, v148
    v_mfma_f32_32x32x16_bf16 a[16:31], v[76:79], v[56:59], a[16:31]
    v_mul_f32 v148, v138, v138
    v_fmac_f32 v148, v139, v139
    v_mfma_f32_32x32x16_bf16 a[32:47], v[72:75], v[60:63], a[32:47]
    s_add_u32 m0, s50, 83968
    s_nop 0
    buffer_load_dwordx4 v18, s[20:23], s51 offen lds
    v_fmac_f32 v148, v140, v140
    v_fmac_f32 v148, v141, v141
    v_fmac_f32 v148, v142, v142
    v_mfma_f32_32x32x16_bf16 a[48:63], v[76:79], v[60:63], a[48:63]
    v_fmac_f32 v148, v143, v143
    v_fmac_f32 v148, v144, v144
    v_fmac_f32 v148, v145, v145
    v_mfma_f32_32x32x16_bf16 a[64:79], v[72:75], v[64:67], a[64:79]
    v_fmac_f32 v148, v146, v146
    v_fmac_f32 v148, v147, v147
    v_mfma_f32_32x32x16_bf16 a[80:95], v[76:79], v[64:67], a[80:95]
    s_nop 1
    v_add_f32_dpp v148, v148, v148 quad_perm:[1,0,3,2] row_mask:0xf bank_mask:0xf
    s_nop 1
    v_mfma_f32_32x32x16_bf16 a[96:111], v[72:75], v[68:71], a[96:111]
    s_add_u32 m0, s50, 84992
    s_nop 0
    buffer_load_dwordx4 v19, s[20:23], s51 offen lds
    v_add_f32_dpp v148, v148, v148 quad_perm:[2,3,0,1] row_mask:0xf bank_mask:0xf
    s_nop 1
    v_add_f32_dpp v148, v148, v148 row_half_mirror row_mask:0xf bank_mask:0xf
    v_mfma_f32_32x32x16_bf16 a[112:127], v[76:79], v[68:71], a[112:127]
    s_nop 1
    v_add_f32_dpp v148, v148, v148 row_mirror row_mask:0xf bank_mask:0xf
    s_waitcnt lgkmcnt(0)
    s_waitcnt vmcnt(12)
    s_barrier
    v_mfma_f32_32x32x16_bf16 a[0:15], v[96:99], v[80:83], a[0:15]
    v_add_u32 v24, 0, v20
    v_add_u32 v25, 0, v21
    v_add_u32 v26, 0, v22
    v_mfma_f32_32x32x16_bf16 a[16:31], v[100:103], v[80:83], a[16:31]
    v_add_u32 v27, 0, v23
    v_add_u32 v30, 0, v28
    v_add_u32 v31, 0, v29
    s_add_u32 m0, s48, 98304
    s_and_b32 s44, s44, 7
    s_lshl_b32 s49, s44, 7
    s_add_u32 s49, s49, s64
    s_lshl_b32 s51, s44, 19
    s_add_u32 s51, s51, s65
    s_add_u32 s44, s44, 1
    buffer_load_dwordx4 v8, s[16:19], s49 offen lds
    v_mfma_f32_32x32x16_bf16 a[32:47], v[96:99], v[84:87], a[32:47]
    ds_read_b128 v[32:35], v24 offset:0
    ds_read_b128 v[36:39], v24 offset:4096
    ds_read_b128 v[40:43], v24 offset:8192
    v_mfma_f32_32x32x16_bf16 a[48:63], v[100:103], v[84:87], a[48:63]
    ds_read_b128 v[44:47], v24 offset:12288
    ds_read_b64_tr_b16 v[48:49], v30 offset:0
    ds_read_b64_tr_b16 v[50:51], v30 offset:1024
    s_add_u32 m0, s48, 99328
    s_nop 0
    buffer_load_dwordx4 v9, s[16:19], s49 offen lds
    v_mfma_f32_32x32x16_bf16 a[64:79], v[96:99], v[88:91], a[64:79]
    ds_read_b64_tr_b16 v[52:53], v31 offset:0
    ds_read_b64_tr_b16 v[54:55], v31 offset:1024
    ds_read_b128 v[56:59], v25 offset:0
    s_nop 1
    v_add_f32_dpp v148, v148, v148 row_bcast:15 row_mask:0xa bank_mask:0xf
    s_nop 1
    v_mfma_f32_32x32x16_bf16 a[80:95], v[100:103], v[88:91], a[80:95]
    ds_read_b128 v[60:63], v25 offset:4096
    ds_read_b128 v[64:67], v25 offset:8192
    ds_read_b128 v[68:71], v25 offset:12288
    s_add_u32 m0, s48, 100352
    s_nop 0
    buffer_load_dwordx4 v10, s[16:19], s49 offen lds
    v_add_f32_dpp v148, v148, v148 row_bcast:31 row_mask:0xc bank_mask:0xf
    s_nop 1
    v_readlane_b32 s60, v148, 63
    v_mfma_f32_32x32x16_bf16 a[96:111], v[96:99], v[92:95], a[96:111]
    ds_read_b64_tr_b16 v[72:73], v30 offset:4096
    ds_read_b64_tr_b16 v[74:75], v30 offset:5120
    ds_read_b64_tr_b16 v[76:77], v31 offset:4096
    s_nop 1
    v_mov_b32 v148, s60
    v_mfma_f32_32x32x16_bf16 a[112:127], v[100:103], v[92:95], a[112:127]
    ds_read_b64_tr_b16 v[78:79], v31 offset:5120
    s_add_u32 m0, s48, 101376
    s_nop 0
    buffer_load_dwordx4 v11, s[16:19], s49 offen lds
    v_mov_b32 v149, 0x3727c5ac
    v_fmac_f32 v149, 0.0015625, v148
    v_rsq_f32 v149, v149
    v_mfma_f32_32x32x16_bf16 a[0:15], v[120:123], v[104:107], a[0:15]
    s_nop 0
    v_mul_f32 v138, v138, v149
    v_mul_f32 v139, v139, v149
    v_mfma_f32_32x32x16_bf16 a[16:31], v[124:127], v[104:107], a[16:31]
    s_add_u32 m0, s48, 102400
    s_nop 0
    buffer_load_dwordx4 v12, s[16:19], s49 offen lds
    v_mul_f32 v140, v140, v149
    v_mul_f32 v141, v141, v149
    v_mfma_f32_32x32x16_bf16 a[32:47], v[120:123], v[108:111], a[32:47]
    v_mul_f32 v142, v142, v149
    v_mul_f32 v143, v143, v149
    v_mul_f32 v144, v144, v149
    v_mfma_f32_32x32x16_bf16 a[48:63], v[124:127], v[108:111], a[48:63]
    s_add_u32 m0, s48, 103424
    s_nop 0
    buffer_load_dwordx4 v13, s[16:19], s49 offen lds
    v_mul_f32 v145, v145, v149
    v_mul_f32 v146, v146, v149
    v_mul_f32 v147, v147, v149
    v_mfma_f32_32x32x16_bf16 a[64:79], v[120:123], v[112:115], a[64:79]
    v_cvt_pk_bf16_f32 v128, v138, v139
    buffer_store_dword v128, v150, s[32:35], s47 offen offset:0
    v_mfma_f32_32x32x16_bf16 a[80:95], v[124:127], v[112:115], a[80:95]
    s_add_u32 m0, s48, 104448
    s_nop 0
    buffer_load_dwordx4 v14, s[16:19], s49 offen lds
    v_cvt_pk_bf16_f32 v129, v140, v141
    buffer_store_dword v129, v150, s[32:35], s47 offen offset:256
    v_cvt_pk_bf16_f32 v130, v142, v143
    v_mfma_f32_32x32x16_bf16 a[96:111], v[120:123], v[116:119], a[96:111]
    buffer_store_dword v130, v150, s[32:35], s47 offen offset:512
    v_cvt_pk_bf16_f32 v131, v144, v145
    buffer_store_dword v131, v150, s[32:35], s47 offen offset:768
    v_mfma_f32_32x32x16_bf16 a[112:127], v[124:127], v[116:119], a[112:127]
    s_add_u32 m0, s48, 105472
    s_nop 0
    buffer_load_dwordx4 v15, s[16:19], s49 offen lds
    v_cvt_pk_bf16_f32 v132, v146, v147
    buffer_store_dword v132, v150, s[32:35], s47 offen offset:1024
    s_waitcnt lgkmcnt(0)
    v_mfma_f32_32x32x16_bf16 a[0:15], v[48:51], v[32:35], a[0:15]
    ds_read_b128 v[80:83], v26 offset:0
    ds_read_b128 v[84:87], v26 offset:4096
    ds_read_b128 v[88:91], v26 offset:8192
    v_mfma_f32_32x32x16_bf16 a[16:31], v[52:55], v[32:35], a[16:31]
    ds_read_b128 v[92:95], v26 offset:12288
    ds_read_b64_tr_b16 v[96:97], v30 offset:8192
    ds_read_b64_tr_b16 v[98:99], v30 offset:9216
    v_mfma_f32_32x32x16_bf16 a[32:47], v[48:51], v[36:39], a[32:47]
    ds_read_b64_tr_b16 v[100:101], v31 offset:8192
    ds_read_b64_tr_b16 v[102:103], v31 offset:9216
    ds_read_b128 v[104:107], v27 offset:0
    s_add_u32 m0, s50, 131072
    s_nop 0
    buffer_load_dwordx4 v16, s[20:23], s51 offen lds
    v_mfma_f32_32x32x16_bf16 a[48:63], v[52:55], v[36:39], a[48:63]
    ds_read_b128 v[108:111], v27 offset:4096
    ds_read_b128 v[112:115], v27 offset:8192
    ds_read_b128 v[116:119], v27 offset:12288
    v_mfma_f32_32x32x16_bf16 a[64:79], v[48:51], v[40:43], a[64:79]
    ds_read_b64_tr_b16 v[120:121], v30 offset:12288
    ds_read_b64_tr_b16 v[122:123], v30 offset:13312
    ds_read_b64_tr_b16 v[124:125], v31 offset:12288
    v_lshlrev_b32 v138, 16, v133
    v_and_b32 v139, 0xffff0000, v133
    v_lshlrev_b32 v140, 16, v134
    v_mfma_f32_32x32x16_bf16 a[80:95], v[52:55], v[40:43], a[80:95]
    ds_read_b64_tr_b16 v[126:127], v31 offset:13312
    v_and_b32 v141, 0xffff0000, v134
    v_lshlrev_b32 v142, 16, v135
    v_and_b32 v143, 0xffff0000, v135
    v_mfma_f32_32x32x16_bf16 a[96:111], v[48:51], v[44:47], a[96:111]
    s_add_u32 m0, s50, 132096
    s_nop 0
    buffer_load_dwordx4 v17, s[20:23], s51 offen lds
    v_lshlrev_b32 v144, 16, v136
    v_and_b32 v145, 0xffff0000, v136
    v_mfma_f32_32x32x16_bf16 a[112:127], v[52:55], v[44:47], a[112:127]
    v_lshlrev_b32 v146, 16, v137
    v_and_b32 v147, 0xffff0000, v137
    v_add_f32 v148, v138, v139
    v_mfma_f32_32x32x16_bf16 a[0:15], v[72:75], v[56:59], a[0:15]
    v_add_f32 v148, v148, v140
    v_add_f32 v148, v148, v141
    v_add_f32 v148, v148, v142
    v_mfma_f32_32x32x16_bf16 a[16:31], v[76:79], v[56:59], a[16:31]
    v_add_f32 v148, v148, v143
    v_add_f32 v148, v148, v144
    v_mfma_f32_32x32x16_bf16 a[32:47], v[72:75], v[60:63], a[32:47]
    s_add_u32 m0, s50, 133120
    s_nop 0
    buffer_load_dwordx4 v18, s[20:23], s51 offen lds
    v_add_f32 v148, v148, v145
    v_add_f32 v148, v148, v146
    v_add_f32 v148, v148, v147
    v_mfma_f32_32x32x16_bf16 a[48:63], v[76:79], v[60:63], a[48:63]
    s_nop 1
    v_add_f32_dpp v148, v148, v148 quad_perm:[1,0,3,2] row_mask:0xf bank_mask:0xf
    s_nop 1
    v_mfma_f32_32x32x16_bf16 a[64:79], v[72:75], v[64:67], a[64:79]
    v_add_f32_dpp v148, v148, v148 quad_perm:[2,3,0,1] row_mask:0xf bank_mask:0xf
    s_nop 1
    v_mfma_f32_32x32x16_bf16 a[80:95], v[76:79], v[64:67], a[80:95]
    v_add_f32_dpp v148, v148, v148 row_half_mirror row_mask:0xf bank_mask:0xf
    s_nop 1
    v_add_f32_dpp v148, v148, v148 row_mirror row_mask:0xf bank_mask:0xf
    v_mfma_f32_32x32x16_bf16 a[96:111], v[72:75], v[68:71], a[96:111]
    s_add_u32 m0, s50, 134144
    s_nop 0
    buffer_load_dwordx4 v19, s[20:23], s51 offen lds
    s_nop 1
    v_add_f32_dpp v148, v148, v148 row_bcast:15 row_mask:0xa bank_mask:0xf
    s_nop 1
    v_mfma_f32_32x32x16_bf16 a[112:127], v[76:79], v[68:71], a[112:127]
    v_add_f32_dpp v148, v148, v148 row_bcast:31 row_mask:0xc bank_mask:0xf
    s_nop 1
    s_waitcnt lgkmcnt(0)
    s_waitcnt vmcnt(17)
    s_barrier
    v_mfma_f32_32x32x16_bf16 a[0:15], v[96:99], v[80:83], a[0:15]
    v_add_u32 v24, 49152, v20
    v_add_u32 v25, 49152, v21
    v_add_u32 v26, 49152, v22
    v_mfma_f32_32x32x16_bf16 a[16:31], v[100:103], v[80:83], a[16:31]
    v_add_u32 v27, 49152, v23
    v_add_u32 v30, 49152, v28
    v_add_u32 v31, 49152, v29
    s_add_u32 m0, s48, 0
    s_and_b32 s44, s44, 7
    s_lshl_b32 s49, s44, 7
    s_add_u32 s49, s49, s64
    s_lshl_b32 s51, s44, 19
    s_add_u32 s51, s51, s65
    s_add_u32 s44, s44, 1
    buffer_load_dwordx4 v8, s[16:19], s49 offen lds
    v_mfma_f32_32x32x16_bf16 a[32:47], v[96:99], v[84:87], a[32:47]
    ds_read_b128 v[32:35], v24 offset:0
    ds_read_b128 v[36:39], v24 offset:4096
    ds_read_b128 v[40:43], v24 offset:8192
    v_mfma_f32_32x32x16_bf16 a[48:63], v[100:103], v[84:87], a[48:63]
    ds_read_b128 v[44:47], v24 offset:12288
    ds_read_b64_tr_b16 v[48:49], v30 offset:0
    ds_read_b64_tr_b16 v[50:51], v30 offset:1024
    s_add_u32 m0, s48, 1024
    s_nop 0
    buffer_load_dwordx4 v9, s[16:19], s49 offen lds
    v_mfma_f32_32x32x16_bf16 a[64:79], v[96:99], v[88:91], a[64:79]
    ds_read_b64_tr_b16 v[52:53], v31 offset:0
    ds_read_b64_tr_b16 v[54:55], v31 offset:1024
    ds_read_b128 v[56:59], v25 offset:0
    v_readlane_b32 s60, v148, 63
    s_nop 1
    v_mov_b32 v148, s60
    v_mfma_f32_32x32x16_bf16 a[80:95], v[100:103], v[88:91], a[80:95]
    ds_read_b128 v[60:63], v25 offset:4096
    ds_read_b128 v[64:67], v25 offset:8192
    ds_read_b128 v[68:71], v25 offset:12288
    s_add_u32 m0, s48, 2048
    s_nop 0
    buffer_load_dwordx4 v10, s[16:19], s49 offen lds
    v_mul_f32 v148, 0.0015625, v148
    v_sub_f32 v138, v138, v148
    v_sub_f32 v139, v139, v148
    v_mfma_f32_32x32x16_bf16 a[96:111], v[96:99], v[92:95], a[96:111]
    ds_read_b64_tr_b16 v[72:73], v30 offset:4096
    ds_read_b64_tr_b16 v[74:75], v30 offset:5120
    ds_read_b64_tr_b16 v[76:77], v31 offset:4096
    v_sub_f32 v140, v140, v148
    v_sub_f32 v141, v141, v148
    v_mfma_f32_32x32x16_bf16 a[112:127], v[100:103], v[92:95], a[112:127]
    ds_read_b64_tr_b16 v[78:79], v31 offset:5120
    s_add_u32 m0, s48, 3072
    s_nop 0
    buffer_load_dwordx4 v11, s[16:19], s49 offen lds
    v_sub_f32 v142, v142, v148
    v_sub_f32 v143, v143, v148
    v_sub_f32 v144, v144, v148
    v_mfma_f32_32x32x16_bf16 a[0:15], v[120:123], v[104:107], a[0:15]
    v_sub_f32 v145, v145, v148
    v_sub_f32 v146, v146, v148
    v_sub_f32 v147, v147, v148
    v_mfma_f32_32x32x16_bf16 a[16:31], v[124:127], v[104:107], a[16:31]
    s_add_u32 m0, s48, 4096
    s_nop 0
    buffer_load_dwordx4 v12, s[16:19], s49 offen lds
    v_mul_f32 v148, v138, v138
    v_fmac_f32 v148, v139, v139
    v_mfma_f32_32x32x16_bf16 a[32:47], v[120:123], v[108:111], a[32:47]
    v_fmac_f32 v148, v140, v140
    v_fmac_f32 v148, v141, v141
    v_fmac_f32 v148, v142, v142
    v_mfma_f32_32x32x16_bf16 a[48:63], v[124:127], v[108:111], a[48:63]
    s_add_u32 m0, s48, 5120
    s_nop 0
    buffer_load_dwordx4 v13, s[16:19], s49 offen lds
    v_fmac_f32 v148, v143, v143
    v_fmac_f32 v148, v144, v144
    v_fmac_f32 v148, v145, v145
    v_mfma_f32_32x32x16_bf16 a[64:79], v[120:123], v[112:115], a[64:79]
    v_fmac_f32 v148, v146, v146
    v_fmac_f32 v148, v147, v147
    v_mfma_f32_32x32x16_bf16 a[80:95], v[124:127], v[112:115], a[80:95]
    s_add_u32 m0, s48, 6144
    s_nop 0
    buffer_load_dwordx4 v14, s[16:19], s49 offen lds
    s_nop 1
    v_add_f32_dpp v148, v148, v148 quad_perm:[1,0,3,2] row_mask:0xf bank_mask:0xf
    s_nop 1
    v_mfma_f32_32x32x16_bf16 a[96:111], v[120:123], v[116:119], a[96:111]
    v_add_f32_dpp v148, v148, v148 quad_perm:[2,3,0,1] row_mask:0xf bank_mask:0xf
    s_nop 1
    v_add_f32_dpp v148, v148, v148 row_half_mirror row_mask:0xf bank_mask:0xf
    v_mfma_f32_32x32x16_bf16 a[112:127], v[124:127], v[116:119], a[112:127]
    s_add_u32 m0, s48, 7168
    s_nop 0
    buffer_load_dwordx4 v15, s[16:19], s49 offen lds
    s_nop 1
    v_add_f32_dpp v148, v148, v148 row_mirror row_mask:0xf bank_mask:0xf
    s_waitcnt lgkmcnt(0)
    v_mfma_f32_32x32x16_bf16 a[0:15], v[48:51], v[32:35], a[0:15]
    ds_read_b128 v[80:83], v26 offset:0
    ds_read_b128 v[84:87], v26 offset:4096
    ds_read_b128 v[88:91], v26 offset:8192
    v_mfma_f32_32x32x16_bf16 a[16:31], v[52:55], v[32:35], a[16:31]
    ds_read_b128 v[92:95], v26 offset:12288
    ds_read_b64_tr_b16 v[96:97], v30 offset:8192
    ds_read_b64_tr_b16 v[98:99], v30 offset:9216
    v_mfma_f32_32x32x16_bf16 a[32:47], v[48:51], v[36:39], a[32:47]
    ds_read_b64_tr_b16 v[100:101], v31 offset:8192
    ds_read_b64_tr_b16 v[102:103], v31 offset:9216
    ds_read_b128 v[104:107], v27 offset:0
    s_add_u32 m0, s50, 32768
    s_nop 0
    buffer_load_dwordx4 v16, s[20:23], s51 offen lds
    v_mfma_f32_32x32x16_bf16 a[48:63], v[52:55], v[36:39], a[48:63]
    ds_read_b128 v[108:111], v27 offset:4096
    ds_read_b128 v[112:115], v27 offset:8192
    ds_read_b128 v[116:119], v27 offset:12288
    v_mfma_f32_32x32x16_bf16 a[64:79], v[48:51], v[40:43], a[64:79]
    ds_read_b64_tr_b16 v[120:121], v30 offset:12288
    ds_read_b64_tr_b16 v[122:123], v30 offset:13312
    ds_read_b64_tr_b16 v[124:125], v31 offset:12288
    s_nop 1
    v_add_f32_dpp v148, v148, v148 row_bcast:15 row_mask:0xa bank_mask:0xf
    s_nop 1
    v_mfma_f32_32x32x16_bf16 a[80:95], v[52:55], v[40:43], a[80:95]
    ds_read_b64_tr_b16 v[126:127], v31 offset:13312
    v_add_f32_dpp v148, v148, v148 row_bcast:31 row_mask:0xc bank_mask:0xf
    s_nop 1
    v_readlane_b32 s60, v148, 63
    v_mfma_f32_32x32x16_bf16 a[96:111], v[48:51], v[44:47], a[96:111]
    s_add_u32 m0, s50, 33792
    s_nop 0
    buffer_load_dwordx4 v17, s[20:23], s51 offen lds
    s_nop 1
    v_mov_b32 v148, s60
    v_mfma_f32_32x32x16_bf16 a[112:127], v[52:55], v[44:47], a[112:127]
    v_mov_b32 v149, 0x3727c5ac
    v_fmac_f32 v149, 0.0015625, v148
    v_rsq_f32 v149, v149
    v_mfma_f32_32x32x16_bf16 a[0:15], v[72:75], v[56:59], a[0:15]
    s_nop 0
    v_mul_f32 v138, v138, v149
    v_mul_f32 v139, v139, v149
    v_mfma_f32_32x32x16_bf16 a[16:31], v[76:79], v[56:59], a[16:31]
    v_mul_f32 v140, v140, v149
    v_mul_f32 v141, v141, v149
    v_mfma_f32_32x32x16_bf16 a[32:47], v[72:75], v[60:63], a[32:47]
    s_add_u32 m0, s50, 34816
    s_nop 0
    buffer_load_dwordx4 v18, s[20:23], s51 offen lds
    v_mul_f32 v142, v142, v149
    v_mul_f32 v143, v143, v149
    v_mul_f32 v144, v144, v149
    v_mfma_f32_32x32x16_bf16 a[48:63], v[76:79], v[60:63], a[48:63]
    v_mul_f32 v145, v145, v149
    v_mul_f32 v146, v146, v149
    v_mul_f32 v147, v147, v149
    v_mfma_f32_32x32x16_bf16 a[64:79], v[72:75], v[64:67], a[64:79]
    v_cvt_pk_bf16_f32 v133, v138, v139
    buffer_store_dword v133, v150, s[32:35], s47 offen offset:1280
    v_mfma_f32_32x32x16_bf16 a[80:95], v[76:79], v[64:67], a[80:95]
    v_cvt_pk_bf16_f32 v134, v140, v141
    buffer_store_dword v134, v150, s[32:35], s47 offen offset:1536
    v_cvt_pk_bf16_f32 v135, v142, v143
    v_mfma_f32_32x32x16_bf16 a[96:111], v[72:75], v[68:71], a[96:111]
    s_add_u32 m0, s50, 35840
    s_nop 0
    buffer_load_dwordx4 v19, s[20:23], s51 offen lds
    buffer_store_dword v135, v150, s[32:35], s47 offen offset:1792
    v_cvt_pk_bf16_f32 v136, v144, v145
    buffer_store_dword v136, v150, s[32:35], s47 offen offset:2048
    v_mfma_f32_32x32x16_bf16 a[112:127], v[76:79], v[68:71], a[112:127]
    v_cvt_pk_bf16_f32 v137, v146, v147
    buffer_store_dword v137, v150, s[32:35], s47 offen offset:2304
    s_waitcnt lgkmcnt(0)
    s_waitcnt vmcnt(17)
    s_barrier
    v_mfma_f32_32x32x16_bf16 a[0:15], v[96:99], v[80:83], a[0:15]
    v_add_u32 v24, 98304, v20
    v_add_u32 v25, 98304, v21
    v_add_u32 v26, 98304, v22
    v_mfma_f32_32x32x16_bf16 a[16:31], v[100:103], v[80:83], a[16:31]
    v_add_u32 v27, 98304, v23
    v_add_u32 v30, 98304, v28
    v_add_u32 v31, 98304, v29
    s_add_u32 m0, s48, 49152
    s_and_b32 s44, s44, 7
    s_lshl_b32 s49, s44, 7
    s_add_u32 s49, s49, s64
    s_lshl_b32 s51, s44, 19
    s_add_u32 s51, s51, s65
    s_add_u32 s44, s44, 1
    buffer_load_dwordx4 v8, s[16:19], s49 offen lds
    v_mfma_f32_32x32x16_bf16 a[32:47], v[96:99], v[84:87], a[32:47]
    ds_read_b128 v[32:35], v24 offset:0
    ds_read_b128 v[36:39], v24 offset:4096
    ds_read_b128 v[40:43], v24 offset:8192
    v_mfma_f32_32x32x16_bf16 a[48:63], v[100:103], v[84:87], a[48:63]
    ds_read_b128 v[44:47], v24 offset:12288
    ds_read_b64_tr_b16 v[48:49], v30 offset:0
    ds_read_b64_tr_b16 v[50:51], v30 offset:1024
    s_add_u32 m0, s48, 50176
    s_nop 0
    buffer_load_dwordx4 v9, s[16:19], s49 offen lds
    v_mfma_f32_32x32x16_bf16 a[64:79], v[96:99], v[88:91], a[64:79]
    ds_read_b64_tr_b16 v[52:53], v31 offset:0
    ds_read_b64_tr_b16 v[54:55], v31 offset:1024
    ds_read_b128 v[56:59], v25 offset:0
    v_mfma_f32_32x32x16_bf16 a[80:95], v[100:103], v[88:91], a[80:95]
    ds_read_b128 v[60:63], v25 offset:4096
    ds_read_b128 v[64:67], v25 offset:8192
    ds_read_b128 v[68:71], v25 offset:12288
    s_add_u32 m0, s48, 51200
    s_nop 0
    buffer_load_dwordx4 v10, s[16:19], s49 offen lds
    v_mfma_f32_32x32x16_bf16 a[96:111], v[96:99], v[92:95], a[96:111]
    ds_read_b64_tr_b16 v[72:73], v30 offset:4096
    ds_read_b64_tr_b16 v[74:75], v30 offset:5120
    ds_read_b64_tr_b16 v[76:77], v31 offset:4096
    v_mfma_f32_32x32x16_bf16 a[112:127], v[100:103], v[92:95], a[112:127]
    ds_read_b64_tr_b16 v[78:79], v31 offset:5120
    s_add_u32 m0, s48, 52224
    s_nop 0
    buffer_load_dwordx4 v11, s[16:19], s49 offen lds
    v_mfma_f32_32x32x16_bf16 a[0:15], v[120:123], v[104:107], a[0:15]
    v_mfma_f32_32x32x16_bf16 a[16:31], v[124:127], v[104:107], a[16:31]
    s_add_u32 m0, s48, 53248
    s_nop 0
    buffer_load_dwordx4 v12, s[16:19], s49 offen lds
    v_mfma_f32_32x32x16_bf16 a[32:47], v[120:123], v[108:111], a[32:47]
    v_mfma_f32_32x32x16_bf16 a[48:63], v[124:127], v[108:111], a[48:63]
    s_add_u32 m0, s48, 54272
    s_nop 0
    buffer_load_dwordx4 v13, s[16:19], s49 offen lds
    v_mfma_f32_32x32x16_bf16 a[64:79], v[120:123], v[112:115], a[64:79]
    v_mfma_f32_32x32x16_bf16 a[80:95], v[124:127], v[112:115], a[80:95]
    s_add_u32 m0, s48, 55296
    s_nop 0
    buffer_load_dwordx4 v14, s[16:19], s49 offen lds
    v_mfma_f32_32x32x16_bf16 a[96:111], v[120:123], v[116:119], a[96:111]
    v_mfma_f32_32x32x16_bf16 a[112:127], v[124:127], v[116:119], a[112:127]
    s_add_u32 m0, s48, 56320
    s_nop 0
    buffer_load_dwordx4 v15, s[16:19], s49 offen lds
    s_waitcnt lgkmcnt(0)
    v_mfma_f32_32x32x16_bf16 a[0:15], v[48:51], v[32:35], a[0:15]
    ds_read_b128 v[80:83], v26 offset:0
    ds_read_b128 v[84:87], v26 offset:4096
    ds_read_b128 v[88:91], v26 offset:8192
    v_mfma_f32_32x32x16_bf16 a[16:31], v[52:55], v[32:35], a[16:31]
    ds_read_b128 v[92:95], v26 offset:12288
    ds_read_b64_tr_b16 v[96:97], v30 offset:8192
    ds_read_b64_tr_b16 v[98:99], v30 offset:9216
    v_mfma_f32_32x32x16_bf16 a[32:47], v[48:51], v[36:39], a[32:47]
    ds_read_b64_tr_b16 v[100:101], v31 offset:8192
    ds_read_b64_tr_b16 v[102:103], v31 offset:9216
    ds_read_b128 v[104:107], v27 offset:0
    s_add_u32 m0, s50, 81920
    s_nop 0
    buffer_load_dwordx4 v16, s[20:23], s51 offen lds
    v_mfma_f32_32x32x16_bf16 a[48:63], v[52:55], v[36:39], a[48:63]
    ds_read_b128 v[108:111], v27 offset:4096
    ds_read_b128 v[112:115], v27 offset:8192
    ds_read_b128 v[116:119], v27 offset:12288
    v_mfma_f32_32x32x16_bf16 a[64:79], v[48:51], v[40:43], a[64:79]
    ds_read_b64_tr_b16 v[120:121], v30 offset:12288
    ds_read_b64_tr_b16 v[122:123], v30 offset:13312
    ds_read_b64_tr_b16 v[124:125], v31 offset:12288
    v_mfma_f32_32x32x16_bf16 a[80:95], v[52:55], v[40:43], a[80:95]
    ds_read_b64_tr_b16 v[126:127], v31 offset:13312
    v_mfma_f32_32x32x16_bf16 a[96:111], v[48:51], v[44:47], a[96:111]
    s_add_u32 m0, s50, 82944
    s_nop 0
    buffer_load_dwordx4 v17, s[20:23], s51 offen lds
    v_mfma_f32_32x32x16_bf16 a[112:127], v[52:55], v[44:47], a[112:127]
    v_mfma_f32_32x32x16_bf16 a[0:15], v[72:75], v[56:59], a[0:15]
    v_mfma_f32_32x32x16_bf16 a[16:31], v[76:79], v[56:59], a[16:31]
    v_mfma_f32_32x32x16_bf16 a[32:47], v[72:75], v[60:63], a[32:47]
    s_add_u32 m0, s50, 83968
    s_nop 0
    buffer_load_dwordx4 v18, s[20:23], s51 offen lds
    v_mfma_f32_32x32x16_bf16 a[48:63], v[76:79], v[60:63], a[48:63]
    v_mfma_f32_32x32x16_bf16 a[64:79], v[72:75], v[64:67], a[64:79]
    v_mfma_f32_32x32x16_bf16 a[80:95], v[76:79], v[64:67], a[80:95]
    v_mfma_f32_32x32x16_bf16 a[96:111], v[72:75], v[68:71], a[96:111]
    s_add_u32 m0, s50, 84992
    s_nop 0
    buffer_load_dwordx4 v19, s[20:23], s51 offen lds
    v_mfma_f32_32x32x16_bf16 a[112:127], v[76:79], v[68:71], a[112:127]
    s_waitcnt lgkmcnt(0)
    s_waitcnt vmcnt(15)
    s_barrier
    v_mfma_f32_32x32x16_bf16 a[0:15], v[96:99], v[80:83], a[0:15]
    v_add_u32 v24, 0, v20
    v_add_u32 v25, 0, v21
    v_add_u32 v26, 0, v22
    v_mfma_f32_32x32x16_bf16 a[16:31], v[100:103], v[80:83], a[16:31]
    v_add_u32 v27, 0, v23
    v_add_u32 v30, 0, v28
    v_add_u32 v31, 0, v29
    s_add_u32 m0, s48, 98304
    s_and_b32 s44, s44, 7
    s_lshl_b32 s49, s44, 7
    s_add_u32 s49, s49, s64
    s_lshl_b32 s51, s44, 19
    s_add_u32 s51, s51, s65
    s_add_u32 s44, s44, 1
    buffer_load_dwordx4 v8, s[16:19], s49 offen lds
    v_mfma_f32_32x32x16_bf16 a[32:47], v[96:99], v[84:87], a[32:47]
    ds_read_b128 v[32:35], v24 offset:0
    ds_read_b128 v[36:39], v24 offset:4096
    ds_read_b128 v[40:43], v24 offset:8192
    v_mfma_f32_32x32x16_bf16 a[48:63], v[100:103], v[84:87], a[48:63]
    ds_read_b128 v[44:47], v24 offset:12288
    ds_read_b64_tr_b16 v[48:49], v30 offset:0
    ds_read_b64_tr_b16 v[50:51], v30 offset:1024
    s_add_u32 m0, s48, 99328
    s_nop 0
    buffer_load_dwordx4 v9, s[16:19], s49 offen lds
    v_mfma_f32_32x32x16_bf16 a[64:79], v[96:99], v[88:91], a[64:79]
    ds_read_b64_tr_b16 v[52:53], v31 offset:0
    ds_read_b64_tr_b16 v[54:55], v31 offset:1024
    ds_read_b128 v[56:59], v25 offset:0
    v_mfma_f32_32x32x16_bf16 a[80:95], v[100:103], v[88:91], a[80:95]
    ds_read_b128 v[60:63], v25 offset:4096
    ds_read_b128 v[64:67], v25 offset:8192
    ds_read_b128 v[68:71], v25 offset:12288
    s_add_u32 m0, s48, 100352
    s_nop 0
    buffer_load_dwordx4 v10, s[16:19], s49 offen lds
    v_mfma_f32_32x32x16_bf16 a[96:111], v[96:99], v[92:95], a[96:111]
    ds_read_b64_tr_b16 v[72:73], v30 offset:4096
    ds_read_b64_tr_b16 v[74:75], v30 offset:5120
    ds_read_b64_tr_b16 v[76:77], v31 offset:4096
    v_mfma_f32_32x32x16_bf16 a[112:127], v[100:103], v[92:95], a[112:127]
    ds_read_b64_tr_b16 v[78:79], v31 offset:5120
    s_add_u32 m0, s48, 101376
    s_nop 0
    buffer_load_dwordx4 v11, s[16:19], s49 offen lds
    v_mfma_f32_32x32x16_bf16 a[0:15], v[120:123], v[104:107], a[0:15]
    v_mfma_f32_32x32x16_bf16 a[16:31], v[124:127], v[104:107], a[16:31]
    s_add_u32 m0, s48, 102400
    s_nop 0
    buffer_load_dwordx4 v12, s[16:19], s49 offen lds
    v_mfma_f32_32x32x16_bf16 a[32:47], v[120:123], v[108:111], a[32:47]
    v_mfma_f32_32x32x16_bf16 a[48:63], v[124:127], v[108:111], a[48:63]
    s_add_u32 m0, s48, 103424
    s_nop 0
    buffer_load_dwordx4 v13, s[16:19], s49 offen lds
    v_mfma_f32_32x32x16_bf16 a[64:79], v[120:123], v[112:115], a[64:79]
    v_mfma_f32_32x32x16_bf16 a[80:95], v[124:127], v[112:115], a[80:95]
    s_add_u32 m0, s48, 104448
    s_nop 0
    buffer_load_dwordx4 v14, s[16:19], s49 offen lds
    v_mfma_f32_32x32x16_bf16 a[96:111], v[120:123], v[116:119], a[96:111]
    v_mfma_f32_32x32x16_bf16 a[112:127], v[124:127], v[116:119], a[112:127]
    s_add_u32 m0, s48, 105472
    s_nop 0
    buffer_load_dwordx4 v15, s[16:19], s49 offen lds
    s_waitcnt lgkmcnt(0)
    v_mfma_f32_32x32x16_bf16 a[0:15], v[48:51], v[32:35], a[0:15]
    ds_read_b128 v[80:83], v26 offset:0
    ds_read_b128 v[84:87], v26 offset:4096
    ds_read_b128 v[88:91], v26 offset:8192
    v_mfma_f32_32x32x16_bf16 a[16:31], v[52:55], v[32:35], a[16:31]
    ds_read_b128 v[92:95], v26 offset:12288
    ds_read_b64_tr_b16 v[96:97], v30 offset:8192
    ds_read_b64_tr_b16 v[98:99], v30 offset:9216
    v_mfma_f32_32x32x16_bf16 a[32:47], v[48:51], v[36:39], a[32:47]
    ds_read_b64_tr_b16 v[100:101], v31 offset:8192
    ds_read_b64_tr_b16 v[102:103], v31 offset:9216
    ds_read_b128 v[104:107], v27 offset:0
    s_add_u32 m0, s50, 131072
    s_nop 0
    buffer_load_dwordx4 v16, s[36:39], s51 offen lds
    v_mfma_f32_32x32x16_bf16 a[48:63], v[52:55], v[36:39], a[48:63]
    ds_read_b128 v[108:111], v27 offset:4096
    ds_read_b128 v[112:115], v27 offset:8192
    ds_read_b128 v[116:119], v27 offset:12288
    v_mfma_f32_32x32x16_bf16 a[64:79], v[48:51], v[40:43], a[64:79]
    ds_read_b64_tr_b16 v[120:121], v30 offset:12288
    ds_read_b64_tr_b16 v[122:123], v30 offset:13312
    ds_read_b64_tr_b16 v[124:125], v31 offset:12288
    v_mfma_f32_32x32x16_bf16 a[80:95], v[52:55], v[40:43], a[80:95]
    ds_read_b64_tr_b16 v[126:127], v31 offset:13312
    v_mfma_f32_32x32x16_bf16 a[96:111], v[48:51], v[44:47], a[96:111]
    s_add_u32 m0, s50, 132096
    s_nop 0
    buffer_load_dwordx4 v17, s[36:39], s51 offen lds
    v_mfma_f32_32x32x16_bf16 a[112:127], v[52:55], v[44:47], a[112:127]
    v_mfma_f32_32x32x16_bf16 a[0:15], v[72:75], v[56:59], a[0:15]
    v_mfma_f32_32x32x16_bf16 a[16:31], v[76:79], v[56:59], a[16:31]
    v_mfma_f32_32x32x16_bf16 a[32:47], v[72:75], v[60:63], a[32:47]
    s_add_u32 m0, s50, 133120
    s_nop 0
    buffer_load_dwordx4 v18, s[36:39], s51 offen lds
    v_mfma_f32_32x32x16_bf16 a[48:63], v[76:79], v[60:63], a[48:63]
    v_mfma_f32_32x32x16_bf16 a[64:79], v[72:75], v[64:67], a[64:79]
    v_mfma_f32_32x32x16_bf16 a[80:95], v[76:79], v[64:67], a[80:95]
    v_mfma_f32_32x32x16_bf16 a[96:111], v[72:75], v[68:71], a[96:111]
    s_add_u32 m0, s50, 134144
    s_nop 0
    buffer_load_dwordx4 v19, s[36:39], s51 offen lds
    v_mfma_f32_32x32x16_bf16 a[112:127], v[76:79], v[68:71], a[112:127]
    s_waitcnt lgkmcnt(0)
    s_waitcnt vmcnt(12)
    s_barrier
    v_mfma_f32_32x32x16_bf16 a[0:15], v[96:99], v[80:83], a[0:15]
    v_add_u32 v24, 49152, v20
    v_add_u32 v25, 49152, v21
    v_add_u32 v26, 49152, v22
    v_mfma_f32_32x32x16_bf16 a[16:31], v[100:103], v[80:83], a[16:31]
    v_add_u32 v27, 49152, v23
    v_add_u32 v30, 49152, v28
    v_add_u32 v31, 49152, v29
    s_add_u32 m0, s48, 0
    s_and_b32 s44, s44, 7
    s_lshl_b32 s49, s44, 7
    s_add_u32 s49, s49, s64
    s_lshl_b32 s51, s44, 19
    s_add_u32 s51, s51, s65
    s_add_u32 s44, s44, 1
    buffer_load_dwordx4 v8, s[16:19], s49 offen lds
    v_mfma_f32_32x32x16_bf16 a[32:47], v[96:99], v[84:87], a[32:47]
    ds_read_b128 v[32:35], v24 offset:0
    ds_read_b128 v[36:39], v24 offset:4096
    ds_read_b128 v[40:43], v24 offset:8192
    v_mfma_f32_32x32x16_bf16 a[48:63], v[100:103], v[84:87], a[48:63]
    ds_read_b128 v[44:47], v24 offset:12288
    ds_read_b64_tr_b16 v[48:49], v30 offset:0
    ds_read_b64_tr_b16 v[50:51], v30 offset:1024
    s_add_u32 m0, s48, 1024
    s_nop 0
    buffer_load_dwordx4 v9, s[16:19], s49 offen lds
    v_mfma_f32_32x32x16_bf16 a[64:79], v[96:99], v[88:91], a[64:79]
    ds_read_b64_tr_b16 v[52:53], v31 offset:0
    ds_read_b64_tr_b16 v[54:55], v31 offset:1024
    ds_read_b128 v[56:59], v25 offset:0
    v_mfma_f32_32x32x16_bf16 a[80:95], v[100:103], v[88:91], a[80:95]
    ds_read_b128 v[60:63], v25 offset:4096
    ds_read_b128 v[64:67], v25 offset:8192
    ds_read_b128 v[68:71], v25 offset:12288
    s_add_u32 m0, s48, 2048
    s_nop 0
    buffer_load_dwordx4 v10, s[16:19], s49 offen lds
    v_mfma_f32_32x32x16_bf16 a[96:111], v[96:99], v[92:95], a[96:111]
    ds_read_b64_tr_b16 v[72:73], v30 offset:4096
    ds_read_b64_tr_b16 v[74:75], v30 offset:5120
    ds_read_b64_tr_b16 v[76:77], v31 offset:4096
    v_mfma_f32_32x32x16_bf16 a[112:127], v[100:103], v[92:95], a[112:127]
    ds_read_b64_tr_b16 v[78:79], v31 offset:5120
    s_add_u32 m0, s48, 3072
    s_nop 0
    buffer_load_dwordx4 v11, s[16:19], s49 offen lds
    v_mfma_f32_32x32x16_bf16 a[0:15], v[120:123], v[104:107], a[0:15]
    v_mfma_f32_32x32x16_bf16 a[16:31], v[124:127], v[104:107], a[16:31]
    s_add_u32 m0, s48, 4096
    s_nop 0
    buffer_load_dwordx4 v12, s[16:19], s49 offen lds
    v_mfma_f32_32x32x16_bf16 a[32:47], v[120:123], v[108:111], a[32:47]
    v_mfma_f32_32x32x16_bf16 a[48:63], v[124:127], v[108:111], a[48:63]
    s_add_u32 m0, s48, 5120
    s_nop 0
    buffer_load_dwordx4 v13, s[16:19], s49 offen lds
    v_mfma_f32_32x32x16_bf16 a[64:79], v[120:123], v[112:115], a[64:79]
    v_mfma_f32_32x32x16_bf16 a[80:95], v[124:127], v[112:115], a[80:95]
    s_add_u32 m0, s48, 6144
    s_nop 0
    buffer_load_dwordx4 v14, s[16:19], s49 offen lds
    v_mfma_f32_32x32x16_bf16 a[96:111], v[120:123], v[116:119], a[96:111]
    v_mfma_f32_32x32x16_bf16 a[112:127], v[124:127], v[116:119], a[112:127]
    s_add_u32 m0, s48, 7168
    s_nop 0
    buffer_load_dwordx4 v15, s[16:19], s49 offen lds
    s_waitcnt lgkmcnt(0)
    v_mfma_f32_32x32x16_bf16 a[0:15], v[48:51], v[32:35], a[0:15]
    ds_read_b128 v[80:83], v26 offset:0
    ds_read_b128 v[84:87], v26 offset:4096
    ds_read_b128 v[88:91], v26 offset:8192
    v_mfma_f32_32x32x16_bf16 a[16:31], v[52:55], v[32:35], a[16:31]
    ds_read_b128 v[92:95], v26 offset:12288
    ds_read_b64_tr_b16 v[96:97], v30 offset:8192
    ds_read_b64_tr_b16 v[98:99], v30 offset:9216
    v_mfma_f32_32x32x16_bf16 a[32:47], v[48:51], v[36:39], a[32:47]
    ds_read_b64_tr_b16 v[100:101], v31 offset:8192
    ds_read_b64_tr_b16 v[102:103], v31 offset:9216
    ds_read_b128 v[104:107], v27 offset:0
    s_add_u32 m0, s50, 32768
    s_nop 0
    buffer_load_dwordx4 v16, s[36:39], s51 offen lds
    v_mfma_f32_32x32x16_bf16 a[48:63], v[52:55], v[36:39], a[48:63]
    ds_read_b128 v[108:111], v27 offset:4096
    ds_read_b128 v[112:115], v27 offset:8192
    ds_read_b128 v[116:119], v27 offset:12288
    v_mfma_f32_32x32x16_bf16 a[64:79], v[48:51], v[40:43], a[64:79]
    ds_read_b64_tr_b16 v[120:121], v30 offset:12288
    ds_read_b64_tr_b16 v[122:123], v30 offset:13312
    ds_read_b64_tr_b16 v[124:125], v31 offset:12288
    v_mfma_f32_32x32x16_bf16 a[80:95], v[52:55], v[40:43], a[80:95]
    ds_read_b64_tr_b16 v[126:127], v31 offset:13312
    v_mfma_f32_32x32x16_bf16 a[96:111], v[48:51], v[44:47], a[96:111]
    s_add_u32 m0, s50, 33792
    s_nop 0
    buffer_load_dwordx4 v17, s[36:39], s51 offen lds
    v_mfma_f32_32x32x16_bf16 a[112:127], v[52:55], v[44:47], a[112:127]
    v_mfma_f32_32x32x16_bf16 a[0:15], v[72:75], v[56:59], a[0:15]
    v_mfma_f32_32x32x16_bf16 a[16:31], v[76:79], v[56:59], a[16:31]
    v_mfma_f32_32x32x16_bf16 a[32:47], v[72:75], v[60:63], a[32:47]
    s_add_u32 m0, s50, 34816
    s_nop 0
    buffer_load_dwordx4 v18, s[36:39], s51 offen lds
    v_mfma_f32_32x32x16_bf16 a[48:63], v[76:79], v[60:63], a[48:63]
    v_mfma_f32_32x32x16_bf16 a[64:79], v[72:75], v[64:67], a[64:79]
    v_mfma_f32_32x32x16_bf16 a[80:95], v[76:79], v[64:67], a[80:95]
    v_mfma_f32_32x32x16_bf16 a[96:111], v[72:75], v[68:71], a[96:111]
    s_add_u32 m0, s50, 35840
    s_nop 0
    buffer_load_dwordx4 v19, s[36:39], s51 offen lds
    v_mfma_f32_32x32x16_bf16 a[112:127], v[76:79], v[68:71], a[112:127]
    s_waitcnt lgkmcnt(0)
    s_waitcnt vmcnt(12)
    s_barrier
    v_mfma_f32_32x32x16_bf16 a[0:15], v[96:99], v[80:83], a[0:15]
    v_add_u32 v24, 98304, v20
    v_add_u32 v25, 98304, v21
    v_add_u32 v26, 98304, v22
    v_mfma_f32_32x32x16_bf16 a[16:31], v[100:103], v[80:83], a[16:31]
    v_add_u32 v27, 98304, v23
    v_add_u32 v30, 98304, v28
    v_add_u32 v31, 98304, v29
    s_add_u32 m0, s48, 49152
    s_and_b32 s44, s44, 7
    s_lshl_b32 s49, s44, 7
    s_add_u32 s49, s49, s64
    s_lshl_b32 s51, s44, 19
    s_add_u32 s51, s51, s65
    s_add_u32 s44, s44, 1
    buffer_load_dwordx4 v8, s[16:19], s49 offen lds
    v_mfma_f32_32x32x16_bf16 a[32:47], v[96:99], v[84:87], a[32:47]
    ds_read_b128 v[32:35], v24 offset:0
    ds_read_b128 v[36:39], v24 offset:4096
    ds_read_b128 v[40:43], v24 offset:8192
    v_mfma_f32_32x32x16_bf16 a[48:63], v[100:103], v[84:87], a[48:63]
    ds_read_b128 v[44:47], v24 offset:12288
    ds_read_b64_tr_b16 v[48:49], v30 offset:0
    ds_read_b64_tr_b16 v[50:51], v30 offset:1024
    s_add_u32 m0, s48, 50176
    s_nop 0
    buffer_load_dwordx4 v9, s[16:19], s49 offen lds
    v_mfma_f32_32x32x16_bf16 a[64:79], v[96:99], v[88:91], a[64:79]
    ds_read_b64_tr_b16 v[52:53], v31 offset:0
    ds_read_b64_tr_b16 v[54:55], v31 offset:1024
    ds_read_b128 v[56:59], v25 offset:0
    v_mfma_f32_32x32x16_bf16 a[80:95], v[100:103], v[88:91], a[80:95]
    ds_read_b128 v[60:63], v25 offset:4096
    ds_read_b128 v[64:67], v25 offset:8192
    ds_read_b128 v[68:71], v25 offset:12288
    s_add_u32 m0, s48, 51200
    s_nop 0
    buffer_load_dwordx4 v10, s[16:19], s49 offen lds
    v_mfma_f32_32x32x16_bf16 a[96:111], v[96:99], v[92:95], a[96:111]
    ds_read_b64_tr_b16 v[72:73], v30 offset:4096
    ds_read_b64_tr_b16 v[74:75], v30 offset:5120
    ds_read_b64_tr_b16 v[76:77], v31 offset:4096
    v_mfma_f32_32x32x16_bf16 a[112:127], v[100:103], v[92:95], a[112:127]
    ds_read_b64_tr_b16 v[78:79], v31 offset:5120
    s_add_u32 m0, s48, 52224
    s_nop 0
    buffer_load_dwordx4 v11, s[16:19], s49 offen lds
    v_mfma_f32_32x32x16_bf16 a[0:15], v[120:123], v[104:107], a[0:15]
    v_mfma_f32_32x32x16_bf16 a[16:31], v[124:127], v[104:107], a[16:31]
    s_add_u32 m0, s48, 53248
    s_nop 0
    buffer_load_dwordx4 v12, s[16:19], s49 offen lds
    v_mfma_f32_32x32x16_bf16 a[32:47], v[120:123], v[108:111], a[32:47]
    v_mfma_f32_32x32x16_bf16 a[48:63], v[124:127], v[108:111], a[48:63]
    s_add_u32 m0, s48, 54272
    s_nop 0
    buffer_load_dwordx4 v13, s[16:19], s49 offen lds
    v_mfma_f32_32x32x16_bf16 a[64:79], v[120:123], v[112:115], a[64:79]
    v_mfma_f32_32x32x16_bf16 a[80:95], v[124:127], v[112:115], a[80:95]
    s_add_u32 m0, s48, 55296
    s_nop 0
    buffer_load_dwordx4 v14, s[16:19], s49 offen lds
    v_mfma_f32_32x32x16_bf16 a[96:111], v[120:123], v[116:119], a[96:111]
    v_mfma_f32_32x32x16_bf16 a[112:127], v[124:127], v[116:119], a[112:127]
    s_add_u32 m0, s48, 56320
    s_nop 0
    buffer_load_dwordx4 v15, s[16:19], s49 offen lds
    s_waitcnt lgkmcnt(0)
    v_mfma_f32_32x32x16_bf16 a[128:143], v[32:35], v[48:51], 0
    ds_read_b128 v[80:83], v26 offset:0
    ds_read_b128 v[84:87], v26 offset:4096
    ds_read_b128 v[88:91], v26 offset:8192
    v_mfma_f32_32x32x16_bf16 a[144:159], v[32:35], v[52:55], 0
    ds_read_b128 v[92:95], v26 offset:12288
    ds_read_b64_tr_b16 v[96:97], v30 offset:8192
    ds_read_b64_tr_b16 v[98:99], v30 offset:9216
    v_mfma_f32_32x32x16_bf16 a[160:175], v[36:39], v[48:51], 0
    ds_read_b64_tr_b16 v[100:101], v31 offset:8192
    ds_read_b64_tr_b16 v[102:103], v31 offset:9216
    ds_read_b128 v[104:107], v27 offset:0
    s_add_u32 m0, s50, 81920
    s_nop 0
    buffer_load_dwordx4 v16, s[36:39], s51 offen lds
    v_mfma_f32_32x32x16_bf16 a[176:191], v[36:39], v[52:55], 0
    ds_read_b128 v[108:111], v27 offset:4096
    ds_read_b128 v[112:115], v27 offset:8192
    ds_read_b128 v[116:119], v27 offset:12288
    v_mfma_f32_32x32x16_bf16 a[192:207], v[40:43], v[48:51], 0
    ds_read_b64_tr_b16 v[120:121], v30 offset:12288
    ds_read_b64_tr_b16 v[122:123], v30 offset:13312
    ds_read_b64_tr_b16 v[124:125], v31 offset:12288
    v_mfma_f32_32x32x16_bf16 a[208:223], v[40:43], v[52:55], 0
    ds_read_b64_tr_b16 v[126:127], v31 offset:13312
    v_mfma_f32_32x32x16_bf16 a[224:239], v[44:47], v[48:51], 0
    s_add_u32 m0, s50, 82944
    s_nop 0
    buffer_load_dwordx4 v17, s[36:39], s51 offen lds
    v_mfma_f32_32x32x16_bf16 a[240:255], v[44:47], v[52:55], 0
    v_mfma_f32_32x32x16_bf16 a[128:143], v[56:59], v[72:75], a[128:143]
    v_mfma_f32_32x32x16_bf16 a[144:159], v[56:59], v[76:79], a[144:159]
    v_mfma_f32_32x32x16_bf16 a[160:175], v[60:63], v[72:75], a[160:175]
    s_add_u32 m0, s50, 83968
    s_nop 0
    buffer_load_dwordx4 v18, s[36:39], s51 offen lds
    v_mfma_f32_32x32x16_bf16 a[176:191], v[60:63], v[76:79], a[176:191]
    v_mfma_f32_32x32x16_bf16 a[192:207], v[64:67], v[72:75], a[192:207]
    v_mfma_f32_32x32x16_bf16 a[208:223], v[64:67], v[76:79], a[208:223]
    v_mfma_f32_32x32x16_bf16 a[224:239], v[68:71], v[72:75], a[224:239]
    s_add_u32 m0, s50, 84992
    s_nop 0
    buffer_load_dwordx4 v19, s[36:39], s51 offen lds
    v_mfma_f32_32x32x16_bf16 a[240:255], v[68:71], v[76:79], a[240:255]
    s_waitcnt lgkmcnt(0)
    s_waitcnt vmcnt(12)
    s_barrier
    v_mfma_f32_32x32x16_bf16 a[128:143], v[80:83], v[96:99], a[128:143]
    v_add_u32 v24, 0, v20
    v_add_u32 v25, 0, v21
    v_add_u32 v26, 0, v22
    v_mfma_f32_32x32x16_bf16 a[144:159], v[80:83], v[100:103], a[144:159]
    v_add_u32 v27, 0, v23
    v_add_u32 v30, 0, v28
    v_add_u32 v31, 0, v29
    s_add_u32 m0, s48, 98304
    s_and_b32 s44, s44, 7
    s_lshl_b32 s49, s44, 7
    s_add_u32 s49, s49, s64
    s_lshl_b32 s51, s44, 19
    s_add_u32 s51, s51, s65
    s_add_u32 s44, s44, 1
    buffer_load_dwordx4 v8, s[16:19], s49 offen lds
    v_mfma_f32_32x32x16_bf16 a[160:175], v[84:87], v[96:99], a[160:175]
    ds_read_b128 v[32:35], v24 offset:0
    ds_read_b128 v[36:39], v24 offset:4096
    ds_read_b128 v[40:43], v24 offset:8192
    v_mfma_f32_32x32x16_bf16 a[176:191], v[84:87], v[100:103], a[176:191]
    ds_read_b128 v[44:47], v24 offset:12288
    ds_read_b64_tr_b16 v[48:49], v30 offset:0
    ds_read_b64_tr_b16 v[50:51], v30 offset:1024
    s_add_u32 m0, s48, 99328
    s_nop 0
    buffer_load_dwordx4 v9, s[16:19], s49 offen lds
    v_mfma_f32_32x32x16_bf16 a[192:207], v[88:91], v[96:99], a[192:207]
    ds_read_b64_tr_b16 v[52:53], v31 offset:0
    ds_read_b64_tr_b16 v[54:55], v31 offset:1024
    ds_read_b128 v[56:59], v25 offset:0
    s_add_u32 s63, s61, 0
    v_accvgpr_read_b32 v156, a0
    v_accvgpr_read_b32 v157, a1
    v_mfma_f32_32x32x16_bf16 a[208:223], v[88:91], v[100:103], a[208:223]
    ds_read_b128 v[60:63], v25 offset:4096
    ds_read_b128 v[64:67], v25 offset:8192
    ds_read_b128 v[68:71], v25 offset:12288
    s_add_u32 m0, s48, 100352
    s_nop 0
    buffer_load_dwordx4 v10, s[16:19], s49 offen lds
    v_accvgpr_read_b32 v158, a2
    v_accvgpr_read_b32 v159, a3
    v_mfma_f32_32x32x16_bf16 a[224:239], v[92:95], v[96:99], a[224:239]
    ds_read_b64_tr_b16 v[72:73], v30 offset:4096
    ds_read_b64_tr_b16 v[74:75], v30 offset:5120
    ds_read_b64_tr_b16 v[76:77], v31 offset:4096
    v_accvgpr_read_b32 v160, a4
    v_accvgpr_read_b32 v161, a5
    v_mfma_f32_32x32x16_bf16 a[240:255], v[92:95], v[100:103], a[240:255]
    ds_read_b64_tr_b16 v[78:79], v31 offset:5120
    s_add_u32 m0, s48, 101376
    s_nop 0
    buffer_load_dwordx4 v11, s[16:19], s49 offen lds
    v_accvgpr_read_b32 v162, a6
    v_accvgpr_read_b32 v163, a7
    v_mfma_f32_32x32x16_bf16 a[128:143], v[104:107], v[120:123], a[128:143]
    v_cvt_pk_bf16_f32 v152, v156, v157
    v_cvt_pk_bf16_f32 v153, v158, v159
    v_cvt_pk_bf16_f32 v154, v160, v161
    v_mfma_f32_32x32x16_bf16 a[144:159], v[104:107], v[124:127], a[144:159]
    s_add_u32 m0, s48, 102400
    s_nop 0
    buffer_load_dwordx4 v12, s[16:19], s49 offen lds
    v_cvt_pk_bf16_f32 v155, v162, v163
    buffer_store_dwordx4 v[152:155], v181, s[24:27], s63 offen offset:0 sc0 sc1
    v_mfma_f32_32x32x16_bf16 a[160:175], v[108:111], v[120:123], a[160:175]
    v_accvgpr_read_b32 v168, a8
    v_accvgpr_read_b32 v169, a9
    v_mfma_f32_32x32x16_bf16 a[176:191], v[108:111], v[124:127], a[176:191]
    s_add_u32 m0, s48, 103424
    s_nop 0
    buffer_load_dwordx4 v13, s[16:19], s49 offen lds
    v_accvgpr_read_b32 v170, a10
    v_accvgpr_read_b32 v171, a11
    v_mfma_f32_32x32x16_bf16 a[192:207], v[112:115], v[120:123], a[192:207]
    v_accvgpr_read_b32 v172, a12
    v_accvgpr_read_b32 v173, a13
    v_accvgpr_read_b32 v174, a14
    v_mfma_f32_32x32x16_bf16 a[208:223], v[112:115], v[124:127], a[208:223]
    s_add_u32 m0, s48, 104448
    s_nop 0
    buffer_load_dwordx4 v14, s[16:19], s49 offen lds
    v_accvgpr_read_b32 v175, a15
    v_cvt_pk_bf16_f32 v164, v168, v169
    v_mfma_f32_32x32x16_bf16 a[224:239], v[116:119], v[120:123], a[224:239]
    v_cvt_pk_bf16_f32 v165, v170, v171
    v_cvt_pk_bf16_f32 v166, v172, v173
    v_mfma_f32_32x32x16_bf16 a[240:255], v[116:119], v[124:127], a[240:255]
    s_add_u32 m0, s48, 105472
    s_nop 0
    buffer_load_dwordx4 v15, s[16:19], s49 offen lds
    v_cvt_pk_bf16_f32 v167, v174, v175
    buffer_store_dwordx4 v[164:167], v181, s[24:27], s63 offen offset:1024 sc0 sc1
    s_waitcnt lgkmcnt(0)
    v_mfma_f32_32x32x16_bf16 a[128:143], v[32:35], v[48:51], a[128:143]
    ds_read_b128 v[80:83], v26 offset:0
    ds_read_b128 v[84:87], v26 offset:4096
    ds_read_b128 v[88:91], v26 offset:8192
    v_mfma_f32_32x32x16_bf16 a[144:159], v[32:35], v[52:55], a[144:159]
    ds_read_b128 v[92:95], v26 offset:12288
    ds_read_b64_tr_b16 v[96:97], v30 offset:8192
    ds_read_b64_tr_b16 v[98:99], v30 offset:9216
    v_mfma_f32_32x32x16_bf16 a[160:175], v[36:39], v[48:51], a[160:175]
    ds_read_b64_tr_b16 v[100:101], v31 offset:8192
    ds_read_b64_tr_b16 v[102:103], v31 offset:9216
    ds_read_b128 v[104:107], v27 offset:0
    s_add_u32 m0, s50, 131072
    s_nop 0
    buffer_load_dwordx4 v16, s[36:39], s51 offen lds
    v_mfma_f32_32x32x16_bf16 a[176:191], v[36:39], v[52:55], a[176:191]
    ds_read_b128 v[108:111], v27 offset:4096
    ds_read_b128 v[112:115], v27 offset:8192
    ds_read_b128 v[116:119], v27 offset:12288
    v_mfma_f32_32x32x16_bf16 a[192:207], v[40:43], v[48:51], a[192:207]
    ds_read_b64_tr_b16 v[120:121], v30 offset:12288
    ds_read_b64_tr_b16 v[122:123], v30 offset:13312
    ds_read_b64_tr_b16 v[124:125], v31 offset:12288
    v_accvgpr_read_b32 v156, a16
    v_accvgpr_read_b32 v157, a17
    v_accvgpr_read_b32 v158, a18
    v_mfma_f32_32x32x16_bf16 a[208:223], v[40:43], v[52:55], a[208:223]
    ds_read_b64_tr_b16 v[126:127], v31 offset:13312
    v_accvgpr_read_b32 v159, a19
    v_accvgpr_read_b32 v160, a20
    v_mfma_f32_32x32x16_bf16 a[224:239], v[44:47], v[48:51], a[224:239]
    s_add_u32 m0, s50, 132096
    s_nop 0
    buffer_load_dwordx4 v17, s[36:39], s51 offen lds
    v_accvgpr_read_b32 v161, a21
    v_accvgpr_read_b32 v162, a22
    v_mfma_f32_32x32x16_bf16 a[240:255], v[44:47], v[52:55], a[240:255]
    v_accvgpr_read_b32 v163, a23
    v_cvt_pk_bf16_f32 v152, v156, v157
    v_mfma_f32_32x32x16_bf16 a[128:143], v[56:59], v[72:75], a[128:143]
    v_cvt_pk_bf16_f32 v153, v158, v159
    v_cvt_pk_bf16_f32 v154, v160, v161
    v_mfma_f32_32x32x16_bf16 a[144:159], v[56:59], v[76:79], a[144:159]
    v_cvt_pk_bf16_f32 v155, v162, v163
    buffer_store_dwordx4 v[152:155], v181, s[24:27], s63 offen offset:2048 sc0 sc1
    v_mfma_f32_32x32x16_bf16 a[160:175], v[60:63], v[72:75], a[160:175]
    s_add_u32 m0, s50, 133120
    s_nop 0
    buffer_load_dwordx4 v18, s[36:39], s51 offen lds
    v_accvgpr_read_b32 v168, a24
    v_accvgpr_read_b32 v169, a25
    v_accvgpr_read_b32 v170, a26
    v_mfma_f32_32x32x16_bf16 a[176:191], v[60:63], v[76:79], a[176:191]
    v_accvgpr_read_b32 v171, a27
    v_accvgpr_read_b32 v172, a28
    v_mfma_f32_32x32x16_bf16 a[192:207], v[64:67], v[72:75], a[192:207]
    v_accvgpr_read_b32 v173, a29
    v_accvgpr_read_b32 v174, a30
    v_mfma_f32_32x32x16_bf16 a[208:223], v[64:67], v[76:79], a[208:223]
    v_accvgpr_read_b32 v175, a31
    v_cvt_pk_bf16_f32 v164, v168, v169
    v_mfma_f32_32x32x16_bf16 a[224:239], v[68:71], v[72:75], a[224:239]
    s_add_u32 m0, s50, 134144
    s_nop 0
    buffer_load_dwordx4 v19, s[36:39], s51 offen lds
    v_cvt_pk_bf16_f32 v165, v170, v171
    v_cvt_pk_bf16_f32 v166, v172, v173
    v_mfma_f32_32x32x16_bf16 a[240:255], v[68:71], v[76:79], a[240:255]
    v_cvt_pk_bf16_f32 v167, v174, v175
    buffer_store_dwordx4 v[164:167], v181, s[24:27], s63 offen offset:3072 sc0 sc1
    s_waitcnt lgkmcnt(0)
    s_waitcnt vmcnt(16)
    s_barrier
    v_mfma_f32_32x32x16_bf16 a[128:143], v[80:83], v[96:99], a[128:143]
    v_add_u32 v24, 49152, v20
    v_add_u32 v25, 49152, v21
    v_add_u32 v26, 49152, v22
    v_mfma_f32_32x32x16_bf16 a[144:159], v[80:83], v[100:103], a[144:159]
    v_add_u32 v27, 49152, v23
    v_add_u32 v30, 49152, v28
    v_add_u32 v31, 49152, v29
    s_add_u32 m0, s48, 0
    s_and_b32 s44, s44, 7
    s_lshl_b32 s49, s44, 7
    s_add_u32 s49, s49, s64
    s_lshl_b32 s51, s44, 19
    s_add_u32 s51, s51, s65
    s_add_u32 s44, s44, 1
    buffer_load_dwordx4 v8, s[16:19], s49 offen lds
    v_mfma_f32_32x32x16_bf16 a[160:175], v[84:87], v[96:99], a[160:175]
    ds_read_b128 v[32:35], v24 offset:0
    ds_read_b128 v[36:39], v24 offset:4096
    ds_read_b128 v[40:43], v24 offset:8192
    v_mfma_f32_32x32x16_bf16 a[176:191], v[84:87], v[100:103], a[176:191]
    ds_read_b128 v[44:47], v24 offset:12288
    ds_read_b64_tr_b16 v[48:49], v30 offset:0
    ds_read_b64_tr_b16 v[50:51], v30 offset:1024
    s_add_u32 m0, s48, 1024
    s_nop 0
    buffer_load_dwordx4 v9, s[16:19], s49 offen lds
    v_mfma_f32_32x32x16_bf16 a[192:207], v[88:91], v[96:99], a[192:207]
    ds_read_b64_tr_b16 v[52:53], v31 offset:0
    ds_read_b64_tr_b16 v[54:55], v31 offset:1024
    ds_read_b128 v[56:59], v25 offset:0
    s_add_u32 s63, s61, 8192
    v_accvgpr_read_b32 v156, a32
    v_accvgpr_read_b32 v157, a33
    v_mfma_f32_32x32x16_bf16 a[208:223], v[88:91], v[100:103], a[208:223]
    ds_read_b128 v[60:63], v25 offset:4096
    ds_read_b128 v[64:67], v25 offset:8192
    ds_read_b128 v[68:71], v25 offset:12288
    s_add_u32 m0, s48, 2048
    s_nop 0
    buffer_load_dwordx4 v10, s[16:19], s49 offen lds
    v_accvgpr_read_b32 v158, a34
    v_accvgpr_read_b32 v159, a35
    v_mfma_f32_32x32x16_bf16 a[224:239], v[92:95], v[96:99], a[224:239]
    ds_read_b64_tr_b16 v[72:73], v30 offset:4096
    ds_read_b64_tr_b16 v[74:75], v30 offset:5120
    ds_read_b64_tr_b16 v[76:77], v31 offset:4096
    v_accvgpr_read_b32 v160, a36
    v_accvgpr_read_b32 v161, a37
    v_mfma_f32_32x32x16_bf16 a[240:255], v[92:95], v[100:103], a[240:255]
    ds_read_b64_tr_b16 v[78:79], v31 offset:5120
    s_add_u32 m0, s48, 3072
    s_nop 0
    buffer_load_dwordx4 v11, s[16:19], s49 offen lds
    v_accvgpr_read_b32 v162, a38
    v_accvgpr_read_b32 v163, a39
    v_mfma_f32_32x32x16_bf16 a[128:143], v[104:107], v[120:123], a[128:143]
    v_cvt_pk_bf16_f32 v152, v156, v157
    v_cvt_pk_bf16_f32 v153, v158, v159
    v_cvt_pk_bf16_f32 v154, v160, v161
    v_mfma_f32_32x32x16_bf16 a[144:159], v[104:107], v[124:127], a[144:159]
    s_add_u32 m0, s48, 4096
    s_nop 0
    buffer_load_dwordx4 v12, s[16:19], s49 offen lds
    v_cvt_pk_bf16_f32 v155, v162, v163
    buffer_store_dwordx4 v[152:155], v181, s[24:27], s63 offen offset:0 sc0 sc1
    v_mfma_f32_32x32x16_bf16 a[160:175], v[108:111], v[120:123], a[160:175]
    v_accvgpr_read_b32 v168, a40
    v_accvgpr_read_b32 v169, a41
    v_mfma_f32_32x32x16_bf16 a[176:191], v[108:111], v[124:127], a[176:191]
    s_add_u32 m0, s48, 5120
    s_nop 0
    buffer_load_dwordx4 v13, s[16:19], s49 offen lds
    v_accvgpr_read_b32 v170, a42
    v_accvgpr_read_b32 v171, a43
    v_mfma_f32_32x32x16_bf16 a[192:207], v[112:115], v[120:123], a[192:207]
    v_accvgpr_read_b32 v172, a44
    v_accvgpr_read_b32 v173, a45
    v_accvgpr_read_b32 v174, a46
    v_mfma_f32_32x32x16_bf16 a[208:223], v[112:115], v[124:127], a[208:223]
    s_add_u32 m0, s48, 6144
    s_nop 0
    buffer_load_dwordx4 v14, s[16:19], s49 offen lds
    v_accvgpr_read_b32 v175, a47
    v_cvt_pk_bf16_f32 v164, v168, v169
    v_mfma_f32_32x32x16_bf16 a[224:239], v[116:119], v[120:123], a[224:239]
    v_cvt_pk_bf16_f32 v165, v170, v171
    v_cvt_pk_bf16_f32 v166, v172, v173
    v_mfma_f32_32x32x16_bf16 a[240:255], v[116:119], v[124:127], a[240:255]
    s_add_u32 m0, s48, 7168
    s_nop 0
    buffer_load_dwordx4 v15, s[16:19], s49 offen lds
    v_cvt_pk_bf16_f32 v167, v174, v175
    buffer_store_dwordx4 v[164:167], v181, s[24:27], s63 offen offset:1024 sc0 sc1
    s_waitcnt lgkmcnt(0)
    v_mfma_f32_32x32x16_bf16 a[128:143], v[32:35], v[48:51], a[128:143]
    ds_read_b128 v[80:83], v26 offset:0
    ds_read_b128 v[84:87], v26 offset:4096
    ds_read_b128 v[88:91], v26 offset:8192
    v_mfma_f32_32x32x16_bf16 a[144:159], v[32:35], v[52:55], a[144:159]
    ds_read_b128 v[92:95], v26 offset:12288
    ds_read_b64_tr_b16 v[96:97], v30 offset:8192
    ds_read_b64_tr_b16 v[98:99], v30 offset:9216
    v_mfma_f32_32x32x16_bf16 a[160:175], v[36:39], v[48:51], a[160:175]
    ds_read_b64_tr_b16 v[100:101], v31 offset:8192
    ds_read_b64_tr_b16 v[102:103], v31 offset:9216
    ds_read_b128 v[104:107], v27 offset:0
    s_add_u32 m0, s50, 32768
    s_nop 0
    buffer_load_dwordx4 v16, s[36:39], s51 offen lds
    v_mfma_f32_32x32x16_bf16 a[176:191], v[36:39], v[52:55], a[176:191]
    ds_read_b128 v[108:111], v27 offset:4096
    ds_read_b128 v[112:115], v27 offset:8192
    ds_read_b128 v[116:119], v27 offset:12288
    v_mfma_f32_32x32x16_bf16 a[192:207], v[40:43], v[48:51], a[192:207]
    ds_read_b64_tr_b16 v[120:121], v30 offset:12288
    ds_read_b64_tr_b16 v[122:123], v30 offset:13312
    ds_read_b64_tr_b16 v[124:125], v31 offset:12288
    v_accvgpr_read_b32 v156, a48
    v_accvgpr_read_b32 v157, a49
    v_accvgpr_read_b32 v158, a50
    v_mfma_f32_32x32x16_bf16 a[208:223], v[40:43], v[52:55], a[208:223]
    ds_read_b64_tr_b16 v[126:127], v31 offset:13312
    v_accvgpr_read_b32 v159, a51
    v_accvgpr_read_b32 v160, a52
    v_mfma_f32_32x32x16_bf16 a[224:239], v[44:47], v[48:51], a[224:239]
    s_add_u32 m0, s50, 33792
    s_nop 0
    buffer_load_dwordx4 v17, s[36:39], s51 offen lds
    v_accvgpr_read_b32 v161, a53
    v_accvgpr_read_b32 v162, a54
    v_mfma_f32_32x32x16_bf16 a[240:255], v[44:47], v[52:55], a[240:255]
    v_accvgpr_read_b32 v163, a55
    v_cvt_pk_bf16_f32 v152, v156, v157
    v_mfma_f32_32x32x16_bf16 a[128:143], v[56:59], v[72:75], a[128:143]
    v_cvt_pk_bf16_f32 v153, v158, v159
    v_cvt_pk_bf16_f32 v154, v160, v161
    v_mfma_f32_32x32x16_bf16 a[144:159], v[56:59], v[76:79], a[144:159]
    v_cvt_pk_bf16_f32 v155, v162, v163
    buffer_store_dwordx4 v[152:155], v181, s[24:27], s63 offen offset:2048 sc0 sc1
    v_mfma_f32_32x32x16_bf16 a[160:175], v[60:63], v[72:75], a[160:175]
    s_add_u32 m0, s50, 34816
    s_nop 0
    buffer_load_dwordx4 v18, s[36:39], s51 offen lds
    v_accvgpr_read_b32 v168, a56
    v_accvgpr_read_b32 v169, a57
    v_accvgpr_read_b32 v170, a58
    v_mfma_f32_32x32x16_bf16 a[176:191], v[60:63], v[76:79], a[176:191]
    v_accvgpr_read_b32 v171, a59
    v_accvgpr_read_b32 v172, a60
    v_mfma_f32_32x32x16_bf16 a[192:207], v[64:67], v[72:75], a[192:207]
    v_accvgpr_read_b32 v173, a61
    v_accvgpr_read_b32 v174, a62
    v_mfma_f32_32x32x16_bf16 a[208:223], v[64:67], v[76:79], a[208:223]
    v_accvgpr_read_b32 v175, a63
    v_cvt_pk_bf16_f32 v164, v168, v169
    v_mfma_f32_32x32x16_bf16 a[224:239], v[68:71], v[72:75], a[224:239]
    s_add_u32 m0, s50, 35840
    s_nop 0
    buffer_load_dwordx4 v19, s[36:39], s51 offen lds
    v_cvt_pk_bf16_f32 v165, v170, v171
    v_cvt_pk_bf16_f32 v166, v172, v173
    v_mfma_f32_32x32x16_bf16 a[240:255], v[68:71], v[76:79], a[240:255]
    v_cvt_pk_bf16_f32 v167, v174, v175
    buffer_store_dwordx4 v[164:167], v181, s[24:27], s63 offen offset:3072 sc0 sc1
    s_waitcnt lgkmcnt(0)
    s_waitcnt vmcnt(17)
    s_barrier
    v_mfma_f32_32x32x16_bf16 a[128:143], v[80:83], v[96:99], a[128:143]
    v_add_u32 v24, 98304, v20
    v_add_u32 v25, 98304, v21
    v_add_u32 v26, 98304, v22
    v_mfma_f32_32x32x16_bf16 a[144:159], v[80:83], v[100:103], a[144:159]
    v_add_u32 v27, 98304, v23
    v_add_u32 v30, 98304, v28
    v_add_u32 v31, 98304, v29
    s_add_u32 m0, s48, 49152
    s_and_b32 s44, s44, 7
    s_lshl_b32 s49, s44, 7
    s_add_u32 s49, s49, s64
    s_lshl_b32 s51, s44, 19
    s_add_u32 s51, s51, s65
    s_add_u32 s44, s44, 1
    buffer_load_dwordx4 v8, s[16:19], s49 offen lds
    v_mfma_f32_32x32x16_bf16 a[160:175], v[84:87], v[96:99], a[160:175]
    ds_read_b128 v[32:35], v24 offset:0
    ds_read_b128 v[36:39], v24 offset:4096
    ds_read_b128 v[40:43], v24 offset:8192
    v_mfma_f32_32x32x16_bf16 a[176:191], v[84:87], v[100:103], a[176:191]
    ds_read_b128 v[44:47], v24 offset:12288
    ds_read_b64_tr_b16 v[48:49], v30 offset:0
    ds_read_b64_tr_b16 v[50:51], v30 offset:1024
    s_add_u32 m0, s48, 50176
    s_nop 0
    buffer_load_dwordx4 v9, s[16:19], s49 offen lds
    v_mfma_f32_32x32x16_bf16 a[192:207], v[88:91], v[96:99], a[192:207]
    ds_read_b64_tr_b16 v[52:53], v31 offset:0
    ds_read_b64_tr_b16 v[54:55], v31 offset:1024
    ds_read_b128 v[56:59], v25 offset:0
    s_add_u32 s63, s61, 16384
    v_accvgpr_read_b32 v156, a64
    v_accvgpr_read_b32 v157, a65
    v_mfma_f32_32x32x16_bf16 a[208:223], v[88:91], v[100:103], a[208:223]
    ds_read_b128 v[60:63], v25 offset:4096
    ds_read_b128 v[64:67], v25 offset:8192
    ds_read_b128 v[68:71], v25 offset:12288
    s_add_u32 m0, s48, 51200
    s_nop 0
    buffer_load_dwordx4 v10, s[16:19], s49 offen lds
    v_accvgpr_read_b32 v158, a66
    v_accvgpr_read_b32 v159, a67
    v_mfma_f32_32x32x16_bf16 a[224:239], v[92:95], v[96:99], a[224:239]
    ds_read_b64_tr_b16 v[72:73], v30 offset:4096
    ds_read_b64_tr_b16 v[74:75], v30 offset:5120
    ds_read_b64_tr_b16 v[76:77], v31 offset:4096
    v_accvgpr_read_b32 v160, a68
    v_accvgpr_read_b32 v161, a69
    v_mfma_f32_32x32x16_bf16 a[240:255], v[92:95], v[100:103], a[240:255]
    ds_read_b64_tr_b16 v[78:79], v31 offset:5120
    s_add_u32 m0, s48, 52224
    s_nop 0
    buffer_load_dwordx4 v11, s[16:19], s49 offen lds
    v_accvgpr_read_b32 v162, a70
    v_accvgpr_read_b32 v163, a71
    v_mfma_f32_32x32x16_bf16 a[128:143], v[104:107], v[120:123], a[128:143]
    v_cvt_pk_bf16_f32 v152, v156, v157
    v_cvt_pk_bf16_f32 v153, v158, v159
    v_cvt_pk_bf16_f32 v154, v160, v161
    v_mfma_f32_32x32x16_bf16 a[144:159], v[104:107], v[124:127], a[144:159]
    s_add_u32 m0, s48, 53248
    s_nop 0
    buffer_load_dwordx4 v12, s[16:19], s49 offen lds
    v_cvt_pk_bf16_f32 v155, v162, v163
    buffer_store_dwordx4 v[152:155], v181, s[24:27], s63 offen offset:0 sc0 sc1
    v_mfma_f32_32x32x16_bf16 a[160:175], v[108:111], v[120:123], a[160:175]
    v_accvgpr_read_b32 v168, a72
    v_accvgpr_read_b32 v169, a73
    v_mfma_f32_32x32x16_bf16 a[176:191], v[108:111], v[124:127], a[176:191]
    s_add_u32 m0, s48, 54272
    s_nop 0
    buffer_load_dwordx4 v13, s[16:19], s49 offen lds
    v_accvgpr_read_b32 v170, a74
    v_accvgpr_read_b32 v171, a75
    v_mfma_f32_32x32x16_bf16 a[192:207], v[112:115], v[120:123], a[192:207]
    v_accvgpr_read_b32 v172, a76
    v_accvgpr_read_b32 v173, a77
    v_accvgpr_read_b32 v174, a78
    v_mfma_f32_32x32x16_bf16 a[208:223], v[112:115], v[124:127], a[208:223]
    s_add_u32 m0, s48, 55296
    s_nop 0
    buffer_load_dwordx4 v14, s[16:19], s49 offen lds
    v_accvgpr_read_b32 v175, a79
    v_cvt_pk_bf16_f32 v164, v168, v169
    v_mfma_f32_32x32x16_bf16 a[224:239], v[116:119], v[120:123], a[224:239]
    v_cvt_pk_bf16_f32 v165, v170, v171
    v_cvt_pk_bf16_f32 v166, v172, v173
    v_mfma_f32_32x32x16_bf16 a[240:255], v[116:119], v[124:127], a[240:255]
    s_add_u32 m0, s48, 56320
    s_nop 0
    buffer_load_dwordx4 v15, s[16:19], s49 offen lds
    v_cvt_pk_bf16_f32 v167, v174, v175
    buffer_store_dwordx4 v[164:167], v181, s[24:27], s63 offen offset:1024 sc0 sc1
    s_waitcnt lgkmcnt(0)
    v_mfma_f32_32x32x16_bf16 a[128:143], v[32:35], v[48:51], a[128:143]
    ds_read_b128 v[80:83], v26 offset:0
    ds_read_b128 v[84:87], v26 offset:4096
    ds_read_b128 v[88:91], v26 offset:8192
    v_mfma_f32_32x32x16_bf16 a[144:159], v[32:35], v[52:55], a[144:159]
    ds_read_b128 v[92:95], v26 offset:12288
    ds_read_b64_tr_b16 v[96:97], v30 offset:8192
    ds_read_b64_tr_b16 v[98:99], v30 offset:9216
    v_mfma_f32_32x32x16_bf16 a[160:175], v[36:39], v[48:51], a[160:175]
    ds_read_b64_tr_b16 v[100:101], v31 offset:8192
    ds_read_b64_tr_b16 v[102:103], v31 offset:9216
    ds_read_b128 v[104:107], v27 offset:0
    s_add_u32 m0, s50, 81920
    s_nop 0
    buffer_load_dwordx4 v16, s[36:39], s51 offen lds
    v_mfma_f32_32x32x16_bf16 a[176:191], v[36:39], v[52:55], a[176:191]
    ds_read_b128 v[108:111], v27 offset:4096
    ds_read_b128 v[112:115], v27 offset:8192
    ds_read_b128 v[116:119], v27 offset:12288
    v_mfma_f32_32x32x16_bf16 a[192:207], v[40:43], v[48:51], a[192:207]
    ds_read_b64_tr_b16 v[120:121], v30 offset:12288
    ds_read_b64_tr_b16 v[122:123], v30 offset:13312
    ds_read_b64_tr_b16 v[124:125], v31 offset:12288
    v_accvgpr_read_b32 v156, a80
    v_accvgpr_read_b32 v157, a81
    v_accvgpr_read_b32 v158, a82
    v_mfma_f32_32x32x16_bf16 a[208:223], v[40:43], v[52:55], a[208:223]
    ds_read_b64_tr_b16 v[126:127], v31 offset:13312
    v_accvgpr_read_b32 v159, a83
    v_accvgpr_read_b32 v160, a84
    v_mfma_f32_32x32x16_bf16 a[224:239], v[44:47], v[48:51], a[224:239]
    s_add_u32 m0, s50, 82944
    s_nop 0
    buffer_load_dwordx4 v17, s[36:39], s51 offen lds
    v_accvgpr_read_b32 v161, a85
    v_accvgpr_read_b32 v162, a86
    v_mfma_f32_32x32x16_bf16 a[240:255], v[44:47], v[52:55], a[240:255]
    v_accvgpr_read_b32 v163, a87
    v_cvt_pk_bf16_f32 v152, v156, v157
    v_mfma_f32_32x32x16_bf16 a[128:143], v[56:59], v[72:75], a[128:143]
    v_cvt_pk_bf16_f32 v153, v158, v159
    v_cvt_pk_bf16_f32 v154, v160, v161
    v_mfma_f32_32x32x16_bf16 a[144:159], v[56:59], v[76:79], a[144:159]
    v_cvt_pk_bf16_f32 v155, v162, v163
    buffer_store_dwordx4 v[152:155], v181, s[24:27], s63 offen offset:2048 sc0 sc1
    v_mfma_f32_32x32x16_bf16 a[160:175], v[60:63], v[72:75], a[160:175]
    s_add_u32 m0, s50, 83968
    s_nop 0
    buffer_load_dwordx4 v18, s[36:39], s51 offen lds
    v_accvgpr_read_b32 v168, a88
    v_accvgpr_read_b32 v169, a89
    v_accvgpr_read_b32 v170, a90
    v_mfma_f32_32x32x16_bf16 a[176:191], v[60:63], v[76:79], a[176:191]
    v_accvgpr_read_b32 v171, a91
    v_accvgpr_read_b32 v172, a92
    v_mfma_f32_32x32x16_bf16 a[192:207], v[64:67], v[72:75], a[192:207]
    v_accvgpr_read_b32 v173, a93
    v_accvgpr_read_b32 v174, a94
    v_mfma_f32_32x32x16_bf16 a[208:223], v[64:67], v[76:79], a[208:223]
    v_accvgpr_read_b32 v175, a95
    v_cvt_pk_bf16_f32 v164, v168, v169
    v_mfma_f32_32x32x16_bf16 a[224:239], v[68:71], v[72:75], a[224:239]
    s_add_u32 m0, s50, 84992
    s_nop 0
    buffer_load_dwordx4 v19, s[36:39], s51 offen lds
    v_cvt_pk_bf16_f32 v165, v170, v171
    v_cvt_pk_bf16_f32 v166, v172, v173
    v_mfma_f32_32x32x16_bf16 a[240:255], v[68:71], v[76:79], a[240:255]
    v_cvt_pk_bf16_f32 v167, v174, v175
    buffer_store_dwordx4 v[164:167], v181, s[24:27], s63 offen offset:3072 sc0 sc1
    s_waitcnt lgkmcnt(0)
    s_waitcnt vmcnt(17)
    s_barrier
    v_mfma_f32_32x32x16_bf16 a[128:143], v[80:83], v[96:99], a[128:143]
    v_add_u32 v24, 0, v20
    v_add_u32 v25, 0, v21
    v_add_u32 v26, 0, v22
    v_mfma_f32_32x32x16_bf16 a[144:159], v[80:83], v[100:103], a[144:159]
    v_add_u32 v27, 0, v23
    v_add_u32 v30, 0, v28
    v_add_u32 v31, 0, v29
    s_add_u32 m0, s48, 98304
    s_and_b32 s44, s44, 7
    s_lshl_b32 s49, s44, 7
    s_add_u32 s49, s49, s64
    s_lshl_b32 s51, s44, 19
    s_add_u32 s51, s51, s65
    s_add_u32 s44, s44, 1
    buffer_load_dwordx4 v8, s[16:19], s49 offen lds
    v_mfma_f32_32x32x16_bf16 a[160:175], v[84:87], v[96:99], a[160:175]
    ds_read_b128 v[32:35], v24 offset:0
    ds_read_b128 v[36:39], v24 offset:4096
    ds_read_b128 v[40:43], v24 offset:8192
    v_mfma_f32_32x32x16_bf16 a[176:191], v[84:87], v[100:103], a[176:191]
    ds_read_b128 v[44:47], v24 offset:12288
    ds_read_b64_tr_b16 v[48:49], v30 offset:0
    ds_read_b64_tr_b16 v[50:51], v30 offset:1024
    s_add_u32 m0, s48, 99328
    s_nop 0
    buffer_load_dwordx4 v9, s[16:19], s49 offen lds
    v_mfma_f32_32x32x16_bf16 a[192:207], v[88:91], v[96:99], a[192:207]
    ds_read_b64_tr_b16 v[52:53], v31 offset:0
    ds_read_b64_tr_b16 v[54:55], v31 offset:1024
    ds_read_b128 v[56:59], v25 offset:0
    s_add_u32 s63, s61, 24576
    v_accvgpr_read_b32 v156, a96
    v_accvgpr_read_b32 v157, a97
    v_mfma_f32_32x32x16_bf16 a[208:223], v[88:91], v[100:103], a[208:223]
    ds_read_b128 v[60:63], v25 offset:4096
    ds_read_b128 v[64:67], v25 offset:8192
    ds_read_b128 v[68:71], v25 offset:12288
    s_add_u32 m0, s48, 100352
    s_nop 0
    buffer_load_dwordx4 v10, s[16:19], s49 offen lds
    v_accvgpr_read_b32 v158, a98
    v_accvgpr_read_b32 v159, a99
    v_mfma_f32_32x32x16_bf16 a[224:239], v[92:95], v[96:99], a[224:239]
    ds_read_b64_tr_b16 v[72:73], v30 offset:4096
    ds_read_b64_tr_b16 v[74:75], v30 offset:5120
    ds_read_b64_tr_b16 v[76:77], v31 offset:4096
    v_accvgpr_read_b32 v160, a100
    v_accvgpr_read_b32 v161, a101
    v_mfma_f32_32x32x16_bf16 a[240:255], v[92:95], v[100:103], a[240:255]
    ds_read_b64_tr_b16 v[78:79], v31 offset:5120
    s_add_u32 m0, s48, 101376
    s_nop 0
    buffer_load_dwordx4 v11, s[16:19], s49 offen lds
    v_accvgpr_read_b32 v162, a102
    v_accvgpr_read_b32 v163, a103
    v_mfma_f32_32x32x16_bf16 a[128:143], v[104:107], v[120:123], a[128:143]
    v_cvt_pk_bf16_f32 v152, v156, v157
    v_cvt_pk_bf16_f32 v153, v158, v159
    v_cvt_pk_bf16_f32 v154, v160, v161
    v_mfma_f32_32x32x16_bf16 a[144:159], v[104:107], v[124:127], a[144:159]
    s_add_u32 m0, s48, 102400
    s_nop 0
    buffer_load_dwordx4 v12, s[16:19], s49 offen lds
    v_cvt_pk_bf16_f32 v155, v162, v163
    buffer_store_dwordx4 v[152:155], v181, s[24:27], s63 offen offset:0 sc0 sc1
    v_mfma_f32_32x32x16_bf16 a[160:175], v[108:111], v[120:123], a[160:175]
    v_accvgpr_read_b32 v168, a104
    v_accvgpr_read_b32 v169, a105
    v_mfma_f32_32x32x16_bf16 a[176:191], v[108:111], v[124:127], a[176:191]
    s_add_u32 m0, s48, 103424
    s_nop 0
    buffer_load_dwordx4 v13, s[16:19], s49 offen lds
    v_accvgpr_read_b32 v170, a106
    v_accvgpr_read_b32 v171, a107
    v_mfma_f32_32x32x16_bf16 a[192:207], v[112:115], v[120:123], a[192:207]
    v_accvgpr_read_b32 v172, a108
    v_accvgpr_read_b32 v173, a109
    v_accvgpr_read_b32 v174, a110
    v_mfma_f32_32x32x16_bf16 a[208:223], v[112:115], v[124:127], a[208:223]
    s_add_u32 m0, s48, 104448
    s_nop 0
    buffer_load_dwordx4 v14, s[16:19], s49 offen lds
    v_accvgpr_read_b32 v175, a111
    v_cvt_pk_bf16_f32 v164, v168, v169
    v_mfma_f32_32x32x16_bf16 a[224:239], v[116:119], v[120:123], a[224:239]
    v_cvt_pk_bf16_f32 v165, v170, v171
    v_cvt_pk_bf16_f32 v166, v172, v173
    v_mfma_f32_32x32x16_bf16 a[240:255], v[116:119], v[124:127], a[240:255]
    s_add_u32 m0, s48, 105472
    s_nop 0
    buffer_load_dwordx4 v15, s[16:19], s49 offen lds
    v_cvt_pk_bf16_f32 v167, v174, v175
    buffer_store_dwordx4 v[164:167], v181, s[24:27], s63 offen offset:1024 sc0 sc1
    s_waitcnt lgkmcnt(0)
    v_mfma_f32_32x32x16_bf16 a[128:143], v[32:35], v[48:51], a[128:143]
    ds_read_b128 v[80:83], v26 offset:0
    ds_read_b128 v[84:87], v26 offset:4096
    ds_read_b128 v[88:91], v26 offset:8192
    v_mfma_f32_32x32x16_bf16 a[144:159], v[32:35], v[52:55], a[144:159]
    ds_read_b128 v[92:95], v26 offset:12288
    ds_read_b64_tr_b16 v[96:97], v30 offset:8192
    ds_read_b64_tr_b16 v[98:99], v30 offset:9216
    v_mfma_f32_32x32x16_bf16 a[160:175], v[36:39], v[48:51], a[160:175]
    ds_read_b64_tr_b16 v[100:101], v31 offset:8192
    ds_read_b64_tr_b16 v[102:103], v31 offset:9216
    ds_read_b128 v[104:107], v27 offset:0
    s_add_u32 m0, s50, 131072
    s_nop 0
    buffer_load_dwordx4 v16, s[36:39], s51 offen lds
    v_mfma_f32_32x32x16_bf16 a[176:191], v[36:39], v[52:55], a[176:191]
    ds_read_b128 v[108:111], v27 offset:4096
    ds_read_b128 v[112:115], v27 offset:8192
    ds_read_b128 v[116:119], v27 offset:12288
    v_mfma_f32_32x32x16_bf16 a[192:207], v[40:43], v[48:51], a[192:207]
    ds_read_b64_tr_b16 v[120:121], v30 offset:12288
    ds_read_b64_tr_b16 v[122:123], v30 offset:13312
    ds_read_b64_tr_b16 v[124:125], v31 offset:12288
    v_accvgpr_read_b32 v156, a112
    v_accvgpr_read_b32 v157, a113
    v_accvgpr_read_b32 v158, a114
    v_mfma_f32_32x32x16_bf16 a[208:223], v[40:43], v[52:55], a[208:223]
    ds_read_b64_tr_b16 v[126:127], v31 offset:13312
    v_accvgpr_read_b32 v159, a115
    v_accvgpr_read_b32 v160, a116
    v_mfma_f32_32x32x16_bf16 a[224:239], v[44:47], v[48:51], a[224:239]
    s_add_u32 m0, s50, 132096
    s_nop 0
    buffer_load_dwordx4 v17, s[36:39], s51 offen lds
    v_accvgpr_read_b32 v161, a117
    v_accvgpr_read_b32 v162, a118
    v_mfma_f32_32x32x16_bf16 a[240:255], v[44:47], v[52:55], a[240:255]
    v_accvgpr_read_b32 v163, a119
    v_cvt_pk_bf16_f32 v152, v156, v157
    v_mfma_f32_32x32x16_bf16 a[128:143], v[56:59], v[72:75], a[128:143]
    v_cvt_pk_bf16_f32 v153, v158, v159
    v_cvt_pk_bf16_f32 v154, v160, v161
    v_mfma_f32_32x32x16_bf16 a[144:159], v[56:59], v[76:79], a[144:159]
    v_cvt_pk_bf16_f32 v155, v162, v163
    buffer_store_dwordx4 v[152:155], v181, s[24:27], s63 offen offset:2048 sc0 sc1
    v_mfma_f32_32x32x16_bf16 a[160:175], v[60:63], v[72:75], a[160:175]
    s_add_u32 m0, s50, 133120
    s_nop 0
    buffer_load_dwordx4 v18, s[36:39], s51 offen lds
    v_accvgpr_read_b32 v168, a120
    v_accvgpr_read_b32 v169, a121
    v_accvgpr_read_b32 v170, a122
    v_mfma_f32_32x32x16_bf16 a[176:191], v[60:63], v[76:79], a[176:191]
    v_accvgpr_read_b32 v171, a123
    v_accvgpr_read_b32 v172, a124
    v_mfma_f32_32x32x16_bf16 a[192:207], v[64:67], v[72:75], a[192:207]
    v_accvgpr_read_b32 v173, a125
    v_accvgpr_read_b32 v174, a126
    v_mfma_f32_32x32x16_bf16 a[208:223], v[64:67], v[76:79], a[208:223]
    v_accvgpr_read_b32 v175, a127
    v_cvt_pk_bf16_f32 v164, v168, v169
    v_mfma_f32_32x32x16_bf16 a[224:239], v[68:71], v[72:75], a[224:239]
    s_add_u32 m0, s50, 134144
    s_nop 0
    buffer_load_dwordx4 v19, s[36:39], s51 offen lds
    v_cvt_pk_bf16_f32 v165, v170, v171
    v_cvt_pk_bf16_f32 v166, v172, v173
    v_mfma_f32_32x32x16_bf16 a[240:255], v[68:71], v[76:79], a[240:255]
    v_cvt_pk_bf16_f32 v167, v174, v175
    buffer_store_dwordx4 v[164:167], v181, s[24:27], s63 offen offset:3072 sc0 sc1
    s_waitcnt lgkmcnt(0)
    s_waitcnt vmcnt(17)
    s_barrier
    v_mfma_f32_32x32x16_bf16 a[128:143], v[80:83], v[96:99], a[128:143]
    v_add_u32 v24, 49152, v20
    v_add_u32 v25, 49152, v21
    v_add_u32 v26, 49152, v22
    v_mfma_f32_32x32x16_bf16 a[144:159], v[80:83], v[100:103], a[144:159]
    v_add_u32 v27, 49152, v23
    v_add_u32 v30, 49152, v28
    v_add_u32 v31, 49152, v29
    s_add_u32 m0, s48, 0
    s_and_b32 s44, s44, 7
    s_lshl_b32 s49, s44, 7
    s_add_u32 s49, s49, s64
    s_lshl_b32 s51, s44, 19
    s_add_u32 s51, s51, s65
    s_add_u32 s44, s44, 1
    buffer_load_dwordx4 v8, s[16:19], s49 offen lds
    v_mfma_f32_32x32x16_bf16 a[160:175], v[84:87], v[96:99], a[160:175]
    ds_read_b128 v[32:35], v24 offset:0
    ds_read_b128 v[36:39], v24 offset:4096
    ds_read_b128 v[40:43], v24 offset:8192
    v_mfma_f32_32x32x16_bf16 a[176:191], v[84:87], v[100:103], a[176:191]
    ds_read_b128 v[44:47], v24 offset:12288
    ds_read_b64_tr_b16 v[48:49], v30 offset:0
    ds_read_b64_tr_b16 v[50:51], v30 offset:1024
    s_add_u32 m0, s48, 1024
    s_nop 0
    buffer_load_dwordx4 v9, s[16:19], s49 offen lds
    v_mfma_f32_32x32x16_bf16 a[192:207], v[88:91], v[96:99], a[192:207]
    ds_read_b64_tr_b16 v[52:53], v31 offset:0
    ds_read_b64_tr_b16 v[54:55], v31 offset:1024
    ds_read_b128 v[56:59], v25 offset:0
    v_mfma_f32_32x32x16_bf16 a[208:223], v[88:91], v[100:103], a[208:223]
    ds_read_b128 v[60:63], v25 offset:4096
    ds_read_b128 v[64:67], v25 offset:8192
    ds_read_b128 v[68:71], v25 offset:12288
    s_add_u32 m0, s48, 2048
    s_nop 0
    buffer_load_dwordx4 v10, s[16:19], s49 offen lds
    v_mfma_f32_32x32x16_bf16 a[224:239], v[92:95], v[96:99], a[224:239]
    ds_read_b64_tr_b16 v[72:73], v30 offset:4096
    ds_read_b64_tr_b16 v[74:75], v30 offset:5120
    ds_read_b64_tr_b16 v[76:77], v31 offset:4096
    v_mfma_f32_32x32x16_bf16 a[240:255], v[92:95], v[100:103], a[240:255]
    ds_read_b64_tr_b16 v[78:79], v31 offset:5120
    s_add_u32 m0, s48, 3072
    s_nop 0
    buffer_load_dwordx4 v11, s[16:19], s49 offen lds
    v_mfma_f32_32x32x16_bf16 a[128:143], v[104:107], v[120:123], a[128:143]
    v_mfma_f32_32x32x16_bf16 a[144:159], v[104:107], v[124:127], a[144:159]
    s_add_u32 m0, s48, 4096
    s_nop 0
    buffer_load_dwordx4 v12, s[16:19], s49 offen lds
    v_mfma_f32_32x32x16_bf16 a[160:175], v[108:111], v[120:123], a[160:175]
    v_mfma_f32_32x32x16_bf16 a[176:191], v[108:111], v[124:127], a[176:191]
    s_add_u32 m0, s48, 5120
    s_nop 0
    buffer_load_dwordx4 v13, s[16:19], s49 offen lds
    v_mfma_f32_32x32x16_bf16 a[192:207], v[112:115], v[120:123], a[192:207]
    v_mfma_f32_32x32x16_bf16 a[208:223], v[112:115], v[124:127], a[208:223]
    s_add_u32 m0, s48, 6144
    s_nop 0
    buffer_load_dwordx4 v14, s[16:19], s49 offen lds
    v_mfma_f32_32x32x16_bf16 a[224:239], v[116:119], v[120:123], a[224:239]
    v_mfma_f32_32x32x16_bf16 a[240:255], v[116:119], v[124:127], a[240:255]
    s_add_u32 m0, s48, 7168
    s_nop 0
    buffer_load_dwordx4 v15, s[16:19], s49 offen lds
    s_waitcnt lgkmcnt(0)
    v_mfma_f32_32x32x16_bf16 a[128:143], v[32:35], v[48:51], a[128:143]
    ds_read_b128 v[80:83], v26 offset:0
    ds_read_b128 v[84:87], v26 offset:4096
    ds_read_b128 v[88:91], v26 offset:8192
    v_mfma_f32_32x32x16_bf16 a[144:159], v[32:35], v[52:55], a[144:159]
    ds_read_b128 v[92:95], v26 offset:12288
    ds_read_b64_tr_b16 v[96:97], v30 offset:8192
    ds_read_b64_tr_b16 v[98:99], v30 offset:9216
    v_mfma_f32_32x32x16_bf16 a[160:175], v[36:39], v[48:51], a[160:175]
    ds_read_b64_tr_b16 v[100:101], v31 offset:8192
    ds_read_b64_tr_b16 v[102:103], v31 offset:9216
    ds_read_b128 v[104:107], v27 offset:0
    s_add_u32 m0, s50, 32768
    s_nop 0
    buffer_load_dwordx4 v16, s[36:39], s51 offen lds
    v_mfma_f32_32x32x16_bf16 a[176:191], v[36:39], v[52:55], a[176:191]
    ds_read_b128 v[108:111], v27 offset:4096
    ds_read_b128 v[112:115], v27 offset:8192
    ds_read_b128 v[116:119], v27 offset:12288
    v_mfma_f32_32x32x16_bf16 a[192:207], v[40:43], v[48:51], a[192:207]
    ds_read_b64_tr_b16 v[120:121], v30 offset:12288
    ds_read_b64_tr_b16 v[122:123], v30 offset:13312
    ds_read_b64_tr_b16 v[124:125], v31 offset:12288
    v_mfma_f32_32x32x16_bf16 a[208:223], v[40:43], v[52:55], a[208:223]
    ds_read_b64_tr_b16 v[126:127], v31 offset:13312
    v_mfma_f32_32x32x16_bf16 a[224:239], v[44:47], v[48:51], a[224:239]
    s_add_u32 m0, s50, 33792
    s_nop 0
    buffer_load_dwordx4 v17, s[36:39], s51 offen lds
    v_mfma_f32_32x32x16_bf16 a[240:255], v[44:47], v[52:55], a[240:255]
    v_mfma_f32_32x32x16_bf16 a[128:143], v[56:59], v[72:75], a[128:143]
    v_mfma_f32_32x32x16_bf16 a[144:159], v[56:59], v[76:79], a[144:159]
    v_mfma_f32_32x32x16_bf16 a[160:175], v[60:63], v[72:75], a[160:175]
    s_add_u32 m0, s50, 34816
    s_nop 0
    buffer_load_dwordx4 v18, s[36:39], s51 offen lds
    v_mfma_f32_32x32x16_bf16 a[176:191], v[60:63], v[76:79], a[176:191]
    v_mfma_f32_32x32x16_bf16 a[192:207], v[64:67], v[72:75], a[192:207]
    v_mfma_f32_32x32x16_bf16 a[208:223], v[64:67], v[76:79], a[208:223]
    v_mfma_f32_32x32x16_bf16 a[224:239], v[68:71], v[72:75], a[224:239]
    s_add_u32 m0, s50, 35840
    s_nop 0
    buffer_load_dwordx4 v19, s[36:39], s51 offen lds
    v_mfma_f32_32x32x16_bf16 a[240:255], v[68:71], v[76:79], a[240:255]
    s_waitcnt lgkmcnt(0)
    s_waitcnt vmcnt(13)
    s_barrier
    v_mfma_f32_32x32x16_bf16 a[128:143], v[80:83], v[96:99], a[128:143]
    v_add_u32 v24, 98304, v20
    v_add_u32 v25, 98304, v21
    v_add_u32 v26, 98304, v22
    v_mfma_f32_32x32x16_bf16 a[144:159], v[80:83], v[100:103], a[144:159]
    v_add_u32 v27, 98304, v23
    v_add_u32 v30, 98304, v28
    v_add_u32 v31, 98304, v29
    v_mfma_f32_32x32x16_bf16 a[160:175], v[84:87], v[96:99], a[160:175]
    ds_read_b128 v[32:35], v24 offset:0
    ds_read_b128 v[36:39], v24 offset:4096
    ds_read_b128 v[40:43], v24 offset:8192
    v_mfma_f32_32x32x16_bf16 a[176:191], v[84:87], v[100:103], a[176:191]
    ds_read_b128 v[44:47], v24 offset:12288
    ds_read_b64_tr_b16 v[48:49], v30 offset:0
    ds_read_b64_tr_b16 v[50:51], v30 offset:1024
    v_mfma_f32_32x32x16_bf16 a[192:207], v[88:91], v[96:99], a[192:207]
    ds_read_b64_tr_b16 v[52:53], v31 offset:0
    ds_read_b64_tr_b16 v[54:55], v31 offset:1024
    ds_read_b128 v[56:59], v25 offset:0
    s_lshl_b32 s55, s54, 6
    v_mfma_f32_32x32x16_bf16 a[208:223], v[88:91], v[100:103], a[208:223]
    ds_read_b128 v[60:63], v25 offset:4096
    ds_read_b128 v[64:67], v25 offset:8192
    ds_read_b128 v[68:71], v25 offset:12288
    v_mfma_f32_32x32x16_bf16 a[224:239], v[92:95], v[96:99], a[224:239]
    ds_read_b64_tr_b16 v[72:73], v30 offset:4096
    ds_read_b64_tr_b16 v[74:75], v30 offset:5120
    ds_read_b64_tr_b16 v[76:77], v31 offset:4096
    s_add_u32 s55, s55, 0
    v_mfma_f32_32x32x16_bf16 a[240:255], v[92:95], v[100:103], a[240:255]
    ds_read_b64_tr_b16 v[78:79], v31 offset:5120
    v_mfma_f32_32x32x16_bf16 a[128:143], v[104:107], v[120:123], a[128:143]
    v_add_u32 v179, s55, v178
    v_mfma_f32_32x32x16_bf16 a[144:159], v[104:107], v[124:127], a[144:159]
    v_mfma_f32_32x32x16_bf16 a[160:175], v[108:111], v[120:123], a[160:175]
    v_mfma_f32_32x32x16_bf16 a[176:191], v[108:111], v[124:127], a[176:191]
    v_mul_u32_u24 v179, 128, v179
    v_mfma_f32_32x32x16_bf16 a[192:207], v[112:115], v[120:123], a[192:207]
    v_mfma_f32_32x32x16_bf16 a[208:223], v[112:115], v[124:127], a[208:223]
    buffer_load_dword v177, v179, s[56:59], 0 offen
    v_mfma_f32_32x32x16_bf16 a[224:239], v[116:119], v[120:123], a[224:239]
    v_mfma_f32_32x32x16_bf16 a[240:255], v[116:119], v[124:127], a[240:255]
    s_waitcnt lgkmcnt(0)
    v_mfma_f32_32x32x16_bf16 a[128:143], v[32:35], v[48:51], a[128:143]
    ds_read_b128 v[80:83], v26 offset:0
    ds_read_b128 v[84:87], v26 offset:4096
    ds_read_b128 v[88:91], v26 offset:8192
    v_mfma_f32_32x32x16_bf16 a[144:159], v[32:35], v[52:55], a[144:159]
    ds_read_b128 v[92:95], v26 offset:12288
    ds_read_b64_tr_b16 v[96:97], v30 offset:8192
    ds_read_b64_tr_b16 v[98:99], v30 offset:9216
    v_mfma_f32_32x32x16_bf16 a[160:175], v[36:39], v[48:51], a[160:175]
    ds_read_b64_tr_b16 v[100:101], v31 offset:8192
    ds_read_b64_tr_b16 v[102:103], v31 offset:9216
    ds_read_b128 v[104:107], v27 offset:0
    v_mfma_f32_32x32x16_bf16 a[176:191], v[36:39], v[52:55], a[176:191]
    ds_read_b128 v[108:111], v27 offset:4096
    ds_read_b128 v[112:115], v27 offset:8192
    ds_read_b128 v[116:119], v27 offset:12288
    v_mfma_f32_32x32x16_bf16 a[192:207], v[40:43], v[48:51], a[192:207]
    ds_read_b64_tr_b16 v[120:121], v30 offset:12288
    ds_read_b64_tr_b16 v[122:123], v30 offset:13312
    ds_read_b64_tr_b16 v[124:125], v31 offset:12288
    v_mfma_f32_32x32x16_bf16 a[208:223], v[40:43], v[52:55], a[208:223]
    ds_read_b64_tr_b16 v[126:127], v31 offset:13312
    v_mfma_f32_32x32x16_bf16 a[224:239], v[44:47], v[48:51], a[224:239]
    v_mfma_f32_32x32x16_bf16 a[240:255], v[44:47], v[52:55], a[240:255]
    v_mfma_f32_32x32x16_bf16 a[128:143], v[56:59], v[72:75], a[128:143]
    v_mfma_f32_32x32x16_bf16 a[144:159], v[56:59], v[76:79], a[144:159]
    v_mfma_f32_32x32x16_bf16 a[160:175], v[60:63], v[72:75], a[160:175]
    v_mfma_f32_32x32x16_bf16 a[176:191], v[60:63], v[76:79], a[176:191]
    v_mfma_f32_32x32x16_bf16 a[192:207], v[64:67], v[72:75], a[192:207]
    v_mfma_f32_32x32x16_bf16 a[208:223], v[64:67], v[76:79], a[208:223]
    v_mfma_f32_32x32x16_bf16 a[224:239], v[68:71], v[72:75], a[224:239]
    v_mfma_f32_32x32x16_bf16 a[240:255], v[68:71], v[76:79], a[240:255]
    s_waitcnt lgkmcnt(0)
    s_waitcnt vmcnt(1)
    s_barrier
    v_mfma_f32_32x32x16_bf16 a[128:143], v[80:83], v[96:99], a[128:143]
    v_add_u32 v24, 0, v20
    v_add_u32 v25, 0, v21
    v_add_u32 v26, 0, v22
    v_mfma_f32_32x32x16_bf16 a[144:159], v[80:83], v[100:103], a[144:159]
    v_add_u32 v27, 0, v23
    v_add_u32 v30, 0, v28
    v_add_u32 v31, 0, v29
    v_mfma_f32_32x32x16_bf16 a[160:175], v[84:87], v[96:99], a[160:175]
    ds_read_b128 v[32:35], v24 offset:0
    ds_read_b128 v[36:39], v24 offset:4096
    ds_read_b128 v[40:43], v24 offset:8192
    v_mfma_f32_32x32x16_bf16 a[176:191], v[84:87], v[100:103], a[176:191]
    ds_read_b128 v[44:47], v24 offset:12288
    ds_read_b64_tr_b16 v[48:49], v30 offset:0
    ds_read_b64_tr_b16 v[50:51], v30 offset:1024
    v_mfma_f32_32x32x16_bf16 a[192:207], v[88:91], v[96:99], a[192:207]
    ds_read_b64_tr_b16 v[52:53], v31 offset:0
    ds_read_b64_tr_b16 v[54:55], v31 offset:1024
    ds_read_b128 v[56:59], v25 offset:0
    v_mfma_f32_32x32x16_bf16 a[208:223], v[88:91], v[100:103], a[208:223]
    ds_read_b128 v[60:63], v25 offset:4096
    ds_read_b128 v[64:67], v25 offset:8192
    ds_read_b128 v[68:71], v25 offset:12288
    v_mfma_f32_32x32x16_bf16 a[224:239], v[92:95], v[96:99], a[224:239]
    ds_read_b64_tr_b16 v[72:73], v30 offset:4096
    ds_read_b64_tr_b16 v[74:75], v30 offset:5120
    ds_read_b64_tr_b16 v[76:77], v31 offset:4096
    v_mfma_f32_32x32x16_bf16 a[240:255], v[92:95], v[100:103], a[240:255]
    ds_read_b64_tr_b16 v[78:79], v31 offset:5120
    v_mfma_f32_32x32x16_bf16 a[128:143], v[104:107], v[120:123], a[128:143]
    v_mfma_f32_32x32x16_bf16 a[144:159], v[104:107], v[124:127], a[144:159]
    v_mfma_f32_32x32x16_bf16 a[160:175], v[108:111], v[120:123], a[160:175]
    v_mfma_f32_32x32x16_bf16 a[176:191], v[108:111], v[124:127], a[176:191]
    v_mfma_f32_32x32x16_bf16 a[192:207], v[112:115], v[120:123], a[192:207]
    v_mfma_f32_32x32x16_bf16 a[208:223], v[112:115], v[124:127], a[208:223]
    v_mfma_f32_32x32x16_bf16 a[224:239], v[116:119], v[120:123], a[224:239]
    v_mfma_f32_32x32x16_bf16 a[240:255], v[116:119], v[124:127], a[240:255]
    s_waitcnt lgkmcnt(0)
    v_mfma_f32_32x32x16_bf16 a[128:143], v[32:35], v[48:51], a[128:143]
    ds_read_b128 v[80:83], v26 offset:0
    ds_read_b128 v[84:87], v26 offset:4096
    ds_read_b128 v[88:91], v26 offset:8192
    v_mfma_f32_32x32x16_bf16 a[144:159], v[32:35], v[52:55], a[144:159]
    ds_read_b128 v[92:95], v26 offset:12288
    ds_read_b64_tr_b16 v[96:97], v30 offset:8192
    ds_read_b64_tr_b16 v[98:99], v30 offset:9216
    v_mfma_f32_32x32x16_bf16 a[160:175], v[36:39], v[48:51], a[160:175]
    ds_read_b64_tr_b16 v[100:101], v31 offset:8192
    ds_read_b64_tr_b16 v[102:103], v31 offset:9216
    ds_read_b128 v[104:107], v27 offset:0
    v_mfma_f32_32x32x16_bf16 a[176:191], v[36:39], v[52:55], a[176:191]
    ds_read_b128 v[108:111], v27 offset:4096
    ds_read_b128 v[112:115], v27 offset:8192
    ds_read_b128 v[116:119], v27 offset:12288
    v_mfma_f32_32x32x16_bf16 a[192:207], v[40:43], v[48:51], a[192:207]
    ds_read_b64_tr_b16 v[120:121], v30 offset:12288
    ds_read_b64_tr_b16 v[122:123], v30 offset:13312
    ds_read_b64_tr_b16 v[124:125], v31 offset:12288
    v_mfma_f32_32x32x16_bf16 a[208:223], v[40:43], v[52:55], a[208:223]
    ds_read_b64_tr_b16 v[126:127], v31 offset:13312
    v_mfma_f32_32x32x16_bf16 a[224:239], v[44:47], v[48:51], a[224:239]
    v_mfma_f32_32x32x16_bf16 a[240:255], v[44:47], v[52:55], a[240:255]
    v_mfma_f32_32x32x16_bf16 a[128:143], v[56:59], v[72:75], a[128:143]
    v_mfma_f32_32x32x16_bf16 a[144:159], v[56:59], v[76:79], a[144:159]
    v_mfma_f32_32x32x16_bf16 a[160:175], v[60:63], v[72:75], a[160:175]
    v_mfma_f32_32x32x16_bf16 a[176:191], v[60:63], v[76:79], a[176:191]
    v_mfma_f32_32x32x16_bf16 a[192:207], v[64:67], v[72:75], a[192:207]
    v_mfma_f32_32x32x16_bf16 a[208:223], v[64:67], v[76:79], a[208:223]
    v_mfma_f32_32x32x16_bf16 a[224:239], v[68:71], v[72:75], a[224:239]
    v_mfma_f32_32x32x16_bf16 a[240:255], v[68:71], v[76:79], a[240:255]
    s_waitcnt lgkmcnt(0)
    v_mfma_f32_32x32x16_bf16 a[128:143], v[80:83], v[96:99], a[128:143]
    v_mfma_f32_32x32x16_bf16 a[144:159], v[80:83], v[100:103], a[144:159]
    v_mfma_f32_32x32x16_bf16 a[160:175], v[84:87], v[96:99], a[160:175]
    v_mfma_f32_32x32x16_bf16 a[176:191], v[84:87], v[100:103], a[176:191]
    v_mfma_f32_32x32x16_bf16 a[192:207], v[88:91], v[96:99], a[192:207]
    v_mfma_f32_32x32x16_bf16 a[208:223], v[88:91], v[100:103], a[208:223]
    v_mfma_f32_32x32x16_bf16 a[224:239], v[92:95], v[96:99], a[224:239]
    v_mfma_f32_32x32x16_bf16 a[240:255], v[92:95], v[100:103], a[240:255]
    v_mfma_f32_32x32x16_bf16 a[128:143], v[104:107], v[120:123], a[128:143]
    v_mfma_f32_32x32x16_bf16 a[144:159], v[104:107], v[124:127], a[144:159]
    v_mfma_f32_32x32x16_bf16 a[160:175], v[108:111], v[120:123], a[160:175]
    v_mfma_f32_32x32x16_bf16 a[176:191], v[108:111], v[124:127], a[176:191]
    v_mfma_f32_32x32x16_bf16 a[192:207], v[112:115], v[120:123], a[192:207]
    v_mfma_f32_32x32x16_bf16 a[208:223], v[112:115], v[124:127], a[208:223]
    v_mfma_f32_32x32x16_bf16 a[224:239], v[116:119], v[120:123], a[224:239]
    v_mfma_f32_32x32x16_bf16 a[240:255], v[116:119], v[124:127], a[240:255]
    s_nop 7
    s_nop 7
    s_add_u32 s63, s62, 0
    v_accvgpr_read_b32 v156, a128
    v_accvgpr_read_b32 v157, a129
    v_accvgpr_read_b32 v158, a130
    v_accvgpr_read_b32 v159, a131
    v_accvgpr_read_b32 v160, a132
    v_accvgpr_read_b32 v161, a133
    v_accvgpr_read_b32 v162, a134
    v_accvgpr_read_b32 v163, a135
    v_cvt_pk_bf16_f32 v152, v156, v157
    v_cvt_pk_bf16_f32 v153, v158, v159
    v_cvt_pk_bf16_f32 v154, v160, v161
    v_cvt_pk_bf16_f32 v155, v162, v163
    buffer_store_dwordx4 v[152:155], v176, s[24:27], s63 offen offset:0 sc0 sc1
    v_accvgpr_read_b32 v168, a136
    v_accvgpr_read_b32 v169, a137
    v_accvgpr_read_b32 v170, a138
    v_accvgpr_read_b32 v171, a139
    v_accvgpr_read_b32 v172, a140
    v_accvgpr_read_b32 v173, a141
    v_accvgpr_read_b32 v174, a142
    v_accvgpr_read_b32 v175, a143
    v_cvt_pk_bf16_f32 v164, v168, v169
    v_cvt_pk_bf16_f32 v165, v170, v171
    v_cvt_pk_bf16_f32 v166, v172, v173
    v_cvt_pk_bf16_f32 v167, v174, v175
    buffer_store_dwordx4 v[164:167], v176, s[24:27], s63 offen offset:1024 sc0 sc1
    s_add_u32 s63, s62, 4096
    v_accvgpr_read_b32 v156, a144
    v_accvgpr_read_b32 v157, a145
    v_accvgpr_read_b32 v158, a146
    v_accvgpr_read_b32 v159, a147
    v_accvgpr_read_b32 v160, a148
    v_accvgpr_read_b32 v161, a149
    v_accvgpr_read_b32 v162, a150
    v_accvgpr_read_b32 v163, a151
    v_cvt_pk_bf16_f32 v152, v156, v157
    v_cvt_pk_bf16_f32 v153, v158, v159
    v_cvt_pk_bf16_f32 v154, v160, v161
    v_cvt_pk_bf16_f32 v155, v162, v163
    buffer_store_dwordx4 v[152:155], v176, s[24:27], s63 offen offset:0 sc0 sc1
    v_accvgpr_read_b32 v168, a152
    v_accvgpr_read_b32 v169, a153
    v_accvgpr_read_b32 v170, a154
    v_accvgpr_read_b32 v171, a155
    v_accvgpr_read_b32 v172, a156
    v_accvgpr_read_b32 v173, a157
    v_accvgpr_read_b32 v174, a158
    v_accvgpr_read_b32 v175, a159
    v_cvt_pk_bf16_f32 v164, v168, v169
    v_cvt_pk_bf16_f32 v165, v170, v171
    v_cvt_pk_bf16_f32 v166, v172, v173
    v_cvt_pk_bf16_f32 v167, v174, v175
    buffer_store_dwordx4 v[164:167], v176, s[24:27], s63 offen offset:1024 sc0 sc1
    s_add_u32 s63, s62, 0
    v_accvgpr_read_b32 v156, a160
    v_accvgpr_read_b32 v157, a161
    v_accvgpr_read_b32 v158, a162
    v_accvgpr_read_b32 v159, a163
    v_accvgpr_read_b32 v160, a164
    v_accvgpr_read_b32 v161, a165
    v_accvgpr_read_b32 v162, a166
    v_accvgpr_read_b32 v163, a167
    v_cvt_pk_bf16_f32 v152, v156, v157
    v_cvt_pk_bf16_f32 v153, v158, v159
    v_cvt_pk_bf16_f32 v154, v160, v161
    v_cvt_pk_bf16_f32 v155, v162, v163
    buffer_store_dwordx4 v[152:155], v176, s[24:27], s63 offen offset:2048 sc0 sc1
    v_accvgpr_read_b32 v168, a168
    v_accvgpr_read_b32 v169, a169
    v_accvgpr_read_b32 v170, a170
    v_accvgpr_read_b32 v171, a171
    v_accvgpr_read_b32 v172, a172
    v_accvgpr_read_b32 v173, a173
    v_accvgpr_read_b32 v174, a174
    v_accvgpr_read_b32 v175, a175
    v_cvt_pk_bf16_f32 v164, v168, v169
    v_cvt_pk_bf16_f32 v165, v170, v171
    v_cvt_pk_bf16_f32 v166, v172, v173
    v_cvt_pk_bf16_f32 v167, v174, v175
    buffer_store_dwordx4 v[164:167], v176, s[24:27], s63 offen offset:3072 sc0 sc1
    s_add_u32 s63, s62, 4096
    v_accvgpr_read_b32 v156, a176
    v_accvgpr_read_b32 v157, a177
    v_accvgpr_read_b32 v158, a178
    v_accvgpr_read_b32 v159, a179
    v_accvgpr_read_b32 v160, a180
    v_accvgpr_read_b32 v161, a181
    v_accvgpr_read_b32 v162, a182
    v_accvgpr_read_b32 v163, a183
    v_cvt_pk_bf16_f32 v152, v156, v157
    v_cvt_pk_bf16_f32 v153, v158, v159
    v_cvt_pk_bf16_f32 v154, v160, v161
    v_cvt_pk_bf16_f32 v155, v162, v163
    buffer_store_dwordx4 v[152:155], v176, s[24:27], s63 offen offset:2048 sc0 sc1
    v_accvgpr_read_b32 v168, a184
    v_accvgpr_read_b32 v169, a185
    v_accvgpr_read_b32 v170, a186
    v_accvgpr_read_b32 v171, a187
    v_accvgpr_read_b32 v172, a188
    v_accvgpr_read_b32 v173, a189
    v_accvgpr_read_b32 v174, a190
    v_accvgpr_read_b32 v175, a191
    v_cvt_pk_bf16_f32 v164, v168, v169
    v_cvt_pk_bf16_f32 v165, v170, v171
    v_cvt_pk_bf16_f32 v166, v172, v173
    v_cvt_pk_bf16_f32 v167, v174, v175
    buffer_store_dwordx4 v[164:167], v176, s[24:27], s63 offen offset:3072 sc0 sc1
    s_add_u32 s63, s62, 16384
    v_accvgpr_read_b32 v156, a192
    v_accvgpr_read_b32 v157, a193
    v_accvgpr_read_b32 v158, a194
    v_accvgpr_read_b32 v159, a195
    v_accvgpr_read_b32 v160, a196
    v_accvgpr_read_b32 v161, a197
    v_accvgpr_read_b32 v162, a198
    v_accvgpr_read_b32 v163, a199
    v_cvt_pk_bf16_f32 v152, v156, v157
    v_cvt_pk_bf16_f32 v153, v158, v159
    v_cvt_pk_bf16_f32 v154, v160, v161
    v_cvt_pk_bf16_f32 v155, v162, v163
    buffer_store_dwordx4 v[152:155], v176, s[24:27], s63 offen offset:0 sc0 sc1
    v_accvgpr_read_b32 v168, a200
    v_accvgpr_read_b32 v169, a201
    v_accvgpr_read_b32 v170, a202
    v_accvgpr_read_b32 v171, a203
    v_accvgpr_read_b32 v172, a204
    v_accvgpr_read_b32 v173, a205
    v_accvgpr_read_b32 v174, a206
    v_accvgpr_read_b32 v175, a207
    v_cvt_pk_bf16_f32 v164, v168, v169
    v_cvt_pk_bf16_f32 v165, v170, v171
    v_cvt_pk_bf16_f32 v166, v172, v173
    v_cvt_pk_bf16_f32 v167, v174, v175
    buffer_store_dwordx4 v[164:167], v176, s[24:27], s63 offen offset:1024 sc0 sc1
    s_add_u32 s63, s62, 20480
    v_accvgpr_read_b32 v156, a208
    v_accvgpr_read_b32 v157, a209
    v_accvgpr_read_b32 v158, a210
    v_accvgpr_read_b32 v159, a211
    v_accvgpr_read_b32 v160, a212
    v_accvgpr_read_b32 v161, a213
    v_accvgpr_read_b32 v162, a214
    v_accvgpr_read_b32 v163, a215
    v_cvt_pk_bf16_f32 v152, v156, v157
    v_cvt_pk_bf16_f32 v153, v158, v159
    v_cvt_pk_bf16_f32 v154, v160, v161
    v_cvt_pk_bf16_f32 v155, v162, v163
    buffer_store_dwordx4 v[152:155], v176, s[24:27], s63 offen offset:0 sc0 sc1
    v_accvgpr_read_b32 v168, a216
    v_accvgpr_read_b32 v169, a217
    v_accvgpr_read_b32 v170, a218
    v_accvgpr_read_b32 v171, a219
    v_accvgpr_read_b32 v172, a220
    v_accvgpr_read_b32 v173, a221
    v_accvgpr_read_b32 v174, a222
    v_accvgpr_read_b32 v175, a223
    v_cvt_pk_bf16_f32 v164, v168, v169
    v_cvt_pk_bf16_f32 v165, v170, v171
    v_cvt_pk_bf16_f32 v166, v172, v173
    v_cvt_pk_bf16_f32 v167, v174, v175
    buffer_store_dwordx4 v[164:167], v176, s[24:27], s63 offen offset:1024 sc0 sc1
    s_add_u32 s63, s62, 16384
    v_accvgpr_read_b32 v156, a224
    v_accvgpr_read_b32 v157, a225
    v_accvgpr_read_b32 v158, a226
    v_accvgpr_read_b32 v159, a227
    v_accvgpr_read_b32 v160, a228
    v_accvgpr_read_b32 v161, a229
    v_accvgpr_read_b32 v162, a230
    v_accvgpr_read_b32 v163, a231
    v_cvt_pk_bf16_f32 v152, v156, v157
    v_cvt_pk_bf16_f32 v153, v158, v159
    v_cvt_pk_bf16_f32 v154, v160, v161
    v_cvt_pk_bf16_f32 v155, v162, v163
    buffer_store_dwordx4 v[152:155], v176, s[24:27], s63 offen offset:2048 sc0 sc1
    v_accvgpr_read_b32 v168, a232
    v_accvgpr_read_b32 v169, a233
    v_accvgpr_read_b32 v170, a234
    v_accvgpr_read_b32 v171, a235
    v_accvgpr_read_b32 v172, a236
    v_accvgpr_read_b32 v173, a237
    v_accvgpr_read_b32 v174, a238
    v_accvgpr_read_b32 v175, a239
    v_cvt_pk_bf16_f32 v164, v168, v169
    v_cvt_pk_bf16_f32 v165, v170, v171
    v_cvt_pk_bf16_f32 v166, v172, v173
    v_cvt_pk_bf16_f32 v167, v174, v175
    buffer_store_dwordx4 v[164:167], v176, s[24:27], s63 offen offset:3072 sc0 sc1
    s_add_u32 s63, s62, 20480
    v_accvgpr_read_b32 v156, a240
    v_accvgpr_read_b32 v157, a241
    v_accvgpr_read_b32 v158, a242
    v_accvgpr_read_b32 v159, a243
    v_accvgpr_read_b32 v160, a244
    v_accvgpr_read_b32 v161, a245
    v_accvgpr_read_b32 v162, a246
    v_accvgpr_read_b32 v163, a247
    v_cvt_pk_bf16_f32 v152, v156, v157
    v_cvt_pk_bf16_f32 v153, v158, v159
    v_cvt_pk_bf16_f32 v154, v160, v161
    v_cvt_pk_bf16_f32 v155, v162, v163
    buffer_store_dwordx4 v[152:155], v176, s[24:27], s63 offen offset:2048 sc0 sc1
    v_accvgpr_read_b32 v168, a248
    v_accvgpr_read_b32 v169, a249
    v_accvgpr_read_b32 v170, a250
    v_accvgpr_read_b32 v171, a251
    v_accvgpr_read_b32 v172, a252
    v_accvgpr_read_b32 v173, a253
    v_accvgpr_read_b32 v174, a254
    v_accvgpr_read_b32 v175, a255
    v_cvt_pk_bf16_f32 v164, v168, v169
    v_cvt_pk_bf16_f32 v165, v170, v171
    v_cvt_pk_bf16_f32 v166, v172, v173
    v_cvt_pk_bf16_f32 v167, v174, v175
    buffer_store_dwordx4 v[164:167], v176, s[24:27], s63 offen offset:3072 sc0 sc1
    s_waitcnt vmcnt(0)
Lkv_end:
    s_endpgm
.globl attn_kernel
.p2align 8
.type attn_kernel,@function
attn_kernel:
    s_cmp_ge_u32 s2, 256
    s_cbranch_scc1 Lat_end
    s_load_dwordx2 s[4:5], s[0:1], 16
    s_load_dwordx2 s[12:13], s[0:1], 104
    s_load_dwordx2 s[6:7], s[0:1], 40
    s_load_dwordx2 s[8:9], s[0:1], 56
    s_load_dwordx2 s[10:11], s[0:1], 72
    v_lshrrev_b32 v1, 6, v0
    s_nop 0
    v_readfirstlane_b32 s45, v1
    s_and_b32 s40, s45, 3
    s_and_b32 s41, s2, 7
    s_lshr_b32 s42, s2, 3
    s_and_b32 s43, s42, 3
    s_lshl_b32 s41, s41, 2
    s_add_u32 s41, s41, s43
    s_lshr_b32 s42, s42, 2
    s_sub_u32 s43, 15, s42
    s_mov_b32 s44, 0
    v_and_b32 v1, 63, v0
    v_lshlrev_b32 v8, 4, v1
    s_cmp_ge_u32 s45, 4
    s_cbranch_scc1 Lat_prod
    s_lshl_b32 s60, s40, 13
    s_add_u32 s47, s60, 16384
    v_add_u32 v15, s47, v8
    v_and_b32 v2, 15, v1
    v_bfe_u32 v3, v1, 4, 1
    v_lshrrev_b32 v4, 5, v1
    v_lshlrev_b32 v5, 4, v2
    v_lshl_add_u32 v5, v3, 9, v5
    v_lshl_add_u32 v8, v4, 10, v5
    v_lshl_add_u32 v7, v4, 3, v5
    v_add_u32 v9, 0x10000, v8
    v_add_u32 v14, 0x20000, v8
    s_lshl_b32 s60, s40, 5
    v_add_u32 v2, s60, v2
    v_lshlrev_b32 v3, 2, v3
    v_lshl_add_u32 v3, v4, 4, v3
    v_sub_u32 v10, v2, v3
    s_waitcnt lgkmcnt(0)
    s_add_u32 s32, s12, 46137344
    s_addc_u32 s33, s13, 0
    s_mov_b32 s34, 16777216
    s_mov_b32 s35, 0x00020000
    s_mov_b32 s70, 48.0
    s_mov_b32 s16, s6
    s_mov_b32 s17, s7
    s_mov_b32 s18, 5242880
    s_mov_b32 s19, 0x00020000
    s_mov_b32 s20, s8
    s_mov_b32 s21, s9
    s_mov_b32 s22, 7077888
    s_mov_b32 s23, 0x00020000
    s_mov_b32 s24, s10
    s_mov_b32 s25, s11
    s_mov_b32 s26, 7077888
    s_mov_b32 s27, 0x00020000
    s_lshl_b32 s46, s2, 2
    s_add_u32 s46, s46, s40
    v_and_b32 v1, 63, v0
    v_and_b32 v2, 31, v1
    v_lshrrev_b32 v3, 5, v1
    v_lshrrev_b32 v4, 1, v2
    v_and_b32 v4, 7, v4
    s_mul_i32 s52, s40, 64
    v_add_u32 v2, s52, v2
    v_mul_u32_u24 v2, 128, v2
    v_add_u32 v2, 0, v2
    v_add_u32 v5, 0, v3
    v_xor_b32 v5, v5, v4
    v_lshl_add_u32 v96, v5, 4, v2
    v_add_u32 v5, 2, v3
    v_xor_b32 v5, v5, v4
    v_lshl_add_u32 v97, v5, 4, v2
    v_add_u32 v5, 4, v3
    v_xor_b32 v5, v5, v4
    v_lshl_add_u32 v98, v5, 4, v2
    v_add_u32 v5, 6, v3
    v_xor_b32 v5, v5, v4
    v_lshl_add_u32 v99, v5, 4, v2
    v_bfe_u32 v2, v1, 2, 2
    v_lshrrev_b32 v3, 5, v1
    v_mad_u32_u24 v3, v3, 8, v2
    v_mul_u32_u24 v4, 256, v3
    v_and_b32 v5, 3, v1
    v_lshl_add_u32 v4, v5, 3, v4
    v_bfe_u32 v5, v1, 4, 1
    v_lshl_add_u32 v4, v5, 5, v4
    v_add_u32 v4, 32768, v4
    v_mov_b32 v5, v2
    v_xor_b32 v2, 0, v5
    v_mad_u32_u24 v104, v2, 64, v4
    v_xor_b32 v2, 1, v5
    v_mad_u32_u24 v105, v2, 64, v4
    v_xor_b32 v2, 2, v5
    v_mad_u32_u24 v106, v2, 64, v4
    v_xor_b32 v2, 3, v5
    v_mad_u32_u24 v107, v2, 64, v4
    s_barrier
    v_add_u32 v100, 0, v96
    v_add_u32 v101, 0, v97
    v_add_u32 v102, 0, v98
    v_add_u32 v103, 0, v99
    v_add_u32 v108, 0, v104
    v_add_u32 v109, 0, v105
    v_add_u32 v110, 0, v106
    v_add_u32 v111, 0, v107
    ds_read_b128 a[64:67], v100 offset:0
    ds_read_b128 a[68:71], v100 offset:4096
    ds_read_b64_tr_b16 a[72:73], v108 offset:0
    ds_read_b64_tr_b16 a[74:75], v108 offset:1024
    ds_read_b64_tr_b16 a[76:77], v109 offset:0
    ds_read_b64_tr_b16 a[78:79], v109 offset:1024
    ds_read_b64_tr_b16 a[80:81], v110 offset:0
    ds_read_b64_tr_b16 a[82:83], v110 offset:1024
    ds_read_b64_tr_b16 a[84:85], v111 offset:0
    ds_read_b64_tr_b16 a[86:87], v111 offset:1024
    s_waitcnt lgkmcnt(0)
    v_mfma_f32_32x32x16_bf16 v[16:31], a[72:75], a[64:67], 0
    ds_read_b128 a[88:91], v101 offset:0
    ds_read_b128 a[92:95], v101 offset:4096
    ds_read_b64_tr_b16 a[96:97], v108 offset:4096
    v_mfma_f32_32x32x16_bf16 v[32:47], a[76:79], a[64:67], 0
    ds_read_b64_tr_b16 a[98:99], v108 offset:5120
    ds_read_b64_tr_b16 a[100:101], v109 offset:4096
    ds_read_b64_tr_b16 a[102:103], v109 offset:5120
    v_mfma_f32_32x32x16_bf16 v[48:63], a[80:83], a[64:67], 0
    ds_read_b64_tr_b16 a[104:105], v110 offset:4096
    ds_read_b64_tr_b16 a[106:107], v110 offset:5120
    ds_read_b64_tr_b16 a[108:109], v111 offset:4096
    v_mfma_f32_32x32x16_bf16 v[64:79], a[84:87], a[64:67], 0
    ds_read_b64_tr_b16 a[110:111], v111 offset:5120
    v_mfma_f32_32x32x16_bf16 a[0:15], a[72:75], a[68:71], 0
    v_mfma_f32_32x32x16_bf16 a[16:31], a[76:79], a[68:71], 0
    v_mfma_f32_32x32x16_bf16 a[32:47], a[80:83], a[68:71], 0
    v_mfma_f32_32x32x16_bf16 a[48:63], a[84:87], a[68:71], 0
    s_waitcnt lgkmcnt(0)
    v_mfma_f32_32x32x16_bf16 v[16:31], a[96:99], a[88:91], v[16:31]
    ds_read_b128 a[64:67], v102 offset:0
    ds_read_b128 a[68:71], v102 offset:4096
    ds_read_b64_tr_b16 a[72:73], v108 offset:8192
    v_mfma_f32_32x32x16_bf16 v[32:47], a[100:103], a[88:91], v[32:47]
    ds_read_b64_tr_b16 a[74:75], v108 offset:9216
    ds_read_b64_tr_b16 a[76:77], v109 offset:8192
    ds_read_b64_tr_b16 a[78:79], v109 offset:9216
    v_mfma_f32_32x32x16_bf16 v[48:63], a[104:107], a[88:91], v[48:63]
    ds_read_b64_tr_b16 a[80:81], v110 offset:8192
    ds_read_b64_tr_b16 a[82:83], v110 offset:9216
    ds_read_b64_tr_b16 a[84:85], v111 offset:8192
    v_mfma_f32_32x32x16_bf16 v[64:79], a[108:111], a[88:91], v[64:79]
    ds_read_b64_tr_b16 a[86:87], v111 offset:9216
    v_mfma_f32_32x32x16_bf16 a[0:15], a[96:99], a[92:95], a[0:15]
    v_mfma_f32_32x32x16_bf16 a[16:31], a[100:103], a[92:95], a[16:31]
    v_mfma_f32_32x32x16_bf16 a[32:47], a[104:107], a[92:95], a[32:47]
    v_mfma_f32_32x32x16_bf16 a[48:63], a[108:111], a[92:95], a[48:63]
    s_waitcnt lgkmcnt(0)
    v_mfma_f32_32x32x16_bf16 v[16:31], a[72:75], a[64:67], v[16:31]
    ds_read_b128 a[88:91], v103 offset:0
    ds_read_b128 a[92:95], v103 offset:4096
    ds_read_b64_tr_b16 a[96:97], v108 offset:12288
    v_mfma_f32_32x32x16_bf16 v[32:47], a[76:79], a[64:67], v[32:47]
    ds_read_b64_tr_b16 a[98:99], v108 offset:13312
    ds_read_b64_tr_b16 a[100:101], v109 offset:12288
    ds_read_b64_tr_b16 a[102:103], v109 offset:13312
    v_mfma_f32_32x32x16_bf16 v[48:63], a[80:83], a[64:67], v[48:63]
    ds_read_b64_tr_b16 a[104:105], v110 offset:12288
    ds_read_b64_tr_b16 a[106:107], v110 offset:13312
    ds_read_b64_tr_b16 a[108:109], v111 offset:12288
    v_mfma_f32_32x32x16_bf16 v[64:79], a[84:87], a[64:67], v[64:79]
    ds_read_b64_tr_b16 a[110:111], v111 offset:13312
    v_mfma_f32_32x32x16_bf16 a[0:15], a[72:75], a[68:71], a[0:15]
    v_mfma_f32_32x32x16_bf16 a[16:31], a[76:79], a[68:71], a[16:31]
    v_mfma_f32_32x32x16_bf16 a[32:47], a[80:83], a[68:71], a[32:47]
    v_mfma_f32_32x32x16_bf16 a[48:63], a[84:87], a[68:71], a[48:63]
    s_waitcnt lgkmcnt(0)
    s_barrier
    v_mfma_f32_32x32x16_bf16 v[16:31], a[96:99], a[88:91], v[16:31]
    v_add_u32 v100, 49152, v96
    v_add_u32 v101, 49152, v97
    v_add_u32 v102, 49152, v98
    v_mfma_f32_32x32x16_bf16 v[32:47], a[100:103], a[88:91], v[32:47]
    v_add_u32 v103, 49152, v99
    v_add_u32 v108, 49152, v104
    v_add_u32 v109, 49152, v105
    v_mfma_f32_32x32x16_bf16 v[48:63], a[104:107], a[88:91], v[48:63]
    v_add_u32 v110, 49152, v106
    v_add_u32 v111, 49152, v107
    ds_read_b128 a[64:67], v100 offset:0
    v_mfma_f32_32x32x16_bf16 v[64:79], a[108:111], a[88:91], v[64:79]
    ds_read_b128 a[68:71], v100 offset:4096
    ds_read_b64_tr_b16 a[72:73], v108 offset:0
    ds_read_b64_tr_b16 a[74:75], v108 offset:1024
    v_mfma_f32_32x32x16_bf16 a[0:15], a[96:99], a[92:95], a[0:15]
    ds_read_b64_tr_b16 a[76:77], v109 offset:0
    ds_read_b64_tr_b16 a[78:79], v109 offset:1024
    ds_read_b64_tr_b16 a[80:81], v110 offset:0
    v_mfma_f32_32x32x16_bf16 a[16:31], a[100:103], a[92:95], a[16:31]
    ds_read_b64_tr_b16 a[82:83], v110 offset:1024
    ds_read_b64_tr_b16 a[84:85], v111 offset:0
    ds_read_b64_tr_b16 a[86:87], v111 offset:1024
    v_mfma_f32_32x32x16_bf16 a[32:47], a[104:107], a[92:95], a[32:47]
    v_mfma_f32_32x32x16_bf16 a[48:63], a[108:111], a[92:95], a[48:63]
    s_waitcnt lgkmcnt(0)
    v_mfma_f32_32x32x16_bf16 v[16:31], a[72:75], a[64:67], v[16:31]
    ds_read_b128 a[88:91], v101 offset:0
    ds_read_b128 a[92:95], v101 offset:4096
    ds_read_b64_tr_b16 a[96:97], v108 offset:4096
    v_mfma_f32_32x32x16_bf16 v[32:47], a[76:79], a[64:67], v[32:47]
    ds_read_b64_tr_b16 a[98:99], v108 offset:5120
    ds_read_b64_tr_b16 a[100:101], v109 offset:4096
    ds_read_b64_tr_b16 a[102:103], v109 offset:5120
    v_mfma_f32_32x32x16_bf16 v[48:63], a[80:83], a[64:67], v[48:63]
    ds_read_b64_tr_b16 a[104:105], v110 offset:4096
    ds_read_b64_tr_b16 a[106:107], v110 offset:5120
    ds_read_b64_tr_b16 a[108:109], v111 offset:4096
    v_mfma_f32_32x32x16_bf16 v[64:79], a[84:87], a[64:67], v[64:79]
    ds_read_b64_tr_b16 a[110:111], v111 offset:5120
    v_mfma_f32_32x32x16_bf16 a[0:15], a[72:75], a[68:71], a[0:15]
    v_mfma_f32_32x32x16_bf16 a[16:31], a[76:79], a[68:71], a[16:31]
    v_mfma_f32_32x32x16_bf16 a[32:47], a[80:83], a[68:71], a[32:47]
    v_mfma_f32_32x32x16_bf16 a[48:63], a[84:87], a[68:71], a[48:63]
    s_waitcnt lgkmcnt(0)
    v_mfma_f32_32x32x16_bf16 v[16:31], a[96:99], a[88:91], v[16:31]
    ds_read_b128 a[64:67], v102 offset:0
    ds_read_b128 a[68:71], v102 offset:4096
    ds_read_b64_tr_b16 a[72:73], v108 offset:8192
    v_mfma_f32_32x32x16_bf16 v[32:47], a[100:103], a[88:91], v[32:47]
    ds_read_b64_tr_b16 a[74:75], v108 offset:9216
    ds_read_b64_tr_b16 a[76:77], v109 offset:8192
    ds_read_b64_tr_b16 a[78:79], v109 offset:9216
    v_mfma_f32_32x32x16_bf16 v[48:63], a[104:107], a[88:91], v[48:63]
    ds_read_b64_tr_b16 a[80:81], v110 offset:8192
    ds_read_b64_tr_b16 a[82:83], v110 offset:9216
    ds_read_b64_tr_b16 a[84:85], v111 offset:8192
    v_mfma_f32_32x32x16_bf16 v[64:79], a[108:111], a[88:91], v[64:79]
    ds_read_b64_tr_b16 a[86:87], v111 offset:9216
    v_mfma_f32_32x32x16_bf16 a[0:15], a[96:99], a[92:95], a[0:15]
    v_mfma_f32_32x32x16_bf16 a[16:31], a[100:103], a[92:95], a[16:31]
    v_mfma_f32_32x32x16_bf16 a[32:47], a[104:107], a[92:95], a[32:47]
    v_mfma_f32_32x32x16_bf16 a[48:63], a[108:111], a[92:95], a[48:63]
    s_waitcnt lgkmcnt(0)
    v_mfma_f32_32x32x16_bf16 v[16:31], a[72:75], a[64:67], v[16:31]
    ds_read_b128 a[88:91], v103 offset:0
    ds_read_b128 a[92:95], v103 offset:4096
    ds_read_b64_tr_b16 a[96:97], v108 offset:12288
    v_mfma_f32_32x32x16_bf16 v[32:47], a[76:79], a[64:67], v[32:47]
    ds_read_b64_tr_b16 a[98:99], v108 offset:13312
    ds_read_b64_tr_b16 a[100:101], v109 offset:12288
    ds_read_b64_tr_b16 a[102:103], v109 offset:13312
    v_mfma_f32_32x32x16_bf16 v[48:63], a[80:83], a[64:67], v[48:63]
    ds_read_b64_tr_b16 a[104:105], v110 offset:12288
    ds_read_b64_tr_b16 a[106:107], v110 offset:13312
    ds_read_b64_tr_b16 a[108:109], v111 offset:12288
    v_mfma_f32_32x32x16_bf16 v[64:79], a[84:87], a[64:67], v[64:79]
    ds_read_b64_tr_b16 a[110:111], v111 offset:13312
    v_mfma_f32_32x32x16_bf16 a[0:15], a[72:75], a[68:71], a[0:15]
    v_mfma_f32_32x32x16_bf16 a[16:31], a[76:79], a[68:71], a[16:31]
    v_mfma_f32_32x32x16_bf16 a[32:47], a[80:83], a[68:71], a[32:47]
    v_mfma_f32_32x32x16_bf16 a[48:63], a[84:87], a[68:71], a[48:63]
    s_waitcnt lgkmcnt(0)
    s_barrier
    v_mfma_f32_32x32x16_bf16 v[16:31], a[96:99], a[88:91], v[16:31]
    v_add_u32 v100, 98304, v96
    v_add_u32 v101, 98304, v97
    v_add_u32 v102, 98304, v98
    v_mfma_f32_32x32x16_bf16 v[32:47], a[100:103], a[88:91], v[32:47]
    v_add_u32 v103, 98304, v99
    v_add_u32 v108, 98304, v104
    v_add_u32 v109, 98304, v105
    v_mfma_f32_32x32x16_bf16 v[48:63], a[104:107], a[88:91], v[48:63]
    v_add_u32 v110, 98304, v106
    v_add_u32 v111, 98304, v107
    ds_read_b128 a[64:67], v100 offset:0
    v_mfma_f32_32x32x16_bf16 v[64:79], a[108:111], a[88:91], v[64:79]
    ds_read_b128 a[68:71], v100 offset:4096
    ds_read_b64_tr_b16 a[72:73], v108 offset:0
    ds_read_b64_tr_b16 a[74:75], v108 offset:1024
    v_mfma_f32_32x32x16_bf16 a[0:15], a[96:99], a[92:95], a[0:15]
    ds_read_b64_tr_b16 a[76:77], v109 offset:0
    ds_read_b64_tr_b16 a[78:79], v109 offset:1024
    ds_read_b64_tr_b16 a[80:81], v110 offset:0
    v_mfma_f32_32x32x16_bf16 a[16:31], a[100:103], a[92:95], a[16:31]
    ds_read_b64_tr_b16 a[82:83], v110 offset:1024
    ds_read_b64_tr_b16 a[84:85], v111 offset:0
    ds_read_b64_tr_b16 a[86:87], v111 offset:1024
    v_mfma_f32_32x32x16_bf16 a[32:47], a[104:107], a[92:95], a[32:47]
    v_mfma_f32_32x32x16_bf16 a[48:63], a[108:111], a[92:95], a[48:63]
    s_waitcnt lgkmcnt(0)
    v_mfma_f32_32x32x16_bf16 v[16:31], a[72:75], a[64:67], v[16:31]
    ds_read_b128 a[88:91], v101 offset:0
    ds_read_b128 a[92:95], v101 offset:4096
    ds_read_b64_tr_b16 a[96:97], v108 offset:4096
    v_mfma_f32_32x32x16_bf16 v[32:47], a[76:79], a[64:67], v[32:47]
    ds_read_b64_tr_b16 a[98:99], v108 offset:5120
    ds_read_b64_tr_b16 a[100:101], v109 offset:4096
    ds_read_b64_tr_b16 a[102:103], v109 offset:5120
    v_mfma_f32_32x32x16_bf16 v[48:63], a[80:83], a[64:67], v[48:63]
    ds_read_b64_tr_b16 a[104:105], v110 offset:4096
    ds_read_b64_tr_b16 a[106:107], v110 offset:5120
    ds_read_b64_tr_b16 a[108:109], v111 offset:4096
    v_mfma_f32_32x32x16_bf16 v[64:79], a[84:87], a[64:67], v[64:79]
    ds_read_b64_tr_b16 a[110:111], v111 offset:5120
    v_mfma_f32_32x32x16_bf16 a[0:15], a[72:75], a[68:71], a[0:15]
    v_mfma_f32_32x32x16_bf16 a[16:31], a[76:79], a[68:71], a[16:31]
    v_mfma_f32_32x32x16_bf16 a[32:47], a[80:83], a[68:71], a[32:47]
    v_mfma_f32_32x32x16_bf16 a[48:63], a[84:87], a[68:71], a[48:63]
    s_waitcnt lgkmcnt(0)
    v_mfma_f32_32x32x16_bf16 v[16:31], a[96:99], a[88:91], v[16:31]
    ds_read_b128 a[64:67], v102 offset:0
    ds_read_b128 a[68:71], v102 offset:4096
    ds_read_b64_tr_b16 a[72:73], v108 offset:8192
    v_mfma_f32_32x32x16_bf16 v[32:47], a[100:103], a[88:91], v[32:47]
    ds_read_b64_tr_b16 a[74:75], v108 offset:9216
    ds_read_b64_tr_b16 a[76:77], v109 offset:8192
    ds_read_b64_tr_b16 a[78:79], v109 offset:9216
    v_mfma_f32_32x32x16_bf16 v[48:63], a[104:107], a[88:91], v[48:63]
    ds_read_b64_tr_b16 a[80:81], v110 offset:8192
    ds_read_b64_tr_b16 a[82:83], v110 offset:9216
    ds_read_b64_tr_b16 a[84:85], v111 offset:8192
    v_mfma_f32_32x32x16_bf16 v[64:79], a[108:111], a[88:91], v[64:79]
    ds_read_b64_tr_b16 a[86:87], v111 offset:9216
    v_mfma_f32_32x32x16_bf16 a[0:15], a[96:99], a[92:95], a[0:15]
    v_mfma_f32_32x32x16_bf16 a[16:31], a[100:103], a[92:95], a[16:31]
    v_mfma_f32_32x32x16_bf16 a[32:47], a[104:107], a[92:95], a[32:47]
    v_mfma_f32_32x32x16_bf16 a[48:63], a[108:111], a[92:95], a[48:63]
    s_waitcnt lgkmcnt(0)
    v_mfma_f32_32x32x16_bf16 v[16:31], a[72:75], a[64:67], v[16:31]
    ds_read_b128 a[88:91], v103 offset:0
    ds_read_b128 a[92:95], v103 offset:4096
    ds_read_b64_tr_b16 a[96:97], v108 offset:12288
    v_mfma_f32_32x32x16_bf16 v[32:47], a[76:79], a[64:67], v[32:47]
    ds_read_b64_tr_b16 a[98:99], v108 offset:13312
    ds_read_b64_tr_b16 a[100:101], v109 offset:12288
    ds_read_b64_tr_b16 a[102:103], v109 offset:13312
    v_mfma_f32_32x32x16_bf16 v[48:63], a[80:83], a[64:67], v[48:63]
    ds_read_b64_tr_b16 a[104:105], v110 offset:12288
    ds_read_b64_tr_b16 a[106:107], v110 offset:13312
    ds_read_b64_tr_b16 a[108:109], v111 offset:12288
    v_mfma_f32_32x32x16_bf16 v[64:79], a[84:87], a[64:67], v[64:79]
    ds_read_b64_tr_b16 a[110:111], v111 offset:13312
    v_mfma_f32_32x32x16_bf16 a[0:15], a[72:75], a[68:71], a[0:15]
    v_mfma_f32_32x32x16_bf16 a[16:31], a[76:79], a[68:71], a[16:31]
    v_mfma_f32_32x32x16_bf16 a[32:47], a[80:83], a[68:71], a[32:47]
    v_mfma_f32_32x32x16_bf16 a[48:63], a[84:87], a[68:71], a[48:63]
    s_waitcnt lgkmcnt(0)
    s_barrier
    v_mfma_f32_32x32x16_bf16 v[16:31], a[96:99], a[88:91], v[16:31]
    v_add_u32 v100, 0, v96
    v_add_u32 v101, 0, v97
    v_add_u32 v102, 0, v98
    v_mfma_f32_32x32x16_bf16 v[32:47], a[100:103], a[88:91], v[32:47]
    v_add_u32 v103, 0, v99
    v_add_u32 v108, 0, v104
    v_add_u32 v109, 0, v105
    v_mfma_f32_32x32x16_bf16 v[48:63], a[104:107], a[88:91], v[48:63]
    v_add_u32 v110, 0, v106
    v_add_u32 v111, 0, v107
    ds_read_b128 a[64:67], v100 offset:0
    v_mfma_f32_32x32x16_bf16 v[64:79], a[108:111], a[88:91], v[64:79]
    ds_read_b128 a[68:71], v100 offset:4096
    ds_read_b64_tr_b16 a[72:73], v108 offset:0
    ds_read_b64_tr_b16 a[74:75], v108 offset:1024
    v_mfma_f32_32x32x16_bf16 a[0:15], a[96:99], a[92:95], a[0:15]
    ds_read_b64_tr_b16 a[76:77], v109 offset:0
    ds_read_b64_tr_b16 a[78:79], v109 offset:1024
    ds_read_b64_tr_b16 a[80:81], v110 offset:0
    v_mfma_f32_32x32x16_bf16 a[16:31], a[100:103], a[92:95], a[16:31]
    ds_read_b64_tr_b16 a[82:83], v110 offset:1024
    ds_read_b64_tr_b16 a[84:85], v111 offset:0
    ds_read_b64_tr_b16 a[86:87], v111 offset:1024
    v_mfma_f32_32x32x16_bf16 a[32:47], a[104:107], a[92:95], a[32:47]
    v_mfma_f32_32x32x16_bf16 a[48:63], a[108:111], a[92:95], a[48:63]
    s_waitcnt lgkmcnt(0)
    v_mfma_f32_32x32x16_bf16 v[16:31], a[72:75], a[64:67], v[16:31]
    ds_read_b128 a[88:91], v101 offset:0
    ds_read_b128 a[92:95], v101 offset:4096
    ds_read_b64_tr_b16 a[96:97], v108 offset:4096
    v_mfma_f32_32x32x16_bf16 v[32:47], a[76:79], a[64:67], v[32:47]
    ds_read_b64_tr_b16 a[98:99], v108 offset:5120
    ds_read_b64_tr_b16 a[100:101], v109 offset:4096
    ds_read_b64_tr_b16 a[102:103], v109 offset:5120
    v_mfma_f32_32x32x16_bf16 v[48:63], a[80:83], a[64:67], v[48:63]
    ds_read_b64_tr_b16 a[104:105], v110 offset:4096
    ds_read_b64_tr_b16 a[106:107], v110 offset:5120
    ds_read_b64_tr_b16 a[108:109], v111 offset:4096
    v_mfma_f32_32x32x16_bf16 v[64:79], a[84:87], a[64:67], v[64:79]
    ds_read_b64_tr_b16 a[110:111], v111 offset:5120
    v_mfma_f32_32x32x16_bf16 a[0:15], a[72:75], a[68:71], a[0:15]
    v_mfma_f32_32x32x16_bf16 a[16:31], a[76:79], a[68:71], a[16:31]
    v_mfma_f32_32x32x16_bf16 a[32:47], a[80:83], a[68:71], a[32:47]
    v_mfma_f32_32x32x16_bf16 a[48:63], a[84:87], a[68:71], a[48:63]
    s_waitcnt lgkmcnt(0)
    v_mfma_f32_32x32x16_bf16 v[16:31], a[96:99], a[88:91], v[16:31]
    ds_read_b128 a[64:67], v102 offset:0
    ds_read_b128 a[68:71], v102 offset:4096
    ds_read_b64_tr_b16 a[72:73], v108 offset:8192
    v_mfma_f32_32x32x16_bf16 v[32:47], a[100:103], a[88:91], v[32:47]
    ds_read_b64_tr_b16 a[74:75], v108 offset:9216
    ds_read_b64_tr_b16 a[76:77], v109 offset:8192
    ds_read_b64_tr_b16 a[78:79], v109 offset:9216
    v_mfma_f32_32x32x16_bf16 v[48:63], a[104:107], a[88:91], v[48:63]
    ds_read_b64_tr_b16 a[80:81], v110 offset:8192
    ds_read_b64_tr_b16 a[82:83], v110 offset:9216
    ds_read_b64_tr_b16 a[84:85], v111 offset:8192
    v_mfma_f32_32x32x16_bf16 v[64:79], a[108:111], a[88:91], v[64:79]
    ds_read_b64_tr_b16 a[86:87], v111 offset:9216
    v_mfma_f32_32x32x16_bf16 a[0:15], a[96:99], a[92:95], a[0:15]
    v_mfma_f32_32x32x16_bf16 a[16:31], a[100:103], a[92:95], a[16:31]
    v_mfma_f32_32x32x16_bf16 a[32:47], a[104:107], a[92:95], a[32:47]
    v_mfma_f32_32x32x16_bf16 a[48:63], a[108:111], a[92:95], a[48:63]
    s_waitcnt lgkmcnt(0)
    v_mfma_f32_32x32x16_bf16 v[16:31], a[72:75], a[64:67], v[16:31]
    ds_read_b128 a[88:91], v103 offset:0
    ds_read_b128 a[92:95], v103 offset:4096
    ds_read_b64_tr_b16 a[96:97], v108 offset:12288
    v_mfma_f32_32x32x16_bf16 v[32:47], a[76:79], a[64:67], v[32:47]
    ds_read_b64_tr_b16 a[98:99], v108 offset:13312
    ds_read_b64_tr_b16 a[100:101], v109 offset:12288
    ds_read_b64_tr_b16 a[102:103], v109 offset:13312
    v_mfma_f32_32x32x16_bf16 v[48:63], a[80:83], a[64:67], v[48:63]
    ds_read_b64_tr_b16 a[104:105], v110 offset:12288
    ds_read_b64_tr_b16 a[106:107], v110 offset:13312
    ds_read_b64_tr_b16 a[108:109], v111 offset:12288
    v_mfma_f32_32x32x16_bf16 v[64:79], a[84:87], a[64:67], v[64:79]
    ds_read_b64_tr_b16 a[110:111], v111 offset:13312
    v_mfma_f32_32x32x16_bf16 a[0:15], a[72:75], a[68:71], a[0:15]
    v_mfma_f32_32x32x16_bf16 a[16:31], a[76:79], a[68:71], a[16:31]
    v_mfma_f32_32x32x16_bf16 a[32:47], a[80:83], a[68:71], a[32:47]
    v_mfma_f32_32x32x16_bf16 a[48:63], a[84:87], a[68:71], a[48:63]
    s_waitcnt lgkmcnt(0)
    s_barrier
    v_mfma_f32_32x32x16_bf16 v[16:31], a[96:99], a[88:91], v[16:31]
    v_add_u32 v100, 49152, v96
    v_add_u32 v101, 49152, v97
    v_add_u32 v102, 49152, v98
    v_mfma_f32_32x32x16_bf16 v[32:47], a[100:103], a[88:91], v[32:47]
    v_add_u32 v103, 49152, v99
    v_add_u32 v108, 49152, v104
    v_add_u32 v109, 49152, v105
    v_mfma_f32_32x32x16_bf16 v[48:63], a[104:107], a[88:91], v[48:63]
    v_add_u32 v110, 49152, v106
    v_add_u32 v111, 49152, v107
    ds_read_b128 a[64:67], v100 offset:0
    v_mfma_f32_32x32x16_bf16 v[64:79], a[108:111], a[88:91], v[64:79]
    ds_read_b128 a[68:71], v100 offset:4096
    ds_read_b64_tr_b16 a[72:73], v108 offset:0
    ds_read_b64_tr_b16 a[74:75], v108 offset:1024
    v_mfma_f32_32x32x16_bf16 a[0:15], a[96:99], a[92:95], a[0:15]
    ds_read_b64_tr_b16 a[76:77], v109 offset:0
    ds_read_b64_tr_b16 a[78:79], v109 offset:1024
    ds_read_b64_tr_b16 a[80:81], v110 offset:0
    v_mfma_f32_32x32x16_bf16 a[16:31], a[100:103], a[92:95], a[16:31]
    ds_read_b64_tr_b16 a[82:83], v110 offset:1024
    ds_read_b64_tr_b16 a[84:85], v111 offset:0
    ds_read_b64_tr_b16 a[86:87], v111 offset:1024
    v_mfma_f32_32x32x16_bf16 a[32:47], a[104:107], a[92:95], a[32:47]
    v_mfma_f32_32x32x16_bf16 a[48:63], a[108:111], a[92:95], a[48:63]
    s_waitcnt lgkmcnt(0)
    v_mfma_f32_32x32x16_bf16 v[16:31], a[72:75], a[64:67], v[16:31]
    ds_read_b128 a[88:91], v101 offset:0
    ds_read_b128 a[92:95], v101 offset:4096
    ds_read_b64_tr_b16 a[96:97], v108 offset:4096
    v_mfma_f32_32x32x16_bf16 v[32:47], a[76:79], a[64:67], v[32:47]
    ds_read_b64_tr_b16 a[98:99], v108 offset:5120
    ds_read_b64_tr_b16 a[100:101], v109 offset:4096
    ds_read_b64_tr_b16 a[102:103], v109 offset:5120
    v_mfma_f32_32x32x16_bf16 v[48:63], a[80:83], a[64:67], v[48:63]
    ds_read_b64_tr_b16 a[104:105], v110 offset:4096
    ds_read_b64_tr_b16 a[106:107], v110 offset:5120
    ds_read_b64_tr_b16 a[108:109], v111 offset:4096
    v_mfma_f32_32x32x16_bf16 v[64:79], a[84:87], a[64:67], v[64:79]
    ds_read_b64_tr_b16 a[110:111], v111 offset:5120
    v_mfma_f32_32x32x16_bf16 a[0:15], a[72:75], a[68:71], a[0:15]
    v_mfma_f32_32x32x16_bf16 a[16:31], a[76:79], a[68:71], a[16:31]
    v_mfma_f32_32x32x16_bf16 a[32:47], a[80:83], a[68:71], a[32:47]
    v_mfma_f32_32x32x16_bf16 a[48:63], a[84:87], a[68:71], a[48:63]
    s_waitcnt lgkmcnt(0)
    v_mfma_f32_32x32x16_bf16 v[16:31], a[96:99], a[88:91], v[16:31]
    ds_read_b128 a[64:67], v102 offset:0
    ds_read_b128 a[68:71], v102 offset:4096
    ds_read_b64_tr_b16 a[72:73], v108 offset:8192
    v_mfma_f32_32x32x16_bf16 v[32:47], a[100:103], a[88:91], v[32:47]
    ds_read_b64_tr_b16 a[74:75], v108 offset:9216
    ds_read_b64_tr_b16 a[76:77], v109 offset:8192
    ds_read_b64_tr_b16 a[78:79], v109 offset:9216
    v_mfma_f32_32x32x16_bf16 v[48:63], a[104:107], a[88:91], v[48:63]
    ds_read_b64_tr_b16 a[80:81], v110 offset:8192
    ds_read_b64_tr_b16 a[82:83], v110 offset:9216
    ds_read_b64_tr_b16 a[84:85], v111 offset:8192
    v_mfma_f32_32x32x16_bf16 v[64:79], a[108:111], a[88:91], v[64:79]
    ds_read_b64_tr_b16 a[86:87], v111 offset:9216
    v_mfma_f32_32x32x16_bf16 a[0:15], a[96:99], a[92:95], a[0:15]
    v_mfma_f32_32x32x16_bf16 a[16:31], a[100:103], a[92:95], a[16:31]
    v_mfma_f32_32x32x16_bf16 a[32:47], a[104:107], a[92:95], a[32:47]
    v_mfma_f32_32x32x16_bf16 a[48:63], a[108:111], a[92:95], a[48:63]
    s_waitcnt lgkmcnt(0)
    v_mfma_f32_32x32x16_bf16 v[16:31], a[72:75], a[64:67], v[16:31]
    ds_read_b128 a[88:91], v103 offset:0
    ds_read_b128 a[92:95], v103 offset:4096
    ds_read_b64_tr_b16 a[96:97], v108 offset:12288
    v_mfma_f32_32x32x16_bf16 v[32:47], a[76:79], a[64:67], v[32:47]
    ds_read_b64_tr_b16 a[98:99], v108 offset:13312
    ds_read_b64_tr_b16 a[100:101], v109 offset:12288
    ds_read_b64_tr_b16 a[102:103], v109 offset:13312
    v_mfma_f32_32x32x16_bf16 v[48:63], a[80:83], a[64:67], v[48:63]
    ds_read_b64_tr_b16 a[104:105], v110 offset:12288
    ds_read_b64_tr_b16 a[106:107], v110 offset:13312
    ds_read_b64_tr_b16 a[108:109], v111 offset:12288
    v_mfma_f32_32x32x16_bf16 v[64:79], a[84:87], a[64:67], v[64:79]
    ds_read_b64_tr_b16 a[110:111], v111 offset:13312
    v_mfma_f32_32x32x16_bf16 a[0:15], a[72:75], a[68:71], a[0:15]
    v_mfma_f32_32x32x16_bf16 a[16:31], a[76:79], a[68:71], a[16:31]
    v_mfma_f32_32x32x16_bf16 a[32:47], a[80:83], a[68:71], a[32:47]
    v_mfma_f32_32x32x16_bf16 a[48:63], a[84:87], a[68:71], a[48:63]
    s_waitcnt lgkmcnt(0)
    s_barrier
    v_mfma_f32_32x32x16_bf16 v[16:31], a[96:99], a[88:91], v[16:31]
    v_add_u32 v100, 98304, v96
    v_add_u32 v101, 98304, v97
    v_add_u32 v102, 98304, v98
    v_mfma_f32_32x32x16_bf16 v[32:47], a[100:103], a[88:91], v[32:47]
    v_add_u32 v103, 98304, v99
    v_add_u32 v108, 98304, v104
    v_add_u32 v109, 98304, v105
    v_mfma_f32_32x32x16_bf16 v[48:63], a[104:107], a[88:91], v[48:63]
    v_add_u32 v110, 98304, v106
    v_add_u32 v111, 98304, v107
    ds_read_b128 a[64:67], v100 offset:0
    v_mfma_f32_32x32x16_bf16 v[64:79], a[108:111], a[88:91], v[64:79]
    ds_read_b128 a[68:71], v100 offset:4096
    ds_read_b64_tr_b16 a[72:73], v108 offset:0
    ds_read_b64_tr_b16 a[74:75], v108 offset:1024
    v_mfma_f32_32x32x16_bf16 a[0:15], a[96:99], a[92:95], a[0:15]
    ds_read_b64_tr_b16 a[76:77], v109 offset:0
    ds_read_b64_tr_b16 a[78:79], v109 offset:1024
    ds_read_b64_tr_b16 a[80:81], v110 offset:0
    v_mfma_f32_32x32x16_bf16 a[16:31], a[100:103], a[92:95], a[16:31]
    ds_read_b64_tr_b16 a[82:83], v110 offset:1024
    ds_read_b64_tr_b16 a[84:85], v111 offset:0
    ds_read_b64_tr_b16 a[86:87], v111 offset:1024
    v_mfma_f32_32x32x16_bf16 a[32:47], a[104:107], a[92:95], a[32:47]
    v_mfma_f32_32x32x16_bf16 a[48:63], a[108:111], a[92:95], a[48:63]
    s_waitcnt lgkmcnt(0)
    v_mfma_f32_32x32x16_bf16 v[16:31], a[72:75], a[64:67], v[16:31]
    ds_read_b128 a[88:91], v101 offset:0
    ds_read_b128 a[92:95], v101 offset:4096
    ds_read_b64_tr_b16 a[96:97], v108 offset:4096
    v_mfma_f32_32x32x16_bf16 v[32:47], a[76:79], a[64:67], v[32:47]
    ds_read_b64_tr_b16 a[98:99], v108 offset:5120
    ds_read_b64_tr_b16 a[100:101], v109 offset:4096
    ds_read_b64_tr_b16 a[102:103], v109 offset:5120
    v_mfma_f32_32x32x16_bf16 v[48:63], a[80:83], a[64:67], v[48:63]
    ds_read_b64_tr_b16 a[104:105], v110 offset:4096
    ds_read_b64_tr_b16 a[106:107], v110 offset:5120
    ds_read_b64_tr_b16 a[108:109], v111 offset:4096
    v_mfma_f32_32x32x16_bf16 v[64:79], a[84:87], a[64:67], v[64:79]
    ds_read_b64_tr_b16 a[110:111], v111 offset:5120
    v_mfma_f32_32x32x16_bf16 a[0:15], a[72:75], a[68:71], a[0:15]
    v_mfma_f32_32x32x16_bf16 a[16:31], a[76:79], a[68:71], a[16:31]
    v_mfma_f32_32x32x16_bf16 a[32:47], a[80:83], a[68:71], a[32:47]
    v_mfma_f32_32x32x16_bf16 a[48:63], a[84:87], a[68:71], a[48:63]
    s_waitcnt lgkmcnt(0)
    v_mfma_f32_32x32x16_bf16 v[16:31], a[96:99], a[88:91], v[16:31]
    ds_read_b128 a[64:67], v102 offset:0
    ds_read_b128 a[68:71], v102 offset:4096
    ds_read_b64_tr_b16 a[72:73], v108 offset:8192
    v_mfma_f32_32x32x16_bf16 v[32:47], a[100:103], a[88:91], v[32:47]
    ds_read_b64_tr_b16 a[74:75], v108 offset:9216
    ds_read_b64_tr_b16 a[76:77], v109 offset:8192
    ds_read_b64_tr_b16 a[78:79], v109 offset:9216
    v_mfma_f32_32x32x16_bf16 v[48:63], a[104:107], a[88:91], v[48:63]
    ds_read_b64_tr_b16 a[80:81], v110 offset:8192
    ds_read_b64_tr_b16 a[82:83], v110 offset:9216
    ds_read_b64_tr_b16 a[84:85], v111 offset:8192
    v_mfma_f32_32x32x16_bf16 v[64:79], a[108:111], a[88:91], v[64:79]
    ds_read_b64_tr_b16 a[86:87], v111 offset:9216
    v_mfma_f32_32x32x16_bf16 a[0:15], a[96:99], a[92:95], a[0:15]
    v_mfma_f32_32x32x16_bf16 a[16:31], a[100:103], a[92:95], a[16:31]
    v_mfma_f32_32x32x16_bf16 a[32:47], a[104:107], a[92:95], a[32:47]
    v_mfma_f32_32x32x16_bf16 a[48:63], a[108:111], a[92:95], a[48:63]
    s_waitcnt lgkmcnt(0)
    v_mfma_f32_32x32x16_bf16 v[16:31], a[72:75], a[64:67], v[16:31]
    ds_read_b128 a[88:91], v103 offset:0
    ds_read_b128 a[92:95], v103 offset:4096
    ds_read_b64_tr_b16 a[96:97], v108 offset:12288
    v_mfma_f32_32x32x16_bf16 v[32:47], a[76:79], a[64:67], v[32:47]
    ds_read_b64_tr_b16 a[98:99], v108 offset:13312
    ds_read_b64_tr_b16 a[100:101], v109 offset:12288
    ds_read_b64_tr_b16 a[102:103], v109 offset:13312
    v_mfma_f32_32x32x16_bf16 v[48:63], a[80:83], a[64:67], v[48:63]
    ds_read_b64_tr_b16 a[104:105], v110 offset:12288
    ds_read_b64_tr_b16 a[106:107], v110 offset:13312
    ds_read_b64_tr_b16 a[108:109], v111 offset:12288
    v_mfma_f32_32x32x16_bf16 v[64:79], a[84:87], a[64:67], v[64:79]
    ds_read_b64_tr_b16 a[110:111], v111 offset:13312
    v_mfma_f32_32x32x16_bf16 a[0:15], a[72:75], a[68:71], a[0:15]
    v_mfma_f32_32x32x16_bf16 a[16:31], a[76:79], a[68:71], a[16:31]
    v_mfma_f32_32x32x16_bf16 a[32:47], a[80:83], a[68:71], a[32:47]
    v_mfma_f32_32x32x16_bf16 a[48:63], a[84:87], a[68:71], a[48:63]
    s_waitcnt lgkmcnt(0)
    s_barrier
    v_mfma_f32_32x32x16_bf16 v[16:31], a[96:99], a[88:91], v[16:31]
    v_add_u32 v100, 0, v96
    v_add_u32 v101, 0, v97
    v_add_u32 v102, 0, v98
    v_mfma_f32_32x32x16_bf16 v[32:47], a[100:103], a[88:91], v[32:47]
    v_add_u32 v103, 0, v99
    v_add_u32 v108, 0, v104
    v_add_u32 v109, 0, v105
    v_mfma_f32_32x32x16_bf16 v[48:63], a[104:107], a[88:91], v[48:63]
    v_add_u32 v110, 0, v106
    v_add_u32 v111, 0, v107
    ds_read_b128 a[64:67], v100 offset:0
    v_mfma_f32_32x32x16_bf16 v[64:79], a[108:111], a[88:91], v[64:79]
    ds_read_b128 a[68:71], v100 offset:4096
    ds_read_b64_tr_b16 a[72:73], v108 offset:0
    ds_read_b64_tr_b16 a[74:75], v108 offset:1024
    v_mfma_f32_32x32x16_bf16 a[0:15], a[96:99], a[92:95], a[0:15]
    ds_read_b64_tr_b16 a[76:77], v109 offset:0
    ds_read_b64_tr_b16 a[78:79], v109 offset:1024
    ds_read_b64_tr_b16 a[80:81], v110 offset:0
    v_mfma_f32_32x32x16_bf16 a[16:31], a[100:103], a[92:95], a[16:31]
    ds_read_b64_tr_b16 a[82:83], v110 offset:1024
    ds_read_b64_tr_b16 a[84:85], v111 offset:0
    ds_read_b64_tr_b16 a[86:87], v111 offset:1024
    v_mfma_f32_32x32x16_bf16 a[32:47], a[104:107], a[92:95], a[32:47]
    v_mfma_f32_32x32x16_bf16 a[48:63], a[108:111], a[92:95], a[48:63]
    s_waitcnt lgkmcnt(0)
    v_mfma_f32_32x32x16_bf16 v[16:31], a[72:75], a[64:67], v[16:31]
    ds_read_b128 a[88:91], v101 offset:0
    ds_read_b128 a[92:95], v101 offset:4096
    ds_read_b64_tr_b16 a[96:97], v108 offset:4096
    v_mfma_f32_32x32x16_bf16 v[32:47], a[76:79], a[64:67], v[32:47]
    ds_read_b64_tr_b16 a[98:99], v108 offset:5120
    ds_read_b64_tr_b16 a[100:101], v109 offset:4096
    ds_read_b64_tr_b16 a[102:103], v109 offset:5120
    v_mfma_f32_32x32x16_bf16 v[48:63], a[80:83], a[64:67], v[48:63]
    ds_read_b64_tr_b16 a[104:105], v110 offset:4096
    ds_read_b64_tr_b16 a[106:107], v110 offset:5120
    ds_read_b64_tr_b16 a[108:109], v111 offset:4096
    v_mfma_f32_32x32x16_bf16 v[64:79], a[84:87], a[64:67], v[64:79]
    ds_read_b64_tr_b16 a[110:111], v111 offset:5120
    v_mfma_f32_32x32x16_bf16 a[0:15], a[72:75], a[68:71], a[0:15]
    v_mfma_f32_32x32x16_bf16 a[16:31], a[76:79], a[68:71], a[16:31]
    v_mfma_f32_32x32x16_bf16 a[32:47], a[80:83], a[68:71], a[32:47]
    v_mfma_f32_32x32x16_bf16 a[48:63], a[84:87], a[68:71], a[48:63]
    s_waitcnt lgkmcnt(0)
    v_mfma_f32_32x32x16_bf16 v[16:31], a[96:99], a[88:91], v[16:31]
    ds_read_b128 a[64:67], v102 offset:0
    ds_read_b128 a[68:71], v102 offset:4096
    ds_read_b64_tr_b16 a[72:73], v108 offset:8192
    v_mfma_f32_32x32x16_bf16 v[32:47], a[100:103], a[88:91], v[32:47]
    ds_read_b64_tr_b16 a[74:75], v108 offset:9216
    ds_read_b64_tr_b16 a[76:77], v109 offset:8192
    ds_read_b64_tr_b16 a[78:79], v109 offset:9216
    v_mfma_f32_32x32x16_bf16 v[48:63], a[104:107], a[88:91], v[48:63]
    ds_read_b64_tr_b16 a[80:81], v110 offset:8192
    ds_read_b64_tr_b16 a[82:83], v110 offset:9216
    ds_read_b64_tr_b16 a[84:85], v111 offset:8192
    v_mfma_f32_32x32x16_bf16 v[64:79], a[108:111], a[88:91], v[64:79]
    ds_read_b64_tr_b16 a[86:87], v111 offset:9216
    v_mfma_f32_32x32x16_bf16 a[0:15], a[96:99], a[92:95], a[0:15]
    v_mfma_f32_32x32x16_bf16 a[16:31], a[100:103], a[92:95], a[16:31]
    v_mfma_f32_32x32x16_bf16 a[32:47], a[104:107], a[92:95], a[32:47]
    v_mfma_f32_32x32x16_bf16 a[48:63], a[108:111], a[92:95], a[48:63]
    s_waitcnt lgkmcnt(0)
    v_mfma_f32_32x32x16_bf16 v[16:31], a[72:75], a[64:67], v[16:31]
    ds_read_b128 a[88:91], v103 offset:0
    ds_read_b128 a[92:95], v103 offset:4096
    ds_read_b64_tr_b16 a[96:97], v108 offset:12288
    v_mfma_f32_32x32x16_bf16 v[32:47], a[76:79], a[64:67], v[32:47]
    ds_read_b64_tr_b16 a[98:99], v108 offset:13312
    ds_read_b64_tr_b16 a[100:101], v109 offset:12288
    ds_read_b64_tr_b16 a[102:103], v109 offset:13312
    v_mfma_f32_32x32x16_bf16 v[48:63], a[80:83], a[64:67], v[48:63]
    ds_read_b64_tr_b16 a[104:105], v110 offset:12288
    ds_read_b64_tr_b16 a[106:107], v110 offset:13312
    ds_read_b64_tr_b16 a[108:109], v111 offset:12288
    v_mfma_f32_32x32x16_bf16 v[64:79], a[84:87], a[64:67], v[64:79]
    ds_read_b64_tr_b16 a[110:111], v111 offset:13312
    v_mfma_f32_32x32x16_bf16 a[0:15], a[72:75], a[68:71], a[0:15]
    v_mfma_f32_32x32x16_bf16 a[16:31], a[76:79], a[68:71], a[16:31]
    v_mfma_f32_32x32x16_bf16 a[32:47], a[80:83], a[68:71], a[32:47]
    v_mfma_f32_32x32x16_bf16 a[48:63], a[84:87], a[68:71], a[48:63]
    s_waitcnt lgkmcnt(0)
    s_barrier
    v_mfma_f32_32x32x16_bf16 v[16:31], a[96:99], a[88:91], v[16:31]
    v_add_u32 v100, 49152, v96
    v_add_u32 v101, 49152, v97
    v_add_u32 v102, 49152, v98
    v_mfma_f32_32x32x16_bf16 v[32:47], a[100:103], a[88:91], v[32:47]
    v_add_u32 v103, 49152, v99
    v_add_u32 v108, 49152, v104
    v_add_u32 v109, 49152, v105
    v_mfma_f32_32x32x16_bf16 v[48:63], a[104:107], a[88:91], v[48:63]
    v_add_u32 v110, 49152, v106
    v_add_u32 v111, 49152, v107
    ds_read_b128 a[64:67], v100 offset:0
    v_mfma_f32_32x32x16_bf16 v[64:79], a[108:111], a[88:91], v[64:79]
    ds_read_b128 a[68:71], v100 offset:4096
    ds_read_b64_tr_b16 a[72:73], v108 offset:0
    ds_read_b64_tr_b16 a[74:75], v108 offset:1024
    v_mfma_f32_32x32x16_bf16 a[0:15], a[96:99], a[92:95], a[0:15]
    ds_read_b64_tr_b16 a[76:77], v109 offset:0
    ds_read_b64_tr_b16 a[78:79], v109 offset:1024
    ds_read_b64_tr_b16 a[80:81], v110 offset:0
    v_mfma_f32_32x32x16_bf16 a[16:31], a[100:103], a[92:95], a[16:31]
    ds_read_b64_tr_b16 a[82:83], v110 offset:1024
    ds_read_b64_tr_b16 a[84:85], v111 offset:0
    ds_read_b64_tr_b16 a[86:87], v111 offset:1024
    v_mfma_f32_32x32x16_bf16 a[32:47], a[104:107], a[92:95], a[32:47]
    v_mfma_f32_32x32x16_bf16 a[48:63], a[108:111], a[92:95], a[48:63]
    s_waitcnt lgkmcnt(0)
    v_mfma_f32_32x32x16_bf16 v[16:31], a[72:75], a[64:67], v[16:31]
    ds_read_b128 a[88:91], v101 offset:0
    ds_read_b128 a[92:95], v101 offset:4096
    ds_read_b64_tr_b16 a[96:97], v108 offset:4096
    v_mfma_f32_32x32x16_bf16 v[32:47], a[76:79], a[64:67], v[32:47]
    ds_read_b64_tr_b16 a[98:99], v108 offset:5120
    ds_read_b64_tr_b16 a[100:101], v109 offset:4096
    ds_read_b64_tr_b16 a[102:103], v109 offset:5120
    v_mfma_f32_32x32x16_bf16 v[48:63], a[80:83], a[64:67], v[48:63]
    ds_read_b64_tr_b16 a[104:105], v110 offset:4096
    ds_read_b64_tr_b16 a[106:107], v110 offset:5120
    ds_read_b64_tr_b16 a[108:109], v111 offset:4096
    v_mfma_f32_32x32x16_bf16 v[64:79], a[84:87], a[64:67], v[64:79]
    ds_read_b64_tr_b16 a[110:111], v111 offset:5120
    v_mfma_f32_32x32x16_bf16 a[0:15], a[72:75], a[68:71], a[0:15]
    v_mfma_f32_32x32x16_bf16 a[16:31], a[76:79], a[68:71], a[16:31]
    v_mfma_f32_32x32x16_bf16 a[32:47], a[80:83], a[68:71], a[32:47]
    v_mfma_f32_32x32x16_bf16 a[48:63], a[84:87], a[68:71], a[48:63]
    s_waitcnt lgkmcnt(0)
    v_mfma_f32_32x32x16_bf16 v[16:31], a[96:99], a[88:91], v[16:31]
    ds_read_b128 a[64:67], v102 offset:0
    ds_read_b128 a[68:71], v102 offset:4096
    ds_read_b64_tr_b16 a[72:73], v108 offset:8192
    v_mfma_f32_32x32x16_bf16 v[32:47], a[100:103], a[88:91], v[32:47]
    ds_read_b64_tr_b16 a[74:75], v108 offset:9216
    ds_read_b64_tr_b16 a[76:77], v109 offset:8192
    ds_read_b64_tr_b16 a[78:79], v109 offset:9216
    v_mfma_f32_32x32x16_bf16 v[48:63], a[104:107], a[88:91], v[48:63]
    ds_read_b64_tr_b16 a[80:81], v110 offset:8192
    ds_read_b64_tr_b16 a[82:83], v110 offset:9216
    ds_read_b64_tr_b16 a[84:85], v111 offset:8192
    v_mfma_f32_32x32x16_bf16 v[64:79], a[108:111], a[88:91], v[64:79]
    ds_read_b64_tr_b16 a[86:87], v111 offset:9216
    v_mfma_f32_32x32x16_bf16 a[0:15], a[96:99], a[92:95], a[0:15]
    v_mfma_f32_32x32x16_bf16 a[16:31], a[100:103], a[92:95], a[16:31]
    v_mfma_f32_32x32x16_bf16 a[32:47], a[104:107], a[92:95], a[32:47]
    v_mfma_f32_32x32x16_bf16 a[48:63], a[108:111], a[92:95], a[48:63]
    s_waitcnt lgkmcnt(0)
    v_mfma_f32_32x32x16_bf16 v[16:31], a[72:75], a[64:67], v[16:31]
    ds_read_b128 a[88:91], v103 offset:0
    ds_read_b128 a[92:95], v103 offset:4096
    ds_read_b64_tr_b16 a[96:97], v108 offset:12288
    v_mfma_f32_32x32x16_bf16 v[32:47], a[76:79], a[64:67], v[32:47]
    ds_read_b64_tr_b16 a[98:99], v108 offset:13312
    ds_read_b64_tr_b16 a[100:101], v109 offset:12288
    ds_read_b64_tr_b16 a[102:103], v109 offset:13312
    v_mfma_f32_32x32x16_bf16 v[48:63], a[80:83], a[64:67], v[48:63]
    ds_read_b64_tr_b16 a[104:105], v110 offset:12288
    ds_read_b64_tr_b16 a[106:107], v110 offset:13312
    ds_read_b64_tr_b16 a[108:109], v111 offset:12288
    v_mfma_f32_32x32x16_bf16 v[64:79], a[84:87], a[64:67], v[64:79]
    ds_read_b64_tr_b16 a[110:111], v111 offset:13312
    v_mfma_f32_32x32x16_bf16 a[0:15], a[72:75], a[68:71], a[0:15]
    v_mfma_f32_32x32x16_bf16 a[16:31], a[76:79], a[68:71], a[16:31]
    v_mfma_f32_32x32x16_bf16 a[32:47], a[80:83], a[68:71], a[32:47]
    v_mfma_f32_32x32x16_bf16 a[48:63], a[84:87], a[68:71], a[48:63]
    s_waitcnt lgkmcnt(0)
    s_barrier
    v_mfma_f32_32x32x16_bf16 v[16:31], a[96:99], a[88:91], v[16:31]
    v_add_u32 v100, 98304, v96
    v_add_u32 v101, 98304, v97
    v_add_u32 v102, 98304, v98
    v_mfma_f32_32x32x16_bf16 v[32:47], a[100:103], a[88:91], v[32:47]
    v_add_u32 v103, 98304, v99
    v_add_u32 v108, 98304, v104
    v_add_u32 v109, 98304, v105
    v_mfma_f32_32x32x16_bf16 v[48:63], a[104:107], a[88:91], v[48:63]
    v_add_u32 v110, 98304, v106
    v_add_u32 v111, 98304, v107
    ds_read_b128 a[64:67], v100 offset:0
    v_mfma_f32_32x32x16_bf16 v[64:79], a[108:111], a[88:91], v[64:79]
    ds_read_b128 a[68:71], v100 offset:4096
    ds_read_b64_tr_b16 a[72:73], v108 offset:0
    ds_read_b64_tr_b16 a[74:75], v108 offset:1024
    v_mfma_f32_32x32x16_bf16 a[0:15], a[96:99], a[92:95], a[0:15]
    ds_read_b64_tr_b16 a[76:77], v109 offset:0
    ds_read_b64_tr_b16 a[78:79], v109 offset:1024
    ds_read_b64_tr_b16 a[80:81], v110 offset:0
    v_mfma_f32_32x32x16_bf16 a[16:31], a[100:103], a[92:95], a[16:31]
    ds_read_b64_tr_b16 a[82:83], v110 offset:1024
    ds_read_b64_tr_b16 a[84:85], v111 offset:0
    ds_read_b64_tr_b16 a[86:87], v111 offset:1024
    v_mfma_f32_32x32x16_bf16 a[32:47], a[104:107], a[92:95], a[32:47]
    v_mfma_f32_32x32x16_bf16 a[48:63], a[108:111], a[92:95], a[48:63]
    s_waitcnt lgkmcnt(0)
    v_mfma_f32_32x32x16_bf16 v[16:31], a[72:75], a[64:67], v[16:31]
    ds_read_b128 a[88:91], v101 offset:0
    ds_read_b128 a[92:95], v101 offset:4096
    ds_read_b64_tr_b16 a[96:97], v108 offset:4096
    v_mfma_f32_32x32x16_bf16 v[32:47], a[76:79], a[64:67], v[32:47]
    ds_read_b64_tr_b16 a[98:99], v108 offset:5120
    ds_read_b64_tr_b16 a[100:101], v109 offset:4096
    ds_read_b64_tr_b16 a[102:103], v109 offset:5120
    v_mfma_f32_32x32x16_bf16 v[48:63], a[80:83], a[64:67], v[48:63]
    ds_read_b64_tr_b16 a[104:105], v110 offset:4096
    ds_read_b64_tr_b16 a[106:107], v110 offset:5120
    ds_read_b64_tr_b16 a[108:109], v111 offset:4096
    v_mfma_f32_32x32x16_bf16 v[64:79], a[84:87], a[64:67], v[64:79]
    ds_read_b64_tr_b16 a[110:111], v111 offset:5120
    v_mfma_f32_32x32x16_bf16 a[0:15], a[72:75], a[68:71], a[0:15]
    v_mfma_f32_32x32x16_bf16 a[16:31], a[76:79], a[68:71], a[16:31]
    v_mfma_f32_32x32x16_bf16 a[32:47], a[80:83], a[68:71], a[32:47]
    v_mfma_f32_32x32x16_bf16 a[48:63], a[84:87], a[68:71], a[48:63]
    s_waitcnt lgkmcnt(0)
    v_mfma_f32_32x32x16_bf16 v[16:31], a[96:99], a[88:91], v[16:31]
    ds_read_b128 a[64:67], v102 offset:0
    ds_read_b128 a[68:71], v102 offset:4096
    ds_read_b64_tr_b16 a[72:73], v108 offset:8192
    v_mfma_f32_32x32x16_bf16 v[32:47], a[100:103], a[88:91], v[32:47]
    ds_read_b64_tr_b16 a[74:75], v108 offset:9216
    ds_read_b64_tr_b16 a[76:77], v109 offset:8192
    ds_read_b64_tr_b16 a[78:79], v109 offset:9216
    v_mfma_f32_32x32x16_bf16 v[48:63], a[104:107], a[88:91], v[48:63]
    ds_read_b64_tr_b16 a[80:81], v110 offset:8192
    ds_read_b64_tr_b16 a[82:83], v110 offset:9216
    ds_read_b64_tr_b16 a[84:85], v111 offset:8192
    v_mfma_f32_32x32x16_bf16 v[64:79], a[108:111], a[88:91], v[64:79]
    ds_read_b64_tr_b16 a[86:87], v111 offset:9216
    v_mfma_f32_32x32x16_bf16 a[0:15], a[96:99], a[92:95], a[0:15]
    v_mfma_f32_32x32x16_bf16 a[16:31], a[100:103], a[92:95], a[16:31]
    v_mfma_f32_32x32x16_bf16 a[32:47], a[104:107], a[92:95], a[32:47]
    v_mfma_f32_32x32x16_bf16 a[48:63], a[108:111], a[92:95], a[48:63]
    s_waitcnt lgkmcnt(0)
    v_mfma_f32_32x32x16_bf16 v[16:31], a[72:75], a[64:67], v[16:31]
    ds_read_b128 a[88:91], v103 offset:0
    ds_read_b128 a[92:95], v103 offset:4096
    ds_read_b64_tr_b16 a[96:97], v108 offset:12288
    v_mfma_f32_32x32x16_bf16 v[32:47], a[76:79], a[64:67], v[32:47]
    ds_read_b64_tr_b16 a[98:99], v108 offset:13312
    ds_read_b64_tr_b16 a[100:101], v109 offset:12288
    ds_read_b64_tr_b16 a[102:103], v109 offset:13312
    v_mfma_f32_32x32x16_bf16 v[48:63], a[80:83], a[64:67], v[48:63]
    ds_read_b64_tr_b16 a[104:105], v110 offset:12288
    ds_read_b64_tr_b16 a[106:107], v110 offset:13312
    ds_read_b64_tr_b16 a[108:109], v111 offset:12288
    v_mfma_f32_32x32x16_bf16 v[64:79], a[84:87], a[64:67], v[64:79]
    ds_read_b64_tr_b16 a[110:111], v111 offset:13312
    v_mfma_f32_32x32x16_bf16 a[0:15], a[72:75], a[68:71], a[0:15]
    v_mfma_f32_32x32x16_bf16 a[16:31], a[76:79], a[68:71], a[16:31]
    v_mfma_f32_32x32x16_bf16 a[32:47], a[80:83], a[68:71], a[32:47]
    v_mfma_f32_32x32x16_bf16 a[48:63], a[84:87], a[68:71], a[48:63]
    s_waitcnt lgkmcnt(0)
    s_barrier
    v_mfma_f32_32x32x16_bf16 v[16:31], a[96:99], a[88:91], v[16:31]
    v_add_u32 v100, 0, v96
    v_add_u32 v101, 0, v97
    v_add_u32 v102, 0, v98
    v_mfma_f32_32x32x16_bf16 v[32:47], a[100:103], a[88:91], v[32:47]
    v_add_u32 v103, 0, v99
    v_add_u32 v108, 0, v104
    v_add_u32 v109, 0, v105
    v_mfma_f32_32x32x16_bf16 v[48:63], a[104:107], a[88:91], v[48:63]
    v_add_u32 v110, 0, v106
    v_add_u32 v111, 0, v107
    ds_read_b128 a[64:67], v100 offset:0
    v_mfma_f32_32x32x16_bf16 v[64:79], a[108:111], a[88:91], v[64:79]
    ds_read_b128 a[68:71], v100 offset:4096
    ds_read_b64_tr_b16 a[72:73], v108 offset:0
    ds_read_b64_tr_b16 a[74:75], v108 offset:1024
    v_mfma_f32_32x32x16_bf16 a[0:15], a[96:99], a[92:95], a[0:15]
    ds_read_b64_tr_b16 a[76:77], v109 offset:0
    ds_read_b64_tr_b16 a[78:79], v109 offset:1024
    ds_read_b64_tr_b16 a[80:81], v110 offset:0
    v_mfma_f32_32x32x16_bf16 a[16:31], a[100:103], a[92:95], a[16:31]
    ds_read_b64_tr_b16 a[82:83], v110 offset:1024
    ds_read_b64_tr_b16 a[84:85], v111 offset:0
    ds_read_b64_tr_b16 a[86:87], v111 offset:1024
    v_mfma_f32_32x32x16_bf16 a[32:47], a[104:107], a[92:95], a[32:47]
    v_mfma_f32_32x32x16_bf16 a[48:63], a[108:111], a[92:95], a[48:63]
    s_waitcnt lgkmcnt(0)
    v_mfma_f32_32x32x16_bf16 v[16:31], a[72:75], a[64:67], v[16:31]
    ds_read_b128 a[88:91], v101 offset:0
    ds_read_b128 a[92:95], v101 offset:4096
    ds_read_b64_tr_b16 a[96:97], v108 offset:4096
    v_mfma_f32_32x32x16_bf16 v[32:47], a[76:79], a[64:67], v[32:47]
    ds_read_b64_tr_b16 a[98:99], v108 offset:5120
    ds_read_b64_tr_b16 a[100:101], v109 offset:4096
    ds_read_b64_tr_b16 a[102:103], v109 offset:5120
    v_mfma_f32_32x32x16_bf16 v[48:63], a[80:83], a[64:67], v[48:63]
    ds_read_b64_tr_b16 a[104:105], v110 offset:4096
    ds_read_b64_tr_b16 a[106:107], v110 offset:5120
    ds_read_b64_tr_b16 a[108:109], v111 offset:4096
    v_mfma_f32_32x32x16_bf16 v[64:79], a[84:87], a[64:67], v[64:79]
    ds_read_b64_tr_b16 a[110:111], v111 offset:5120
    v_mfma_f32_32x32x16_bf16 a[0:15], a[72:75], a[68:71], a[0:15]
    v_mfma_f32_32x32x16_bf16 a[16:31], a[76:79], a[68:71], a[16:31]
    v_mfma_f32_32x32x16_bf16 a[32:47], a[80:83], a[68:71], a[32:47]
    v_mfma_f32_32x32x16_bf16 a[48:63], a[84:87], a[68:71], a[48:63]
    s_waitcnt lgkmcnt(0)
    v_mfma_f32_32x32x16_bf16 v[16:31], a[96:99], a[88:91], v[16:31]
    ds_read_b128 a[64:67], v102 offset:0
    ds_read_b128 a[68:71], v102 offset:4096
    ds_read_b64_tr_b16 a[72:73], v108 offset:8192
    v_mfma_f32_32x32x16_bf16 v[32:47], a[100:103], a[88:91], v[32:47]
    ds_read_b64_tr_b16 a[74:75], v108 offset:9216
    ds_read_b64_tr_b16 a[76:77], v109 offset:8192
    ds_read_b64_tr_b16 a[78:79], v109 offset:9216
    v_mfma_f32_32x32x16_bf16 v[48:63], a[104:107], a[88:91], v[48:63]
    ds_read_b64_tr_b16 a[80:81], v110 offset:8192
    ds_read_b64_tr_b16 a[82:83], v110 offset:9216
    ds_read_b64_tr_b16 a[84:85], v111 offset:8192
    v_mfma_f32_32x32x16_bf16 v[64:79], a[108:111], a[88:91], v[64:79]
    ds_read_b64_tr_b16 a[86:87], v111 offset:9216
    v_mfma_f32_32x32x16_bf16 a[0:15], a[96:99], a[92:95], a[0:15]
    v_mfma_f32_32x32x16_bf16 a[16:31], a[100:103], a[92:95], a[16:31]
    v_mfma_f32_32x32x16_bf16 a[32:47], a[104:107], a[92:95], a[32:47]
    v_mfma_f32_32x32x16_bf16 a[48:63], a[108:111], a[92:95], a[48:63]
    s_waitcnt lgkmcnt(0)
    v_mfma_f32_32x32x16_bf16 v[16:31], a[72:75], a[64:67], v[16:31]
    ds_read_b128 a[88:91], v103 offset:0
    ds_read_b128 a[92:95], v103 offset:4096
    ds_read_b64_tr_b16 a[96:97], v108 offset:12288
    v_mfma_f32_32x32x16_bf16 v[32:47], a[76:79], a[64:67], v[32:47]
    ds_read_b64_tr_b16 a[98:99], v108 offset:13312
    ds_read_b64_tr_b16 a[100:101], v109 offset:12288
    ds_read_b64_tr_b16 a[102:103], v109 offset:13312
    v_mfma_f32_32x32x16_bf16 v[48:63], a[80:83], a[64:67], v[48:63]
    ds_read_b64_tr_b16 a[104:105], v110 offset:12288
    ds_read_b64_tr_b16 a[106:107], v110 offset:13312
    ds_read_b64_tr_b16 a[108:109], v111 offset:12288
    v_mfma_f32_32x32x16_bf16 v[64:79], a[84:87], a[64:67], v[64:79]
    ds_read_b64_tr_b16 a[110:111], v111 offset:13312
    v_mfma_f32_32x32x16_bf16 a[0:15], a[72:75], a[68:71], a[0:15]
    v_mfma_f32_32x32x16_bf16 a[16:31], a[76:79], a[68:71], a[16:31]
    v_mfma_f32_32x32x16_bf16 a[32:47], a[80:83], a[68:71], a[32:47]
    v_mfma_f32_32x32x16_bf16 a[48:63], a[84:87], a[68:71], a[48:63]
    s_waitcnt lgkmcnt(0)
    v_mfma_f32_32x32x16_bf16 v[16:31], a[96:99], a[88:91], v[16:31]
    v_mfma_f32_32x32x16_bf16 v[32:47], a[100:103], a[88:91], v[32:47]
    v_mfma_f32_32x32x16_bf16 v[48:63], a[104:107], a[88:91], v[48:63]
    v_mfma_f32_32x32x16_bf16 v[64:79], a[108:111], a[88:91], v[64:79]
    v_mfma_f32_32x32x16_bf16 a[0:15], a[96:99], a[92:95], a[0:15]
    v_mfma_f32_32x32x16_bf16 a[16:31], a[100:103], a[92:95], a[16:31]
    v_mfma_f32_32x32x16_bf16 a[32:47], a[104:107], a[92:95], a[32:47]
    v_mfma_f32_32x32x16_bf16 a[48:63], a[108:111], a[92:95], a[48:63]
    s_mov_b32 s72, 0.12751743082459868
    s_mov_b32 s73, s72
    v_mov_b32 v96, 0
    v_mov_b32 v97, 0
    v_mov_b32 v98, 0
    v_mov_b32 v99, 0
    v_mov_b32 v100, 0
    v_mov_b32 v101, 0
    v_mov_b32 v102, 0
    v_mov_b32 v103, 0
    v_add_u32 v104, s47, v8
    v_mov_b32 v105, v7
    v_mov_b32 v108, 0x3f803f80
    v_mov_b32 v109, 0x3f803f80
    v_mov_b32 v110, 0x3f803f80
    v_mov_b32 v111, 0x3f803f80
    s_nop 3
    v_pk_mul_f32 v[16:17], v[16:17], s[72:73]
    v_pk_mul_f32 v[18:19], v[18:19], s[72:73]
    v_pk_mul_f32 v[20:21], v[20:21], s[72:73]
    v_pk_mul_f32 v[22:23], v[22:23], s[72:73]
    v_pk_mul_f32 v[24:25], v[24:25], s[72:73]
    v_pk_mul_f32 v[26:27], v[26:27], s[72:73]
    v_pk_mul_f32 v[28:29], v[28:29], s[72:73]
    v_pk_mul_f32 v[30:31], v[30:31], s[72:73]
    v_pk_mul_f32 v[32:33], v[32:33], s[72:73]
    v_pk_mul_f32 v[34:35], v[34:35], s[72:73]
    v_pk_mul_f32 v[36:37], v[36:37], s[72:73]
    v_pk_mul_f32 v[38:39], v[38:39], s[72:73]
    v_pk_mul_f32 v[40:41], v[40:41], s[72:73]
    v_pk_mul_f32 v[42:43], v[42:43], s[72:73]
    v_pk_mul_f32 v[44:45], v[44:45], s[72:73]
    v_pk_mul_f32 v[46:47], v[46:47], s[72:73]
    v_pk_mul_f32 v[48:49], v[48:49], s[72:73]
    v_pk_mul_f32 v[50:51], v[50:51], s[72:73]
    v_pk_mul_f32 v[52:53], v[52:53], s[72:73]
    v_pk_mul_f32 v[54:55], v[54:55], s[72:73]
    v_pk_mul_f32 v[56:57], v[56:57], s[72:73]
    v_pk_mul_f32 v[58:59], v[58:59], s[72:73]
    v_pk_mul_f32 v[60:61], v[60:61], s[72:73]
    v_pk_mul_f32 v[62:63], v[62:63], s[72:73]
    v_pk_mul_f32 v[64:65], v[64:65], s[72:73]
    v_pk_mul_f32 v[66:67], v[66:67], s[72:73]
    v_pk_mul_f32 v[68:69], v[68:69], s[72:73]
    v_pk_mul_f32 v[70:71], v[70:71], s[72:73]
    v_pk_mul_f32 v[72:73], v[72:73], s[72:73]
    v_pk_mul_f32 v[74:75], v[74:75], s[72:73]
    v_pk_mul_f32 v[76:77], v[76:77], s[72:73]
    v_pk_mul_f32 v[78:79], v[78:79], s[72:73]
    v_cvt_pk_bf16_f32 v16, v16, v17
    v_cvt_pk_bf16_f32 v17, v18, v19
    v_cvt_pk_bf16_f32 v18, v20, v21
    v_cvt_pk_bf16_f32 v19, v22, v23
    v_cvt_pk_bf16_f32 v20, v24, v25
    v_cvt_pk_bf16_f32 v21, v26, v27
    v_cvt_pk_bf16_f32 v22, v28, v29
    v_cvt_pk_bf16_f32 v23, v30, v31
    v_cvt_pk_bf16_f32 v24, v32, v33
    v_cvt_pk_bf16_f32 v25, v34, v35
    v_cvt_pk_bf16_f32 v26, v36, v37
    v_cvt_pk_bf16_f32 v27, v38, v39
    v_cvt_pk_bf16_f32 v28, v40, v41
    v_cvt_pk_bf16_f32 v29, v42, v43
    v_cvt_pk_bf16_f32 v30, v44, v45
    v_cvt_pk_bf16_f32 v31, v46, v47
    v_cvt_pk_bf16_f32 v32, v48, v49
    v_cvt_pk_bf16_f32 v33, v50, v51
    v_cvt_pk_bf16_f32 v34, v52, v53
    v_cvt_pk_bf16_f32 v35, v54, v55
    v_cvt_pk_bf16_f32 v36, v56, v57
    v_cvt_pk_bf16_f32 v37, v58, v59
    v_cvt_pk_bf16_f32 v38, v60, v61
    v_cvt_pk_bf16_f32 v39, v62, v63
    v_cvt_pk_bf16_f32 v40, v64, v65
    v_cvt_pk_bf16_f32 v41, v66, v67
    v_cvt_pk_bf16_f32 v42, v68, v69
    v_cvt_pk_bf16_f32 v43, v70, v71
    v_cvt_pk_bf16_f32 v44, v72, v73
    v_cvt_pk_bf16_f32 v45, v74, v75
    v_cvt_pk_bf16_f32 v46, v76, v77
    v_cvt_pk_bf16_f32 v47, v78, v79
    s_barrier
    ds_write_b128 v15, v[16:19] offset:0
    ds_write_b128 v15, v[20:23] offset:1024
    ds_write_b128 v15, v[24:27] offset:2048
    ds_write_b128 v15, v[28:31] offset:3072
    ds_write_b128 v15, v[32:35] offset:4096
    ds_write_b128 v15, v[36:39] offset:5120
    ds_write_b128 v15, v[40:43] offset:6144
    ds_write_b128 v15, v[44:47] offset:7168
    v_accvgpr_read_b32 v80, a0
    v_accvgpr_read_b32 v81, a1
    v_accvgpr_read_b32 v82, a2
    v_accvgpr_read_b32 v83, a3
    v_accvgpr_read_b32 v84, a4
    v_accvgpr_read_b32 v85, a5
    v_accvgpr_read_b32 v86, a6
    v_accvgpr_read_b32 v87, a7
    v_accvgpr_read_b32 v88, a8
    v_accvgpr_read_b32 v89, a9
    v_accvgpr_read_b32 v90, a10
    v_accvgpr_read_b32 v91, a11
    v_accvgpr_read_b32 v92, a12
    v_accvgpr_read_b32 v93, a13
    v_accvgpr_read_b32 v94, a14
    v_accvgpr_read_b32 v95, a15
    v_pk_mul_f32 v[80:81], v[80:81], s[72:73]
    v_pk_mul_f32 v[82:83], v[82:83], s[72:73]
    v_pk_mul_f32 v[84:85], v[84:85], s[72:73]
    v_pk_mul_f32 v[86:87], v[86:87], s[72:73]
    v_pk_mul_f32 v[88:89], v[88:89], s[72:73]
    v_pk_mul_f32 v[90:91], v[90:91], s[72:73]
    v_pk_mul_f32 v[92:93], v[92:93], s[72:73]
    v_pk_mul_f32 v[94:95], v[94:95], s[72:73]
    v_cvt_pk_bf16_f32 v48, v80, v81
    v_cvt_pk_bf16_f32 v49, v82, v83
    v_cvt_pk_bf16_f32 v50, v84, v85
    v_cvt_pk_bf16_f32 v51, v86, v87
    v_cvt_pk_bf16_f32 v52, v88, v89
    v_cvt_pk_bf16_f32 v53, v90, v91
    v_cvt_pk_bf16_f32 v54, v92, v93
    v_cvt_pk_bf16_f32 v55, v94, v95
    s_waitcnt lgkmcnt(0)
    ds_read_b128 a[64:67], v104 offset:0
    ds_read_b128 a[68:71], v104 offset:256
    ds_read_b128 a[72:75], v104 offset:2048
    ds_read_b128 a[76:79], v104 offset:2304
    ds_read_b128 a[80:83], v104 offset:4096
    ds_read_b128 a[84:87], v104 offset:4352
    ds_read_b128 a[88:91], v104 offset:6144
    ds_read_b128 a[92:95], v104 offset:6400
    v_accvgpr_read_b32 v80, a16
    v_accvgpr_read_b32 v81, a17
    v_accvgpr_read_b32 v82, a18
    v_accvgpr_read_b32 v83, a19
    v_accvgpr_read_b32 v84, a20
    v_accvgpr_read_b32 v85, a21
    v_accvgpr_read_b32 v86, a22
    v_accvgpr_read_b32 v87, a23
    v_accvgpr_read_b32 v88, a24
    v_accvgpr_read_b32 v89, a25
    v_accvgpr_read_b32 v90, a26
    v_accvgpr_read_b32 v91, a27
    v_accvgpr_read_b32 v92, a28
    v_accvgpr_read_b32 v93, a29
    v_accvgpr_read_b32 v94, a30
    v_accvgpr_read_b32 v95, a31
    v_pk_mul_f32 v[80:81], v[80:81], s[72:73]
    v_pk_mul_f32 v[82:83], v[82:83], s[72:73]
    v_pk_mul_f32 v[84:85], v[84:85], s[72:73]
    v_pk_mul_f32 v[86:87], v[86:87], s[72:73]
    v_pk_mul_f32 v[88:89], v[88:89], s[72:73]
    v_pk_mul_f32 v[90:91], v[90:91], s[72:73]
    v_pk_mul_f32 v[92:93], v[92:93], s[72:73]
    v_pk_mul_f32 v[94:95], v[94:95], s[72:73]
    v_cvt_pk_bf16_f32 v56, v80, v81
    v_cvt_pk_bf16_f32 v57, v82, v83
    v_cvt_pk_bf16_f32 v58, v84, v85
    v_cvt_pk_bf16_f32 v59, v86, v87
    v_cvt_pk_bf16_f32 v60, v88, v89
    v_cvt_pk_bf16_f32 v61, v90, v91
    v_cvt_pk_bf16_f32 v62, v92, v93
    v_cvt_pk_bf16_f32 v63, v94, v95
    v_accvgpr_read_b32 v80, a32
    v_accvgpr_read_b32 v81, a33
    v_accvgpr_read_b32 v82, a34
    v_accvgpr_read_b32 v83, a35
    v_accvgpr_read_b32 v84, a36
    v_accvgpr_read_b32 v85, a37
    v_accvgpr_read_b32 v86, a38
    v_accvgpr_read_b32 v87, a39
    v_accvgpr_read_b32 v88, a40
    v_accvgpr_read_b32 v89, a41
    v_accvgpr_read_b32 v90, a42
    v_accvgpr_read_b32 v91, a43
    v_accvgpr_read_b32 v92, a44
    v_accvgpr_read_b32 v93, a45
    v_accvgpr_read_b32 v94, a46
    v_accvgpr_read_b32 v95, a47
    v_pk_mul_f32 v[80:81], v[80:81], s[72:73]
    v_pk_mul_f32 v[82:83], v[82:83], s[72:73]
    v_pk_mul_f32 v[84:85], v[84:85], s[72:73]
    v_pk_mul_f32 v[86:87], v[86:87], s[72:73]
    v_pk_mul_f32 v[88:89], v[88:89], s[72:73]
    v_pk_mul_f32 v[90:91], v[90:91], s[72:73]
    v_pk_mul_f32 v[92:93], v[92:93], s[72:73]
    v_pk_mul_f32 v[94:95], v[94:95], s[72:73]
    v_cvt_pk_bf16_f32 v64, v80, v81
    v_cvt_pk_bf16_f32 v65, v82, v83
    v_cvt_pk_bf16_f32 v66, v84, v85
    v_cvt_pk_bf16_f32 v67, v86, v87
    v_cvt_pk_bf16_f32 v68, v88, v89
    v_cvt_pk_bf16_f32 v69, v90, v91
    v_cvt_pk_bf16_f32 v70, v92, v93
    v_cvt_pk_bf16_f32 v71, v94, v95
    v_accvgpr_read_b32 v80, a48
    v_accvgpr_read_b32 v81, a49
    v_accvgpr_read_b32 v82, a50
    v_accvgpr_read_b32 v83, a51
    v_accvgpr_read_b32 v84, a52
    v_accvgpr_read_b32 v85, a53
    v_accvgpr_read_b32 v86, a54
    v_accvgpr_read_b32 v87, a55
    v_accvgpr_read_b32 v88, a56
    v_accvgpr_read_b32 v89, a57
    v_accvgpr_read_b32 v90, a58
    v_accvgpr_read_b32 v91, a59
    v_accvgpr_read_b32 v92, a60
    v_accvgpr_read_b32 v93, a61
    v_accvgpr_read_b32 v94, a62
    v_accvgpr_read_b32 v95, a63
    v_pk_mul_f32 v[80:81], v[80:81], s[72:73]
    v_pk_mul_f32 v[82:83], v[82:83], s[72:73]
    v_pk_mul_f32 v[84:85], v[84:85], s[72:73]
    v_pk_mul_f32 v[86:87], v[86:87], s[72:73]
    v_pk_mul_f32 v[88:89], v[88:89], s[72:73]
    v_pk_mul_f32 v[90:91], v[90:91], s[72:73]
    v_pk_mul_f32 v[92:93], v[92:93], s[72:73]
    v_pk_mul_f32 v[94:95], v[94:95], s[72:73]
    v_cvt_pk_bf16_f32 v72, v80, v81
    v_cvt_pk_bf16_f32 v73, v82, v83
    v_cvt_pk_bf16_f32 v74, v84, v85
    v_cvt_pk_bf16_f32 v75, v86, v87
    v_cvt_pk_bf16_f32 v76, v88, v89
    v_cvt_pk_bf16_f32 v77, v90, v91
    v_cvt_pk_bf16_f32 v78, v92, v93
    v_cvt_pk_bf16_f32 v79, v94, v95
    s_waitcnt lgkmcnt(0)
Lat_blk:
    s_add_u32 s66, s43, 1
    s_lshl_b32 s66, s66, 1
    s_sub_u32 s69, s66, 2
    s_sub_u32 s68, s66, 1
    ds_read_b128 a[96:99], v14 offset:16384
    ds_read_b128 a[100:103], v14 offset:16640
    ds_read_b128 a[104:107], v14 offset:24576
    ds_read_b128 a[108:111], v14 offset:24832
    ds_read_b128 a[112:115], v14 offset:18432
    ds_read_b128 a[116:119], v14 offset:18688
    ds_read_b128 a[120:123], v14 offset:26624
    ds_read_b128 a[124:127], v14 offset:26880
    s_waitcnt lgkmcnt(7)
    v_mfma_f32_16x16x32_bf16 v[16:19], a[96:99], a[64:67], v[96:99]
    v_accvgpr_write_b32 a0, 0
    v_accvgpr_write_b32 a1, 0
    v_mfma_f32_16x16x32_bf16 v[20:23], a[96:99], a[68:71], v[100:103]
    v_accvgpr_write_b32 a2, 0
    v_accvgpr_write_b32 a3, 0
    ds_read_b128 a[96:99], v14 offset:20480
    s_waitcnt lgkmcnt(7)
    v_mfma_f32_16x16x32_bf16 v[24:27], a[100:103], a[64:67], v[96:99]
    v_accvgpr_write_b32 a4, 0
    v_accvgpr_write_b32 a5, 0
    v_mfma_f32_16x16x32_bf16 v[28:31], a[100:103], a[68:71], v[100:103]
    v_accvgpr_write_b32 a6, 0
    v_accvgpr_write_b32 a7, 0
    ds_read_b128 a[100:103], v14 offset:20736
    s_waitcnt lgkmcnt(7)
    v_mfma_f32_16x16x32_bf16 v[32:35], a[104:107], a[64:67], v[96:99]
    v_accvgpr_write_b32 a8, 0
    v_accvgpr_write_b32 a9, 0
    v_mfma_f32_16x16x32_bf16 v[36:39], a[104:107], a[68:71], v[100:103]
    v_accvgpr_write_b32 a10, 0
    v_accvgpr_write_b32 a11, 0
    ds_read_b128 a[104:107], v14 offset:28672
    s_waitcnt lgkmcnt(7)
    v_mfma_f32_16x16x32_bf16 v[40:43], a[108:111], a[64:67], v[96:99]
    v_accvgpr_write_b32 a12, 0
    v_accvgpr_write_b32 a13, 0
    v_mfma_f32_16x16x32_bf16 v[44:47], a[108:111], a[68:71], v[100:103]
    v_accvgpr_write_b32 a14, 0
    v_accvgpr_write_b32 a15, 0
    ds_read_b128 a[108:111], v14 offset:28928
    s_waitcnt lgkmcnt(7)
    v_mfma_f32_16x16x32_bf16 v[16:19], a[112:115], a[72:75], v[16:19]
    v_accvgpr_write_b32 a16, 0
    v_accvgpr_write_b32 a17, 0
    v_mfma_f32_16x16x32_bf16 v[20:23], a[112:115], a[76:79], v[20:23]
    v_accvgpr_write_b32 a18, 0
    v_accvgpr_write_b32 a19, 0
    ds_read_b128 a[112:115], v14 offset:22528
    s_waitcnt lgkmcnt(7)
    v_mfma_f32_16x16x32_bf16 v[24:27], a[116:119], a[72:75], v[24:27]
    v_accvgpr_write_b32 a20, 0
    v_accvgpr_write_b32 a21, 0
    v_mfma_f32_16x16x32_bf16 v[28:31], a[116:119], a[76:79], v[28:31]
    v_accvgpr_write_b32 a22, 0
    v_accvgpr_write_b32 a23, 0
    ds_read_b128 a[116:119], v14 offset:22784
    s_waitcnt lgkmcnt(7)
    v_mfma_f32_16x16x32_bf16 v[32:35], a[120:123], a[72:75], v[32:35]
    v_accvgpr_write_b32 a24, 0
    v_accvgpr_write_b32 a25, 0
    v_mfma_f32_16x16x32_bf16 v[36:39], a[120:123], a[76:79], v[36:39]
    v_accvgpr_write_b32 a26, 0
    v_accvgpr_write_b32 a27, 0
    ds_read_b128 a[120:123], v14 offset:30720
    s_waitcnt lgkmcnt(7)
    v_mfma_f32_16x16x32_bf16 v[40:43], a[124:127], a[72:75], v[40:43]
    v_accvgpr_write_b32 a28, 0
    v_accvgpr_write_b32 a29, 0
    v_mfma_f32_16x16x32_bf16 v[44:47], a[124:127], a[76:79], v[44:47]
    v_accvgpr_write_b32 a30, 0
    v_accvgpr_write_b32 a31, 0
    ds_read_b128 a[124:127], v14 offset:30976
    s_waitcnt lgkmcnt(7)
    v_mfma_f32_16x16x32_bf16 v[16:19], a[96:99], a[80:83], v[16:19]
    v_accvgpr_write_b32 a32, 0
    v_accvgpr_write_b32 a33, 0
    v_mfma_f32_16x16x32_bf16 v[20:23], a[96:99], a[84:87], v[20:23]
    v_accvgpr_write_b32 a34, 0
    v_accvgpr_write_b32 a35, 0
    s_waitcnt lgkmcnt(6)
    v_mfma_f32_16x16x32_bf16 v[24:27], a[100:103], a[80:83], v[24:27]
    v_accvgpr_write_b32 a36, 0
    v_accvgpr_write_b32 a37, 0
    v_mfma_f32_16x16x32_bf16 v[28:31], a[100:103], a[84:87], v[28:31]
    v_accvgpr_write_b32 a38, 0
    v_accvgpr_write_b32 a39, 0
    s_waitcnt lgkmcnt(5)
    v_mfma_f32_16x16x32_bf16 v[32:35], a[104:107], a[80:83], v[32:35]
    v_accvgpr_write_b32 a40, 0
    v_accvgpr_write_b32 a41, 0
    v_mfma_f32_16x16x32_bf16 v[36:39], a[104:107], a[84:87], v[36:39]
    v_accvgpr_write_b32 a42, 0
    v_accvgpr_write_b32 a43, 0
    s_waitcnt lgkmcnt(4)
    v_mfma_f32_16x16x32_bf16 v[40:43], a[108:111], a[80:83], v[40:43]
    v_accvgpr_write_b32 a44, 0
    v_accvgpr_write_b32 a45, 0
    v_mfma_f32_16x16x32_bf16 v[44:47], a[108:111], a[84:87], v[44:47]
    v_accvgpr_write_b32 a46, 0
    v_accvgpr_write_b32 a47, 0
    s_waitcnt lgkmcnt(3)
    v_mfma_f32_16x16x32_bf16 v[16:19], a[112:115], a[88:91], v[16:19]
    v_accvgpr_write_b32 a48, 0
    v_accvgpr_write_b32 a49, 0
    v_mfma_f32_16x16x32_bf16 v[20:23], a[112:115], a[92:95], v[20:23]
    v_accvgpr_write_b32 a50, 0
    v_accvgpr_write_b32 a51, 0
    s_waitcnt lgkmcnt(2)
    v_mfma_f32_16x16x32_bf16 v[24:27], a[116:119], a[88:91], v[24:27]
    v_accvgpr_write_b32 a52, 0
    v_accvgpr_write_b32 a53, 0
    v_mfma_f32_16x16x32_bf16 v[28:31], a[116:119], a[92:95], v[28:31]
    v_accvgpr_write_b32 a54, 0
    v_accvgpr_write_b32 a55, 0
    s_waitcnt lgkmcnt(1)
    v_mfma_f32_16x16x32_bf16 v[32:35], a[120:123], a[88:91], v[32:35]
    v_accvgpr_write_b32 a56, 0
    v_accvgpr_write_b32 a57, 0
    v_mfma_f32_16x16x32_bf16 v[36:39], a[120:123], a[92:95], v[36:39]
    v_accvgpr_write_b32 a58, 0
    v_accvgpr_write_b32 a59, 0
    s_waitcnt lgkmcnt(0)
    v_mfma_f32_16x16x32_bf16 v[40:43], a[124:127], a[88:91], v[40:43]
    v_accvgpr_write_b32 a60, 0
    v_accvgpr_write_b32 a61, 0
    v_mfma_f32_16x16x32_bf16 v[44:47], a[124:127], a[92:95], v[44:47]
    v_accvgpr_write_b32 a62, 0
    v_accvgpr_write_b32 a63, 0
    v_mov_b32 v112, 0
    v_mov_b32 v113, 0
    v_mov_b32 v114, 0
    v_mov_b32 v115, 0
    v_mov_b32 v120, 0
    v_mov_b32 v121, 0
    v_mov_b32 v122, 0
    v_mov_b32 v123, 0
    ds_write_b128 v15, v[48:51] offset:0
    ds_write_b128 v15, v[52:55] offset:1024
    ds_write_b128 v15, v[56:59] offset:2048
    ds_write_b128 v15, v[60:63] offset:3072
    ds_write_b128 v15, v[64:67] offset:4096
    ds_write_b128 v15, v[68:71] offset:5120
    ds_write_b128 v15, v[72:75] offset:6144
    ds_write_b128 v15, v[76:79] offset:7168
    s_barrier
    ds_read_b128 a[96:99], v8 offset:49152
    ds_read_b128 a[100:103], v8 offset:49408
    ds_read_b128 a[104:107], v8 offset:57344
    ds_read_b128 a[108:111], v8 offset:57600
    ds_read_b128 a[112:115], v8 offset:51200
    ds_read_b128 a[116:119], v8 offset:51456
    ds_read_b128 a[120:123], v8 offset:59392
    s_mov_b32 s67, 0
    s_cmp_lt_u32 s67, s69
    s_cbranch_scc1 Lat_nm1
    s_sub_u32 s72, s67, s69
    s_lshl_b32 s72, s72, 6
    v_subrev_u32 v12, s72, v10
    v_mov_b32 v117, 0xf149f2ca
    s_nop 7
    v_cmp_gt_i32 s[74:75], 0, v12
    v_cmp_gt_i32 s[76:77], 1, v12
    v_cmp_gt_i32 s[78:79], 2, v12
    v_cmp_gt_i32 s[80:81], 3, v12
    s_nop 0
    v_cndmask_b32 v16, v16, v117, s[74:75]
    v_cndmask_b32 v17, v17, v117, s[76:77]
    v_cndmask_b32 v18, v18, v117, s[78:79]
    v_cndmask_b32 v19, v19, v117, s[80:81]
    v_cmp_gt_i32 s[74:75], -16, v12
    v_cmp_gt_i32 s[76:77], -15, v12
    v_cmp_gt_i32 s[78:79], -14, v12
    v_cmp_gt_i32 s[80:81], -13, v12
    s_nop 0
    v_cndmask_b32 v20, v20, v117, s[74:75]
    v_cndmask_b32 v21, v21, v117, s[76:77]
    v_cndmask_b32 v22, v22, v117, s[78:79]
    v_cndmask_b32 v23, v23, v117, s[80:81]
    v_cmp_gt_i32 s[74:75], 8, v12
    v_cmp_gt_i32 s[76:77], 9, v12
    v_cmp_gt_i32 s[78:79], 10, v12
    v_cmp_gt_i32 s[80:81], 11, v12
    s_nop 0
    v_cndmask_b32 v24, v24, v117, s[74:75]
    v_cndmask_b32 v25, v25, v117, s[76:77]
    v_cndmask_b32 v26, v26, v117, s[78:79]
    v_cndmask_b32 v27, v27, v117, s[80:81]
    v_cmp_gt_i32 s[74:75], -8, v12
    v_cmp_gt_i32 s[76:77], -7, v12
    v_cmp_gt_i32 s[78:79], -6, v12
    v_cmp_gt_i32 s[80:81], -5, v12
    s_nop 0
    v_cndmask_b32 v28, v28, v117, s[74:75]
    v_cndmask_b32 v29, v29, v117, s[76:77]
    v_cndmask_b32 v30, v30, v117, s[78:79]
    v_cndmask_b32 v31, v31, v117, s[80:81]
    v_cmp_gt_i32 s[74:75], 32, v12
    v_cmp_gt_i32 s[76:77], 33, v12
    v_cmp_gt_i32 s[78:79], 34, v12
    v_cmp_gt_i32 s[80:81], 35, v12
    s_nop 0
    v_cndmask_b32 v32, v32, v117, s[74:75]
    v_cndmask_b32 v33, v33, v117, s[76:77]
    v_cndmask_b32 v34, v34, v117, s[78:79]
    v_cndmask_b32 v35, v35, v117, s[80:81]
    v_cmp_gt_i32 s[74:75], 16, v12
    v_cmp_gt_i32 s[76:77], 17, v12
    v_cmp_gt_i32 s[78:79], 18, v12
    v_cmp_gt_i32 s[80:81], 19, v12
    s_nop 0
    v_cndmask_b32 v36, v36, v117, s[74:75]
    v_cndmask_b32 v37, v37, v117, s[76:77]
    v_cndmask_b32 v38, v38, v117, s[78:79]
    v_cndmask_b32 v39, v39, v117, s[80:81]
    v_cmp_gt_i32 s[74:75], 40, v12
    v_cmp_gt_i32 s[76:77], 41, v12
    v_cmp_gt_i32 s[78:79], 42, v12
    v_cmp_gt_i32 s[80:81], 43, v12
    s_nop 0
    v_cndmask_b32 v40, v40, v117, s[74:75]
    v_cndmask_b32 v41, v41, v117, s[76:77]
    v_cndmask_b32 v42, v42, v117, s[78:79]
    v_cndmask_b32 v43, v43, v117, s[80:81]
    v_cmp_gt_i32 s[74:75], 24, v12
    v_cmp_gt_i32 s[76:77], 25, v12
    v_cmp_gt_i32 s[78:79], 26, v12
    v_cmp_gt_i32 s[80:81], 27, v12
    s_nop 0
    v_cndmask_b32 v44, v44, v117, s[74:75]
    v_cndmask_b32 v45, v45, v117, s[76:77]
    v_cndmask_b32 v46, v46, v117, s[78:79]
    v_cndmask_b32 v47, v47, v117, s[80:81]
Lat_nm1:
    s_nop 7
    v_max3_f32 v11, v16, v17, v18
    v_max3_f32 v106, v20, v21, v22
    v_max3_f32 v11, v11, v19, v24
    v_max3_f32 v106, v106, v23, v28
    v_max3_f32 v11, v11, v25, v26
    v_max3_f32 v106, v106, v29, v30
    v_max3_f32 v11, v11, v27, v32
    v_max3_f32 v106, v106, v31, v36
    v_max3_f32 v11, v11, v33, v34
    v_max3_f32 v106, v106, v37, v38
    v_max3_f32 v11, v11, v35, v40
    v_max3_f32 v106, v106, v39, v44
    v_max3_f32 v11, v11, v41, v42
    v_max3_f32 v106, v106, v45, v46
    v_max_f32 v11, v11, v43
    v_max_f32 v106, v106, v47
    s_nop 0
    v_mov_b32 v116, v11
    v_mov_b32 v117, v106
    s_nop 1
    v_permlane16_swap_b32 v116, v11
    v_permlane16_swap_b32 v117, v106
    s_nop 1
    v_max_f32 v11, v11, v116
    v_max_f32 v106, v106, v117
    s_nop 0
    v_mov_b32 v116, v11
    v_mov_b32 v117, v106
    s_nop 1
    v_permlane32_swap_b32 v116, v11
    v_permlane32_swap_b32 v117, v106
    s_nop 1
    v_max_f32 v11, v11, v116
    v_max_f32 v106, v106, v117
    s_nop 0
    v_sub_f32 v16, v16, v11
    v_sub_f32 v17, v17, v11
    v_sub_f32 v18, v18, v11
    v_sub_f32 v19, v19, v11
    v_sub_f32 v24, v24, v11
    v_sub_f32 v25, v25, v11
    v_sub_f32 v26, v26, v11
    v_sub_f32 v27, v27, v11
    v_sub_f32 v32, v32, v11
    v_sub_f32 v33, v33, v11
    v_sub_f32 v34, v34, v11
    v_sub_f32 v35, v35, v11
    v_sub_f32 v40, v40, v11
    v_sub_f32 v41, v41, v11
    v_sub_f32 v42, v42, v11
    v_sub_f32 v43, v43, v11
    v_sub_f32 v96, 0, v11
    v_sub_f32 v97, 0, v11
    v_sub_f32 v98, 0, v11
    v_sub_f32 v99, 0, v11
    v_sub_f32 v20, v20, v106
    v_sub_f32 v21, v21, v106
    v_sub_f32 v22, v22, v106
    v_sub_f32 v23, v23, v106
    v_sub_f32 v28, v28, v106
    v_sub_f32 v29, v29, v106
    v_sub_f32 v30, v30, v106
    v_sub_f32 v31, v31, v106
    v_sub_f32 v36, v36, v106
    v_sub_f32 v37, v37, v106
    v_sub_f32 v38, v38, v106
    v_sub_f32 v39, v39, v106
    v_sub_f32 v44, v44, v106
    v_sub_f32 v45, v45, v106
    v_sub_f32 v46, v46, v106
    v_sub_f32 v47, v47, v106
    v_sub_f32 v100, 0, v106
    v_sub_f32 v101, 0, v106
    v_sub_f32 v102, 0, v106
    v_sub_f32 v103, 0, v106
    v_and_b32 v1, 63, v0
    s_lshl_b32 s72, s46, 6
    s_add_u32 s72, s72, 0
    v_add_u32 v2, s72, v1
    v_mul_u32_u24 v2, 128, v2
    buffer_load_dword v13, v2, s[16:19], 0 offen
    s_mov_b32 s16, s24
    s_mov_b32 s17, s25
    s_mov_b32 s18, s26
Lat_loop:
Lat_b0:
    s_waitcnt lgkmcnt(3)
    v_mfma_f32_16x16x32_bf16 v[48:51], a[96:99], a[64:67], v[96:99]
    ds_read_b128 a[124:127], v8 offset:59648
    v_exp_f32 v16, v16
    v_mfma_f32_16x16x32_bf16 v[52:55], a[96:99], a[68:71], v[100:103]
    v_exp_f32 v17, v17
    v_mfma_f32_16x16x32_bf16 v[56:59], a[100:103], a[64:67], v[96:99]
    ds_read_b128 a[96:99], v8 offset:53248
    v_exp_f32 v18, v18
    v_mfma_f32_16x16x32_bf16 v[60:63], a[100:103], a[68:71], v[100:103]
    v_exp_f32 v19, v19
    v_mfma_f32_16x16x32_bf16 v[64:67], a[104:107], a[64:67], v[96:99]
    ds_read_b128 a[100:103], v8 offset:53504
    v_cvt_pk_bf16_f32 v80, v16, v17
    v_mfma_f32_16x16x32_bf16 v[68:71], a[104:107], a[68:71], v[100:103]
    v_exp_f32 v24, v24
    v_mfma_f32_16x16x32_bf16 v[72:75], a[108:111], a[64:67], v[96:99]
    ds_read_b128 a[104:107], v8 offset:61440
    v_cvt_pk_bf16_f32 v81, v18, v19
    v_mfma_f32_16x16x32_bf16 v[76:79], a[108:111], a[68:71], v[100:103]
    v_exp_f32 v25, v25
    s_waitcnt lgkmcnt(3)
    v_mfma_f32_16x16x32_bf16 v[48:51], a[112:115], a[72:75], v[48:51]
    ds_read_b128 a[108:111], v8 offset:61696
    v_exp_f32 v26, v26
    v_mfma_f32_16x16x32_bf16 v[52:55], a[112:115], a[76:79], v[52:55]
    v_exp_f32 v27, v27
    v_mfma_f32_16x16x32_bf16 v[56:59], a[116:119], a[72:75], v[56:59]
    ds_read_b128 a[112:115], v8 offset:55296
    v_cvt_pk_bf16_f32 v82, v24, v25
    v_mfma_f32_16x16x32_bf16 v[60:63], a[116:119], a[76:79], v[60:63]
    v_exp_f32 v20, v20
    v_mfma_f32_16x16x32_bf16 v[64:67], a[120:123], a[72:75], v[64:67]
    ds_read_b128 a[116:119], v8 offset:55552
    v_cvt_pk_bf16_f32 v83, v26, v27
    v_mfma_f32_16x16x32_bf16 v[68:71], a[120:123], a[76:79], v[68:71]
    v_exp_f32 v21, v21
    v_mfma_f32_16x16x32_bf16 v[72:75], a[124:127], a[72:75], v[72:75]
    ds_read_b128 a[120:123], v8 offset:63488
    v_exp_f32 v22, v22
    v_mfma_f32_16x16x32_bf16 v[76:79], a[124:127], a[76:79], v[76:79]
    v_exp_f32 v23, v23
    s_waitcnt lgkmcnt(3)
    v_mfma_f32_16x16x32_bf16 v[48:51], a[96:99], a[80:83], v[48:51]
    ds_read_b128 a[124:127], v8 offset:63744
    v_cvt_pk_bf16_f32 v84, v20, v21
    v_mfma_f32_16x16x32_bf16 v[52:55], a[96:99], a[84:87], v[52:55]
    v_exp_f32 v28, v28
    v_mfma_f32_16x16x32_bf16 v[56:59], a[100:103], a[80:83], v[56:59]
    ds_read_b128 a[96:99], v9 offset:16384
    v_cvt_pk_bf16_f32 v85, v22, v23
    v_mfma_f32_16x16x32_bf16 v[60:63], a[100:103], a[84:87], v[60:63]
    v_exp_f32 v29, v29
    v_mfma_f32_16x16x32_bf16 v[64:67], a[104:107], a[80:83], v[64:67]
    ds_read_b128 a[100:103], v9 offset:16640
    v_exp_f32 v30, v30
    v_mfma_f32_16x16x32_bf16 v[68:71], a[104:107], a[84:87], v[68:71]
    v_exp_f32 v31, v31
    v_mfma_f32_16x16x32_bf16 v[72:75], a[108:111], a[80:83], v[72:75]
    ds_read_b128 a[104:107], v9 offset:20480
    v_cvt_pk_bf16_f32 v86, v28, v29
    v_mfma_f32_16x16x32_bf16 v[76:79], a[108:111], a[84:87], v[76:79]
    v_exp_f32 v32, v32
    s_waitcnt lgkmcnt(3)
    v_mfma_f32_16x16x32_bf16 v[48:51], a[112:115], a[88:91], v[48:51]
    ds_read_b128 a[108:111], v9 offset:20736
    v_cvt_pk_bf16_f32 v87, v30, v31
    v_mfma_f32_16x16x32_bf16 v[52:55], a[112:115], a[92:95], v[52:55]
    v_exp_f32 v33, v33
    v_mfma_f32_16x16x32_bf16 v[56:59], a[116:119], a[88:91], v[56:59]
    ds_read_b128 a[112:115], v9 offset:24576
    v_exp_f32 v34, v34
    v_mfma_f32_16x16x32_bf16 v[60:63], a[116:119], a[92:95], v[60:63]
    v_exp_f32 v35, v35
    v_mfma_f32_16x16x32_bf16 v[64:67], a[120:123], a[88:91], v[64:67]
    ds_read_b128 a[116:119], v9 offset:24832
    v_cvt_pk_bf16_f32 v88, v32, v33
    v_mfma_f32_16x16x32_bf16 v[68:71], a[120:123], a[92:95], v[68:71]
    v_exp_f32 v40, v40
    v_mfma_f32_16x16x32_bf16 v[72:75], a[124:127], a[88:91], v[72:75]
    ds_read_b128 a[120:123], v9 offset:28672
    v_cvt_pk_bf16_f32 v89, v34, v35
    v_mfma_f32_16x16x32_bf16 v[76:79], a[124:127], a[92:95], v[76:79]
    v_exp_f32 v41, v41
    s_waitcnt lgkmcnt(3)
    v_mfma_f32_16x16x32_bf16 a[0:3], a[96:99], v[80:83], a[0:3]
    ds_read_b128 a[124:127], v9 offset:28928
    v_exp_f32 v42, v42
    v_mfma_f32_16x16x32_bf16 a[4:7], a[96:99], v[84:87], a[4:7]
    v_exp_f32 v43, v43
    v_mfma_f32_16x16x32_bf16 a[8:11], a[100:103], v[80:83], a[8:11]
    ds_read_b128 a[96:99], v9 offset:18432
    v_cvt_pk_bf16_f32 v90, v40, v41
    v_mfma_f32_16x16x32_bf16 a[12:15], a[100:103], v[84:87], a[12:15]
    v_exp_f32 v36, v36
    v_mfma_f32_16x16x32_bf16 a[16:19], a[104:107], v[80:83], a[16:19]
    ds_read_b128 a[100:103], v9 offset:18688
    v_cvt_pk_bf16_f32 v91, v42, v43
    v_mfma_f32_16x16x32_bf16 a[20:23], a[104:107], v[84:87], a[20:23]
    v_exp_f32 v37, v37
    s_add_u32 s67, s67, 1
    s_cmp_lt_u32 s67, s69
    s_cbranch_scc1 Lat_nm2
    s_sub_u32 s72, s67, s69
    s_lshl_b32 s72, s72, 6
    v_subrev_u32 v12, s72, v10
    v_mov_b32 v117, 0xf149f2ca
    s_nop 7
    v_cmp_gt_i32 s[74:75], 0, v12
    v_cmp_gt_i32 s[76:77], 1, v12
    v_cmp_gt_i32 s[78:79], 2, v12
    v_cmp_gt_i32 s[80:81], 3, v12
    s_nop 0
    v_cndmask_b32 v48, v48, v117, s[74:75]
    v_cndmask_b32 v49, v49, v117, s[76:77]
    v_cndmask_b32 v50, v50, v117, s[78:79]
    v_cndmask_b32 v51, v51, v117, s[80:81]
    v_cmp_gt_i32 s[74:75], -16, v12
    v_cmp_gt_i32 s[76:77], -15, v12
    v_cmp_gt_i32 s[78:79], -14, v12
    v_cmp_gt_i32 s[80:81], -13, v12
    s_nop 0
    v_cndmask_b32 v52, v52, v117, s[74:75]
    v_cndmask_b32 v53, v53, v117, s[76:77]
    v_cndmask_b32 v54, v54, v117, s[78:79]
    v_cndmask_b32 v55, v55, v117, s[80:81]
    v_cmp_gt_i32 s[74:75], 8, v12
    v_cmp_gt_i32 s[76:77], 9, v12
    v_cmp_gt_i32 s[78:79], 10, v12
    v_cmp_gt_i32 s[80:81], 11, v12
    s_nop 0
    v_cndmask_b32 v56, v56, v117, s[74:75]
    v_cndmask_b32 v57, v57, v117, s[76:77]
    v_cndmask_b32 v58, v58, v117, s[78:79]
    v_cndmask_b32 v59, v59, v117, s[80:81]
    v_cmp_gt_i32 s[74:75], -8, v12
    v_cmp_gt_i32 s[76:77], -7, v12
    v_cmp_gt_i32 s[78:79], -6, v12
    v_cmp_gt_i32 s[80:81], -5, v12
    s_nop 0
    v_cndmask_b32 v60, v60, v117, s[74:75]
    v_cndmask_b32 v61, v61, v117, s[76:77]
    v_cndmask_b32 v62, v62, v117, s[78:79]
    v_cndmask_b32 v63, v63, v117, s[80:81]
    v_cmp_gt_i32 s[74:75], 32, v12
    v_cmp_gt_i32 s[76:77], 33, v12
    v_cmp_gt_i32 s[78:79], 34, v12
    v_cmp_gt_i32 s[80:81], 35, v12
    s_nop 0
    v_cndmask_b32 v64, v64, v117, s[74:75]
    v_cndmask_b32 v65, v65, v117, s[76:77]
    v_cndmask_b32 v66, v66, v117, s[78:79]
    v_cndmask_b32 v67, v67, v117, s[80:81]
    v_cmp_gt_i32 s[74:75], 16, v12
    v_cmp_gt_i32 s[76:77], 17, v12
    v_cmp_gt_i32 s[78:79], 18, v12
    v_cmp_gt_i32 s[80:81], 19, v12
    s_nop 0
    v_cndmask_b32 v68, v68, v117, s[74:75]
    v_cndmask_b32 v69, v69, v117, s[76:77]
    v_cndmask_b32 v70, v70, v117, s[78:79]
    v_cndmask_b32 v71, v71, v117, s[80:81]
    v_cmp_gt_i32 s[74:75], 40, v12
    v_cmp_gt_i32 s[76:77], 41, v12
    v_cmp_gt_i32 s[78:79], 42, v12
    v_cmp_gt_i32 s[80:81], 43, v12
    s_nop 0
    v_cndmask_b32 v72, v72, v117, s[74:75]
    v_cndmask_b32 v73, v73, v117, s[76:77]
    v_cndmask_b32 v74, v74, v117, s[78:79]
    v_cndmask_b32 v75, v75, v117, s[80:81]
    v_cmp_gt_i32 s[74:75], 24, v12
    v_cmp_gt_i32 s[76:77], 25, v12
    v_cmp_gt_i32 s[78:79], 26, v12
    v_cmp_gt_i32 s[80:81], 27, v12
    s_nop 0
    v_cndmask_b32 v76, v76, v117, s[74:75]
    v_cndmask_b32 v77, v77, v117, s[76:77]
    v_cndmask_b32 v78, v78, v117, s[78:79]
    v_cndmask_b32 v79, v79, v117, s[80:81]
Lat_nm2:
    v_mfma_f32_16x16x32_bf16 a[24:27], a[108:111], v[80:83], a[24:27]
    ds_read_b128 a[104:107], v9 offset:22528
    v_exp_f32 v38, v38
    v_mfma_f32_16x16x32_bf16 a[28:31], a[108:111], v[84:87], a[28:31]
    v_exp_f32 v39, v39
    s_waitcnt lgkmcnt(3)
    v_mfma_f32_16x16x32_bf16 a[32:35], a[112:115], v[80:83], a[32:35]
    ds_read_b128 a[108:111], v9 offset:22784
    v_cvt_pk_bf16_f32 v92, v36, v37
    v_mfma_f32_16x16x32_bf16 a[36:39], a[112:115], v[84:87], a[36:39]
    v_exp_f32 v44, v44
    v_mfma_f32_16x16x32_bf16 a[40:43], a[116:119], v[80:83], a[40:43]
    ds_read_b128 a[112:115], v9 offset:26624
    v_cvt_pk_bf16_f32 v93, v38, v39
    v_mfma_f32_16x16x32_bf16 a[44:47], a[116:119], v[84:87], a[44:47]
    v_exp_f32 v45, v45
    v_mfma_f32_16x16x32_bf16 a[48:51], a[120:123], v[80:83], a[48:51]
    ds_read_b128 a[116:119], v9 offset:26880
    v_exp_f32 v46, v46
    v_mfma_f32_16x16x32_bf16 a[52:55], a[120:123], v[84:87], a[52:55]
    v_exp_f32 v47, v47
    v_mfma_f32_16x16x32_bf16 a[56:59], a[124:127], v[80:83], a[56:59]
    ds_read_b128 a[120:123], v9 offset:30720
    v_cvt_pk_bf16_f32 v94, v44, v45
    v_cvt_pk_bf16_f32 v95, v46, v47
    v_mfma_f32_16x16x32_bf16 a[60:63], a[124:127], v[84:87], a[60:63]
    v_max3_f32 v11, v48, v49, v50
    v_max3_f32 v106, v52, v53, v54
    s_waitcnt lgkmcnt(3)
    v_mfma_f32_16x16x32_bf16 a[0:3], a[96:99], v[88:91], a[0:3]
    ds_read_b128 a[124:127], v9 offset:30976
    v_max3_f32 v11, v11, v51, v56
    v_mfma_f32_16x16x32_bf16 a[4:7], a[96:99], v[92:95], a[4:7]
    v_max3_f32 v106, v106, v55, v60
    v_max3_f32 v11, v11, v57, v58
    s_barrier
    v_mfma_f32_16x16x32_bf16 a[8:11], a[100:103], v[88:91], a[8:11]
    ds_read_b128 a[96:99], v9 offset:0
    v_max3_f32 v106, v106, v61, v62
    v_mfma_f32_16x16x32_bf16 a[12:15], a[100:103], v[92:95], a[12:15]
    v_max3_f32 v11, v11, v59, v64
    v_max3_f32 v106, v106, v63, v68
    v_mfma_f32_16x16x32_bf16 v[112:115], v[108:111], v[80:83], v[112:115]
    v_max3_f32 v11, v11, v65, v66
    v_max3_f32 v106, v106, v69, v70
    v_mfma_f32_16x16x32_bf16 a[16:19], a[104:107], v[88:91], a[16:19]
    ds_read_b128 a[100:103], v9 offset:256
    v_max3_f32 v11, v11, v67, v72
    v_mfma_f32_16x16x32_bf16 a[20:23], a[104:107], v[92:95], a[20:23]
    v_max3_f32 v106, v106, v71, v76
    v_max3_f32 v11, v11, v73, v74
    v_mfma_f32_16x16x32_bf16 v[120:123], v[108:111], v[84:87], v[120:123]
    v_max3_f32 v106, v106, v77, v78
    v_max_f32 v11, v11, v75
    v_mfma_f32_16x16x32_bf16 a[24:27], a[108:111], v[88:91], a[24:27]
    ds_read_b128 a[104:107], v9 offset:8192
    v_max_f32 v106, v106, v79
    v_mfma_f32_16x16x32_bf16 a[28:31], a[108:111], v[92:95], a[28:31]
    v_max_f32 v116, v11, v106
    v_cmp_lt_f32 vcc, s70, v116
    v_mfma_f32_16x16x32_bf16 v[112:115], v[108:111], v[88:91], v[112:115]
    s_waitcnt lgkmcnt(3)
    v_mfma_f32_16x16x32_bf16 a[32:35], a[112:115], v[88:91], a[32:35]
    ds_read_b128 a[108:111], v9 offset:8448
    v_mfma_f32_16x16x32_bf16 a[36:39], a[112:115], v[92:95], a[36:39]
    v_mfma_f32_16x16x32_bf16 v[120:123], v[108:111], v[92:95], v[120:123]
    v_mfma_f32_16x16x32_bf16 a[40:43], a[116:119], v[88:91], a[40:43]
    ds_read_b128 a[112:115], v9 offset:2048
    v_mfma_f32_16x16x32_bf16 a[44:47], a[116:119], v[92:95], a[44:47]
    v_mfma_f32_16x16x32_bf16 a[48:51], a[120:123], v[88:91], a[48:51]
    ds_read_b128 a[116:119], v9 offset:2304
    v_mfma_f32_16x16x32_bf16 a[52:55], a[120:123], v[92:95], a[52:55]
    v_mfma_f32_16x16x32_bf16 a[56:59], a[124:127], v[88:91], a[56:59]
    ds_read_b128 a[120:123], v9 offset:10240
    v_mfma_f32_16x16x32_bf16 a[60:63], a[124:127], v[92:95], a[60:63]
    s_cbranch_vccnz Lat_slow0
Lat_b1:
    s_cmp_eq_u32 s67, s68
    s_cbranch_scc1 Lat_last1
    s_waitcnt lgkmcnt(3)
    v_mfma_f32_16x16x32_bf16 v[16:19], a[96:99], a[64:67], v[96:99]
    ds_read_b128 a[124:127], v9 offset:10496
    v_exp_f32 v48, v48
    v_mfma_f32_16x16x32_bf16 v[20:23], a[96:99], a[68:71], v[100:103]
    v_exp_f32 v49, v49
    v_mfma_f32_16x16x32_bf16 v[24:27], a[100:103], a[64:67], v[96:99]
    ds_read_b128 a[96:99], v9 offset:4096
    v_exp_f32 v50, v50
    v_mfma_f32_16x16x32_bf16 v[28:31], a[100:103], a[68:71], v[100:103]
    v_exp_f32 v51, v51
    v_mfma_f32_16x16x32_bf16 v[32:35], a[104:107], a[64:67], v[96:99]
    ds_read_b128 a[100:103], v9 offset:4352
    v_cvt_pk_bf16_f32 v80, v48, v49
    v_mfma_f32_16x16x32_bf16 v[36:39], a[104:107], a[68:71], v[100:103]
    v_exp_f32 v56, v56
    v_mfma_f32_16x16x32_bf16 v[40:43], a[108:111], a[64:67], v[96:99]
    ds_read_b128 a[104:107], v9 offset:12288
    v_cvt_pk_bf16_f32 v81, v50, v51
    v_mfma_f32_16x16x32_bf16 v[44:47], a[108:111], a[68:71], v[100:103]
    v_exp_f32 v57, v57
    s_waitcnt lgkmcnt(3)
    v_mfma_f32_16x16x32_bf16 v[16:19], a[112:115], a[72:75], v[16:19]
    ds_read_b128 a[108:111], v9 offset:12544
    v_exp_f32 v58, v58
    v_mfma_f32_16x16x32_bf16 v[20:23], a[112:115], a[76:79], v[20:23]
    v_exp_f32 v59, v59
    v_mfma_f32_16x16x32_bf16 v[24:27], a[116:119], a[72:75], v[24:27]
    ds_read_b128 a[112:115], v9 offset:6144
    v_cvt_pk_bf16_f32 v82, v56, v57
    v_mfma_f32_16x16x32_bf16 v[28:31], a[116:119], a[76:79], v[28:31]
    v_exp_f32 v52, v52
    v_mfma_f32_16x16x32_bf16 v[32:35], a[120:123], a[72:75], v[32:35]
    ds_read_b128 a[116:119], v9 offset:6400
    v_cvt_pk_bf16_f32 v83, v58, v59
    v_mfma_f32_16x16x32_bf16 v[36:39], a[120:123], a[76:79], v[36:39]
    v_exp_f32 v53, v53
    v_mfma_f32_16x16x32_bf16 v[40:43], a[124:127], a[72:75], v[40:43]
    ds_read_b128 a[120:123], v9 offset:14336
    v_exp_f32 v54, v54
    v_mfma_f32_16x16x32_bf16 v[44:47], a[124:127], a[76:79], v[44:47]
    v_exp_f32 v55, v55
    s_waitcnt lgkmcnt(3)
    v_mfma_f32_16x16x32_bf16 v[16:19], a[96:99], a[80:83], v[16:19]
    ds_read_b128 a[124:127], v9 offset:14592
    v_cvt_pk_bf16_f32 v84, v52, v53
    v_mfma_f32_16x16x32_bf16 v[20:23], a[96:99], a[84:87], v[20:23]
    v_exp_f32 v60, v60
    v_mfma_f32_16x16x32_bf16 v[24:27], a[100:103], a[80:83], v[24:27]
    ds_read_b128 a[96:99], v9 offset:49152
    v_cvt_pk_bf16_f32 v85, v54, v55
    v_mfma_f32_16x16x32_bf16 v[28:31], a[100:103], a[84:87], v[28:31]
    v_exp_f32 v61, v61
    v_mfma_f32_16x16x32_bf16 v[32:35], a[104:107], a[80:83], v[32:35]
    ds_read_b128 a[100:103], v9 offset:49408
    v_exp_f32 v62, v62
    v_mfma_f32_16x16x32_bf16 v[36:39], a[104:107], a[84:87], v[36:39]
    v_exp_f32 v63, v63
    v_mfma_f32_16x16x32_bf16 v[40:43], a[108:111], a[80:83], v[40:43]
    ds_read_b128 a[104:107], v9 offset:53248
    v_cvt_pk_bf16_f32 v86, v60, v61
    v_mfma_f32_16x16x32_bf16 v[44:47], a[108:111], a[84:87], v[44:47]
    v_exp_f32 v64, v64
    s_waitcnt lgkmcnt(3)
    v_mfma_f32_16x16x32_bf16 v[16:19], a[112:115], a[88:91], v[16:19]
    ds_read_b128 a[108:111], v9 offset:53504
    v_cvt_pk_bf16_f32 v87, v62, v63
    v_mfma_f32_16x16x32_bf16 v[20:23], a[112:115], a[92:95], v[20:23]
    v_exp_f32 v65, v65
    v_mfma_f32_16x16x32_bf16 v[24:27], a[116:119], a[88:91], v[24:27]
    ds_read_b128 a[112:115], v9 offset:57344
    v_exp_f32 v66, v66
    v_mfma_f32_16x16x32_bf16 v[28:31], a[116:119], a[92:95], v[28:31]
    v_exp_f32 v67, v67
    v_mfma_f32_16x16x32_bf16 v[32:35], a[120:123], a[88:91], v[32:35]
    ds_read_b128 a[116:119], v9 offset:57600
    v_cvt_pk_bf16_f32 v88, v64, v65
    v_mfma_f32_16x16x32_bf16 v[36:39], a[120:123], a[92:95], v[36:39]
    v_exp_f32 v72, v72
    v_mfma_f32_16x16x32_bf16 v[40:43], a[124:127], a[88:91], v[40:43]
    ds_read_b128 a[120:123], v9 offset:61440
    v_cvt_pk_bf16_f32 v89, v66, v67
    v_mfma_f32_16x16x32_bf16 v[44:47], a[124:127], a[92:95], v[44:47]
    v_exp_f32 v73, v73
    s_waitcnt lgkmcnt(3)
    v_mfma_f32_16x16x32_bf16 a[0:3], a[96:99], v[80:83], a[0:3]
    ds_read_b128 a[124:127], v9 offset:61696
    v_exp_f32 v74, v74
    v_mfma_f32_16x16x32_bf16 a[4:7], a[96:99], v[84:87], a[4:7]
    v_exp_f32 v75, v75
    v_mfma_f32_16x16x32_bf16 a[8:11], a[100:103], v[80:83], a[8:11]
    ds_read_b128 a[96:99], v9 offset:51200
    v_cvt_pk_bf16_f32 v90, v72, v73
    v_mfma_f32_16x16x32_bf16 a[12:15], a[100:103], v[84:87], a[12:15]
    v_exp_f32 v68, v68
    v_mfma_f32_16x16x32_bf16 a[16:19], a[104:107], v[80:83], a[16:19]
    ds_read_b128 a[100:103], v9 offset:51456
    v_cvt_pk_bf16_f32 v91, v74, v75
    v_mfma_f32_16x16x32_bf16 a[20:23], a[104:107], v[84:87], a[20:23]
    v_exp_f32 v69, v69
    s_add_u32 s67, s67, 1
    s_cmp_lt_u32 s67, s69
    s_cbranch_scc1 Lat_nm3
    s_sub_u32 s72, s67, s69
    s_lshl_b32 s72, s72, 6
    v_subrev_u32 v12, s72, v10
    v_mov_b32 v117, 0xf149f2ca
    s_nop 7
    v_cmp_gt_i32 s[74:75], 0, v12
    v_cmp_gt_i32 s[76:77], 1, v12
    v_cmp_gt_i32 s[78:79], 2, v12
    v_cmp_gt_i32 s[80:81], 3, v12
    s_nop 0
    v_cndmask_b32 v16, v16, v117, s[74:75]
    v_cndmask_b32 v17, v17, v117, s[76:77]
    v_cndmask_b32 v18, v18, v117, s[78:79]
    v_cndmask_b32 v19, v19, v117, s[80:81]
    v_cmp_gt_i32 s[74:75], -16, v12
    v_cmp_gt_i32 s[76:77], -15, v12
    v_cmp_gt_i32 s[78:79], -14, v12
    v_cmp_gt_i32 s[80:81], -13, v12
    s_nop 0
    v_cndmask_b32 v20, v20, v117, s[74:75]
    v_cndmask_b32 v21, v21, v117, s[76:77]
    v_cndmask_b32 v22, v22, v117, s[78:79]
    v_cndmask_b32 v23, v23, v117, s[80:81]
    v_cmp_gt_i32 s[74:75], 8, v12
    v_cmp_gt_i32 s[76:77], 9, v12
    v_cmp_gt_i32 s[78:79], 10, v12
    v_cmp_gt_i32 s[80:81], 11, v12
    s_nop 0
    v_cndmask_b32 v24, v24, v117, s[74:75]
    v_cndmask_b32 v25, v25, v117, s[76:77]
    v_cndmask_b32 v26, v26, v117, s[78:79]
    v_cndmask_b32 v27, v27, v117, s[80:81]
    v_cmp_gt_i32 s[74:75], -8, v12
    v_cmp_gt_i32 s[76:77], -7, v12
    v_cmp_gt_i32 s[78:79], -6, v12
    v_cmp_gt_i32 s[80:81], -5, v12
    s_nop 0
    v_cndmask_b32 v28, v28, v117, s[74:75]
    v_cndmask_b32 v29, v29, v117, s[76:77]
    v_cndmask_b32 v30, v30, v117, s[78:79]
    v_cndmask_b32 v31, v31, v117, s[80:81]
    v_cmp_gt_i32 s[74:75], 32, v12
    v_cmp_gt_i32 s[76:77], 33, v12
    v_cmp_gt_i32 s[78:79], 34, v12
    v_cmp_gt_i32 s[80:81], 35, v12
    s_nop 0
    v_cndmask_b32 v32, v32, v117, s[74:75]
    v_cndmask_b32 v33, v33, v117, s[76:77]
    v_cndmask_b32 v34, v34, v117, s[78:79]
    v_cndmask_b32 v35, v35, v117, s[80:81]
    v_cmp_gt_i32 s[74:75], 16, v12
    v_cmp_gt_i32 s[76:77], 17, v12
    v_cmp_gt_i32 s[78:79], 18, v12
    v_cmp_gt_i32 s[80:81], 19, v12
    s_nop 0
    v_cndmask_b32 v36, v36, v117, s[74:75]
    v_cndmask_b32 v37, v37, v117, s[76:77]
    v_cndmask_b32 v38, v38, v117, s[78:79]
    v_cndmask_b32 v39, v39, v117, s[80:81]
    v_cmp_gt_i32 s[74:75], 40, v12
    v_cmp_gt_i32 s[76:77], 41, v12
    v_cmp_gt_i32 s[78:79], 42, v12
    v_cmp_gt_i32 s[80:81], 43, v12
    s_nop 0
    v_cndmask_b32 v40, v40, v117, s[74:75]
    v_cndmask_b32 v41, v41, v117, s[76:77]
    v_cndmask_b32 v42, v42, v117, s[78:79]
    v_cndmask_b32 v43, v43, v117, s[80:81]
    v_cmp_gt_i32 s[74:75], 24, v12
    v_cmp_gt_i32 s[76:77], 25, v12
    v_cmp_gt_i32 s[78:79], 26, v12
    v_cmp_gt_i32 s[80:81], 27, v12
    s_nop 0
    v_cndmask_b32 v44, v44, v117, s[74:75]
    v_cndmask_b32 v45, v45, v117, s[76:77]
    v_cndmask_b32 v46, v46, v117, s[78:79]
    v_cndmask_b32 v47, v47, v117, s[80:81]
Lat_nm3:
    v_mfma_f32_16x16x32_bf16 a[24:27], a[108:111], v[80:83], a[24:27]
    ds_read_b128 a[104:107], v9 offset:55296
    v_exp_f32 v70, v70
    v_mfma_f32_16x16x32_bf16 a[28:31], a[108:111], v[84:87], a[28:31]
    v_exp_f32 v71, v71
    s_waitcnt lgkmcnt(3)
    v_mfma_f32_16x16x32_bf16 a[32:35], a[112:115], v[80:83], a[32:35]
    ds_read_b128 a[108:111], v9 offset:55552
    v_cvt_pk_bf16_f32 v92, v68, v69
    v_mfma_f32_16x16x32_bf16 a[36:39], a[112:115], v[84:87], a[36:39]
    v_exp_f32 v76, v76
    v_mfma_f32_16x16x32_bf16 a[40:43], a[116:119], v[80:83], a[40:43]
    ds_read_b128 a[112:115], v9 offset:59392
    v_cvt_pk_bf16_f32 v93, v70, v71
    v_mfma_f32_16x16x32_bf16 a[44:47], a[116:119], v[84:87], a[44:47]
    v_exp_f32 v77, v77
    v_mfma_f32_16x16x32_bf16 a[48:51], a[120:123], v[80:83], a[48:51]
    ds_read_b128 a[116:119], v9 offset:59648
    v_exp_f32 v78, v78
    v_mfma_f32_16x16x32_bf16 a[52:55], a[120:123], v[84:87], a[52:55]
    v_exp_f32 v79, v79
    v_mfma_f32_16x16x32_bf16 a[56:59], a[124:127], v[80:83], a[56:59]
    ds_read_b128 a[120:123], v9 offset:63488
    v_cvt_pk_bf16_f32 v94, v76, v77
    v_cvt_pk_bf16_f32 v95, v78, v79
    v_mfma_f32_16x16x32_bf16 a[60:63], a[124:127], v[84:87], a[60:63]
    v_max3_f32 v11, v16, v17, v18
    v_max3_f32 v106, v20, v21, v22
    s_waitcnt lgkmcnt(3)
    v_mfma_f32_16x16x32_bf16 a[0:3], a[96:99], v[88:91], a[0:3]
    ds_read_b128 a[124:127], v9 offset:63744
    v_max3_f32 v11, v11, v19, v24
    v_mfma_f32_16x16x32_bf16 a[4:7], a[96:99], v[92:95], a[4:7]
    v_max3_f32 v106, v106, v23, v28
    v_max3_f32 v11, v11, v25, v26
    s_barrier
    v_mfma_f32_16x16x32_bf16 a[8:11], a[100:103], v[88:91], a[8:11]
    ds_read_b128 a[96:99], v9 offset:32768
    v_max3_f32 v106, v106, v29, v30
    v_mfma_f32_16x16x32_bf16 a[12:15], a[100:103], v[92:95], a[12:15]
    v_max3_f32 v11, v11, v27, v32
    v_max3_f32 v106, v106, v31, v36
    v_mfma_f32_16x16x32_bf16 v[112:115], v[108:111], v[80:83], v[112:115]
    v_max3_f32 v11, v11, v33, v34
    v_max3_f32 v106, v106, v37, v38
    v_mfma_f32_16x16x32_bf16 a[16:19], a[104:107], v[88:91], a[16:19]
    ds_read_b128 a[100:103], v9 offset:33024
    v_max3_f32 v11, v11, v35, v40
    v_mfma_f32_16x16x32_bf16 a[20:23], a[104:107], v[92:95], a[20:23]
    v_max3_f32 v106, v106, v39, v44
    v_max3_f32 v11, v11, v41, v42
    v_mfma_f32_16x16x32_bf16 v[120:123], v[108:111], v[84:87], v[120:123]
    v_max3_f32 v106, v106, v45, v46
    v_max_f32 v11, v11, v43
    v_mfma_f32_16x16x32_bf16 a[24:27], a[108:111], v[88:91], a[24:27]
    ds_read_b128 a[104:107], v9 offset:40960
    v_max_f32 v106, v106, v47
    v_mfma_f32_16x16x32_bf16 a[28:31], a[108:111], v[92:95], a[28:31]
    v_max_f32 v116, v11, v106
    v_cmp_lt_f32 vcc, s70, v116
    v_mfma_f32_16x16x32_bf16 v[112:115], v[108:111], v[88:91], v[112:115]
    s_waitcnt lgkmcnt(3)
    v_mfma_f32_16x16x32_bf16 a[32:35], a[112:115], v[88:91], a[32:35]
    ds_read_b128 a[108:111], v9 offset:41216
    v_mfma_f32_16x16x32_bf16 a[36:39], a[112:115], v[92:95], a[36:39]
    v_mfma_f32_16x16x32_bf16 v[120:123], v[108:111], v[92:95], v[120:123]
    v_mfma_f32_16x16x32_bf16 a[40:43], a[116:119], v[88:91], a[40:43]
    ds_read_b128 a[112:115], v9 offset:34816
    v_mfma_f32_16x16x32_bf16 a[44:47], a[116:119], v[92:95], a[44:47]
    v_mfma_f32_16x16x32_bf16 a[48:51], a[120:123], v[88:91], a[48:51]
    ds_read_b128 a[116:119], v9 offset:35072
    v_mfma_f32_16x16x32_bf16 a[52:55], a[120:123], v[92:95], a[52:55]
    v_mfma_f32_16x16x32_bf16 a[56:59], a[124:127], v[88:91], a[56:59]
    ds_read_b128 a[120:123], v9 offset:43008
    v_mfma_f32_16x16x32_bf16 a[60:63], a[124:127], v[92:95], a[60:63]
    s_cbranch_vccnz Lat_slow1
Lat_b2:
    s_waitcnt lgkmcnt(3)
    v_mfma_f32_16x16x32_bf16 v[48:51], a[96:99], a[64:67], v[96:99]
    ds_read_b128 a[124:127], v9 offset:43264
    v_exp_f32 v16, v16
    v_mfma_f32_16x16x32_bf16 v[52:55], a[96:99], a[68:71], v[100:103]
    v_exp_f32 v17, v17
    v_mfma_f32_16x16x32_bf16 v[56:59], a[100:103], a[64:67], v[96:99]
    ds_read_b128 a[96:99], v9 offset:36864
    v_exp_f32 v18, v18
    v_mfma_f32_16x16x32_bf16 v[60:63], a[100:103], a[68:71], v[100:103]
    v_exp_f32 v19, v19
    v_mfma_f32_16x16x32_bf16 v[64:67], a[104:107], a[64:67], v[96:99]
    ds_read_b128 a[100:103], v9 offset:37120
    v_cvt_pk_bf16_f32 v80, v16, v17
    v_mfma_f32_16x16x32_bf16 v[68:71], a[104:107], a[68:71], v[100:103]
    v_exp_f32 v24, v24
    v_mfma_f32_16x16x32_bf16 v[72:75], a[108:111], a[64:67], v[96:99]
    ds_read_b128 a[104:107], v9 offset:45056
    v_cvt_pk_bf16_f32 v81, v18, v19
    v_mfma_f32_16x16x32_bf16 v[76:79], a[108:111], a[68:71], v[100:103]
    v_exp_f32 v25, v25
    s_waitcnt lgkmcnt(3)
    v_mfma_f32_16x16x32_bf16 v[48:51], a[112:115], a[72:75], v[48:51]
    ds_read_b128 a[108:111], v9 offset:45312
    v_exp_f32 v26, v26
    v_mfma_f32_16x16x32_bf16 v[52:55], a[112:115], a[76:79], v[52:55]
    v_exp_f32 v27, v27
    v_mfma_f32_16x16x32_bf16 v[56:59], a[116:119], a[72:75], v[56:59]
    ds_read_b128 a[112:115], v9 offset:38912
    v_cvt_pk_bf16_f32 v82, v24, v25
    v_mfma_f32_16x16x32_bf16 v[60:63], a[116:119], a[76:79], v[60:63]
    v_exp_f32 v20, v20
    v_mfma_f32_16x16x32_bf16 v[64:67], a[120:123], a[72:75], v[64:67]
    ds_read_b128 a[116:119], v9 offset:39168
    v_cvt_pk_bf16_f32 v83, v26, v27
    v_mfma_f32_16x16x32_bf16 v[68:71], a[120:123], a[76:79], v[68:71]
    v_exp_f32 v21, v21
    v_mfma_f32_16x16x32_bf16 v[72:75], a[124:127], a[72:75], v[72:75]
    ds_read_b128 a[120:123], v9 offset:47104
    v_exp_f32 v22, v22
    v_mfma_f32_16x16x32_bf16 v[76:79], a[124:127], a[76:79], v[76:79]
    v_exp_f32 v23, v23
    s_waitcnt lgkmcnt(3)
    v_mfma_f32_16x16x32_bf16 v[48:51], a[96:99], a[80:83], v[48:51]
    ds_read_b128 a[124:127], v9 offset:47360
    v_cvt_pk_bf16_f32 v84, v20, v21
    v_mfma_f32_16x16x32_bf16 v[52:55], a[96:99], a[84:87], v[52:55]
    v_exp_f32 v28, v28
    v_mfma_f32_16x16x32_bf16 v[56:59], a[100:103], a[80:83], v[56:59]
    ds_read_b128 a[96:99], v14 offset:0
    v_cvt_pk_bf16_f32 v85, v22, v23
    v_mfma_f32_16x16x32_bf16 v[60:63], a[100:103], a[84:87], v[60:63]
    v_exp_f32 v29, v29
    v_mfma_f32_16x16x32_bf16 v[64:67], a[104:107], a[80:83], v[64:67]
    ds_read_b128 a[100:103], v14 offset:256
    v_exp_f32 v30, v30
    v_mfma_f32_16x16x32_bf16 v[68:71], a[104:107], a[84:87], v[68:71]
    v_exp_f32 v31, v31
    v_mfma_f32_16x16x32_bf16 v[72:75], a[108:111], a[80:83], v[72:75]
    ds_read_b128 a[104:107], v14 offset:4096
    v_cvt_pk_bf16_f32 v86, v28, v29
    v_mfma_f32_16x16x32_bf16 v[76:79], a[108:111], a[84:87], v[76:79]
    v_exp_f32 v32, v32
    s_waitcnt lgkmcnt(3)
    v_mfma_f32_16x16x32_bf16 v[48:51], a[112:115], a[88:91], v[48:51]
    ds_read_b128 a[108:111], v14 offset:4352
    v_cvt_pk_bf16_f32 v87, v30, v31
    v_mfma_f32_16x16x32_bf16 v[52:55], a[112:115], a[92:95], v[52:55]
    v_exp_f32 v33, v33
    v_mfma_f32_16x16x32_bf16 v[56:59], a[116:119], a[88:91], v[56:59]
    ds_read_b128 a[112:115], v14 offset:8192
    v_exp_f32 v34, v34
    v_mfma_f32_16x16x32_bf16 v[60:63], a[116:119], a[92:95], v[60:63]
    v_exp_f32 v35, v35
    v_mfma_f32_16x16x32_bf16 v[64:67], a[120:123], a[88:91], v[64:67]
    ds_read_b128 a[116:119], v14 offset:8448
    v_cvt_pk_bf16_f32 v88, v32, v33
    v_mfma_f32_16x16x32_bf16 v[68:71], a[120:123], a[92:95], v[68:71]
    v_exp_f32 v40, v40
    v_mfma_f32_16x16x32_bf16 v[72:75], a[124:127], a[88:91], v[72:75]
    ds_read_b128 a[120:123], v14 offset:12288
    v_cvt_pk_bf16_f32 v89, v34, v35
    v_mfma_f32_16x16x32_bf16 v[76:79], a[124:127], a[92:95], v[76:79]
    v_exp_f32 v41, v41
    s_waitcnt lgkmcnt(3)
    v_mfma_f32_16x16x32_bf16 a[0:3], a[96:99], v[80:83], a[0:3]
    ds_read_b128 a[124:127], v14 offset:12544
    v_exp_f32 v42, v42
    v_mfma_f32_16x16x32_bf16 a[4:7], a[96:99], v[84:87], a[4:7]
    v_exp_f32 v43, v43
    v_mfma_f32_16x16x32_bf16 a[8:11], a[100:103], v[80:83], a[8:11]
    ds_read_b128 a[96:99], v14 offset:2048
    v_cvt_pk_bf16_f32 v90, v40, v41
    v_mfma_f32_16x16x32_bf16 a[12:15], a[100:103], v[84:87], a[12:15]
    v_exp_f32 v36, v36
    v_mfma_f32_16x16x32_bf16 a[16:19], a[104:107], v[80:83], a[16:19]
    ds_read_b128 a[100:103], v14 offset:2304
    v_cvt_pk_bf16_f32 v91, v42, v43
    v_mfma_f32_16x16x32_bf16 a[20:23], a[104:107], v[84:87], a[20:23]
    v_exp_f32 v37, v37
    s_add_u32 s67, s67, 1
    s_cmp_lt_u32 s67, s69
    s_cbranch_scc1 Lat_nm4
    s_sub_u32 s72, s67, s69
    s_lshl_b32 s72, s72, 6
    v_subrev_u32 v12, s72, v10
    v_mov_b32 v117, 0xf149f2ca
    s_nop 7
    v_cmp_gt_i32 s[74:75], 0, v12
    v_cmp_gt_i32 s[76:77], 1, v12
    v_cmp_gt_i32 s[78:79], 2, v12
    v_cmp_gt_i32 s[80:81], 3, v12
    s_nop 0
    v_cndmask_b32 v48, v48, v117, s[74:75]
    v_cndmask_b32 v49, v49, v117, s[76:77]
    v_cndmask_b32 v50, v50, v117, s[78:79]
    v_cndmask_b32 v51, v51, v117, s[80:81]
    v_cmp_gt_i32 s[74:75], -16, v12
    v_cmp_gt_i32 s[76:77], -15, v12
    v_cmp_gt_i32 s[78:79], -14, v12
    v_cmp_gt_i32 s[80:81], -13, v12
    s_nop 0
    v_cndmask_b32 v52, v52, v117, s[74:75]
    v_cndmask_b32 v53, v53, v117, s[76:77]
    v_cndmask_b32 v54, v54, v117, s[78:79]
    v_cndmask_b32 v55, v55, v117, s[80:81]
    v_cmp_gt_i32 s[74:75], 8, v12
    v_cmp_gt_i32 s[76:77], 9, v12
    v_cmp_gt_i32 s[78:79], 10, v12
    v_cmp_gt_i32 s[80:81], 11, v12
    s_nop 0
    v_cndmask_b32 v56, v56, v117, s[74:75]
    v_cndmask_b32 v57, v57, v117, s[76:77]
    v_cndmask_b32 v58, v58, v117, s[78:79]
    v_cndmask_b32 v59, v59, v117, s[80:81]
    v_cmp_gt_i32 s[74:75], -8, v12
    v_cmp_gt_i32 s[76:77], -7, v12
    v_cmp_gt_i32 s[78:79], -6, v12
    v_cmp_gt_i32 s[80:81], -5, v12
    s_nop 0
    v_cndmask_b32 v60, v60, v117, s[74:75]
    v_cndmask_b32 v61, v61, v117, s[76:77]
    v_cndmask_b32 v62, v62, v117, s[78:79]
    v_cndmask_b32 v63, v63, v117, s[80:81]
    v_cmp_gt_i32 s[74:75], 32, v12
    v_cmp_gt_i32 s[76:77], 33, v12
    v_cmp_gt_i32 s[78:79], 34, v12
    v_cmp_gt_i32 s[80:81], 35, v12
    s_nop 0
    v_cndmask_b32 v64, v64, v117, s[74:75]
    v_cndmask_b32 v65, v65, v117, s[76:77]
    v_cndmask_b32 v66, v66, v117, s[78:79]
    v_cndmask_b32 v67, v67, v117, s[80:81]
    v_cmp_gt_i32 s[74:75], 16, v12
    v_cmp_gt_i32 s[76:77], 17, v12
    v_cmp_gt_i32 s[78:79], 18, v12
    v_cmp_gt_i32 s[80:81], 19, v12
    s_nop 0
    v_cndmask_b32 v68, v68, v117, s[74:75]
    v_cndmask_b32 v69, v69, v117, s[76:77]
    v_cndmask_b32 v70, v70, v117, s[78:79]
    v_cndmask_b32 v71, v71, v117, s[80:81]
    v_cmp_gt_i32 s[74:75], 40, v12
    v_cmp_gt_i32 s[76:77], 41, v12
    v_cmp_gt_i32 s[78:79], 42, v12
    v_cmp_gt_i32 s[80:81], 43, v12
    s_nop 0
    v_cndmask_b32 v72, v72, v117, s[74:75]
    v_cndmask_b32 v73, v73, v117, s[76:77]
    v_cndmask_b32 v74, v74, v117, s[78:79]
    v_cndmask_b32 v75, v75, v117, s[80:81]
    v_cmp_gt_i32 s[74:75], 24, v12
    v_cmp_gt_i32 s[76:77], 25, v12
    v_cmp_gt_i32 s[78:79], 26, v12
    v_cmp_gt_i32 s[80:81], 27, v12
    s_nop 0
    v_cndmask_b32 v76, v76, v117, s[74:75]
    v_cndmask_b32 v77, v77, v117, s[76:77]
    v_cndmask_b32 v78, v78, v117, s[78:79]
    v_cndmask_b32 v79, v79, v117, s[80:81]
Lat_nm4:
    v_mfma_f32_16x16x32_bf16 a[24:27], a[108:111], v[80:83], a[24:27]
    ds_read_b128 a[104:107], v14 offset:6144
    v_exp_f32 v38, v38
    v_mfma_f32_16x16x32_bf16 a[28:31], a[108:111], v[84:87], a[28:31]
    v_exp_f32 v39, v39
    s_waitcnt lgkmcnt(3)
    v_mfma_f32_16x16x32_bf16 a[32:35], a[112:115], v[80:83], a[32:35]
    ds_read_b128 a[108:111], v14 offset:6400
    v_cvt_pk_bf16_f32 v92, v36, v37
    v_mfma_f32_16x16x32_bf16 a[36:39], a[112:115], v[84:87], a[36:39]
    v_exp_f32 v44, v44
    v_mfma_f32_16x16x32_bf16 a[40:43], a[116:119], v[80:83], a[40:43]
    ds_read_b128 a[112:115], v14 offset:10240
    v_cvt_pk_bf16_f32 v93, v38, v39
    v_mfma_f32_16x16x32_bf16 a[44:47], a[116:119], v[84:87], a[44:47]
    v_exp_f32 v45, v45
    v_mfma_f32_16x16x32_bf16 a[48:51], a[120:123], v[80:83], a[48:51]
    ds_read_b128 a[116:119], v14 offset:10496
    v_exp_f32 v46, v46
    v_mfma_f32_16x16x32_bf16 a[52:55], a[120:123], v[84:87], a[52:55]
    v_exp_f32 v47, v47
    v_mfma_f32_16x16x32_bf16 a[56:59], a[124:127], v[80:83], a[56:59]
    ds_read_b128 a[120:123], v14 offset:14336
    v_cvt_pk_bf16_f32 v94, v44, v45
    v_cvt_pk_bf16_f32 v95, v46, v47
    v_mfma_f32_16x16x32_bf16 a[60:63], a[124:127], v[84:87], a[60:63]
    v_max3_f32 v11, v48, v49, v50
    v_max3_f32 v106, v52, v53, v54
    s_waitcnt lgkmcnt(3)
    v_mfma_f32_16x16x32_bf16 a[0:3], a[96:99], v[88:91], a[0:3]
    ds_read_b128 a[124:127], v14 offset:14592
    v_max3_f32 v11, v11, v51, v56
    v_mfma_f32_16x16x32_bf16 a[4:7], a[96:99], v[92:95], a[4:7]
    v_max3_f32 v106, v106, v55, v60
    v_max3_f32 v11, v11, v57, v58
    s_barrier
    v_mfma_f32_16x16x32_bf16 a[8:11], a[100:103], v[88:91], a[8:11]
    ds_read_b128 a[96:99], v14 offset:16384
    v_max3_f32 v106, v106, v61, v62
    v_mfma_f32_16x16x32_bf16 a[12:15], a[100:103], v[92:95], a[12:15]
    v_max3_f32 v11, v11, v59, v64
    v_max3_f32 v106, v106, v63, v68
    v_mfma_f32_16x16x32_bf16 v[112:115], v[108:111], v[80:83], v[112:115]
    v_max3_f32 v11, v11, v65, v66
    v_max3_f32 v106, v106, v69, v70
    v_mfma_f32_16x16x32_bf16 a[16:19], a[104:107], v[88:91], a[16:19]
    ds_read_b128 a[100:103], v14 offset:16640
    v_max3_f32 v11, v11, v67, v72
    v_mfma_f32_16x16x32_bf16 a[20:23], a[104:107], v[92:95], a[20:23]
    v_max3_f32 v106, v106, v71, v76
    v_max3_f32 v11, v11, v73, v74
    v_mfma_f32_16x16x32_bf16 v[120:123], v[108:111], v[84:87], v[120:123]
    v_max3_f32 v106, v106, v77, v78
    v_max_f32 v11, v11, v75
    v_mfma_f32_16x16x32_bf16 a[24:27], a[108:111], v[88:91], a[24:27]
    ds_read_b128 a[104:107], v14 offset:24576
    v_max_f32 v106, v106, v79
    v_mfma_f32_16x16x32_bf16 a[28:31], a[108:111], v[92:95], a[28:31]
    v_max_f32 v116, v11, v106
    v_cmp_lt_f32 vcc, s70, v116
    v_mfma_f32_16x16x32_bf16 v[112:115], v[108:111], v[88:91], v[112:115]
    s_waitcnt lgkmcnt(3)
    v_mfma_f32_16x16x32_bf16 a[32:35], a[112:115], v[88:91], a[32:35]
    ds_read_b128 a[108:111], v14 offset:24832
    v_mfma_f32_16x16x32_bf16 a[36:39], a[112:115], v[92:95], a[36:39]
    v_mfma_f32_16x16x32_bf16 v[120:123], v[108:111], v[92:95], v[120:123]
    v_mfma_f32_16x16x32_bf16 a[40:43], a[116:119], v[88:91], a[40:43]
    ds_read_b128 a[112:115], v14 offset:18432
    v_mfma_f32_16x16x32_bf16 a[44:47], a[116:119], v[92:95], a[44:47]
    v_mfma_f32_16x16x32_bf16 a[48:51], a[120:123], v[88:91], a[48:51]
    ds_read_b128 a[116:119], v14 offset:18688
    v_mfma_f32_16x16x32_bf16 a[52:55], a[120:123], v[92:95], a[52:55]
    v_mfma_f32_16x16x32_bf16 a[56:59], a[124:127], v[88:91], a[56:59]
    ds_read_b128 a[120:123], v14 offset:26624
    v_mfma_f32_16x16x32_bf16 a[60:63], a[124:127], v[92:95], a[60:63]
    s_cbranch_vccnz Lat_slow2
Lat_b3:
    s_cmp_eq_u32 s67, s68
    s_cbranch_scc1 Lat_last3
    s_waitcnt lgkmcnt(3)
    v_mfma_f32_16x16x32_bf16 v[16:19], a[96:99], a[64:67], v[96:99]
    ds_read_b128 a[124:127], v14 offset:26880
    v_exp_f32 v48, v48
    v_mfma_f32_16x16x32_bf16 v[20:23], a[96:99], a[68:71], v[100:103]
    v_exp_f32 v49, v49
    v_mfma_f32_16x16x32_bf16 v[24:27], a[100:103], a[64:67], v[96:99]
    ds_read_b128 a[96:99], v14 offset:20480
    v_exp_f32 v50, v50
    v_mfma_f32_16x16x32_bf16 v[28:31], a[100:103], a[68:71], v[100:103]
    v_exp_f32 v51, v51
    v_mfma_f32_16x16x32_bf16 v[32:35], a[104:107], a[64:67], v[96:99]
    ds_read_b128 a[100:103], v14 offset:20736
    v_cvt_pk_bf16_f32 v80, v48, v49
    v_mfma_f32_16x16x32_bf16 v[36:39], a[104:107], a[68:71], v[100:103]
    v_exp_f32 v56, v56
    v_mfma_f32_16x16x32_bf16 v[40:43], a[108:111], a[64:67], v[96:99]
    ds_read_b128 a[104:107], v14 offset:28672
    v_cvt_pk_bf16_f32 v81, v50, v51
    v_mfma_f32_16x16x32_bf16 v[44:47], a[108:111], a[68:71], v[100:103]
    v_exp_f32 v57, v57
    s_waitcnt lgkmcnt(3)
    v_mfma_f32_16x16x32_bf16 v[16:19], a[112:115], a[72:75], v[16:19]
    ds_read_b128 a[108:111], v14 offset:28928
    v_exp_f32 v58, v58
    v_mfma_f32_16x16x32_bf16 v[20:23], a[112:115], a[76:79], v[20:23]
    v_exp_f32 v59, v59
    v_mfma_f32_16x16x32_bf16 v[24:27], a[116:119], a[72:75], v[24:27]
    ds_read_b128 a[112:115], v14 offset:22528
    v_cvt_pk_bf16_f32 v82, v56, v57
    v_mfma_f32_16x16x32_bf16 v[28:31], a[116:119], a[76:79], v[28:31]
    v_exp_f32 v52, v52
    v_mfma_f32_16x16x32_bf16 v[32:35], a[120:123], a[72:75], v[32:35]
    ds_read_b128 a[116:119], v14 offset:22784
    v_cvt_pk_bf16_f32 v83, v58, v59
    v_mfma_f32_16x16x32_bf16 v[36:39], a[120:123], a[76:79], v[36:39]
    v_exp_f32 v53, v53
    v_mfma_f32_16x16x32_bf16 v[40:43], a[124:127], a[72:75], v[40:43]
    ds_read_b128 a[120:123], v14 offset:30720
    v_exp_f32 v54, v54
    v_mfma_f32_16x16x32_bf16 v[44:47], a[124:127], a[76:79], v[44:47]
    v_exp_f32 v55, v55
    s_waitcnt lgkmcnt(3)
    v_mfma_f32_16x16x32_bf16 v[16:19], a[96:99], a[80:83], v[16:19]
    ds_read_b128 a[124:127], v14 offset:30976
    v_cvt_pk_bf16_f32 v84, v52, v53
    v_mfma_f32_16x16x32_bf16 v[20:23], a[96:99], a[84:87], v[20:23]
    v_exp_f32 v60, v60
    v_mfma_f32_16x16x32_bf16 v[24:27], a[100:103], a[80:83], v[24:27]
    ds_read_b128 a[96:99], v8 offset:0
    v_cvt_pk_bf16_f32 v85, v54, v55
    v_mfma_f32_16x16x32_bf16 v[28:31], a[100:103], a[84:87], v[28:31]
    v_exp_f32 v61, v61
    v_mfma_f32_16x16x32_bf16 v[32:35], a[104:107], a[80:83], v[32:35]
    ds_read_b128 a[100:103], v8 offset:256
    v_exp_f32 v62, v62
    v_mfma_f32_16x16x32_bf16 v[36:39], a[104:107], a[84:87], v[36:39]
    v_exp_f32 v63, v63
    v_mfma_f32_16x16x32_bf16 v[40:43], a[108:111], a[80:83], v[40:43]
    ds_read_b128 a[104:107], v8 offset:4096
    v_cvt_pk_bf16_f32 v86, v60, v61
    v_mfma_f32_16x16x32_bf16 v[44:47], a[108:111], a[84:87], v[44:47]
    v_exp_f32 v64, v64
    s_waitcnt lgkmcnt(3)
    v_mfma_f32_16x16x32_bf16 v[16:19], a[112:115], a[88:91], v[16:19]
    ds_read_b128 a[108:111], v8 offset:4352
    v_cvt_pk_bf16_f32 v87, v62, v63
    v_mfma_f32_16x16x32_bf16 v[20:23], a[112:115], a[92:95], v[20:23]
    v_exp_f32 v65, v65
    v_mfma_f32_16x16x32_bf16 v[24:27], a[116:119], a[88:91], v[24:27]
    ds_read_b128 a[112:115], v8 offset:8192
    v_exp_f32 v66, v66
    v_mfma_f32_16x16x32_bf16 v[28:31], a[116:119], a[92:95], v[28:31]
    v_exp_f32 v67, v67
    v_mfma_f32_16x16x32_bf16 v[32:35], a[120:123], a[88:91], v[32:35]
    ds_read_b128 a[116:119], v8 offset:8448
    v_cvt_pk_bf16_f32 v88, v64, v65
    v_mfma_f32_16x16x32_bf16 v[36:39], a[120:123], a[92:95], v[36:39]
    v_exp_f32 v72, v72
    v_mfma_f32_16x16x32_bf16 v[40:43], a[124:127], a[88:91], v[40:43]
    ds_read_b128 a[120:123], v8 offset:12288
    v_cvt_pk_bf16_f32 v89, v66, v67
    v_mfma_f32_16x16x32_bf16 v[44:47], a[124:127], a[92:95], v[44:47]
    v_exp_f32 v73, v73
    s_waitcnt lgkmcnt(3)
    v_mfma_f32_16x16x32_bf16 a[0:3], a[96:99], v[80:83], a[0:3]
    ds_read_b128 a[124:127], v8 offset:12544
    v_exp_f32 v74, v74
    v_mfma_f32_16x16x32_bf16 a[4:7], a[96:99], v[84:87], a[4:7]
    v_exp_f32 v75, v75
    v_mfma_f32_16x16x32_bf16 a[8:11], a[100:103], v[80:83], a[8:11]
    ds_read_b128 a[96:99], v8 offset:2048
    v_cvt_pk_bf16_f32 v90, v72, v73
    v_mfma_f32_16x16x32_bf16 a[12:15], a[100:103], v[84:87], a[12:15]
    v_exp_f32 v68, v68
    v_mfma_f32_16x16x32_bf16 a[16:19], a[104:107], v[80:83], a[16:19]
    ds_read_b128 a[100:103], v8 offset:2304
    v_cvt_pk_bf16_f32 v91, v74, v75
    v_mfma_f32_16x16x32_bf16 a[20:23], a[104:107], v[84:87], a[20:23]
    v_exp_f32 v69, v69
    s_add_u32 s67, s67, 1
    s_cmp_lt_u32 s67, s69
    s_cbranch_scc1 Lat_nm5
    s_sub_u32 s72, s67, s69
    s_lshl_b32 s72, s72, 6
    v_subrev_u32 v12, s72, v10
    v_mov_b32 v117, 0xf149f2ca
    s_nop 7
    v_cmp_gt_i32 s[74:75], 0, v12
    v_cmp_gt_i32 s[76:77], 1, v12
    v_cmp_gt_i32 s[78:79], 2, v12
    v_cmp_gt_i32 s[80:81], 3, v12
    s_nop 0
    v_cndmask_b32 v16, v16, v117, s[74:75]
    v_cndmask_b32 v17, v17, v117, s[76:77]
    v_cndmask_b32 v18, v18, v117, s[78:79]
    v_cndmask_b32 v19, v19, v117, s[80:81]
    v_cmp_gt_i32 s[74:75], -16, v12
    v_cmp_gt_i32 s[76:77], -15, v12
    v_cmp_gt_i32 s[78:79], -14, v12
    v_cmp_gt_i32 s[80:81], -13, v12
    s_nop 0
    v_cndmask_b32 v20, v20, v117, s[74:75]
    v_cndmask_b32 v21, v21, v117, s[76:77]
    v_cndmask_b32 v22, v22, v117, s[78:79]
    v_cndmask_b32 v23, v23, v117, s[80:81]
    v_cmp_gt_i32 s[74:75], 8, v12
    v_cmp_gt_i32 s[76:77], 9, v12
    v_cmp_gt_i32 s[78:79], 10, v12
    v_cmp_gt_i32 s[80:81], 11, v12
    s_nop 0
    v_cndmask_b32 v24, v24, v117, s[74:75]
    v_cndmask_b32 v25, v25, v117, s[76:77]
    v_cndmask_b32 v26, v26, v117, s[78:79]
    v_cndmask_b32 v27, v27, v117, s[80:81]
    v_cmp_gt_i32 s[74:75], -8, v12
    v_cmp_gt_i32 s[76:77], -7, v12
    v_cmp_gt_i32 s[78:79], -6, v12
    v_cmp_gt_i32 s[80:81], -5, v12
    s_nop 0
    v_cndmask_b32 v28, v28, v117, s[74:75]
    v_cndmask_b32 v29, v29, v117, s[76:77]
    v_cndmask_b32 v30, v30, v117, s[78:79]
    v_cndmask_b32 v31, v31, v117, s[80:81]
    v_cmp_gt_i32 s[74:75], 32, v12
    v_cmp_gt_i32 s[76:77], 33, v12
    v_cmp_gt_i32 s[78:79], 34, v12
    v_cmp_gt_i32 s[80:81], 35, v12
    s_nop 0
    v_cndmask_b32 v32, v32, v117, s[74:75]
    v_cndmask_b32 v33, v33, v117, s[76:77]
    v_cndmask_b32 v34, v34, v117, s[78:79]
    v_cndmask_b32 v35, v35, v117, s[80:81]
    v_cmp_gt_i32 s[74:75], 16, v12
    v_cmp_gt_i32 s[76:77], 17, v12
    v_cmp_gt_i32 s[78:79], 18, v12
    v_cmp_gt_i32 s[80:81], 19, v12
    s_nop 0
    v_cndmask_b32 v36, v36, v117, s[74:75]
    v_cndmask_b32 v37, v37, v117, s[76:77]
    v_cndmask_b32 v38, v38, v117, s[78:79]
    v_cndmask_b32 v39, v39, v117, s[80:81]
    v_cmp_gt_i32 s[74:75], 40, v12
    v_cmp_gt_i32 s[76:77], 41, v12
    v_cmp_gt_i32 s[78:79], 42, v12
    v_cmp_gt_i32 s[80:81], 43, v12
    s_nop 0
    v_cndmask_b32 v40, v40, v117, s[74:75]
    v_cndmask_b32 v41, v41, v117, s[76:77]
    v_cndmask_b32 v42, v42, v117, s[78:79]
    v_cndmask_b32 v43, v43, v117, s[80:81]
    v_cmp_gt_i32 s[74:75], 24, v12
    v_cmp_gt_i32 s[76:77], 25, v12
    v_cmp_gt_i32 s[78:79], 26, v12
    v_cmp_gt_i32 s[80:81], 27, v12
    s_nop 0
    v_cndmask_b32 v44, v44, v117, s[74:75]
    v_cndmask_b32 v45, v45, v117, s[76:77]
    v_cndmask_b32 v46, v46, v117, s[78:79]
    v_cndmask_b32 v47, v47, v117, s[80:81]
Lat_nm5:
    v_mfma_f32_16x16x32_bf16 a[24:27], a[108:111], v[80:83], a[24:27]
    ds_read_b128 a[104:107], v8 offset:6144
    v_exp_f32 v70, v70
    v_mfma_f32_16x16x32_bf16 a[28:31], a[108:111], v[84:87], a[28:31]
    v_exp_f32 v71, v71
    s_waitcnt lgkmcnt(3)
    v_mfma_f32_16x16x32_bf16 a[32:35], a[112:115], v[80:83], a[32:35]
    ds_read_b128 a[108:111], v8 offset:6400
    v_cvt_pk_bf16_f32 v92, v68, v69
    v_mfma_f32_16x16x32_bf16 a[36:39], a[112:115], v[84:87], a[36:39]
    v_exp_f32 v76, v76
    v_mfma_f32_16x16x32_bf16 a[40:43], a[116:119], v[80:83], a[40:43]
    ds_read_b128 a[112:115], v8 offset:10240
    v_cvt_pk_bf16_f32 v93, v70, v71
    v_mfma_f32_16x16x32_bf16 a[44:47], a[116:119], v[84:87], a[44:47]
    v_exp_f32 v77, v77
    v_mfma_f32_16x16x32_bf16 a[48:51], a[120:123], v[80:83], a[48:51]
    ds_read_b128 a[116:119], v8 offset:10496
    v_exp_f32 v78, v78
    v_mfma_f32_16x16x32_bf16 a[52:55], a[120:123], v[84:87], a[52:55]
    v_exp_f32 v79, v79
    v_mfma_f32_16x16x32_bf16 a[56:59], a[124:127], v[80:83], a[56:59]
    ds_read_b128 a[120:123], v8 offset:14336
    v_cvt_pk_bf16_f32 v94, v76, v77
    v_cvt_pk_bf16_f32 v95, v78, v79
    v_mfma_f32_16x16x32_bf16 a[60:63], a[124:127], v[84:87], a[60:63]
    v_max3_f32 v11, v16, v17, v18
    v_max3_f32 v106, v20, v21, v22
    s_waitcnt lgkmcnt(3)
    v_mfma_f32_16x16x32_bf16 a[0:3], a[96:99], v[88:91], a[0:3]
    ds_read_b128 a[124:127], v8 offset:14592
    v_max3_f32 v11, v11, v19, v24
    v_mfma_f32_16x16x32_bf16 a[4:7], a[96:99], v[92:95], a[4:7]
    v_max3_f32 v106, v106, v23, v28
    v_max3_f32 v11, v11, v25, v26
    s_barrier
    v_mfma_f32_16x16x32_bf16 a[8:11], a[100:103], v[88:91], a[8:11]
    ds_read_b128 a[96:99], v8 offset:49152
    v_max3_f32 v106, v106, v29, v30
    v_mfma_f32_16x16x32_bf16 a[12:15], a[100:103], v[92:95], a[12:15]
    v_max3_f32 v11, v11, v27, v32
    v_max3_f32 v106, v106, v31, v36
    v_mfma_f32_16x16x32_bf16 v[112:115], v[108:111], v[80:83], v[112:115]
    v_max3_f32 v11, v11, v33, v34
    v_max3_f32 v106, v106, v37, v38
    v_mfma_f32_16x16x32_bf16 a[16:19], a[104:107], v[88:91], a[16:19]
    ds_read_b128 a[100:103], v8 offset:49408
    v_max3_f32 v11, v11, v35, v40
    v_mfma_f32_16x16x32_bf16 a[20:23], a[104:107], v[92:95], a[20:23]
    v_max3_f32 v106, v106, v39, v44
    v_max3_f32 v11, v11, v41, v42
    v_mfma_f32_16x16x32_bf16 v[120:123], v[108:111], v[84:87], v[120:123]
    v_max3_f32 v106, v106, v45, v46
    v_max_f32 v11, v11, v43
    v_mfma_f32_16x16x32_bf16 a[24:27], a[108:111], v[88:91], a[24:27]
    ds_read_b128 a[104:107], v8 offset:57344
    v_max_f32 v106, v106, v47
    v_mfma_f32_16x16x32_bf16 a[28:31], a[108:111], v[92:95], a[28:31]
    v_max_f32 v116, v11, v106
    v_cmp_lt_f32 vcc, s70, v116
    v_mfma_f32_16x16x32_bf16 v[112:115], v[108:111], v[88:91], v[112:115]
    s_waitcnt lgkmcnt(3)
    v_mfma_f32_16x16x32_bf16 a[32:35], a[112:115], v[88:91], a[32:35]
    ds_read_b128 a[108:111], v8 offset:57600
    v_mfma_f32_16x16x32_bf16 a[36:39], a[112:115], v[92:95], a[36:39]
    v_mfma_f32_16x16x32_bf16 v[120:123], v[108:111], v[92:95], v[120:123]
    v_mfma_f32_16x16x32_bf16 a[40:43], a[116:119], v[88:91], a[40:43]
    ds_read_b128 a[112:115], v8 offset:51200
    v_mfma_f32_16x16x32_bf16 a[44:47], a[116:119], v[92:95], a[44:47]
    v_mfma_f32_16x16x32_bf16 a[48:51], a[120:123], v[88:91], a[48:51]
    ds_read_b128 a[116:119], v8 offset:51456
    v_mfma_f32_16x16x32_bf16 a[52:55], a[120:123], v[92:95], a[52:55]
    v_mfma_f32_16x16x32_bf16 a[56:59], a[124:127], v[88:91], a[56:59]
    ds_read_b128 a[120:123], v8 offset:59392
    v_mfma_f32_16x16x32_bf16 a[60:63], a[124:127], v[92:95], a[60:63]
    s_cbranch_vccnz Lat_slow3
    s_branch Lat_loop
Lat_slow0:
    v_mov_b32 v116, v11
    v_mov_b32 v117, v106
    s_nop 1
    v_permlane16_swap_b32 v116, v11
    v_permlane16_swap_b32 v117, v106
    s_nop 1
    v_max_f32 v11, v11, v116
    v_max_f32 v106, v106, v117
    s_nop 0
    v_mov_b32 v116, v11
    v_mov_b32 v117, v106
    s_nop 1
    v_permlane32_swap_b32 v116, v11
    v_permlane32_swap_b32 v117, v106
    s_nop 1
    v_max_f32 v11, v11, v116
    v_max_f32 v106, v106, v117
    s_nop 0
    v_max_f32 v11, 0, v11
    v_sub_f32 v116, 0, v11
    v_exp_f32 v116, v116
    v_sub_f32 v48, v48, v11
    v_sub_f32 v49, v49, v11
    v_sub_f32 v50, v50, v11
    v_sub_f32 v51, v51, v11
    v_sub_f32 v56, v56, v11
    v_sub_f32 v57, v57, v11
    v_sub_f32 v58, v58, v11
    v_sub_f32 v59, v59, v11
    v_sub_f32 v64, v64, v11
    v_sub_f32 v65, v65, v11
    v_sub_f32 v66, v66, v11
    v_sub_f32 v67, v67, v11
    v_sub_f32 v72, v72, v11
    v_sub_f32 v73, v73, v11
    v_sub_f32 v74, v74, v11
    v_sub_f32 v75, v75, v11
    v_sub_f32 v96, v96, v11
    v_sub_f32 v97, v97, v11
    v_sub_f32 v98, v98, v11
    v_sub_f32 v99, v99, v11
    v_mul_f32 v112, v112, v116
    v_mul_f32 v113, v113, v116
    v_mul_f32 v114, v114, v116
    v_mul_f32 v115, v115, v116
    v_accvgpr_read_b32 v1, a0
    v_accvgpr_read_b32 v2, a1
    v_accvgpr_read_b32 v3, a2
    v_accvgpr_read_b32 v4, a3
    v_mul_f32 v1, v1, v116
    v_mul_f32 v2, v2, v116
    v_mul_f32 v3, v3, v116
    v_mul_f32 v4, v4, v116
    v_accvgpr_write_b32 a0, v1
    v_accvgpr_write_b32 a1, v2
    v_accvgpr_write_b32 a2, v3
    v_accvgpr_write_b32 a3, v4
    v_accvgpr_read_b32 v1, a8
    v_accvgpr_read_b32 v2, a9
    v_accvgpr_read_b32 v3, a10
    v_accvgpr_read_b32 v4, a11
    v_mul_f32 v1, v1, v116
    v_mul_f32 v2, v2, v116
    v_mul_f32 v3, v3, v116
    v_mul_f32 v4, v4, v116
    v_accvgpr_write_b32 a8, v1
    v_accvgpr_write_b32 a9, v2
    v_accvgpr_write_b32 a10, v3
    v_accvgpr_write_b32 a11, v4
    v_accvgpr_read_b32 v1, a16
    v_accvgpr_read_b32 v2, a17
    v_accvgpr_read_b32 v3, a18
    v_accvgpr_read_b32 v4, a19
    v_mul_f32 v1, v1, v116
    v_mul_f32 v2, v2, v116
    v_mul_f32 v3, v3, v116
    v_mul_f32 v4, v4, v116
    v_accvgpr_write_b32 a16, v1
    v_accvgpr_write_b32 a17, v2
    v_accvgpr_write_b32 a18, v3
    v_accvgpr_write_b32 a19, v4
    v_accvgpr_read_b32 v1, a24
    v_accvgpr_read_b32 v2, a25
    v_accvgpr_read_b32 v3, a26
    v_accvgpr_read_b32 v4, a27
    v_mul_f32 v1, v1, v116
    v_mul_f32 v2, v2, v116
    v_mul_f32 v3, v3, v116
    v_mul_f32 v4, v4, v116
    v_accvgpr_write_b32 a24, v1
    v_accvgpr_write_b32 a25, v2
    v_accvgpr_write_b32 a26, v3
    v_accvgpr_write_b32 a27, v4
    v_accvgpr_read_b32 v1, a32
    v_accvgpr_read_b32 v2, a33
    v_accvgpr_read_b32 v3, a34
    v_accvgpr_read_b32 v4, a35
    v_mul_f32 v1, v1, v116
    v_mul_f32 v2, v2, v116
    v_mul_f32 v3, v3, v116
    v_mul_f32 v4, v4, v116
    v_accvgpr_write_b32 a32, v1
    v_accvgpr_write_b32 a33, v2
    v_accvgpr_write_b32 a34, v3
    v_accvgpr_write_b32 a35, v4
    v_accvgpr_read_b32 v1, a40
    v_accvgpr_read_b32 v2, a41
    v_accvgpr_read_b32 v3, a42
    v_accvgpr_read_b32 v4, a43
    v_mul_f32 v1, v1, v116
    v_mul_f32 v2, v2, v116
    v_mul_f32 v3, v3, v116
    v_mul_f32 v4, v4, v116
    v_accvgpr_write_b32 a40, v1
    v_accvgpr_write_b32 a41, v2
    v_accvgpr_write_b32 a42, v3
    v_accvgpr_write_b32 a43, v4
    v_accvgpr_read_b32 v1, a48
    v_accvgpr_read_b32 v2, a49
    v_accvgpr_read_b32 v3, a50
    v_accvgpr_read_b32 v4, a51
    v_mul_f32 v1, v1, v116
    v_mul_f32 v2, v2, v116
    v_mul_f32 v3, v3, v116
    v_mul_f32 v4, v4, v116
    v_accvgpr_write_b32 a48, v1
    v_accvgpr_write_b32 a49, v2
    v_accvgpr_write_b32 a50, v3
    v_accvgpr_write_b32 a51, v4
    v_accvgpr_read_b32 v1, a56
    v_accvgpr_read_b32 v2, a57
    v_accvgpr_read_b32 v3, a58
    v_accvgpr_read_b32 v4, a59
    v_mul_f32 v1, v1, v116
    v_mul_f32 v2, v2, v116
    v_mul_f32 v3, v3, v116
    v_mul_f32 v4, v4, v116
    v_accvgpr_write_b32 a56, v1
    v_accvgpr_write_b32 a57, v2
    v_accvgpr_write_b32 a58, v3
    v_accvgpr_write_b32 a59, v4
    v_max_f32 v106, 0, v106
    v_sub_f32 v116, 0, v106
    v_exp_f32 v116, v116
    v_sub_f32 v52, v52, v106
    v_sub_f32 v53, v53, v106
    v_sub_f32 v54, v54, v106
    v_sub_f32 v55, v55, v106
    v_sub_f32 v60, v60, v106
    v_sub_f32 v61, v61, v106
    v_sub_f32 v62, v62, v106
    v_sub_f32 v63, v63, v106
    v_sub_f32 v68, v68, v106
    v_sub_f32 v69, v69, v106
    v_sub_f32 v70, v70, v106
    v_sub_f32 v71, v71, v106
    v_sub_f32 v76, v76, v106
    v_sub_f32 v77, v77, v106
    v_sub_f32 v78, v78, v106
    v_sub_f32 v79, v79, v106
    v_sub_f32 v100, v100, v106
    v_sub_f32 v101, v101, v106
    v_sub_f32 v102, v102, v106
    v_sub_f32 v103, v103, v106
    v_mul_f32 v120, v120, v116
    v_mul_f32 v121, v121, v116
    v_mul_f32 v122, v122, v116
    v_mul_f32 v123, v123, v116
    v_accvgpr_read_b32 v1, a4
    v_accvgpr_read_b32 v2, a5
    v_accvgpr_read_b32 v3, a6
    v_accvgpr_read_b32 v4, a7
    v_mul_f32 v1, v1, v116
    v_mul_f32 v2, v2, v116
    v_mul_f32 v3, v3, v116
    v_mul_f32 v4, v4, v116
    v_accvgpr_write_b32 a4, v1
    v_accvgpr_write_b32 a5, v2
    v_accvgpr_write_b32 a6, v3
    v_accvgpr_write_b32 a7, v4
    v_accvgpr_read_b32 v1, a12
    v_accvgpr_read_b32 v2, a13
    v_accvgpr_read_b32 v3, a14
    v_accvgpr_read_b32 v4, a15
    v_mul_f32 v1, v1, v116
    v_mul_f32 v2, v2, v116
    v_mul_f32 v3, v3, v116
    v_mul_f32 v4, v4, v116
    v_accvgpr_write_b32 a12, v1
    v_accvgpr_write_b32 a13, v2
    v_accvgpr_write_b32 a14, v3
    v_accvgpr_write_b32 a15, v4
    v_accvgpr_read_b32 v1, a20
    v_accvgpr_read_b32 v2, a21
    v_accvgpr_read_b32 v3, a22
    v_accvgpr_read_b32 v4, a23
    v_mul_f32 v1, v1, v116
    v_mul_f32 v2, v2, v116
    v_mul_f32 v3, v3, v116
    v_mul_f32 v4, v4, v116
    v_accvgpr_write_b32 a20, v1
    v_accvgpr_write_b32 a21, v2
    v_accvgpr_write_b32 a22, v3
    v_accvgpr_write_b32 a23, v4
    v_accvgpr_read_b32 v1, a28
    v_accvgpr_read_b32 v2, a29
    v_accvgpr_read_b32 v3, a30
    v_accvgpr_read_b32 v4, a31
    v_mul_f32 v1, v1, v116
    v_mul_f32 v2, v2, v116
    v_mul_f32 v3, v3, v116
    v_mul_f32 v4, v4, v116
    v_accvgpr_write_b32 a28, v1
    v_accvgpr_write_b32 a29, v2
    v_accvgpr_write_b32 a30, v3
    v_accvgpr_write_b32 a31, v4
    v_accvgpr_read_b32 v1, a36
    v_accvgpr_read_b32 v2, a37
    v_accvgpr_read_b32 v3, a38
    v_accvgpr_read_b32 v4, a39
    v_mul_f32 v1, v1, v116
    v_mul_f32 v2, v2, v116
    v_mul_f32 v3, v3, v116
    v_mul_f32 v4, v4, v116
    v_accvgpr_write_b32 a36, v1
    v_accvgpr_write_b32 a37, v2
    v_accvgpr_write_b32 a38, v3
    v_accvgpr_write_b32 a39, v4
    v_accvgpr_read_b32 v1, a44
    v_accvgpr_read_b32 v2, a45
    v_accvgpr_read_b32 v3, a46
    v_accvgpr_read_b32 v4, a47
    v_mul_f32 v1, v1, v116
    v_mul_f32 v2, v2, v116
    v_mul_f32 v3, v3, v116
    v_mul_f32 v4, v4, v116
    v_accvgpr_write_b32 a44, v1
    v_accvgpr_write_b32 a45, v2
    v_accvgpr_write_b32 a46, v3
    v_accvgpr_write_b32 a47, v4
    v_accvgpr_read_b32 v1, a52
    v_accvgpr_read_b32 v2, a53
    v_accvgpr_read_b32 v3, a54
    v_accvgpr_read_b32 v4, a55
    v_mul_f32 v1, v1, v116
    v_mul_f32 v2, v2, v116
    v_mul_f32 v3, v3, v116
    v_mul_f32 v4, v4, v116
    v_accvgpr_write_b32 a52, v1
    v_accvgpr_write_b32 a53, v2
    v_accvgpr_write_b32 a54, v3
    v_accvgpr_write_b32 a55, v4
    v_accvgpr_read_b32 v1, a60
    v_accvgpr_read_b32 v2, a61
    v_accvgpr_read_b32 v3, a62
    v_accvgpr_read_b32 v4, a63
    v_mul_f32 v1, v1, v116
    v_mul_f32 v2, v2, v116
    v_mul_f32 v3, v3, v116
    v_mul_f32 v4, v4, v116
    v_accvgpr_write_b32 a60, v1
    v_accvgpr_write_b32 a61, v2
    v_accvgpr_write_b32 a62, v3
    v_accvgpr_write_b32 a63, v4
    s_nop 1
    s_branch Lat_b1
Lat_slow1:
    v_mov_b32 v116, v11
    v_mov_b32 v117, v106
    s_nop 1
    v_permlane16_swap_b32 v116, v11
    v_permlane16_swap_b32 v117, v106
    s_nop 1
    v_max_f32 v11, v11, v116
    v_max_f32 v106, v106, v117
    s_nop 0
    v_mov_b32 v116, v11
    v_mov_b32 v117, v106
    s_nop 1
    v_permlane32_swap_b32 v116, v11
    v_permlane32_swap_b32 v117, v106
    s_nop 1
    v_max_f32 v11, v11, v116
    v_max_f32 v106, v106, v117
    s_nop 0
    v_max_f32 v11, 0, v11
    v_sub_f32 v116, 0, v11
    v_exp_f32 v116, v116
    v_sub_f32 v16, v16, v11
    v_sub_f32 v17, v17, v11
    v_sub_f32 v18, v18, v11
    v_sub_f32 v19, v19, v11
    v_sub_f32 v24, v24, v11
    v_sub_f32 v25, v25, v11
    v_sub_f32 v26, v26, v11
    v_sub_f32 v27, v27, v11
    v_sub_f32 v32, v32, v11
    v_sub_f32 v33, v33, v11
    v_sub_f32 v34, v34, v11
    v_sub_f32 v35, v35, v11
    v_sub_f32 v40, v40, v11
    v_sub_f32 v41, v41, v11
    v_sub_f32 v42, v42, v11
    v_sub_f32 v43, v43, v11
    v_sub_f32 v96, v96, v11
    v_sub_f32 v97, v97, v11
    v_sub_f32 v98, v98, v11
    v_sub_f32 v99, v99, v11
    v_mul_f32 v112, v112, v116
    v_mul_f32 v113, v113, v116
    v_mul_f32 v114, v114, v116
    v_mul_f32 v115, v115, v116
    v_accvgpr_read_b32 v1, a0
    v_accvgpr_read_b32 v2, a1
    v_accvgpr_read_b32 v3, a2
    v_accvgpr_read_b32 v4, a3
    v_mul_f32 v1, v1, v116
    v_mul_f32 v2, v2, v116
    v_mul_f32 v3, v3, v116
    v_mul_f32 v4, v4, v116
    v_accvgpr_write_b32 a0, v1
    v_accvgpr_write_b32 a1, v2
    v_accvgpr_write_b32 a2, v3
    v_accvgpr_write_b32 a3, v4
    v_accvgpr_read_b32 v1, a8
    v_accvgpr_read_b32 v2, a9
    v_accvgpr_read_b32 v3, a10
    v_accvgpr_read_b32 v4, a11
    v_mul_f32 v1, v1, v116
    v_mul_f32 v2, v2, v116
    v_mul_f32 v3, v3, v116
    v_mul_f32 v4, v4, v116
    v_accvgpr_write_b32 a8, v1
    v_accvgpr_write_b32 a9, v2
    v_accvgpr_write_b32 a10, v3
    v_accvgpr_write_b32 a11, v4
    v_accvgpr_read_b32 v1, a16
    v_accvgpr_read_b32 v2, a17
    v_accvgpr_read_b32 v3, a18
    v_accvgpr_read_b32 v4, a19
    v_mul_f32 v1, v1, v116
    v_mul_f32 v2, v2, v116
    v_mul_f32 v3, v3, v116
    v_mul_f32 v4, v4, v116
    v_accvgpr_write_b32 a16, v1
    v_accvgpr_write_b32 a17, v2
    v_accvgpr_write_b32 a18, v3
    v_accvgpr_write_b32 a19, v4
    v_accvgpr_read_b32 v1, a24
    v_accvgpr_read_b32 v2, a25
    v_accvgpr_read_b32 v3, a26
    v_accvgpr_read_b32 v4, a27
    v_mul_f32 v1, v1, v116
    v_mul_f32 v2, v2, v116
    v_mul_f32 v3, v3, v116
    v_mul_f32 v4, v4, v116
    v_accvgpr_write_b32 a24, v1
    v_accvgpr_write_b32 a25, v2
    v_accvgpr_write_b32 a26, v3
    v_accvgpr_write_b32 a27, v4
    v_accvgpr_read_b32 v1, a32
    v_accvgpr_read_b32 v2, a33
    v_accvgpr_read_b32 v3, a34
    v_accvgpr_read_b32 v4, a35
    v_mul_f32 v1, v1, v116
    v_mul_f32 v2, v2, v116
    v_mul_f32 v3, v3, v116
    v_mul_f32 v4, v4, v116
    v_accvgpr_write_b32 a32, v1
    v_accvgpr_write_b32 a33, v2
    v_accvgpr_write_b32 a34, v3
    v_accvgpr_write_b32 a35, v4
    v_accvgpr_read_b32 v1, a40
    v_accvgpr_read_b32 v2, a41
    v_accvgpr_read_b32 v3, a42
    v_accvgpr_read_b32 v4, a43
    v_mul_f32 v1, v1, v116
    v_mul_f32 v2, v2, v116
    v_mul_f32 v3, v3, v116
    v_mul_f32 v4, v4, v116
    v_accvgpr_write_b32 a40, v1
    v_accvgpr_write_b32 a41, v2
    v_accvgpr_write_b32 a42, v3
    v_accvgpr_write_b32 a43, v4
    v_accvgpr_read_b32 v1, a48
    v_accvgpr_read_b32 v2, a49
    v_accvgpr_read_b32 v3, a50
    v_accvgpr_read_b32 v4, a51
    v_mul_f32 v1, v1, v116
    v_mul_f32 v2, v2, v116
    v_mul_f32 v3, v3, v116
    v_mul_f32 v4, v4, v116
    v_accvgpr_write_b32 a48, v1
    v_accvgpr_write_b32 a49, v2
    v_accvgpr_write_b32 a50, v3
    v_accvgpr_write_b32 a51, v4
    v_accvgpr_read_b32 v1, a56
    v_accvgpr_read_b32 v2, a57
    v_accvgpr_read_b32 v3, a58
    v_accvgpr_read_b32 v4, a59
    v_mul_f32 v1, v1, v116
    v_mul_f32 v2, v2, v116
    v_mul_f32 v3, v3, v116
    v_mul_f32 v4, v4, v116
    v_accvgpr_write_b32 a56, v1
    v_accvgpr_write_b32 a57, v2
    v_accvgpr_write_b32 a58, v3
    v_accvgpr_write_b32 a59, v4
    v_max_f32 v106, 0, v106
    v_sub_f32 v116, 0, v106
    v_exp_f32 v116, v116
    v_sub_f32 v20, v20, v106
    v_sub_f32 v21, v21, v106
    v_sub_f32 v22, v22, v106
    v_sub_f32 v23, v23, v106
    v_sub_f32 v28, v28, v106
    v_sub_f32 v29, v29, v106
    v_sub_f32 v30, v30, v106
    v_sub_f32 v31, v31, v106
    v_sub_f32 v36, v36, v106
    v_sub_f32 v37, v37, v106
    v_sub_f32 v38, v38, v106
    v_sub_f32 v39, v39, v106
    v_sub_f32 v44, v44, v106
    v_sub_f32 v45, v45, v106
    v_sub_f32 v46, v46, v106
    v_sub_f32 v47, v47, v106
    v_sub_f32 v100, v100, v106
    v_sub_f32 v101, v101, v106
    v_sub_f32 v102, v102, v106
    v_sub_f32 v103, v103, v106
    v_mul_f32 v120, v120, v116
    v_mul_f32 v121, v121, v116
    v_mul_f32 v122, v122, v116
    v_mul_f32 v123, v123, v116
    v_accvgpr_read_b32 v1, a4
    v_accvgpr_read_b32 v2, a5
    v_accvgpr_read_b32 v3, a6
    v_accvgpr_read_b32 v4, a7
    v_mul_f32 v1, v1, v116
    v_mul_f32 v2, v2, v116
    v_mul_f32 v3, v3, v116
    v_mul_f32 v4, v4, v116
    v_accvgpr_write_b32 a4, v1
    v_accvgpr_write_b32 a5, v2
    v_accvgpr_write_b32 a6, v3
    v_accvgpr_write_b32 a7, v4
    v_accvgpr_read_b32 v1, a12
    v_accvgpr_read_b32 v2, a13
    v_accvgpr_read_b32 v3, a14
    v_accvgpr_read_b32 v4, a15
    v_mul_f32 v1, v1, v116
    v_mul_f32 v2, v2, v116
    v_mul_f32 v3, v3, v116
    v_mul_f32 v4, v4, v116
    v_accvgpr_write_b32 a12, v1
    v_accvgpr_write_b32 a13, v2
    v_accvgpr_write_b32 a14, v3
    v_accvgpr_write_b32 a15, v4
    v_accvgpr_read_b32 v1, a20
    v_accvgpr_read_b32 v2, a21
    v_accvgpr_read_b32 v3, a22
    v_accvgpr_read_b32 v4, a23
    v_mul_f32 v1, v1, v116
    v_mul_f32 v2, v2, v116
    v_mul_f32 v3, v3, v116
    v_mul_f32 v4, v4, v116
    v_accvgpr_write_b32 a20, v1
    v_accvgpr_write_b32 a21, v2
    v_accvgpr_write_b32 a22, v3
    v_accvgpr_write_b32 a23, v4
    v_accvgpr_read_b32 v1, a28
    v_accvgpr_read_b32 v2, a29
    v_accvgpr_read_b32 v3, a30
    v_accvgpr_read_b32 v4, a31
    v_mul_f32 v1, v1, v116
    v_mul_f32 v2, v2, v116
    v_mul_f32 v3, v3, v116
    v_mul_f32 v4, v4, v116
    v_accvgpr_write_b32 a28, v1
    v_accvgpr_write_b32 a29, v2
    v_accvgpr_write_b32 a30, v3
    v_accvgpr_write_b32 a31, v4
    v_accvgpr_read_b32 v1, a36
    v_accvgpr_read_b32 v2, a37
    v_accvgpr_read_b32 v3, a38
    v_accvgpr_read_b32 v4, a39
    v_mul_f32 v1, v1, v116
    v_mul_f32 v2, v2, v116
    v_mul_f32 v3, v3, v116
    v_mul_f32 v4, v4, v116
    v_accvgpr_write_b32 a36, v1
    v_accvgpr_write_b32 a37, v2
    v_accvgpr_write_b32 a38, v3
    v_accvgpr_write_b32 a39, v4
    v_accvgpr_read_b32 v1, a44
    v_accvgpr_read_b32 v2, a45
    v_accvgpr_read_b32 v3, a46
    v_accvgpr_read_b32 v4, a47
    v_mul_f32 v1, v1, v116
    v_mul_f32 v2, v2, v116
    v_mul_f32 v3, v3, v116
    v_mul_f32 v4, v4, v116
    v_accvgpr_write_b32 a44, v1
    v_accvgpr_write_b32 a45, v2
    v_accvgpr_write_b32 a46, v3
    v_accvgpr_write_b32 a47, v4
    v_accvgpr_read_b32 v1, a52
    v_accvgpr_read_b32 v2, a53
    v_accvgpr_read_b32 v3, a54
    v_accvgpr_read_b32 v4, a55
    v_mul_f32 v1, v1, v116
    v_mul_f32 v2, v2, v116
    v_mul_f32 v3, v3, v116
    v_mul_f32 v4, v4, v116
    v_accvgpr_write_b32 a52, v1
    v_accvgpr_write_b32 a53, v2
    v_accvgpr_write_b32 a54, v3
    v_accvgpr_write_b32 a55, v4
    v_accvgpr_read_b32 v1, a60
    v_accvgpr_read_b32 v2, a61
    v_accvgpr_read_b32 v3, a62
    v_accvgpr_read_b32 v4, a63
    v_mul_f32 v1, v1, v116
    v_mul_f32 v2, v2, v116
    v_mul_f32 v3, v3, v116
    v_mul_f32 v4, v4, v116
    v_accvgpr_write_b32 a60, v1
    v_accvgpr_write_b32 a61, v2
    v_accvgpr_write_b32 a62, v3
    v_accvgpr_write_b32 a63, v4
    s_nop 1
    s_branch Lat_b2
Lat_slow2:
    v_mov_b32 v116, v11
    v_mov_b32 v117, v106
    s_nop 1
    v_permlane16_swap_b32 v116, v11
    v_permlane16_swap_b32 v117, v106
    s_nop 1
    v_max_f32 v11, v11, v116
    v_max_f32 v106, v106, v117
    s_nop 0
    v_mov_b32 v116, v11
    v_mov_b32 v117, v106
    s_nop 1
    v_permlane32_swap_b32 v116, v11
    v_permlane32_swap_b32 v117, v106
    s_nop 1
    v_max_f32 v11, v11, v116
    v_max_f32 v106, v106, v117
    s_nop 0
    v_max_f32 v11, 0, v11
    v_sub_f32 v116, 0, v11
    v_exp_f32 v116, v116
    v_sub_f32 v48, v48, v11
    v_sub_f32 v49, v49, v11
    v_sub_f32 v50, v50, v11
    v_sub_f32 v51, v51, v11
    v_sub_f32 v56, v56, v11
    v_sub_f32 v57, v57, v11
    v_sub_f32 v58, v58, v11
    v_sub_f32 v59, v59, v11
    v_sub_f32 v64, v64, v11
    v_sub_f32 v65, v65, v11
    v_sub_f32 v66, v66, v11
    v_sub_f32 v67, v67, v11
    v_sub_f32 v72, v72, v11
    v_sub_f32 v73, v73, v11
    v_sub_f32 v74, v74, v11
    v_sub_f32 v75, v75, v11
    v_sub_f32 v96, v96, v11
    v_sub_f32 v97, v97, v11
    v_sub_f32 v98, v98, v11
    v_sub_f32 v99, v99, v11
    v_mul_f32 v112, v112, v116
    v_mul_f32 v113, v113, v116
    v_mul_f32 v114, v114, v116
    v_mul_f32 v115, v115, v116
    v_accvgpr_read_b32 v1, a0
    v_accvgpr_read_b32 v2, a1
    v_accvgpr_read_b32 v3, a2
    v_accvgpr_read_b32 v4, a3
    v_mul_f32 v1, v1, v116
    v_mul_f32 v2, v2, v116
    v_mul_f32 v3, v3, v116
    v_mul_f32 v4, v4, v116
    v_accvgpr_write_b32 a0, v1
    v_accvgpr_write_b32 a1, v2
    v_accvgpr_write_b32 a2, v3
    v_accvgpr_write_b32 a3, v4
    v_accvgpr_read_b32 v1, a8
    v_accvgpr_read_b32 v2, a9
    v_accvgpr_read_b32 v3, a10
    v_accvgpr_read_b32 v4, a11
    v_mul_f32 v1, v1, v116
    v_mul_f32 v2, v2, v116
    v_mul_f32 v3, v3, v116
    v_mul_f32 v4, v4, v116
    v_accvgpr_write_b32 a8, v1
    v_accvgpr_write_b32 a9, v2
    v_accvgpr_write_b32 a10, v3
    v_accvgpr_write_b32 a11, v4
    v_accvgpr_read_b32 v1, a16
    v_accvgpr_read_b32 v2, a17
    v_accvgpr_read_b32 v3, a18
    v_accvgpr_read_b32 v4, a19
    v_mul_f32 v1, v1, v116
    v_mul_f32 v2, v2, v116
    v_mul_f32 v3, v3, v116
    v_mul_f32 v4, v4, v116
    v_accvgpr_write_b32 a16, v1
    v_accvgpr_write_b32 a17, v2
    v_accvgpr_write_b32 a18, v3
    v_accvgpr_write_b32 a19, v4
    v_accvgpr_read_b32 v1, a24
    v_accvgpr_read_b32 v2, a25
    v_accvgpr_read_b32 v3, a26
    v_accvgpr_read_b32 v4, a27
    v_mul_f32 v1, v1, v116
    v_mul_f32 v2, v2, v116
    v_mul_f32 v3, v3, v116
    v_mul_f32 v4, v4, v116
    v_accvgpr_write_b32 a24, v1
    v_accvgpr_write_b32 a25, v2
    v_accvgpr_write_b32 a26, v3
    v_accvgpr_write_b32 a27, v4
    v_accvgpr_read_b32 v1, a32
    v_accvgpr_read_b32 v2, a33
    v_accvgpr_read_b32 v3, a34
    v_accvgpr_read_b32 v4, a35
    v_mul_f32 v1, v1, v116
    v_mul_f32 v2, v2, v116
    v_mul_f32 v3, v3, v116
    v_mul_f32 v4, v4, v116
    v_accvgpr_write_b32 a32, v1
    v_accvgpr_write_b32 a33, v2
    v_accvgpr_write_b32 a34, v3
    v_accvgpr_write_b32 a35, v4
    v_accvgpr_read_b32 v1, a40
    v_accvgpr_read_b32 v2, a41
    v_accvgpr_read_b32 v3, a42
    v_accvgpr_read_b32 v4, a43
    v_mul_f32 v1, v1, v116
    v_mul_f32 v2, v2, v116
    v_mul_f32 v3, v3, v116
    v_mul_f32 v4, v4, v116
    v_accvgpr_write_b32 a40, v1
    v_accvgpr_write_b32 a41, v2
    v_accvgpr_write_b32 a42, v3
    v_accvgpr_write_b32 a43, v4
    v_accvgpr_read_b32 v1, a48
    v_accvgpr_read_b32 v2, a49
    v_accvgpr_read_b32 v3, a50
    v_accvgpr_read_b32 v4, a51
    v_mul_f32 v1, v1, v116
    v_mul_f32 v2, v2, v116
    v_mul_f32 v3, v3, v116
    v_mul_f32 v4, v4, v116
    v_accvgpr_write_b32 a48, v1
    v_accvgpr_write_b32 a49, v2
    v_accvgpr_write_b32 a50, v3
    v_accvgpr_write_b32 a51, v4
    v_accvgpr_read_b32 v1, a56
    v_accvgpr_read_b32 v2, a57
    v_accvgpr_read_b32 v3, a58
    v_accvgpr_read_b32 v4, a59
    v_mul_f32 v1, v1, v116
    v_mul_f32 v2, v2, v116
    v_mul_f32 v3, v3, v116
    v_mul_f32 v4, v4, v116
    v_accvgpr_write_b32 a56, v1
    v_accvgpr_write_b32 a57, v2
    v_accvgpr_write_b32 a58, v3
    v_accvgpr_write_b32 a59, v4
    v_max_f32 v106, 0, v106
    v_sub_f32 v116, 0, v106
    v_exp_f32 v116, v116
    v_sub_f32 v52, v52, v106
    v_sub_f32 v53, v53, v106
    v_sub_f32 v54, v54, v106
    v_sub_f32 v55, v55, v106
    v_sub_f32 v60, v60, v106
    v_sub_f32 v61, v61, v106
    v_sub_f32 v62, v62, v106
    v_sub_f32 v63, v63, v106
    v_sub_f32 v68, v68, v106
    v_sub_f32 v69, v69, v106
    v_sub_f32 v70, v70, v106
    v_sub_f32 v71, v71, v106
    v_sub_f32 v76, v76, v106
    v_sub_f32 v77, v77, v106
    v_sub_f32 v78, v78, v106
    v_sub_f32 v79, v79, v106
    v_sub_f32 v100, v100, v106
    v_sub_f32 v101, v101, v106
    v_sub_f32 v102, v102, v106
    v_sub_f32 v103, v103, v106
    v_mul_f32 v120, v120, v116
    v_mul_f32 v121, v121, v116
    v_mul_f32 v122, v122, v116
    v_mul_f32 v123, v123, v116
    v_accvgpr_read_b32 v1, a4
    v_accvgpr_read_b32 v2, a5
    v_accvgpr_read_b32 v3, a6
    v_accvgpr_read_b32 v4, a7
    v_mul_f32 v1, v1, v116
    v_mul_f32 v2, v2, v116
    v_mul_f32 v3, v3, v116
    v_mul_f32 v4, v4, v116
    v_accvgpr_write_b32 a4, v1
    v_accvgpr_write_b32 a5, v2
    v_accvgpr_write_b32 a6, v3
    v_accvgpr_write_b32 a7, v4
    v_accvgpr_read_b32 v1, a12
    v_accvgpr_read_b32 v2, a13
    v_accvgpr_read_b32 v3, a14
    v_accvgpr_read_b32 v4, a15
    v_mul_f32 v1, v1, v116
    v_mul_f32 v2, v2, v116
    v_mul_f32 v3, v3, v116
    v_mul_f32 v4, v4, v116
    v_accvgpr_write_b32 a12, v1
    v_accvgpr_write_b32 a13, v2
    v_accvgpr_write_b32 a14, v3
    v_accvgpr_write_b32 a15, v4
    v_accvgpr_read_b32 v1, a20
    v_accvgpr_read_b32 v2, a21
    v_accvgpr_read_b32 v3, a22
    v_accvgpr_read_b32 v4, a23
    v_mul_f32 v1, v1, v116
    v_mul_f32 v2, v2, v116
    v_mul_f32 v3, v3, v116
    v_mul_f32 v4, v4, v116
    v_accvgpr_write_b32 a20, v1
    v_accvgpr_write_b32 a21, v2
    v_accvgpr_write_b32 a22, v3
    v_accvgpr_write_b32 a23, v4
    v_accvgpr_read_b32 v1, a28
    v_accvgpr_read_b32 v2, a29
    v_accvgpr_read_b32 v3, a30
    v_accvgpr_read_b32 v4, a31
    v_mul_f32 v1, v1, v116
    v_mul_f32 v2, v2, v116
    v_mul_f32 v3, v3, v116
    v_mul_f32 v4, v4, v116
    v_accvgpr_write_b32 a28, v1
    v_accvgpr_write_b32 a29, v2
    v_accvgpr_write_b32 a30, v3
    v_accvgpr_write_b32 a31, v4
    v_accvgpr_read_b32 v1, a36
    v_accvgpr_read_b32 v2, a37
    v_accvgpr_read_b32 v3, a38
    v_accvgpr_read_b32 v4, a39
    v_mul_f32 v1, v1, v116
    v_mul_f32 v2, v2, v116
    v_mul_f32 v3, v3, v116
    v_mul_f32 v4, v4, v116
    v_accvgpr_write_b32 a36, v1
    v_accvgpr_write_b32 a37, v2
    v_accvgpr_write_b32 a38, v3
    v_accvgpr_write_b32 a39, v4
    v_accvgpr_read_b32 v1, a44
    v_accvgpr_read_b32 v2, a45
    v_accvgpr_read_b32 v3, a46
    v_accvgpr_read_b32 v4, a47
    v_mul_f32 v1, v1, v116
    v_mul_f32 v2, v2, v116
    v_mul_f32 v3, v3, v116
    v_mul_f32 v4, v4, v116
    v_accvgpr_write_b32 a44, v1
    v_accvgpr_write_b32 a45, v2
    v_accvgpr_write_b32 a46, v3
    v_accvgpr_write_b32 a47, v4
    v_accvgpr_read_b32 v1, a52
    v_accvgpr_read_b32 v2, a53
    v_accvgpr_read_b32 v3, a54
    v_accvgpr_read_b32 v4, a55
    v_mul_f32 v1, v1, v116
    v_mul_f32 v2, v2, v116
    v_mul_f32 v3, v3, v116
    v_mul_f32 v4, v4, v116
    v_accvgpr_write_b32 a52, v1
    v_accvgpr_write_b32 a53, v2
    v_accvgpr_write_b32 a54, v3
    v_accvgpr_write_b32 a55, v4
    v_accvgpr_read_b32 v1, a60
    v_accvgpr_read_b32 v2, a61
    v_accvgpr_read_b32 v3, a62
    v_accvgpr_read_b32 v4, a63
    v_mul_f32 v1, v1, v116
    v_mul_f32 v2, v2, v116
    v_mul_f32 v3, v3, v116
    v_mul_f32 v4, v4, v116
    v_accvgpr_write_b32 a60, v1
    v_accvgpr_write_b32 a61, v2
    v_accvgpr_write_b32 a62, v3
    v_accvgpr_write_b32 a63, v4
    s_nop 1
    s_branch Lat_b3
Lat_slow3:
    v_mov_b32 v116, v11
    v_mov_b32 v117, v106
    s_nop 1
    v_permlane16_swap_b32 v116, v11
    v_permlane16_swap_b32 v117, v106
    s_nop 1
    v_max_f32 v11, v11, v116
    v_max_f32 v106, v106, v117
    s_nop 0
    v_mov_b32 v116, v11
    v_mov_b32 v117, v106
    s_nop 1
    v_permlane32_swap_b32 v116, v11
    v_permlane32_swap_b32 v117, v106
    s_nop 1
    v_max_f32 v11, v11, v116
    v_max_f32 v106, v106, v117
    s_nop 0
    v_max_f32 v11, 0, v11
    v_sub_f32 v116, 0, v11
    v_exp_f32 v116, v116
    v_sub_f32 v16, v16, v11
    v_sub_f32 v17, v17, v11
    v_sub_f32 v18, v18, v11
    v_sub_f32 v19, v19, v11
    v_sub_f32 v24, v24, v11
    v_sub_f32 v25, v25, v11
    v_sub_f32 v26, v26, v11
    v_sub_f32 v27, v27, v11
    v_sub_f32 v32, v32, v11
    v_sub_f32 v33, v33, v11
    v_sub_f32 v34, v34, v11
    v_sub_f32 v35, v35, v11
    v_sub_f32 v40, v40, v11
    v_sub_f32 v41, v41, v11
    v_sub_f32 v42, v42, v11
    v_sub_f32 v43, v43, v11
    v_sub_f32 v96, v96, v11
    v_sub_f32 v97, v97, v11
    v_sub_f32 v98, v98, v11
    v_sub_f32 v99, v99, v11
    v_mul_f32 v112, v112, v116
    v_mul_f32 v113, v113, v116
    v_mul_f32 v114, v114, v116
    v_mul_f32 v115, v115, v116
    v_accvgpr_read_b32 v1, a0
    v_accvgpr_read_b32 v2, a1
    v_accvgpr_read_b32 v3, a2
    v_accvgpr_read_b32 v4, a3
    v_mul_f32 v1, v1, v116
    v_mul_f32 v2, v2, v116
    v_mul_f32 v3, v3, v116
    v_mul_f32 v4, v4, v116
    v_accvgpr_write_b32 a0, v1
    v_accvgpr_write_b32 a1, v2
    v_accvgpr_write_b32 a2, v3
    v_accvgpr_write_b32 a3, v4
    v_accvgpr_read_b32 v1, a8
    v_accvgpr_read_b32 v2, a9
    v_accvgpr_read_b32 v3, a10
    v_accvgpr_read_b32 v4, a11
    v_mul_f32 v1, v1, v116
    v_mul_f32 v2, v2, v116
    v_mul_f32 v3, v3, v116
    v_mul_f32 v4, v4, v116
    v_accvgpr_write_b32 a8, v1
    v_accvgpr_write_b32 a9, v2
    v_accvgpr_write_b32 a10, v3
    v_accvgpr_write_b32 a11, v4
    v_accvgpr_read_b32 v1, a16
    v_accvgpr_read_b32 v2, a17
    v_accvgpr_read_b32 v3, a18
    v_accvgpr_read_b32 v4, a19
    v_mul_f32 v1, v1, v116
    v_mul_f32 v2, v2, v116
    v_mul_f32 v3, v3, v116
    v_mul_f32 v4, v4, v116
    v_accvgpr_write_b32 a16, v1
    v_accvgpr_write_b32 a17, v2
    v_accvgpr_write_b32 a18, v3
    v_accvgpr_write_b32 a19, v4
    v_accvgpr_read_b32 v1, a24
    v_accvgpr_read_b32 v2, a25
    v_accvgpr_read_b32 v3, a26
    v_accvgpr_read_b32 v4, a27
    v_mul_f32 v1, v1, v116
    v_mul_f32 v2, v2, v116
    v_mul_f32 v3, v3, v116
    v_mul_f32 v4, v4, v116
    v_accvgpr_write_b32 a24, v1
    v_accvgpr_write_b32 a25, v2
    v_accvgpr_write_b32 a26, v3
    v_accvgpr_write_b32 a27, v4
    v_accvgpr_read_b32 v1, a32
    v_accvgpr_read_b32 v2, a33
    v_accvgpr_read_b32 v3, a34
    v_accvgpr_read_b32 v4, a35
    v_mul_f32 v1, v1, v116
    v_mul_f32 v2, v2, v116
    v_mul_f32 v3, v3, v116
    v_mul_f32 v4, v4, v116
    v_accvgpr_write_b32 a32, v1
    v_accvgpr_write_b32 a33, v2
    v_accvgpr_write_b32 a34, v3
    v_accvgpr_write_b32 a35, v4
    v_accvgpr_read_b32 v1, a40
    v_accvgpr_read_b32 v2, a41
    v_accvgpr_read_b32 v3, a42
    v_accvgpr_read_b32 v4, a43
    v_mul_f32 v1, v1, v116
    v_mul_f32 v2, v2, v116
    v_mul_f32 v3, v3, v116
    v_mul_f32 v4, v4, v116
    v_accvgpr_write_b32 a40, v1
    v_accvgpr_write_b32 a41, v2
    v_accvgpr_write_b32 a42, v3
    v_accvgpr_write_b32 a43, v4
    v_accvgpr_read_b32 v1, a48
    v_accvgpr_read_b32 v2, a49
    v_accvgpr_read_b32 v3, a50
    v_accvgpr_read_b32 v4, a51
    v_mul_f32 v1, v1, v116
    v_mul_f32 v2, v2, v116
    v_mul_f32 v3, v3, v116
    v_mul_f32 v4, v4, v116
    v_accvgpr_write_b32 a48, v1
    v_accvgpr_write_b32 a49, v2
    v_accvgpr_write_b32 a50, v3
    v_accvgpr_write_b32 a51, v4
    v_accvgpr_read_b32 v1, a56
    v_accvgpr_read_b32 v2, a57
    v_accvgpr_read_b32 v3, a58
    v_accvgpr_read_b32 v4, a59
    v_mul_f32 v1, v1, v116
    v_mul_f32 v2, v2, v116
    v_mul_f32 v3, v3, v116
    v_mul_f32 v4, v4, v116
    v_accvgpr_write_b32 a56, v1
    v_accvgpr_write_b32 a57, v2
    v_accvgpr_write_b32 a58, v3
    v_accvgpr_write_b32 a59, v4
    v_max_f32 v106, 0, v106
    v_sub_f32 v116, 0, v106
    v_exp_f32 v116, v116
    v_sub_f32 v20, v20, v106
    v_sub_f32 v21, v21, v106
    v_sub_f32 v22, v22, v106
    v_sub_f32 v23, v23, v106
    v_sub_f32 v28, v28, v106
    v_sub_f32 v29, v29, v106
    v_sub_f32 v30, v30, v106
    v_sub_f32 v31, v31, v106
    v_sub_f32 v36, v36, v106
    v_sub_f32 v37, v37, v106
    v_sub_f32 v38, v38, v106
    v_sub_f32 v39, v39, v106
    v_sub_f32 v44, v44, v106
    v_sub_f32 v45, v45, v106
    v_sub_f32 v46, v46, v106
    v_sub_f32 v47, v47, v106
    v_sub_f32 v100, v100, v106
    v_sub_f32 v101, v101, v106
    v_sub_f32 v102, v102, v106
    v_sub_f32 v103, v103, v106
    v_mul_f32 v120, v120, v116
    v_mul_f32 v121, v121, v116
    v_mul_f32 v122, v122, v116
    v_mul_f32 v123, v123, v116
    v_accvgpr_read_b32 v1, a4
    v_accvgpr_read_b32 v2, a5
    v_accvgpr_read_b32 v3, a6
    v_accvgpr_read_b32 v4, a7
    v_mul_f32 v1, v1, v116
    v_mul_f32 v2, v2, v116
    v_mul_f32 v3, v3, v116
    v_mul_f32 v4, v4, v116
    v_accvgpr_write_b32 a4, v1
    v_accvgpr_write_b32 a5, v2
    v_accvgpr_write_b32 a6, v3
    v_accvgpr_write_b32 a7, v4
    v_accvgpr_read_b32 v1, a12
    v_accvgpr_read_b32 v2, a13
    v_accvgpr_read_b32 v3, a14
    v_accvgpr_read_b32 v4, a15
    v_mul_f32 v1, v1, v116
    v_mul_f32 v2, v2, v116
    v_mul_f32 v3, v3, v116
    v_mul_f32 v4, v4, v116
    v_accvgpr_write_b32 a12, v1
    v_accvgpr_write_b32 a13, v2
    v_accvgpr_write_b32 a14, v3
    v_accvgpr_write_b32 a15, v4
    v_accvgpr_read_b32 v1, a20
    v_accvgpr_read_b32 v2, a21
    v_accvgpr_read_b32 v3, a22
    v_accvgpr_read_b32 v4, a23
    v_mul_f32 v1, v1, v116
    v_mul_f32 v2, v2, v116
    v_mul_f32 v3, v3, v116
    v_mul_f32 v4, v4, v116
    v_accvgpr_write_b32 a20, v1
    v_accvgpr_write_b32 a21, v2
    v_accvgpr_write_b32 a22, v3
    v_accvgpr_write_b32 a23, v4
    v_accvgpr_read_b32 v1, a28
    v_accvgpr_read_b32 v2, a29
    v_accvgpr_read_b32 v3, a30
    v_accvgpr_read_b32 v4, a31
    v_mul_f32 v1, v1, v116
    v_mul_f32 v2, v2, v116
    v_mul_f32 v3, v3, v116
    v_mul_f32 v4, v4, v116
    v_accvgpr_write_b32 a28, v1
    v_accvgpr_write_b32 a29, v2
    v_accvgpr_write_b32 a30, v3
    v_accvgpr_write_b32 a31, v4
    v_accvgpr_read_b32 v1, a36
    v_accvgpr_read_b32 v2, a37
    v_accvgpr_read_b32 v3, a38
    v_accvgpr_read_b32 v4, a39
    v_mul_f32 v1, v1, v116
    v_mul_f32 v2, v2, v116
    v_mul_f32 v3, v3, v116
    v_mul_f32 v4, v4, v116
    v_accvgpr_write_b32 a36, v1
    v_accvgpr_write_b32 a37, v2
    v_accvgpr_write_b32 a38, v3
    v_accvgpr_write_b32 a39, v4
    v_accvgpr_read_b32 v1, a44
    v_accvgpr_read_b32 v2, a45
    v_accvgpr_read_b32 v3, a46
    v_accvgpr_read_b32 v4, a47
    v_mul_f32 v1, v1, v116
    v_mul_f32 v2, v2, v116
    v_mul_f32 v3, v3, v116
    v_mul_f32 v4, v4, v116
    v_accvgpr_write_b32 a44, v1
    v_accvgpr_write_b32 a45, v2
    v_accvgpr_write_b32 a46, v3
    v_accvgpr_write_b32 a47, v4
    v_accvgpr_read_b32 v1, a52
    v_accvgpr_read_b32 v2, a53
    v_accvgpr_read_b32 v3, a54
    v_accvgpr_read_b32 v4, a55
    v_mul_f32 v1, v1, v116
    v_mul_f32 v2, v2, v116
    v_mul_f32 v3, v3, v116
    v_mul_f32 v4, v4, v116
    v_accvgpr_write_b32 a52, v1
    v_accvgpr_write_b32 a53, v2
    v_accvgpr_write_b32 a54, v3
    v_accvgpr_write_b32 a55, v4
    v_accvgpr_read_b32 v1, a60
    v_accvgpr_read_b32 v2, a61
    v_accvgpr_read_b32 v3, a62
    v_accvgpr_read_b32 v4, a63
    v_mul_f32 v1, v1, v116
    v_mul_f32 v2, v2, v116
    v_mul_f32 v3, v3, v116
    v_mul_f32 v4, v4, v116
    v_accvgpr_write_b32 a60, v1
    v_accvgpr_write_b32 a61, v2
    v_accvgpr_write_b32 a62, v3
    v_accvgpr_write_b32 a63, v4
    s_nop 1
    s_branch Lat_b0
Lat_last1:
    s_waitcnt lgkmcnt(0)
    ds_read_b128 a[96:99], v9 offset:49152
    ds_read_b128 a[100:103], v9 offset:49408
    ds_read_b128 a[104:107], v9 offset:53248
    ds_read_b128 a[108:111], v9 offset:53504
    ds_read_b128 a[112:115], v9 offset:57344
    ds_read_b128 a[116:119], v9 offset:57600
    ds_read_b128 a[120:123], v9 offset:61440
    v_exp_f32 v48, v48
    v_exp_f32 v49, v49
    v_exp_f32 v50, v50
    v_exp_f32 v51, v51
    v_cvt_pk_bf16_f32 v80, v48, v49
    v_exp_f32 v56, v56
    v_exp_f32 v57, v57
    v_cvt_pk_bf16_f32 v81, v50, v51
    v_exp_f32 v58, v58
    v_exp_f32 v59, v59
    v_cvt_pk_bf16_f32 v82, v56, v57
    v_exp_f32 v52, v52
    v_exp_f32 v53, v53
    v_cvt_pk_bf16_f32 v83, v58, v59
    v_exp_f32 v54, v54
    v_exp_f32 v55, v55
    v_cvt_pk_bf16_f32 v84, v52, v53
    v_exp_f32 v60, v60
    v_exp_f32 v61, v61
    v_cvt_pk_bf16_f32 v85, v54, v55
    v_exp_f32 v62, v62
    v_exp_f32 v63, v63
    v_cvt_pk_bf16_f32 v86, v60, v61
    v_exp_f32 v64, v64
    v_exp_f32 v65, v65
    v_cvt_pk_bf16_f32 v87, v62, v63
    s_nop 1
    s_waitcnt lgkmcnt(3)
    v_mfma_f32_16x16x32_bf16 a[0:3], a[96:99], v[80:83], a[0:3]
    ds_read_b128 a[124:127], v9 offset:61696
    v_exp_f32 v66, v66
    v_mfma_f32_16x16x32_bf16 a[4:7], a[96:99], v[84:87], a[4:7]
    v_exp_f32 v67, v67
    v_cvt_pk_bf16_f32 v88, v64, v65
    v_mfma_f32_16x16x32_bf16 a[8:11], a[100:103], v[80:83], a[8:11]
    ds_read_b128 a[96:99], v9 offset:51200
    v_exp_f32 v72, v72
    v_mfma_f32_16x16x32_bf16 a[12:15], a[100:103], v[84:87], a[12:15]
    v_exp_f32 v73, v73
    v_cvt_pk_bf16_f32 v89, v66, v67
    v_mfma_f32_16x16x32_bf16 a[16:19], a[104:107], v[80:83], a[16:19]
    ds_read_b128 a[100:103], v9 offset:51456
    v_exp_f32 v74, v74
    v_mfma_f32_16x16x32_bf16 a[20:23], a[104:107], v[84:87], a[20:23]
    v_exp_f32 v75, v75
    v_cvt_pk_bf16_f32 v90, v72, v73
    v_mfma_f32_16x16x32_bf16 a[24:27], a[108:111], v[80:83], a[24:27]
    ds_read_b128 a[104:107], v9 offset:55296
    v_exp_f32 v68, v68
    v_mfma_f32_16x16x32_bf16 a[28:31], a[108:111], v[84:87], a[28:31]
    v_exp_f32 v69, v69
    v_cvt_pk_bf16_f32 v91, v74, v75
    s_waitcnt lgkmcnt(3)
    v_mfma_f32_16x16x32_bf16 a[32:35], a[112:115], v[80:83], a[32:35]
    ds_read_b128 a[108:111], v9 offset:55552
    v_exp_f32 v70, v70
    v_mfma_f32_16x16x32_bf16 a[36:39], a[112:115], v[84:87], a[36:39]
    v_exp_f32 v71, v71
    v_cvt_pk_bf16_f32 v92, v68, v69
    v_mfma_f32_16x16x32_bf16 a[40:43], a[116:119], v[80:83], a[40:43]
    ds_read_b128 a[112:115], v9 offset:59392
    v_exp_f32 v76, v76
    v_exp_f32 v77, v77
    v_mfma_f32_16x16x32_bf16 a[44:47], a[116:119], v[84:87], a[44:47]
    v_cvt_pk_bf16_f32 v93, v70, v71
    v_exp_f32 v78, v78
    v_mfma_f32_16x16x32_bf16 a[48:51], a[120:123], v[80:83], a[48:51]
    ds_read_b128 a[116:119], v9 offset:59648
    v_exp_f32 v79, v79
    v_mfma_f32_16x16x32_bf16 a[52:55], a[120:123], v[84:87], a[52:55]
    v_cvt_pk_bf16_f32 v94, v76, v77
    v_cvt_pk_bf16_f32 v95, v78, v79
    v_mfma_f32_16x16x32_bf16 a[56:59], a[124:127], v[80:83], a[56:59]
    ds_read_b128 a[120:123], v9 offset:63488
    v_mfma_f32_16x16x32_bf16 a[60:63], a[124:127], v[84:87], a[60:63]
    s_waitcnt lgkmcnt(3)
    v_mfma_f32_16x16x32_bf16 a[0:3], a[96:99], v[88:91], a[0:3]
    ds_read_b128 a[124:127], v9 offset:63744
    v_mfma_f32_16x16x32_bf16 a[4:7], a[96:99], v[92:95], a[4:7]
    v_mfma_f32_16x16x32_bf16 a[8:11], a[100:103], v[88:91], a[8:11]
    v_mfma_f32_16x16x32_bf16 a[12:15], a[100:103], v[92:95], a[12:15]
    v_mfma_f32_16x16x32_bf16 v[112:115], v[108:111], v[80:83], v[112:115]
    v_mfma_f32_16x16x32_bf16 a[16:19], a[104:107], v[88:91], a[16:19]
    v_mfma_f32_16x16x32_bf16 a[20:23], a[104:107], v[92:95], a[20:23]
    v_mfma_f32_16x16x32_bf16 v[120:123], v[108:111], v[84:87], v[120:123]
    v_mfma_f32_16x16x32_bf16 a[24:27], a[108:111], v[88:91], a[24:27]
    v_mfma_f32_16x16x32_bf16 a[28:31], a[108:111], v[92:95], a[28:31]
    v_mfma_f32_16x16x32_bf16 v[112:115], v[108:111], v[88:91], v[112:115]
    s_waitcnt lgkmcnt(0)
    v_mfma_f32_16x16x32_bf16 a[32:35], a[112:115], v[88:91], a[32:35]
    v_mfma_f32_16x16x32_bf16 a[36:39], a[112:115], v[92:95], a[36:39]
    v_mfma_f32_16x16x32_bf16 v[120:123], v[108:111], v[92:95], v[120:123]
    v_mfma_f32_16x16x32_bf16 a[40:43], a[116:119], v[88:91], a[40:43]
    v_mfma_f32_16x16x32_bf16 a[44:47], a[116:119], v[92:95], a[44:47]
    v_mfma_f32_16x16x32_bf16 a[48:51], a[120:123], v[88:91], a[48:51]
    v_mfma_f32_16x16x32_bf16 a[52:55], a[120:123], v[92:95], a[52:55]
    v_mfma_f32_16x16x32_bf16 a[56:59], a[124:127], v[88:91], a[56:59]
    v_mfma_f32_16x16x32_bf16 a[60:63], a[124:127], v[92:95], a[60:63]
    s_branch Lat_fin
Lat_last3:
    s_waitcnt lgkmcnt(0)
    ds_read_b128 a[96:99], v8 offset:0
    ds_read_b128 a[100:103], v8 offset:256
    ds_read_b128 a[104:107], v8 offset:4096
    ds_read_b128 a[108:111], v8 offset:4352
    ds_read_b128 a[112:115], v8 offset:8192
    ds_read_b128 a[116:119], v8 offset:8448
    ds_read_b128 a[120:123], v8 offset:12288
    v_exp_f32 v48, v48
    v_exp_f32 v49, v49
    v_exp_f32 v50, v50
    v_exp_f32 v51, v51
    v_cvt_pk_bf16_f32 v80, v48, v49
    v_exp_f32 v56, v56
    v_exp_f32 v57, v57
    v_cvt_pk_bf16_f32 v81, v50, v51
    v_exp_f32 v58, v58
    v_exp_f32 v59, v59
    v_cvt_pk_bf16_f32 v82, v56, v57
    v_exp_f32 v52, v52
    v_exp_f32 v53, v53
    v_cvt_pk_bf16_f32 v83, v58, v59
    v_exp_f32 v54, v54
    v_exp_f32 v55, v55
    v_cvt_pk_bf16_f32 v84, v52, v53
    v_exp_f32 v60, v60
    v_exp_f32 v61, v61
    v_cvt_pk_bf16_f32 v85, v54, v55
    v_exp_f32 v62, v62
    v_exp_f32 v63, v63
    v_cvt_pk_bf16_f32 v86, v60, v61
    v_exp_f32 v64, v64
    v_exp_f32 v65, v65
    v_cvt_pk_bf16_f32 v87, v62, v63
    s_nop 1
    s_waitcnt lgkmcnt(3)
    v_mfma_f32_16x16x32_bf16 a[0:3], a[96:99], v[80:83], a[0:3]
    ds_read_b128 a[124:127], v8 offset:12544
    v_exp_f32 v66, v66
    v_mfma_f32_16x16x32_bf16 a[4:7], a[96:99], v[84:87], a[4:7]
    v_exp_f32 v67, v67
    v_cvt_pk_bf16_f32 v88, v64, v65
    v_mfma_f32_16x16x32_bf16 a[8:11], a[100:103], v[80:83], a[8:11]
    ds_read_b128 a[96:99], v8 offset:2048
    v_exp_f32 v72, v72
    v_mfma_f32_16x16x32_bf16 a[12:15], a[100:103], v[84:87], a[12:15]
    v_exp_f32 v73, v73
    v_cvt_pk_bf16_f32 v89, v66, v67
    v_mfma_f32_16x16x32_bf16 a[16:19], a[104:107], v[80:83], a[16:19]
    ds_read_b128 a[100:103], v8 offset:2304
    v_exp_f32 v74, v74
    v_mfma_f32_16x16x32_bf16 a[20:23], a[104:107], v[84:87], a[20:23]
    v_exp_f32 v75, v75
    v_cvt_pk_bf16_f32 v90, v72, v73
    v_mfma_f32_16x16x32_bf16 a[24:27], a[108:111], v[80:83], a[24:27]
    ds_read_b128 a[104:107], v8 offset:6144
    v_exp_f32 v68, v68
    v_mfma_f32_16x16x32_bf16 a[28:31], a[108:111], v[84:87], a[28:31]
    v_exp_f32 v69, v69
    v_cvt_pk_bf16_f32 v91, v74, v75
    s_waitcnt lgkmcnt(3)
    v_mfma_f32_16x16x32_bf16 a[32:35], a[112:115], v[80:83], a[32:35]
    ds_read_b128 a[108:111], v8 offset:6400
    v_exp_f32 v70, v70
    v_mfma_f32_16x16x32_bf16 a[36:39], a[112:115], v[84:87], a[36:39]
    v_exp_f32 v71, v71
    v_cvt_pk_bf16_f32 v92, v68, v69
    v_mfma_f32_16x16x32_bf16 a[40:43], a[116:119], v[80:83], a[40:43]
    ds_read_b128 a[112:115], v8 offset:10240
    v_exp_f32 v76, v76
    v_exp_f32 v77, v77
    v_mfma_f32_16x16x32_bf16 a[44:47], a[116:119], v[84:87], a[44:47]
    v_cvt_pk_bf16_f32 v93, v70, v71
    v_exp_f32 v78, v78
    v_mfma_f32_16x16x32_bf16 a[48:51], a[120:123], v[80:83], a[48:51]
    ds_read_b128 a[116:119], v8 offset:10496
    v_exp_f32 v79, v79
    v_mfma_f32_16x16x32_bf16 a[52:55], a[120:123], v[84:87], a[52:55]
    v_cvt_pk_bf16_f32 v94, v76, v77
    v_cvt_pk_bf16_f32 v95, v78, v79
    v_mfma_f32_16x16x32_bf16 a[56:59], a[124:127], v[80:83], a[56:59]
    ds_read_b128 a[120:123], v8 offset:14336
    v_mfma_f32_16x16x32_bf16 a[60:63], a[124:127], v[84:87], a[60:63]
    s_waitcnt lgkmcnt(3)
    v_mfma_f32_16x16x32_bf16 a[0:3], a[96:99], v[88:91], a[0:3]
    ds_read_b128 a[124:127], v8 offset:14592
    v_mfma_f32_16x16x32_bf16 a[4:7], a[96:99], v[92:95], a[4:7]
    v_mfma_f32_16x16x32_bf16 a[8:11], a[100:103], v[88:91], a[8:11]
    v_mfma_f32_16x16x32_bf16 a[12:15], a[100:103], v[92:95], a[12:15]
    v_mfma_f32_16x16x32_bf16 v[112:115], v[108:111], v[80:83], v[112:115]
    v_mfma_f32_16x16x32_bf16 a[16:19], a[104:107], v[88:91], a[16:19]
    v_mfma_f32_16x16x32_bf16 a[20:23], a[104:107], v[92:95], a[20:23]
    v_mfma_f32_16x16x32_bf16 v[120:123], v[108:111], v[84:87], v[120:123]
    v_mfma_f32_16x16x32_bf16 a[24:27], a[108:111], v[88:91], a[24:27]
    v_mfma_f32_16x16x32_bf16 a[28:31], a[108:111], v[92:95], a[28:31]
    v_mfma_f32_16x16x32_bf16 v[112:115], v[108:111], v[88:91], v[112:115]
    s_waitcnt lgkmcnt(0)
    v_mfma_f32_16x16x32_bf16 a[32:35], a[112:115], v[88:91], a[32:35]
    v_mfma_f32_16x16x32_bf16 a[36:39], a[112:115], v[92:95], a[36:39]
    v_mfma_f32_16x16x32_bf16 v[120:123], v[108:111], v[92:95], v[120:123]
    v_mfma_f32_16x16x32_bf16 a[40:43], a[116:119], v[88:91], a[40:43]
    v_mfma_f32_16x16x32_bf16 a[44:47], a[116:119], v[92:95], a[44:47]
    v_mfma_f32_16x16x32_bf16 a[48:51], a[120:123], v[88:91], a[48:51]
    v_mfma_f32_16x16x32_bf16 a[52:55], a[120:123], v[92:95], a[52:55]
    v_mfma_f32_16x16x32_bf16 a[56:59], a[124:127], v[88:91], a[56:59]
    v_mfma_f32_16x16x32_bf16 a[60:63], a[124:127], v[92:95], a[60:63]
Lat_fin:
    s_barrier
    ds_read_b128 a[64:67], v104 offset:0
    ds_read_b128 a[68:71], v104 offset:256
    ds_read_b128 a[72:75], v104 offset:2048
    ds_read_b128 a[76:79], v104 offset:2304
    ds_read_b128 a[80:83], v104 offset:4096
    ds_read_b128 a[84:87], v104 offset:4352
    ds_read_b128 a[88:91], v104 offset:6144
    ds_read_b128 a[92:95], v104 offset:6400
    s_nop 7
    v_rcp_f32 v112, v112
    v_rcp_f32 v114, v120
    s_lshl_b32 s72, s43, 20
    s_lshl_b32 s73, s41, 13
    s_add_u32 s72, s72, s73
    s_lshl_b32 s73, s40, 18
    s_add_u32 s72, s72, s73
    s_add_u32 s73, s72, 4096
    s_nop 7
    s_nop 3
    v_accvgpr_read_b32 v16, a0
    v_accvgpr_read_b32 v17, a1
    v_accvgpr_read_b32 v18, a2
    v_accvgpr_read_b32 v19, a3
    v_accvgpr_read_b32 v20, a4
    v_accvgpr_read_b32 v21, a5
    v_accvgpr_read_b32 v22, a6
    v_accvgpr_read_b32 v23, a7
    v_mul_f32 v16, v16, v112
    v_mul_f32 v17, v17, v112
    v_mul_f32 v18, v18, v112
    v_mul_f32 v19, v19, v112
    v_mul_f32 v20, v20, v114
    v_mul_f32 v21, v21, v114
    v_mul_f32 v22, v22, v114
    v_mul_f32 v23, v23, v114
    v_cvt_pk_bf16_f32 v16, v16, v17
    v_cvt_pk_bf16_f32 v17, v18, v19
    v_cvt_pk_bf16_f32 v18, v20, v21
    v_cvt_pk_bf16_f32 v19, v22, v23
    buffer_store_dwordx2 v[16:17], v105, s[32:35], s72 offen offset:0 sc0 sc1
    buffer_store_dwordx2 v[18:19], v105, s[32:35], s72 offen offset:256 sc0 sc1
    v_accvgpr_read_b32 v24, a8
    v_accvgpr_read_b32 v25, a9
    v_accvgpr_read_b32 v26, a10
    v_accvgpr_read_b32 v27, a11
    v_accvgpr_read_b32 v28, a12
    v_accvgpr_read_b32 v29, a13
    v_accvgpr_read_b32 v30, a14
    v_accvgpr_read_b32 v31, a15
    v_mul_f32 v24, v24, v112
    v_mul_f32 v25, v25, v112
    v_mul_f32 v26, v26, v112
    v_mul_f32 v27, v27, v112
    v_mul_f32 v28, v28, v114
    v_mul_f32 v29, v29, v114
    v_mul_f32 v30, v30, v114
    v_mul_f32 v31, v31, v114
    v_cvt_pk_bf16_f32 v24, v24, v25
    v_cvt_pk_bf16_f32 v25, v26, v27
    v_cvt_pk_bf16_f32 v26, v28, v29
    v_cvt_pk_bf16_f32 v27, v30, v31
    buffer_store_dwordx2 v[24:25], v105, s[32:35], s72 offen offset:1024 sc0 sc1
    buffer_store_dwordx2 v[26:27], v105, s[32:35], s72 offen offset:1280 sc0 sc1
    v_accvgpr_read_b32 v32, a16
    v_accvgpr_read_b32 v33, a17
    v_accvgpr_read_b32 v34, a18
    v_accvgpr_read_b32 v35, a19
    v_accvgpr_read_b32 v36, a20
    v_accvgpr_read_b32 v37, a21
    v_accvgpr_read_b32 v38, a22
    v_accvgpr_read_b32 v39, a23
    v_mul_f32 v32, v32, v112
    v_mul_f32 v33, v33, v112
    v_mul_f32 v34, v34, v112
    v_mul_f32 v35, v35, v112
    v_mul_f32 v36, v36, v114
    v_mul_f32 v37, v37, v114
    v_mul_f32 v38, v38, v114
    v_mul_f32 v39, v39, v114
    v_cvt_pk_bf16_f32 v32, v32, v33
    v_cvt_pk_bf16_f32 v33, v34, v35
    v_cvt_pk_bf16_f32 v34, v36, v37
    v_cvt_pk_bf16_f32 v35, v38, v39
    buffer_store_dwordx2 v[32:33], v105, s[32:35], s72 offen offset:2048 sc0 sc1
    buffer_store_dwordx2 v[34:35], v105, s[32:35], s72 offen offset:2304 sc0 sc1
    v_accvgpr_read_b32 v40, a24
    v_accvgpr_read_b32 v41, a25
    v_accvgpr_read_b32 v42, a26
    v_accvgpr_read_b32 v43, a27
    v_accvgpr_read_b32 v44, a28
    v_accvgpr_read_b32 v45, a29
    v_accvgpr_read_b32 v46, a30
    v_accvgpr_read_b32 v47, a31
    v_mul_f32 v40, v40, v112
    v_mul_f32 v41, v41, v112
    v_mul_f32 v42, v42, v112
    v_mul_f32 v43, v43, v112
    v_mul_f32 v44, v44, v114
    v_mul_f32 v45, v45, v114
    v_mul_f32 v46, v46, v114
    v_mul_f32 v47, v47, v114
    v_cvt_pk_bf16_f32 v40, v40, v41
    v_cvt_pk_bf16_f32 v41, v42, v43
    v_cvt_pk_bf16_f32 v42, v44, v45
    v_cvt_pk_bf16_f32 v43, v46, v47
    buffer_store_dwordx2 v[40:41], v105, s[32:35], s72 offen offset:3072 sc0 sc1
    buffer_store_dwordx2 v[42:43], v105, s[32:35], s72 offen offset:3328 sc0 sc1
    v_accvgpr_read_b32 v48, a32
    v_accvgpr_read_b32 v49, a33
    v_accvgpr_read_b32 v50, a34
    v_accvgpr_read_b32 v51, a35
    v_accvgpr_read_b32 v52, a36
    v_accvgpr_read_b32 v53, a37
    v_accvgpr_read_b32 v54, a38
    v_accvgpr_read_b32 v55, a39
    v_mul_f32 v48, v48, v112
    v_mul_f32 v49, v49, v112
    v_mul_f32 v50, v50, v112
    v_mul_f32 v51, v51, v112
    v_mul_f32 v52, v52, v114
    v_mul_f32 v53, v53, v114
    v_mul_f32 v54, v54, v114
    v_mul_f32 v55, v55, v114
    v_cvt_pk_bf16_f32 v48, v48, v49
    v_cvt_pk_bf16_f32 v49, v50, v51
    v_cvt_pk_bf16_f32 v50, v52, v53
    v_cvt_pk_bf16_f32 v51, v54, v55
    buffer_store_dwordx2 v[48:49], v105, s[32:35], s73 offen offset:0 sc0 sc1
    buffer_store_dwordx2 v[50:51], v105, s[32:35], s73 offen offset:256 sc0 sc1
    v_accvgpr_read_b32 v56, a40
    v_accvgpr_read_b32 v57, a41
    v_accvgpr_read_b32 v58, a42
    v_accvgpr_read_b32 v59, a43
    v_accvgpr_read_b32 v60, a44
    v_accvgpr_read_b32 v61, a45
    v_accvgpr_read_b32 v62, a46
    v_accvgpr_read_b32 v63, a47
    v_mul_f32 v56, v56, v112
    v_mul_f32 v57, v57, v112
    v_mul_f32 v58, v58, v112
    v_mul_f32 v59, v59, v112
    v_mul_f32 v60, v60, v114
    v_mul_f32 v61, v61, v114
    v_mul_f32 v62, v62, v114
    v_mul_f32 v63, v63, v114
    v_cvt_pk_bf16_f32 v56, v56, v57
    v_cvt_pk_bf16_f32 v57, v58, v59
    v_cvt_pk_bf16_f32 v58, v60, v61
    v_cvt_pk_bf16_f32 v59, v62, v63
    buffer_store_dwordx2 v[56:57], v105, s[32:35], s73 offen offset:1024 sc0 sc1
    buffer_store_dwordx2 v[58:59], v105, s[32:35], s73 offen offset:1280 sc0 sc1
    v_accvgpr_read_b32 v64, a48
    v_accvgpr_read_b32 v65, a49
    v_accvgpr_read_b32 v66, a50
    v_accvgpr_read_b32 v67, a51
    v_accvgpr_read_b32 v68, a52
    v_accvgpr_read_b32 v69, a53
    v_accvgpr_read_b32 v70, a54
    v_accvgpr_read_b32 v71, a55
    v_mul_f32 v64, v64, v112
    v_mul_f32 v65, v65, v112
    v_mul_f32 v66, v66, v112
    v_mul_f32 v67, v67, v112
    v_mul_f32 v68, v68, v114
    v_mul_f32 v69, v69, v114
    v_mul_f32 v70, v70, v114
    v_mul_f32 v71, v71, v114
    v_cvt_pk_bf16_f32 v64, v64, v65
    v_cvt_pk_bf16_f32 v65, v66, v67
    v_cvt_pk_bf16_f32 v66, v68, v69
    v_cvt_pk_bf16_f32 v67, v70, v71
    buffer_store_dwordx2 v[64:65], v105, s[32:35], s73 offen offset:2048 sc0 sc1
    buffer_store_dwordx2 v[66:67], v105, s[32:35], s73 offen offset:2304 sc0 sc1
    v_accvgpr_read_b32 v72, a56
    v_accvgpr_read_b32 v73, a57
    v_accvgpr_read_b32 v74, a58
    v_accvgpr_read_b32 v75, a59
    v_accvgpr_read_b32 v76, a60
    v_accvgpr_read_b32 v77, a61
    v_accvgpr_read_b32 v78, a62
    v_accvgpr_read_b32 v79, a63
    v_mul_f32 v72, v72, v112
    v_mul_f32 v73, v73, v112
    v_mul_f32 v74, v74, v112
    v_mul_f32 v75, v75, v112
    v_mul_f32 v76, v76, v114
    v_mul_f32 v77, v77, v114
    v_mul_f32 v78, v78, v114
    v_mul_f32 v79, v79, v114
    v_cvt_pk_bf16_f32 v72, v72, v73
    v_cvt_pk_bf16_f32 v73, v74, v75
    v_cvt_pk_bf16_f32 v74, v76, v77
    v_cvt_pk_bf16_f32 v75, v78, v79
    buffer_store_dwordx2 v[72:73], v105, s[32:35], s73 offen offset:3072 sc0 sc1
    buffer_store_dwordx2 v[74:75], v105, s[32:35], s73 offen offset:3328 sc0 sc1
    s_cmp_eq_u32 s44, 1
    s_cbranch_scc1 Lat_end2
    s_mov_b32 s44, 1
    s_mov_b32 s43, s42
    v_and_b32 v1, 63, v0
    s_lshl_b32 s72, s46, 6
    s_add_u32 s72, s72, 0
    v_add_u32 v2, s72, v1
    v_mul_u32_u24 v2, 128, v2
    buffer_load_dword v13, v2, s[20:23], 0 offen
    v_mov_b32 v96, 0
    v_mov_b32 v97, 0
    v_mov_b32 v98, 0
    v_mov_b32 v99, 0
    v_mov_b32 v100, 0
    v_mov_b32 v101, 0
    v_mov_b32 v102, 0
    v_mov_b32 v103, 0
    s_barrier
    s_branch Lat_blk
Lat_end2:
    s_endpgm
Lat_prod:
    v_and_b32 v1, 63, v0
    s_mul_i32 s48, s40, 8192
    s_lshr_b32 s52, s48, 4
    v_add_u32 v2, s52, v1
    v_lshrrev_b32 v3, 3, v2
    v_and_b32 v4, 7, v2
    v_lshrrev_b32 v5, 1, v3
    v_and_b32 v5, 7, v5
    v_xor_b32 v4, v4, v5
    s_mov_b32 s53, 1280
    v_mul_lo_u32 v3, v3, s53
    v_lshl_add_u32 v84, v4, 4, v3
    v_add_u32 v2, s52, v1
    v_add_u32 v2, 64, v2
    v_lshrrev_b32 v3, 3, v2
    v_and_b32 v4, 7, v2
    v_lshrrev_b32 v5, 1, v3
    v_and_b32 v5, 7, v5
    v_xor_b32 v4, v4, v5
    s_mov_b32 s53, 1280
    v_mul_lo_u32 v3, v3, s53
    v_lshl_add_u32 v85, v4, 4, v3
    v_add_u32 v2, s52, v1
    v_add_u32 v2, 128, v2
    v_lshrrev_b32 v3, 3, v2
    v_and_b32 v4, 7, v2
    v_lshrrev_b32 v5, 1, v3
    v_and_b32 v5, 7, v5
    v_xor_b32 v4, v4, v5
    s_mov_b32 s53, 1280
    v_mul_lo_u32 v3, v3, s53
    v_lshl_add_u32 v86, v4, 4, v3
    v_add_u32 v2, s52, v1
    v_add_u32 v2, 192, v2
    v_lshrrev_b32 v3, 3, v2
    v_and_b32 v4, 7, v2
    v_lshrrev_b32 v5, 1, v3
    v_and_b32 v5, 7, v5
    v_xor_b32 v4, v4, v5
    s_mov_b32 s53, 1280
    v_mul_lo_u32 v3, v3, s53
    v_lshl_add_u32 v87, v4, 4, v3
    v_add_u32 v2, s52, v1
    v_add_u32 v2, 256, v2
    v_lshrrev_b32 v3, 3, v2
    v_and_b32 v4, 7, v2
    v_lshrrev_b32 v5, 1, v3
    v_and_b32 v5, 7, v5
    v_xor_b32 v4, v4, v5
    s_mov_b32 s53, 1280
    v_mul_lo_u32 v3, v3, s53
    v_lshl_add_u32 v88, v4, 4, v3
    v_add_u32 v2, s52, v1
    v_add_u32 v2, 320, v2
    v_lshrrev_b32 v3, 3, v2
    v_and_b32 v4, 7, v2
    v_lshrrev_b32 v5, 1, v3
    v_and_b32 v5, 7, v5
    v_xor_b32 v4, v4, v5
    s_mov_b32 s53, 1280
    v_mul_lo_u32 v3, v3, s53
    v_lshl_add_u32 v89, v4, 4, v3
    v_add_u32 v2, s52, v1
    v_add_u32 v2, 384, v2
    v_lshrrev_b32 v3, 3, v2
    v_and_b32 v4, 7, v2
    v_lshrrev_b32 v5, 1, v3
    v_and_b32 v5, 7, v5
    v_xor_b32 v4, v4, v5
    s_mov_b32 s53, 1280
    v_mul_lo_u32 v3, v3, s53
    v_lshl_add_u32 v90, v4, 4, v3
    v_add_u32 v2, s52, v1
    v_add_u32 v2, 448, v2
    v_lshrrev_b32 v3, 3, v2
    v_and_b32 v4, 7, v2
    v_lshrrev_b32 v5, 1, v3
    v_and_b32 v5, 7, v5
    v_xor_b32 v4, v4, v5
    s_mov_b32 s53, 1280
    v_mul_lo_u32 v3, v3, s53
    v_lshl_add_u32 v91, v4, 4, v3
    s_mul_i32 s50, s40, 4096
    s_lshr_b32 s52, s50, 4
    v_add_u32 v2, s52, v1
    v_lshrrev_b32 v3, 4, v2
    v_and_b32 v4, 15, v2
    v_and_b32 v5, 3, v3
    v_lshlrev_b32 v5, 2, v5
    v_xor_b32 v4, v4, v5
    s_mov_b32 s53, 8192
    v_mul_lo_u32 v3, v3, s53
    v_lshl_add_u32 v92, v4, 4, v3
    v_add_u32 v2, s52, v1
    v_add_u32 v2, 64, v2
    v_lshrrev_b32 v3, 4, v2
    v_and_b32 v4, 15, v2
    v_and_b32 v5, 3, v3
    v_lshlrev_b32 v5, 2, v5
    v_xor_b32 v4, v4, v5
    s_mov_b32 s53, 8192
    v_mul_lo_u32 v3, v3, s53
    v_lshl_add_u32 v93, v4, 4, v3
    v_add_u32 v2, s52, v1
    v_add_u32 v2, 128, v2
    v_lshrrev_b32 v3, 4, v2
    v_and_b32 v4, 15, v2
    v_and_b32 v5, 3, v3
    v_lshlrev_b32 v5, 2, v5
    v_xor_b32 v4, v4, v5
    s_mov_b32 s53, 8192
    v_mul_lo_u32 v3, v3, s53
    v_lshl_add_u32 v94, v4, 4, v3
    v_add_u32 v2, s52, v1
    v_add_u32 v2, 192, v2
    v_lshrrev_b32 v3, 4, v2
    v_and_b32 v4, 15, v2
    v_and_b32 v5, 3, v3
    v_lshlrev_b32 v5, 2, v5
    v_xor_b32 v4, v4, v5
    s_mov_b32 s53, 8192
    v_mul_lo_u32 v3, v3, s53
    v_lshl_add_u32 v95, v4, 4, v3
    s_lshl_b32 s60, s40, 5
    s_lshl_b32 s61, s43, 7
    s_sub_u32 s61, s61, s60
    s_mul_i32 s61, s61, 1280
    s_lshl_b32 s62, s42, 7
    s_sub_u32 s62, s62, s60
    s_sub_u32 s62, s62, 32
    s_mul_i32 s62, s62, 1280
    v_add_u32 v84, s61, v84
    v_add_u32 v85, s61, v85
    v_add_u32 v86, s61, v86
    v_add_u32 v87, s61, v87
    v_add_u32 v88, s62, v88
    v_add_u32 v89, s62, v89
    v_add_u32 v90, s62, v90
    v_add_u32 v91, s62, v91
    s_mov_b32 s74, 100926217
    s_mov_b32 s75, 526085
    s_lshl_b32 s61, s40, 12
    v_add_u32 v8, s61, v8
    s_mov_b32 s71, 0x7f000000
    s_waitcnt lgkmcnt(0)
    s_mov_b32 s16, s12
    s_mov_b32 s17, s13
    s_mov_b32 s18, 2621440
    s_mov_b32 s19, 0x00020000
    s_mov_b32 s20, s4
    s_mov_b32 s21, s5
    s_mov_b32 s22, 5242880
    s_mov_b32 s23, 0x00020000
    s_add_u32 s24, s12, 4194304
    s_addc_u32 s25, s13, 0
    s_mov_b32 s26, 16777216
    s_mov_b32 s27, 0x00020000
    s_add_u32 s28, s12, 25165824
    s_addc_u32 s29, s13, 0
    s_mov_b32 s30, 16777216
    s_mov_b32 s31, 0x00020000
    s_mov_b32 s36, s6
    s_mov_b32 s37, s7
    s_mov_b32 s38, 5242880
    s_mov_b32 s39, 0x00020000
    s_mov_b32 s80, s8
    s_mov_b32 s81, s9
    s_mov_b32 s82, 7077888
    s_mov_b32 s83, 0x00020000
    s_mov_b32 s84, s10
    s_mov_b32 s85, s11
    s_mov_b32 s86, 7077888
    s_mov_b32 s87, 0x00020000
    v_and_b32 v1, 63, v0
    s_lshl_b32 s60, s2, 2
    s_add_u32 s60, s60, s40
    s_mul_i32 s60, s60, 256
    v_lshlrev_b32 v2, 7, v1
    v_add_u32 v2, s60, v2
    v_mov_b32 v3, s71
    v_cmp_gt_u32 vcc, 2, v1
    s_nop 1
    v_cndmask_b32 v9, v3, v2, vcc
    s_mov_b32 s77, 0
    s_add_u32 s66, s43, 1
    s_lshl_b32 s66, s66, 1
    s_lshl_b32 s62, s41, 19
    s_mov_b32 s63, s62
    s_mov_b32 s64, 0
    s_mov_b32 s65, 0
    s_mov_b32 s78, s66
    s_mov_b32 s79, s66
    s_add_u32 s76, s66, 3
    s_andn2_b32 s76, s76, 3
    s_mov_b32 s88, s62
    s_add_u32 s89, s42, 1
    s_lshl_b32 s89, s89, 1
    s_mov_b32 s49, 0
    s_lshl_b32 s51, s41, 8
    s_cmp_eq_u32 s64, s76
    s_cselect_b32 s64, 0, s64
    s_cselect_b32 s62, s88, s62
    s_cselect_b32 s78, s89, s78
    s_and_b32 s68, s64, 3
    s_lshl_b32 s68, s68, 3
    s_lshr_b32 s68, s74, s68
    s_and_b32 s68, s68, 15
    s_lshl_b32 s68, s68, 14
    s_add_u32 m0, s68, s61
    s_cmp_lt_u32 s64, s78
    s_cselect_b32 s68, s62, s71
    buffer_load_dwordx4 v8, s[24:27], s68 offen offset:0 lds
    buffer_load_dwordx4 v8, s[24:27], s68 offen offset:1024 lds
    buffer_load_dwordx4 v8, s[24:27], s68 offen offset:2048 lds
    buffer_load_dwordx4 v8, s[24:27], s68 offen offset:3072 lds
    s_add_u32 s62, s62, 16384
    s_add_u32 s64, s64, 1
    s_add_u32 m0, s48, 0
    s_nop 0
    buffer_load_dwordx4 v84, s[16:19], s49 offen lds
    s_add_u32 m0, s48, 1024
    s_nop 0
    buffer_load_dwordx4 v85, s[16:19], s49 offen lds
    s_add_u32 m0, s48, 2048
    s_nop 0
    buffer_load_dwordx4 v86, s[16:19], s49 offen lds
    s_add_u32 m0, s48, 3072
    s_nop 0
    buffer_load_dwordx4 v87, s[16:19], s49 offen lds
    s_add_u32 m0, s48, 4096
    s_nop 0
    buffer_load_dwordx4 v88, s[16:19], s49 offen lds
    s_add_u32 m0, s48, 5120
    s_nop 0
    buffer_load_dwordx4 v89, s[16:19], s49 offen lds
    s_add_u32 m0, s48, 6144
    s_nop 0
    buffer_load_dwordx4 v90, s[16:19], s49 offen lds
    s_add_u32 m0, s48, 7168
    s_nop 0
    buffer_load_dwordx4 v91, s[16:19], s49 offen lds
    s_add_u32 s49, s49, 128
    s_add_u32 m0, s50, 32768
    s_nop 0
    buffer_load_dwordx4 v92, s[20:23], s51 offen lds
    s_add_u32 m0, s50, 33792
    s_nop 0
    buffer_load_dwordx4 v93, s[20:23], s51 offen lds
    s_add_u32 m0, s50, 34816
    s_nop 0
    buffer_load_dwordx4 v94, s[20:23], s51 offen lds
    s_add_u32 m0, s50, 35840
    s_nop 0
    buffer_load_dwordx4 v95, s[20:23], s51 offen lds
    s_add_u32 s51, s51, 524288
    s_add_u32 m0, s48, 49152
    s_nop 0
    buffer_load_dwordx4 v84, s[16:19], s49 offen lds
    s_add_u32 m0, s48, 50176
    s_nop 0
    buffer_load_dwordx4 v85, s[16:19], s49 offen lds
    s_add_u32 m0, s48, 51200
    s_nop 0
    buffer_load_dwordx4 v86, s[16:19], s49 offen lds
    s_add_u32 m0, s48, 52224
    s_nop 0
    buffer_load_dwordx4 v87, s[16:19], s49 offen lds
    s_add_u32 m0, s48, 53248
    s_nop 0
    buffer_load_dwordx4 v88, s[16:19], s49 offen lds
    s_add_u32 m0, s48, 54272
    s_nop 0
    buffer_load_dwordx4 v89, s[16:19], s49 offen lds
    s_add_u32 m0, s48, 55296
    s_nop 0
    buffer_load_dwordx4 v90, s[16:19], s49 offen lds
    s_add_u32 m0, s48, 56320
    s_nop 0
    buffer_load_dwordx4 v91, s[16:19], s49 offen lds
    s_add_u32 s49, s49, 128
    s_add_u32 m0, s50, 81920
    s_nop 0
    buffer_load_dwordx4 v92, s[20:23], s51 offen lds
    s_add_u32 m0, s50, 82944
    s_nop 0
    buffer_load_dwordx4 v93, s[20:23], s51 offen lds
    s_add_u32 m0, s50, 83968
    s_nop 0
    buffer_load_dwordx4 v94, s[20:23], s51 offen lds
    s_add_u32 m0, s50, 84992
    s_nop 0
    buffer_load_dwordx4 v95, s[20:23], s51 offen lds
    s_add_u32 s51, s51, 524288
    s_add_u32 m0, s48, 98304
    s_nop 0
    buffer_load_dwordx4 v84, s[16:19], s49 offen lds
    s_add_u32 m0, s48, 99328
    s_nop 0
    buffer_load_dwordx4 v85, s[16:19], s49 offen lds
    s_add_u32 m0, s48, 100352
    s_nop 0
    buffer_load_dwordx4 v86, s[16:19], s49 offen lds
    s_add_u32 m0, s48, 101376
    s_nop 0
    buffer_load_dwordx4 v87, s[16:19], s49 offen lds
    s_add_u32 m0, s48, 102400
    s_nop 0
    buffer_load_dwordx4 v88, s[16:19], s49 offen lds
    s_add_u32 m0, s48, 103424
    s_nop 0
    buffer_load_dwordx4 v89, s[16:19], s49 offen lds
    s_add_u32 m0, s48, 104448
    s_nop 0
    buffer_load_dwordx4 v90, s[16:19], s49 offen lds
    s_add_u32 m0, s48, 105472
    s_nop 0
    buffer_load_dwordx4 v91, s[16:19], s49 offen lds
    s_add_u32 s49, s49, 128
    s_add_u32 m0, s50, 131072
    s_nop 0
    buffer_load_dwordx4 v92, s[20:23], s51 offen lds
    s_add_u32 m0, s50, 132096
    s_nop 0
    buffer_load_dwordx4 v93, s[20:23], s51 offen lds
    s_add_u32 m0, s50, 133120
    s_nop 0
    buffer_load_dwordx4 v94, s[20:23], s51 offen lds
    s_add_u32 m0, s50, 134144
    s_nop 0
    buffer_load_dwordx4 v95, s[20:23], s51 offen lds
    s_add_u32 s51, s51, 524288
    s_waitcnt vmcnt(24)
    s_barrier
    s_waitcnt vmcnt(12)
    s_barrier
    s_add_u32 m0, s48, 0
    s_nop 0
    buffer_load_dwordx4 v84, s[16:19], s49 offen lds
    s_add_u32 m0, s48, 1024
    s_nop 0
    buffer_load_dwordx4 v85, s[16:19], s49 offen lds
    s_add_u32 m0, s48, 2048
    s_nop 0
    buffer_load_dwordx4 v86, s[16:19], s49 offen lds
    s_add_u32 m0, s48, 3072
    s_nop 0
    buffer_load_dwordx4 v87, s[16:19], s49 offen lds
    s_add_u32 m0, s48, 4096
    s_nop 0
    buffer_load_dwordx4 v88, s[16:19], s49 offen lds
    s_add_u32 m0, s48, 5120
    s_nop 0
    buffer_load_dwordx4 v89, s[16:19], s49 offen lds
    s_add_u32 m0, s48, 6144
    s_nop 0
    buffer_load_dwordx4 v90, s[16:19], s49 offen lds
    s_add_u32 m0, s48, 7168
    s_nop 0
    buffer_load_dwordx4 v91, s[16:19], s49 offen lds
    s_add_u32 s49, s49, 128
    s_add_u32 m0, s50, 32768
    s_nop 0
    buffer_load_dwordx4 v92, s[20:23], s51 offen lds
    s_add_u32 m0, s50, 33792
    s_nop 0
    buffer_load_dwordx4 v93, s[20:23], s51 offen lds
    s_add_u32 m0, s50, 34816
    s_nop 0
    buffer_load_dwordx4 v94, s[20:23], s51 offen lds
    s_add_u32 m0, s50, 35840
    s_nop 0
    buffer_load_dwordx4 v95, s[20:23], s51 offen lds
    s_add_u32 s51, s51, 524288
    s_waitcnt vmcnt(12)
    s_barrier
    s_add_u32 m0, s48, 49152
    s_nop 0
    buffer_load_dwordx4 v84, s[16:19], s49 offen lds
    s_add_u32 m0, s48, 50176
    s_nop 0
    buffer_load_dwordx4 v85, s[16:19], s49 offen lds
    s_add_u32 m0, s48, 51200
    s_nop 0
    buffer_load_dwordx4 v86, s[16:19], s49 offen lds
    s_add_u32 m0, s48, 52224
    s_nop 0
    buffer_load_dwordx4 v87, s[16:19], s49 offen lds
    s_add_u32 m0, s48, 53248
    s_nop 0
    buffer_load_dwordx4 v88, s[16:19], s49 offen lds
    s_add_u32 m0, s48, 54272
    s_nop 0
    buffer_load_dwordx4 v89, s[16:19], s49 offen lds
    s_add_u32 m0, s48, 55296
    s_nop 0
    buffer_load_dwordx4 v90, s[16:19], s49 offen lds
    s_add_u32 m0, s48, 56320
    s_nop 0
    buffer_load_dwordx4 v91, s[16:19], s49 offen lds
    s_add_u32 s49, s49, 128
    s_add_u32 m0, s50, 81920
    s_nop 0
    buffer_load_dwordx4 v92, s[20:23], s51 offen lds
    s_add_u32 m0, s50, 82944
    s_nop 0
    buffer_load_dwordx4 v93, s[20:23], s51 offen lds
    s_add_u32 m0, s50, 83968
    s_nop 0
    buffer_load_dwordx4 v94, s[20:23], s51 offen lds
    s_add_u32 m0, s50, 84992
    s_nop 0
    buffer_load_dwordx4 v95, s[20:23], s51 offen lds
    s_add_u32 s51, s51, 524288
    s_waitcnt vmcnt(12)
    s_barrier
    s_add_u32 m0, s48, 98304
    s_nop 0
    buffer_load_dwordx4 v84, s[16:19], s49 offen lds
    s_add_u32 m0, s48, 99328
    s_nop 0
    buffer_load_dwordx4 v85, s[16:19], s49 offen lds
    s_add_u32 m0, s48, 100352
    s_nop 0
    buffer_load_dwordx4 v86, s[16:19], s49 offen lds
    s_add_u32 m0, s48, 101376
    s_nop 0
    buffer_load_dwordx4 v87, s[16:19], s49 offen lds
    s_add_u32 m0, s48, 102400
    s_nop 0
    buffer_load_dwordx4 v88, s[16:19], s49 offen lds
    s_add_u32 m0, s48, 103424
    s_nop 0
    buffer_load_dwordx4 v89, s[16:19], s49 offen lds
    s_add_u32 m0, s48, 104448
    s_nop 0
    buffer_load_dwordx4 v90, s[16:19], s49 offen lds
    s_add_u32 m0, s48, 105472
    s_nop 0
    buffer_load_dwordx4 v91, s[16:19], s49 offen lds
    s_add_u32 s49, s49, 128
    s_add_u32 m0, s50, 131072
    s_nop 0
    buffer_load_dwordx4 v92, s[20:23], s51 offen lds
    s_add_u32 m0, s50, 132096
    s_nop 0
    buffer_load_dwordx4 v93, s[20:23], s51 offen lds
    s_add_u32 m0, s50, 133120
    s_nop 0
    buffer_load_dwordx4 v94, s[20:23], s51 offen lds
    s_add_u32 m0, s50, 134144
    s_nop 0
    buffer_load_dwordx4 v95, s[20:23], s51 offen lds
    s_add_u32 s51, s51, 524288
    s_waitcnt vmcnt(12)
    s_barrier
    s_add_u32 m0, s48, 0
    s_nop 0
    buffer_load_dwordx4 v84, s[16:19], s49 offen lds
    s_add_u32 m0, s48, 1024
    s_nop 0
    buffer_load_dwordx4 v85, s[16:19], s49 offen lds
    s_add_u32 m0, s48, 2048
    s_nop 0
    buffer_load_dwordx4 v86, s[16:19], s49 offen lds
    s_add_u32 m0, s48, 3072
    s_nop 0
    buffer_load_dwordx4 v87, s[16:19], s49 offen lds
    s_add_u32 m0, s48, 4096
    s_nop 0
    buffer_load_dwordx4 v88, s[16:19], s49 offen lds
    s_add_u32 m0, s48, 5120
    s_nop 0
    buffer_load_dwordx4 v89, s[16:19], s49 offen lds
    s_add_u32 m0, s48, 6144
    s_nop 0
    buffer_load_dwordx4 v90, s[16:19], s49 offen lds
    s_add_u32 m0, s48, 7168
    s_nop 0
    buffer_load_dwordx4 v91, s[16:19], s49 offen lds
    s_add_u32 s49, s49, 128
    s_add_u32 m0, s50, 32768
    s_nop 0
    buffer_load_dwordx4 v92, s[20:23], s51 offen lds
    s_add_u32 m0, s50, 33792
    s_nop 0
    buffer_load_dwordx4 v93, s[20:23], s51 offen lds
    s_add_u32 m0, s50, 34816
    s_nop 0
    buffer_load_dwordx4 v94, s[20:23], s51 offen lds
    s_add_u32 m0, s50, 35840
    s_nop 0
    buffer_load_dwordx4 v95, s[20:23], s51 offen lds
    s_add_u32 s51, s51, 524288
    s_waitcnt vmcnt(12)
    s_barrier
    s_add_u32 m0, s48, 49152
    s_nop 0
    buffer_load_dwordx4 v84, s[16:19], s49 offen lds
    s_add_u32 m0, s48, 50176
    s_nop 0
    buffer_load_dwordx4 v85, s[16:19], s49 offen lds
    s_add_u32 m0, s48, 51200
    s_nop 0
    buffer_load_dwordx4 v86, s[16:19], s49 offen lds
    s_add_u32 m0, s48, 52224
    s_nop 0
    buffer_load_dwordx4 v87, s[16:19], s49 offen lds
    s_add_u32 m0, s48, 53248
    s_nop 0
    buffer_load_dwordx4 v88, s[16:19], s49 offen lds
    s_add_u32 m0, s48, 54272
    s_nop 0
    buffer_load_dwordx4 v89, s[16:19], s49 offen lds
    s_add_u32 m0, s48, 55296
    s_nop 0
    buffer_load_dwordx4 v90, s[16:19], s49 offen lds
    s_add_u32 m0, s48, 56320
    s_nop 0
    buffer_load_dwordx4 v91, s[16:19], s49 offen lds
    s_add_u32 s49, s49, 128
    s_add_u32 m0, s50, 81920
    s_nop 0
    buffer_load_dwordx4 v92, s[20:23], s51 offen lds
    s_add_u32 m0, s50, 82944
    s_nop 0
    buffer_load_dwordx4 v93, s[20:23], s51 offen lds
    s_add_u32 m0, s50, 83968
    s_nop 0
    buffer_load_dwordx4 v94, s[20:23], s51 offen lds
    s_add_u32 m0, s50, 84992
    s_nop 0
    buffer_load_dwordx4 v95, s[20:23], s51 offen lds
    s_add_u32 s51, s51, 524288
    s_waitcnt vmcnt(12)
    s_barrier
    s_add_u32 m0, s48, 98304
    s_nop 0
    buffer_load_dwordx4 v84, s[16:19], s49 offen lds
    s_add_u32 m0, s48, 99328
    s_nop 0
    buffer_load_dwordx4 v85, s[16:19], s49 offen lds
    s_add_u32 m0, s48, 100352
    s_nop 0
    buffer_load_dwordx4 v86, s[16:19], s49 offen lds
    s_add_u32 m0, s48, 101376
    s_nop 0
    buffer_load_dwordx4 v87, s[16:19], s49 offen lds
    s_add_u32 m0, s48, 102400
    s_nop 0
    buffer_load_dwordx4 v88, s[16:19], s49 offen lds
    s_add_u32 m0, s48, 103424
    s_nop 0
    buffer_load_dwordx4 v89, s[16:19], s49 offen lds
    s_add_u32 m0, s48, 104448
    s_nop 0
    buffer_load_dwordx4 v90, s[16:19], s49 offen lds
    s_add_u32 m0, s48, 105472
    s_nop 0
    buffer_load_dwordx4 v91, s[16:19], s49 offen lds
    s_add_u32 s49, s49, 128
    s_add_u32 m0, s50, 131072
    s_nop 0
    buffer_load_dwordx4 v92, s[20:23], s51 offen lds
    s_add_u32 m0, s50, 132096
    s_nop 0
    buffer_load_dwordx4 v93, s[20:23], s51 offen lds
    s_add_u32 m0, s50, 133120
    s_nop 0
    buffer_load_dwordx4 v94, s[20:23], s51 offen lds
    s_add_u32 m0, s50, 134144
    s_nop 0
    buffer_load_dwordx4 v95, s[20:23], s51 offen lds
    s_add_u32 s51, s51, 524288
    s_waitcnt vmcnt(12)
    s_barrier
    s_add_u32 m0, s48, 0
    s_nop 0
    buffer_load_dwordx4 v84, s[16:19], s49 offen lds
    s_add_u32 m0, s48, 1024
    s_nop 0
    buffer_load_dwordx4 v85, s[16:19], s49 offen lds
    s_add_u32 m0, s48, 2048
    s_nop 0
    buffer_load_dwordx4 v86, s[16:19], s49 offen lds
    s_add_u32 m0, s48, 3072
    s_nop 0
    buffer_load_dwordx4 v87, s[16:19], s49 offen lds
    s_add_u32 m0, s48, 4096
    s_nop 0
    buffer_load_dwordx4 v88, s[16:19], s49 offen lds
    s_add_u32 m0, s48, 5120
    s_nop 0
    buffer_load_dwordx4 v89, s[16:19], s49 offen lds
    s_add_u32 m0, s48, 6144
    s_nop 0
    buffer_load_dwordx4 v90, s[16:19], s49 offen lds
    s_add_u32 m0, s48, 7168
    s_nop 0
    buffer_load_dwordx4 v91, s[16:19], s49 offen lds
    s_add_u32 s49, s49, 128
    s_add_u32 m0, s50, 32768
    s_nop 0
    buffer_load_dwordx4 v92, s[20:23], s51 offen lds
    s_add_u32 m0, s50, 33792
    s_nop 0
    buffer_load_dwordx4 v93, s[20:23], s51 offen lds
    s_add_u32 m0, s50, 34816
    s_nop 0
    buffer_load_dwordx4 v94, s[20:23], s51 offen lds
    s_add_u32 m0, s50, 35840
    s_nop 0
    buffer_load_dwordx4 v95, s[20:23], s51 offen lds
    s_add_u32 s51, s51, 524288
    s_waitcnt vmcnt(12)
    s_barrier
    s_cmp_eq_u32 s64, s76
    s_cselect_b32 s64, 0, s64
    s_cselect_b32 s62, s88, s62
    s_cselect_b32 s78, s89, s78
    s_and_b32 s68, s64, 3
    s_lshl_b32 s68, s68, 3
    s_lshr_b32 s68, s74, s68
    s_and_b32 s68, s68, 15
    s_lshl_b32 s68, s68, 14
    s_add_u32 m0, s68, s61
    s_cmp_lt_u32 s64, s78
    s_cselect_b32 s68, s62, s71
    buffer_load_dwordx4 v8, s[24:27], s68 offen offset:0 lds
    buffer_load_dwordx4 v8, s[24:27], s68 offen offset:1024 lds
    buffer_load_dwordx4 v8, s[24:27], s68 offen offset:2048 lds
    buffer_load_dwordx4 v8, s[24:27], s68 offen offset:3072 lds
    s_add_u32 s62, s62, 16384
    s_add_u32 s64, s64, 1
    s_cmp_eq_u32 s64, s76
    s_cselect_b32 s64, 0, s64
    s_cselect_b32 s62, s88, s62
    s_cselect_b32 s78, s89, s78
    s_and_b32 s68, s64, 3
    s_lshl_b32 s68, s68, 3
    s_lshr_b32 s68, s74, s68
    s_and_b32 s68, s68, 15
    s_lshl_b32 s68, s68, 14
    s_add_u32 m0, s68, s61
    s_cmp_lt_u32 s64, s78
    s_cselect_b32 s68, s62, s71
    buffer_load_dwordx4 v8, s[24:27], s68 offen offset:0 lds
    buffer_load_dwordx4 v8, s[24:27], s68 offen offset:1024 lds
    buffer_load_dwordx4 v8, s[24:27], s68 offen offset:2048 lds
    buffer_load_dwordx4 v8, s[24:27], s68 offen offset:3072 lds
    s_add_u32 s62, s62, 16384
    s_add_u32 s64, s64, 1
    s_cmp_eq_u32 s65, s76
    s_cselect_b32 s65, 0, s65
    s_cselect_b32 s63, s88, s63
    s_cselect_b32 s79, s89, s79
    s_and_b32 s68, s65, 3
    s_lshl_b32 s68, s68, 3
    s_lshr_b32 s68, s75, s68
    s_and_b32 s68, s68, 15
    s_lshl_b32 s68, s68, 14
    s_add_u32 m0, s68, s61
    s_cmp_lt_u32 s65, s79
    s_cselect_b32 s68, s63, s71
    buffer_load_dwordx4 v8, s[28:31], s68 offen offset:0 lds
    buffer_load_dwordx4 v8, s[28:31], s68 offen offset:1024 lds
    buffer_load_dwordx4 v8, s[28:31], s68 offen offset:2048 lds
    buffer_load_dwordx4 v8, s[28:31], s68 offen offset:3072 lds
    s_add_u32 s63, s63, 16384
    s_add_u32 s65, s65, 1
    s_waitcnt vmcnt(12)
    s_barrier
    s_cmp_eq_u32 s64, s76
    s_cselect_b32 s64, 0, s64
    s_cselect_b32 s62, s88, s62
    s_cselect_b32 s78, s89, s78
    s_and_b32 s68, s64, 3
    s_lshl_b32 s68, s68, 3
    s_lshr_b32 s68, s74, s68
    s_and_b32 s68, s68, 15
    s_lshl_b32 s68, s68, 14
    s_add_u32 m0, s68, s61
    s_cmp_lt_u32 s64, s78
    s_cselect_b32 s68, s62, s71
    buffer_load_dwordx4 v8, s[24:27], s68 offen offset:0 lds
    buffer_load_dwordx4 v8, s[24:27], s68 offen offset:1024 lds
    buffer_load_dwordx4 v8, s[24:27], s68 offen offset:2048 lds
    buffer_load_dwordx4 v8, s[24:27], s68 offen offset:3072 lds
    s_add_u32 s62, s62, 16384
    s_add_u32 s64, s64, 1
    s_cmp_eq_u32 s65, s76
    s_cselect_b32 s65, 0, s65
    s_cselect_b32 s63, s88, s63
    s_cselect_b32 s79, s89, s79
    s_and_b32 s68, s65, 3
    s_lshl_b32 s68, s68, 3
    s_lshr_b32 s68, s75, s68
    s_and_b32 s68, s68, 15
    s_lshl_b32 s68, s68, 14
    s_add_u32 m0, s68, s61
    s_cmp_lt_u32 s65, s79
    s_cselect_b32 s68, s63, s71
    buffer_load_dwordx4 v8, s[28:31], s68 offen offset:0 lds
    buffer_load_dwordx4 v8, s[28:31], s68 offen offset:1024 lds
    buffer_load_dwordx4 v8, s[28:31], s68 offen offset:2048 lds
    buffer_load_dwordx4 v8, s[28:31], s68 offen offset:3072 lds
    s_add_u32 s63, s63, 16384
    s_add_u32 s65, s65, 1
    s_cmp_eq_u32 s65, s76
    s_cselect_b32 s65, 0, s65
    s_cselect_b32 s63, s88, s63
    s_cselect_b32 s79, s89, s79
    s_and_b32 s68, s65, 3
    s_lshl_b32 s68, s68, 3
    s_lshr_b32 s68, s75, s68
    s_and_b32 s68, s68, 15
    s_lshl_b32 s68, s68, 14
    s_add_u32 m0, s68, s61
    s_cmp_lt_u32 s65, s79
    s_cselect_b32 s68, s63, s71
    buffer_load_dwordx4 v8, s[28:31], s68 offen offset:0 lds
    buffer_load_dwordx4 v8, s[28:31], s68 offen offset:1024 lds
    buffer_load_dwordx4 v8, s[28:31], s68 offen offset:2048 lds
    buffer_load_dwordx4 v8, s[28:31], s68 offen offset:3072 lds
    s_add_u32 s63, s63, 16384
    s_add_u32 s65, s65, 1
Lat_pblk:
    s_waitcnt vmcnt(20)
    s_barrier
    s_waitcnt vmcnt(12)
    s_barrier
    s_cmp_eq_u32 s64, s76
    s_cselect_b32 s64, 0, s64
    s_cselect_b32 s62, s88, s62
    s_cselect_b32 s78, s89, s78
    s_and_b32 s68, s64, 3
    s_lshl_b32 s68, s68, 3
    s_lshr_b32 s68, s74, s68
    s_and_b32 s68, s68, 15
    s_lshl_b32 s68, s68, 14
    s_add_u32 m0, s68, s61
    s_cmp_lt_u32 s64, s78
    s_cselect_b32 s68, s62, s71
    buffer_load_dwordx4 v8, s[24:27], s68 offen offset:0 lds
    buffer_load_dwordx4 v8, s[24:27], s68 offen offset:1024 lds
    buffer_load_dwordx4 v8, s[24:27], s68 offen offset:2048 lds
    buffer_load_dwordx4 v8, s[24:27], s68 offen offset:3072 lds
    s_add_u32 s62, s62, 16384
    s_add_u32 s64, s64, 1
    s_mov_b32 s67, 1
Lat_ploop:
    s_waitcnt vmcnt(8)
    s_barrier
    s_cmp_eq_u32 s64, s76
    s_cselect_b32 s64, 0, s64
    s_cselect_b32 s62, s88, s62
    s_cselect_b32 s78, s89, s78
    s_and_b32 s68, s64, 3
    s_lshl_b32 s68, s68, 3
    s_lshr_b32 s68, s74, s68
    s_and_b32 s68, s68, 15
    s_lshl_b32 s68, s68, 14
    s_add_u32 m0, s68, s61
    s_cmp_lt_u32 s64, s78
    s_cselect_b32 s68, s62, s71
    buffer_load_dwordx4 v8, s[24:27], s68 offen offset:0 lds
    buffer_load_dwordx4 v8, s[24:27], s68 offen offset:1024 lds
    buffer_load_dwordx4 v8, s[24:27], s68 offen offset:2048 lds
    buffer_load_dwordx4 v8, s[24:27], s68 offen offset:3072 lds
    s_add_u32 s62, s62, 16384
    s_add_u32 s64, s64, 1
    s_cmp_eq_u32 s65, s76
    s_cselect_b32 s65, 0, s65
    s_cselect_b32 s63, s88, s63
    s_cselect_b32 s79, s89, s79
    s_and_b32 s68, s65, 3
    s_lshl_b32 s68, s68, 3
    s_lshr_b32 s68, s75, s68
    s_and_b32 s68, s68, 15
    s_lshl_b32 s68, s68, 14
    s_add_u32 m0, s68, s61
    s_cmp_lt_u32 s65, s79
    s_cselect_b32 s68, s63, s71
    buffer_load_dwordx4 v8, s[28:31], s68 offen offset:0 lds
    buffer_load_dwordx4 v8, s[28:31], s68 offen offset:1024 lds
    buffer_load_dwordx4 v8, s[28:31], s68 offen offset:2048 lds
    buffer_load_dwordx4 v8, s[28:31], s68 offen offset:3072 lds
    s_add_u32 s63, s63, 16384
    s_add_u32 s65, s65, 1
    s_add_u32 s67, s67, 1
    s_cmp_lt_u32 s67, s66
    s_cbranch_scc1 Lat_ploop
    s_waitcnt vmcnt(0)
    s_barrier
    s_cmp_eq_u32 s44, 1
    s_cbranch_scc1 Lat_end
    s_mov_b32 s44, 1
    s_mov_b32 s43, s42
    s_mov_b32 s66, s89
    s_cmp_eq_u32 s64, 4
    s_cbranch_scc1 Lat_p0
    s_cmp_eq_u32 s64, s76
    s_cselect_b32 s64, 0, s64
    s_cselect_b32 s62, s88, s62
    s_cselect_b32 s78, s89, s78
    s_and_b32 s68, s64, 3
    s_lshl_b32 s68, s68, 3
    s_lshr_b32 s68, s74, s68
    s_and_b32 s68, s68, 15
    s_lshl_b32 s68, s68, 14
    s_add_u32 m0, s68, s61
    s_cmp_lt_u32 s64, s78
    s_cselect_b32 s68, s62, s71
    buffer_load_dwordx4 v8, s[24:27], s68 offen offset:0 lds
    buffer_load_dwordx4 v8, s[24:27], s68 offen offset:1024 lds
    buffer_load_dwordx4 v8, s[24:27], s68 offen offset:2048 lds
    buffer_load_dwordx4 v8, s[24:27], s68 offen offset:3072 lds
    s_add_u32 s62, s62, 16384
    s_add_u32 s64, s64, 1
    s_cmp_eq_u32 s65, s76
    s_cselect_b32 s65, 0, s65
    s_cselect_b32 s63, s88, s63
    s_cselect_b32 s79, s89, s79
    s_and_b32 s68, s65, 3
    s_lshl_b32 s68, s68, 3
    s_lshr_b32 s68, s75, s68
    s_and_b32 s68, s68, 15
    s_lshl_b32 s68, s68, 14
    s_add_u32 m0, s68, s61
    s_cmp_lt_u32 s65, s79
    s_cselect_b32 s68, s63, s71
    buffer_load_dwordx4 v8, s[28:31], s68 offen offset:0 lds
    buffer_load_dwordx4 v8, s[28:31], s68 offen offset:1024 lds
    buffer_load_dwordx4 v8, s[28:31], s68 offen offset:2048 lds
    buffer_load_dwordx4 v8, s[28:31], s68 offen offset:3072 lds
    s_add_u32 s63, s63, 16384
    s_add_u32 s65, s65, 1
    s_cmp_eq_u32 s64, s76
    s_cselect_b32 s64, 0, s64
    s_cselect_b32 s62, s88, s62
    s_cselect_b32 s78, s89, s78
    s_and_b32 s68, s64, 3
    s_lshl_b32 s68, s68, 3
    s_lshr_b32 s68, s74, s68
    s_and_b32 s68, s68, 15
    s_lshl_b32 s68, s68, 14
    s_add_u32 m0, s68, s61
    s_cmp_lt_u32 s64, s78
    s_cselect_b32 s68, s62, s71
    buffer_load_dwordx4 v8, s[24:27], s68 offen offset:0 lds
    buffer_load_dwordx4 v8, s[24:27], s68 offen offset:1024 lds
    buffer_load_dwordx4 v8, s[24:27], s68 offen offset:2048 lds
    buffer_load_dwordx4 v8, s[24:27], s68 offen offset:3072 lds
    s_add_u32 s62, s62, 16384
    s_add_u32 s64, s64, 1
    s_cmp_eq_u32 s65, s76
    s_cselect_b32 s65, 0, s65
    s_cselect_b32 s63, s88, s63
    s_cselect_b32 s79, s89, s79
    s_and_b32 s68, s65, 3
    s_lshl_b32 s68, s68, 3
    s_lshr_b32 s68, s75, s68
    s_and_b32 s68, s68, 15
    s_lshl_b32 s68, s68, 14
    s_add_u32 m0, s68, s61
    s_cmp_lt_u32 s65, s79
    s_cselect_b32 s68, s63, s71
    buffer_load_dwordx4 v8, s[28:31], s68 offen offset:0 lds
    buffer_load_dwordx4 v8, s[28:31], s68 offen offset:1024 lds
    buffer_load_dwordx4 v8, s[28:31], s68 offen offset:2048 lds
    buffer_load_dwordx4 v8, s[28:31], s68 offen offset:3072 lds
    s_add_u32 s63, s63, 16384
    s_add_u32 s65, s65, 1
Lat_p0:
    s_cmp_eq_u32 s65, s76
    s_cselect_b32 s65, 0, s65
    s_cselect_b32 s63, s88, s63
    s_cselect_b32 s79, s89, s79
    s_and_b32 s68, s65, 3
    s_lshl_b32 s68, s68, 3
    s_lshr_b32 s68, s75, s68
    s_and_b32 s68, s68, 15
    s_lshl_b32 s68, s68, 14
    s_add_u32 m0, s68, s61
    s_cmp_lt_u32 s65, s79
    s_cselect_b32 s68, s63, s71
    buffer_load_dwordx4 v8, s[28:31], s68 offen offset:0 lds
    buffer_load_dwordx4 v8, s[28:31], s68 offen offset:1024 lds
    buffer_load_dwordx4 v8, s[28:31], s68 offen offset:2048 lds
    buffer_load_dwordx4 v8, s[28:31], s68 offen offset:3072 lds
    s_add_u32 s63, s63, 16384
    s_add_u32 s65, s65, 1
    s_branch Lat_pblk
Lat_end:
    s_endpgm
.globl oproj_kernel
.p2align 8
.type oproj_kernel,@function
oproj_kernel:
    s_cmp_ge_u32 s2, 256
    s_cbranch_scc1 Lop_end
    s_load_dwordx2 s[4:5], s[0:1], 40
    s_load_dwordx2 s[12:13], s[0:1], 104
    v_lshrrev_b32 v1, 6, v0
    s_nop 0
    v_readfirstlane_b32 s45, v1
    s_and_b32 s40, s45, 3
    s_and_b32 s44, s2, 7
    s_lshr_b32 s41, s44, 1
    s_and_b32 s44, s44, 1
    s_lshl_b32 s44, s44, 3
    s_lshr_b32 s42, s2, 3
    s_and_b32 s43, s42, 3
    s_lshr_b32 s42, s42, 2
    s_add_u32 s42, s42, s44
    s_cmp_lt_u32 s45, 4
    s_cbranch_scc1 Lop_cons
    s_lshl_b32 s60, s42, 20
    s_lshl_b32 s61, s41, 16
    s_add_u32 s49, s60, s61
    s_mul_i32 s60, s41, 1310720
    s_mul_i32 s61, s43, 320
    s_add_u32 s51, s60, s61
    v_and_b32 v1, 63, v0
    s_mul_i32 s48, s40, 4096
    v_lshlrev_b32 v2, 4, v1
    s_mul_i32 s52, s40, 4
    s_add_u32 s52, s52, 0
    s_and_b32 s53, s52, 3
    s_lshl_b32 s53, s53, 10
    s_lshr_b32 s52, s52, 2
    s_mul_i32 s52, s52, 262144
    s_add_u32 s52, s52, s53
    v_add_u32 v8, s52, v2
    s_mul_i32 s52, s40, 4
    s_add_u32 s52, s52, 1
    s_and_b32 s53, s52, 3
    s_lshl_b32 s53, s53, 10
    s_lshr_b32 s52, s52, 2
    s_mul_i32 s52, s52, 262144
    s_add_u32 s52, s52, s53
    v_add_u32 v9, s52, v2
    s_mul_i32 s52, s40, 4
    s_add_u32 s52, s52, 2
    s_and_b32 s53, s52, 3
    s_lshl_b32 s53, s53, 10
    s_lshr_b32 s52, s52, 2
    s_mul_i32 s52, s52, 262144
    s_add_u32 s52, s52, s53
    v_add_u32 v10, s52, v2
    s_mul_i32 s52, s40, 4
    s_add_u32 s52, s52, 3
    s_and_b32 s53, s52, 3
    s_lshl_b32 s53, s53, 10
    s_lshr_b32 s52, s52, 2
    s_mul_i32 s52, s52, 262144
    s_add_u32 s52, s52, s53
    v_add_u32 v11, s52, v2
    s_mul_i32 s50, s40, 5120
    s_lshr_b32 s52, s50, 4
    v_add_u32 v2, s52, v1
    v_mul_u32_u24 v3, 3277, v2
    v_lshrrev_b32 v3, 16, v3
    v_mul_u32_u24 v4, 20, v3
    v_sub_u32 v4, v2, v4
    s_mov_b32 s53, 1280
    v_mul_lo_u32 v3, v3, s53
    v_lshl_add_u32 v12, v4, 4, v3
    v_add_u32 v2, s52, v1
    v_add_u32 v2, 64, v2
    v_mul_u32_u24 v3, 3277, v2
    v_lshrrev_b32 v3, 16, v3
    v_mul_u32_u24 v4, 20, v3
    v_sub_u32 v4, v2, v4
    s_mov_b32 s53, 1280
    v_mul_lo_u32 v3, v3, s53
    v_lshl_add_u32 v13, v4, 4, v3
    v_add_u32 v2, s52, v1
    v_add_u32 v2, 128, v2
    v_mul_u32_u24 v3, 3277, v2
    v_lshrrev_b32 v3, 16, v3
    v_mul_u32_u24 v4, 20, v3
    v_sub_u32 v4, v2, v4
    s_mov_b32 s53, 1280
    v_mul_lo_u32 v3, v3, s53
    v_lshl_add_u32 v14, v4, 4, v3
    v_add_u32 v2, s52, v1
    v_add_u32 v2, 192, v2
    v_mul_u32_u24 v3, 3277, v2
    v_lshrrev_b32 v3, 16, v3
    v_mul_u32_u24 v4, 20, v3
    v_sub_u32 v4, v2, v4
    s_mov_b32 s53, 1280
    v_mul_lo_u32 v3, v3, s53
    v_lshl_add_u32 v15, v4, 4, v3
    v_add_u32 v2, s52, v1
    v_add_u32 v2, 256, v2
    v_mul_u32_u24 v3, 3277, v2
    v_lshrrev_b32 v3, 16, v3
    v_mul_u32_u24 v4, 20, v3
    v_sub_u32 v4, v2, v4
    s_mov_b32 s53, 1280
    v_mul_lo_u32 v3, v3, s53
    v_lshl_add_u32 v16, v4, 4, v3
    s_waitcnt lgkmcnt(0)
    s_add_u32 s16, s12, 46137344
    s_addc_u32 s17, s13, 0
    s_mov_b32 s18, 16777216
    s_mov_b32 s19, 0x00020000
    s_mov_b32 s20, s4
    s_mov_b32 s21, s5
    s_mov_b32 s22, 5242880
    s_mov_b32 s23, 0x00020000
    s_add_u32 m0, s48, 0
    s_nop 0
    buffer_load_dwordx4 v8, s[16:19], s49 offen lds
    s_add_u32 m0, s48, 1024
    s_nop 0
    buffer_load_dwordx4 v9, s[16:19], s49 offen lds
    s_add_u32 m0, s48, 2048
    s_nop 0
    buffer_load_dwordx4 v10, s[16:19], s49 offen lds
    s_add_u32 m0, s48, 3072
    s_nop 0
    buffer_load_dwordx4 v11, s[16:19], s49 offen lds
    s_add_u32 s49, s49, 4096
    s_add_u32 m0, s50, 16384
    s_nop 0
    buffer_load_dwordx4 v12, s[20:23], s51 offen lds
    s_add_u32 m0, s50, 17408
    s_nop 0
    buffer_load_dwordx4 v13, s[20:23], s51 offen lds
    s_add_u32 m0, s50, 18432
    s_nop 0
    buffer_load_dwordx4 v14, s[20:23], s51 offen lds
    s_add_u32 m0, s50, 19456
    s_nop 0
    buffer_load_dwordx4 v15, s[20:23], s51 offen lds
    s_add_u32 m0, s50, 20480
    s_nop 0
    buffer_load_dwordx4 v16, s[20:23], s51 offen lds
    s_add_u32 s51, s51, 81920
    s_add_u32 m0, s48, 36864
    s_nop 0
    buffer_load_dwordx4 v8, s[16:19], s49 offen lds
    s_add_u32 m0, s48, 37888
    s_nop 0
    buffer_load_dwordx4 v9, s[16:19], s49 offen lds
    s_add_u32 m0, s48, 38912
    s_nop 0
    buffer_load_dwordx4 v10, s[16:19], s49 offen lds
    s_add_u32 m0, s48, 39936
    s_nop 0
    buffer_load_dwordx4 v11, s[16:19], s49 offen lds
    s_add_u32 s49, s49, 4096
    s_add_u32 m0, s50, 53248
    s_nop 0
    buffer_load_dwordx4 v12, s[20:23], s51 offen lds
    s_add_u32 m0, s50, 54272
    s_nop 0
    buffer_load_dwordx4 v13, s[20:23], s51 offen lds
    s_add_u32 m0, s50, 55296
    s_nop 0
    buffer_load_dwordx4 v14, s[20:23], s51 offen lds
    s_add_u32 m0, s50, 56320
    s_nop 0
    buffer_load_dwordx4 v15, s[20:23], s51 offen lds
    s_add_u32 m0, s50, 57344
    s_nop 0
    buffer_load_dwordx4 v16, s[20:23], s51 offen lds
    s_add_u32 s51, s51, 81920
    s_add_u32 m0, s48, 73728
    s_nop 0
    buffer_load_dwordx4 v8, s[16:19], s49 offen lds
    s_add_u32 m0, s48, 74752
    s_nop 0
    buffer_load_dwordx4 v9, s[16:19], s49 offen lds
    s_add_u32 m0, s48, 75776
    s_nop 0
    buffer_load_dwordx4 v10, s[16:19], s49 offen lds
    s_add_u32 m0, s48, 76800
    s_nop 0
    buffer_load_dwordx4 v11, s[16:19], s49 offen lds
    s_add_u32 s49, s49, 4096
    s_add_u32 m0, s50, 90112
    s_nop 0
    buffer_load_dwordx4 v12, s[20:23], s51 offen lds
    s_add_u32 m0, s50, 91136
    s_nop 0
    buffer_load_dwordx4 v13, s[20:23], s51 offen lds
    s_add_u32 m0, s50, 92160
    s_nop 0
    buffer_load_dwordx4 v14, s[20:23], s51 offen lds
    s_add_u32 m0, s50, 93184
    s_nop 0
    buffer_load_dwordx4 v15, s[20:23], s51 offen lds
    s_add_u32 m0, s50, 94208
    s_nop 0
    buffer_load_dwordx4 v16, s[20:23], s51 offen lds
    s_add_u32 s51, s51, 81920
    s_add_u32 m0, s48, 110592
    s_nop 0
    buffer_load_dwordx4 v8, s[16:19], s49 offen lds
    s_add_u32 m0, s48, 111616
    s_nop 0
    buffer_load_dwordx4 v9, s[16:19], s49 offen lds
    s_add_u32 m0, s48, 112640
    s_nop 0
    buffer_load_dwordx4 v10, s[16:19], s49 offen lds
    s_add_u32 m0, s48, 113664
    s_nop 0
    buffer_load_dwordx4 v11, s[16:19], s49 offen lds
    s_add_u32 s49, s49, 4096
    s_add_u32 m0, s50, 126976
    s_nop 0
    buffer_load_dwordx4 v12, s[20:23], s51 offen lds
    s_add_u32 m0, s50, 128000
    s_nop 0
    buffer_load_dwordx4 v13, s[20:23], s51 offen lds
    s_add_u32 m0, s50, 129024
    s_nop 0
    buffer_load_dwordx4 v14, s[20:23], s51 offen lds
    s_add_u32 m0, s50, 130048
    s_nop 0
    buffer_load_dwordx4 v15, s[20:23], s51 offen lds
    s_add_u32 m0, s50, 131072
    s_nop 0
    buffer_load_dwordx4 v16, s[20:23], s51 offen lds
    s_add_u32 s51, s51, 81920
    s_waitcnt vmcnt(27)
    s_barrier
    s_waitcnt vmcnt(18)
    s_barrier
    s_add_u32 m0, s48, 0
    s_nop 0
    buffer_load_dwordx4 v8, s[16:19], s49 offen lds
    s_add_u32 m0, s48, 1024
    s_nop 0
    buffer_load_dwordx4 v9, s[16:19], s49 offen lds
    s_add_u32 m0, s48, 2048
    s_nop 0
    buffer_load_dwordx4 v10, s[16:19], s49 offen lds
    s_add_u32 m0, s48, 3072
    s_nop 0
    buffer_load_dwordx4 v11, s[16:19], s49 offen lds
    s_add_u32 s49, s49, 4096
    s_add_u32 m0, s50, 16384
    s_nop 0
    buffer_load_dwordx4 v12, s[20:23], s51 offen lds
    s_add_u32 m0, s50, 17408
    s_nop 0
    buffer_load_dwordx4 v13, s[20:23], s51 offen lds
    s_add_u32 m0, s50, 18432
    s_nop 0
    buffer_load_dwordx4 v14, s[20:23], s51 offen lds
    s_add_u32 m0, s50, 19456
    s_nop 0
    buffer_load_dwordx4 v15, s[20:23], s51 offen lds
    s_add_u32 m0, s50, 20480
    s_nop 0
    buffer_load_dwordx4 v16, s[20:23], s51 offen lds
    s_add_u32 s51, s51, 81920
    s_waitcnt vmcnt(18)
    s_barrier
    s_add_u32 m0, s48, 36864
    s_nop 0
    buffer_load_dwordx4 v8, s[16:19], s49 offen lds
    s_add_u32 m0, s48, 37888
    s_nop 0
    buffer_load_dwordx4 v9, s[16:19], s49 offen lds
    s_add_u32 m0, s48, 38912
    s_nop 0
    buffer_load_dwordx4 v10, s[16:19], s49 offen lds
    s_add_u32 m0, s48, 39936
    s_nop 0
    buffer_load_dwordx4 v11, s[16:19], s49 offen lds
    s_add_u32 s49, s49, 4096
    s_add_u32 m0, s50, 53248
    s_nop 0
    buffer_load_dwordx4 v12, s[20:23], s51 offen lds
    s_add_u32 m0, s50, 54272
    s_nop 0
    buffer_load_dwordx4 v13, s[20:23], s51 offen lds
    s_add_u32 m0, s50, 55296
    s_nop 0
    buffer_load_dwordx4 v14, s[20:23], s51 offen lds
    s_add_u32 m0, s50, 56320
    s_nop 0
    buffer_load_dwordx4 v15, s[20:23], s51 offen lds
    s_add_u32 m0, s50, 57344
    s_nop 0
    buffer_load_dwordx4 v16, s[20:23], s51 offen lds
    s_add_u32 s51, s51, 81920
    s_waitcnt vmcnt(18)
    s_barrier
    s_add_u32 m0, s48, 73728
    s_nop 0
    buffer_load_dwordx4 v8, s[16:19], s49 offen lds
    s_add_u32 m0, s48, 74752
    s_nop 0
    buffer_load_dwordx4 v9, s[16:19], s49 offen lds
    s_add_u32 m0, s48, 75776
    s_nop 0
    buffer_load_dwordx4 v10, s[16:19], s49 offen lds
    s_add_u32 m0, s48, 76800
    s_nop 0
    buffer_load_dwordx4 v11, s[16:19], s49 offen lds
    s_add_u32 s49, s49, 4096
    s_add_u32 m0, s50, 90112
    s_nop 0
    buffer_load_dwordx4 v12, s[20:23], s51 offen lds
    s_add_u32 m0, s50, 91136
    s_nop 0
    buffer_load_dwordx4 v13, s[20:23], s51 offen lds
    s_add_u32 m0, s50, 92160
    s_nop 0
    buffer_load_dwordx4 v14, s[20:23], s51 offen lds
    s_add_u32 m0, s50, 93184
    s_nop 0
    buffer_load_dwordx4 v15, s[20:23], s51 offen lds
    s_add_u32 m0, s50, 94208
    s_nop 0
    buffer_load_dwordx4 v16, s[20:23], s51 offen lds
    s_add_u32 s51, s51, 81920
    s_waitcnt vmcnt(18)
    s_barrier
    s_add_u32 m0, s48, 110592
    s_nop 0
    buffer_load_dwordx4 v8, s[16:19], s49 offen lds
    s_add_u32 m0, s48, 111616
    s_nop 0
    buffer_load_dwordx4 v9, s[16:19], s49 offen lds
    s_add_u32 m0, s48, 112640
    s_nop 0
    buffer_load_dwordx4 v10, s[16:19], s49 offen lds
    s_add_u32 m0, s48, 113664
    s_nop 0
    buffer_load_dwordx4 v11, s[16:19], s49 offen lds
    s_add_u32 s49, s49, 4096
    s_add_u32 m0, s50, 126976
    s_nop 0
    buffer_load_dwordx4 v12, s[20:23], s51 offen lds
    s_add_u32 m0, s50, 128000
    s_nop 0
    buffer_load_dwordx4 v13, s[20:23], s51 offen lds
    s_add_u32 m0, s50, 129024
    s_nop 0
    buffer_load_dwordx4 v14, s[20:23], s51 offen lds
    s_add_u32 m0, s50, 130048
    s_nop 0
    buffer_load_dwordx4 v15, s[20:23], s51 offen lds
    s_add_u32 m0, s50, 131072
    s_nop 0
    buffer_load_dwordx4 v16, s[20:23], s51 offen lds
    s_add_u32 s51, s51, 81920
    s_waitcnt vmcnt(18)
    s_barrier
    s_add_u32 m0, s48, 0
    s_nop 0
    buffer_load_dwordx4 v8, s[16:19], s49 offen lds
    s_add_u32 m0, s48, 1024
    s_nop 0
    buffer_load_dwordx4 v9, s[16:19], s49 offen lds
    s_add_u32 m0, s48, 2048
    s_nop 0
    buffer_load_dwordx4 v10, s[16:19], s49 offen lds
    s_add_u32 m0, s48, 3072
    s_nop 0
    buffer_load_dwordx4 v11, s[16:19], s49 offen lds
    s_add_u32 s49, s49, 4096
    s_add_u32 m0, s50, 16384
    s_nop 0
    buffer_load_dwordx4 v12, s[20:23], s51 offen lds
    s_add_u32 m0, s50, 17408
    s_nop 0
    buffer_load_dwordx4 v13, s[20:23], s51 offen lds
    s_add_u32 m0, s50, 18432
    s_nop 0
    buffer_load_dwordx4 v14, s[20:23], s51 offen lds
    s_add_u32 m0, s50, 19456
    s_nop 0
    buffer_load_dwordx4 v15, s[20:23], s51 offen lds
    s_add_u32 m0, s50, 20480
    s_nop 0
    buffer_load_dwordx4 v16, s[20:23], s51 offen lds
    s_add_u32 s51, s51, 81920
    s_waitcnt vmcnt(18)
    s_barrier
    s_add_u32 m0, s48, 36864
    s_nop 0
    buffer_load_dwordx4 v8, s[16:19], s49 offen lds
    s_add_u32 m0, s48, 37888
    s_nop 0
    buffer_load_dwordx4 v9, s[16:19], s49 offen lds
    s_add_u32 m0, s48, 38912
    s_nop 0
    buffer_load_dwordx4 v10, s[16:19], s49 offen lds
    s_add_u32 m0, s48, 39936
    s_nop 0
    buffer_load_dwordx4 v11, s[16:19], s49 offen lds
    s_add_u32 s49, s49, 4096
    s_add_u32 m0, s50, 53248
    s_nop 0
    buffer_load_dwordx4 v12, s[20:23], s51 offen lds
    s_add_u32 m0, s50, 54272
    s_nop 0
    buffer_load_dwordx4 v13, s[20:23], s51 offen lds
    s_add_u32 m0, s50, 55296
    s_nop 0
    buffer_load_dwordx4 v14, s[20:23], s51 offen lds
    s_add_u32 m0, s50, 56320
    s_nop 0
    buffer_load_dwordx4 v15, s[20:23], s51 offen lds
    s_add_u32 m0, s50, 57344
    s_nop 0
    buffer_load_dwordx4 v16, s[20:23], s51 offen lds
    s_add_u32 s51, s51, 81920
    s_waitcnt vmcnt(18)
    s_barrier
    s_add_u32 m0, s48, 73728
    s_nop 0
    buffer_load_dwordx4 v8, s[16:19], s49 offen lds
    s_add_u32 m0, s48, 74752
    s_nop 0
    buffer_load_dwordx4 v9, s[16:19], s49 offen lds
    s_add_u32 m0, s48, 75776
    s_nop 0
    buffer_load_dwordx4 v10, s[16:19], s49 offen lds
    s_add_u32 m0, s48, 76800
    s_nop 0
    buffer_load_dwordx4 v11, s[16:19], s49 offen lds
    s_add_u32 s49, s49, 4096
    s_add_u32 m0, s50, 90112
    s_nop 0
    buffer_load_dwordx4 v12, s[20:23], s51 offen lds
    s_add_u32 m0, s50, 91136
    s_nop 0
    buffer_load_dwordx4 v13, s[20:23], s51 offen lds
    s_add_u32 m0, s50, 92160
    s_nop 0
    buffer_load_dwordx4 v14, s[20:23], s51 offen lds
    s_add_u32 m0, s50, 93184
    s_nop 0
    buffer_load_dwordx4 v15, s[20:23], s51 offen lds
    s_add_u32 m0, s50, 94208
    s_nop 0
    buffer_load_dwordx4 v16, s[20:23], s51 offen lds
    s_add_u32 s51, s51, 81920
    s_waitcnt vmcnt(18)
    s_barrier
    s_add_u32 m0, s48, 110592
    s_nop 0
    buffer_load_dwordx4 v8, s[16:19], s49 offen lds
    s_add_u32 m0, s48, 111616
    s_nop 0
    buffer_load_dwordx4 v9, s[16:19], s49 offen lds
    s_add_u32 m0, s48, 112640
    s_nop 0
    buffer_load_dwordx4 v10, s[16:19], s49 offen lds
    s_add_u32 m0, s48, 113664
    s_nop 0
    buffer_load_dwordx4 v11, s[16:19], s49 offen lds
    s_add_u32 s49, s49, 4096
    s_add_u32 m0, s50, 126976
    s_nop 0
    buffer_load_dwordx4 v12, s[20:23], s51 offen lds
    s_add_u32 m0, s50, 128000
    s_nop 0
    buffer_load_dwordx4 v13, s[20:23], s51 offen lds
    s_add_u32 m0, s50, 129024
    s_nop 0
    buffer_load_dwordx4 v14, s[20:23], s51 offen lds
    s_add_u32 m0, s50, 130048
    s_nop 0
    buffer_load_dwordx4 v15, s[20:23], s51 offen lds
    s_add_u32 m0, s50, 131072
    s_nop 0
    buffer_load_dwordx4 v16, s[20:23], s51 offen lds
    s_add_u32 s51, s51, 81920
    s_waitcnt vmcnt(18)
    s_barrier
    s_add_u32 m0, s48, 0
    s_nop 0
    buffer_load_dwordx4 v8, s[16:19], s49 offen lds
    s_add_u32 m0, s48, 1024
    s_nop 0
    buffer_load_dwordx4 v9, s[16:19], s49 offen lds
    s_add_u32 m0, s48, 2048
    s_nop 0
    buffer_load_dwordx4 v10, s[16:19], s49 offen lds
    s_add_u32 m0, s48, 3072
    s_nop 0
    buffer_load_dwordx4 v11, s[16:19], s49 offen lds
    s_add_u32 s49, s49, 4096
    s_add_u32 m0, s50, 16384
    s_nop 0
    buffer_load_dwordx4 v12, s[20:23], s51 offen lds
    s_add_u32 m0, s50, 17408
    s_nop 0
    buffer_load_dwordx4 v13, s[20:23], s51 offen lds
    s_add_u32 m0, s50, 18432
    s_nop 0
    buffer_load_dwordx4 v14, s[20:23], s51 offen lds
    s_add_u32 m0, s50, 19456
    s_nop 0
    buffer_load_dwordx4 v15, s[20:23], s51 offen lds
    s_add_u32 m0, s50, 20480
    s_nop 0
    buffer_load_dwordx4 v16, s[20:23], s51 offen lds
    s_add_u32 s51, s51, 81920
    s_waitcnt vmcnt(18)
    s_barrier
    s_add_u32 m0, s48, 36864
    s_nop 0
    buffer_load_dwordx4 v8, s[16:19], s49 offen lds
    s_add_u32 m0, s48, 37888
    s_nop 0
    buffer_load_dwordx4 v9, s[16:19], s49 offen lds
    s_add_u32 m0, s48, 38912
    s_nop 0
    buffer_load_dwordx4 v10, s[16:19], s49 offen lds
    s_add_u32 m0, s48, 39936
    s_nop 0
    buffer_load_dwordx4 v11, s[16:19], s49 offen lds
    s_add_u32 s49, s49, 4096
    s_add_u32 m0, s50, 53248
    s_nop 0
    buffer_load_dwordx4 v12, s[20:23], s51 offen lds
    s_add_u32 m0, s50, 54272
    s_nop 0
    buffer_load_dwordx4 v13, s[20:23], s51 offen lds
    s_add_u32 m0, s50, 55296
    s_nop 0
    buffer_load_dwordx4 v14, s[20:23], s51 offen lds
    s_add_u32 m0, s50, 56320
    s_nop 0
    buffer_load_dwordx4 v15, s[20:23], s51 offen lds
    s_add_u32 m0, s50, 57344
    s_nop 0
    buffer_load_dwordx4 v16, s[20:23], s51 offen lds
    s_add_u32 s51, s51, 81920
    s_waitcnt vmcnt(18)
    s_barrier
    s_add_u32 m0, s48, 73728
    s_nop 0
    buffer_load_dwordx4 v8, s[16:19], s49 offen lds
    s_add_u32 m0, s48, 74752
    s_nop 0
    buffer_load_dwordx4 v9, s[16:19], s49 offen lds
    s_add_u32 m0, s48, 75776
    s_nop 0
    buffer_load_dwordx4 v10, s[16:19], s49 offen lds
    s_add_u32 m0, s48, 76800
    s_nop 0
    buffer_load_dwordx4 v11, s[16:19], s49 offen lds
    s_add_u32 s49, s49, 4096
    s_add_u32 m0, s50, 90112
    s_nop 0
    buffer_load_dwordx4 v12, s[20:23], s51 offen lds
    s_add_u32 m0, s50, 91136
    s_nop 0
    buffer_load_dwordx4 v13, s[20:23], s51 offen lds
    s_add_u32 m0, s50, 92160
    s_nop 0
    buffer_load_dwordx4 v14, s[20:23], s51 offen lds
    s_add_u32 m0, s50, 93184
    s_nop 0
    buffer_load_dwordx4 v15, s[20:23], s51 offen lds
    s_add_u32 m0, s50, 94208
    s_nop 0
    buffer_load_dwordx4 v16, s[20:23], s51 offen lds
    s_add_u32 s51, s51, 81920
    s_waitcnt vmcnt(18)
    s_barrier
    s_add_u32 m0, s48, 110592
    s_nop 0
    buffer_load_dwordx4 v8, s[16:19], s49 offen lds
    s_add_u32 m0, s48, 111616
    s_nop 0
    buffer_load_dwordx4 v9, s[16:19], s49 offen lds
    s_add_u32 m0, s48, 112640
    s_nop 0
    buffer_load_dwordx4 v10, s[16:19], s49 offen lds
    s_add_u32 m0, s48, 113664
    s_nop 0
    buffer_load_dwordx4 v11, s[16:19], s49 offen lds
    s_add_u32 s49, s49, 4096
    s_add_u32 m0, s50, 126976
    s_nop 0
    buffer_load_dwordx4 v12, s[20:23], s51 offen lds
    s_add_u32 m0, s50, 128000
    s_nop 0
    buffer_load_dwordx4 v13, s[20:23], s51 offen lds
    s_add_u32 m0, s50, 129024
    s_nop 0
    buffer_load_dwordx4 v14, s[20:23], s51 offen lds
    s_add_u32 m0, s50, 130048
    s_nop 0
    buffer_load_dwordx4 v15, s[20:23], s51 offen lds
    s_add_u32 m0, s50, 131072
    s_nop 0
    buffer_load_dwordx4 v16, s[20:23], s51 offen lds
    s_add_u32 s51, s51, 81920
    s_waitcnt vmcnt(18)
    s_barrier
    s_waitcnt vmcnt(9)
    s_barrier
    s_waitcnt vmcnt(0)
    s_barrier
    s_endpgm
Lop_cons:
    s_lshr_b32 s46, s2, 3
    s_lshl_b32 s46, s46, 2
    s_add_u32 s46, s46, s40
    s_lshl_b32 s47, s44, 20
    s_lshl_b32 s61, s41, 16
    s_add_u32 s47, s47, s61
    s_mul_i32 s63, s41, 1310720
    v_and_b32 v1, 63, v0
    s_waitcnt lgkmcnt(0)
    s_add_u32 s16, s12, 46137344
    s_addc_u32 s17, s13, 0
    s_mov_b32 s18, 16777216
    s_mov_b32 s19, 0x00020000
    s_mov_b32 s20, s4
    s_mov_b32 s21, s5
    s_mov_b32 s22, 5242880
    s_mov_b32 s23, 0x00020000
    v_and_b32 v1, 63, v0
    v_lshlrev_b32 v2, 4, v1
    v_add_u32 v17, 0, v2
    s_mul_i32 s52, s40, 4096
    v_add_u32 v17, s52, v17
    v_bfe_u32 v2, v1, 2, 2
    v_lshrrev_b32 v3, 5, v1
    v_mad_u32_u24 v3, v3, 4, v2
    v_mul_u32_u24 v4, 320, v3
    v_and_b32 v5, 3, v1
    v_lshl_add_u32 v4, v5, 3, v4
    v_bfe_u32 v5, v1, 4, 1
    v_lshl_add_u32 v4, v5, 5, v4
    v_add_u32 v4, 16384, v4
    v_mov_b32 v19, v4
    s_add_u32 s24, s12, 67108864
    s_addc_u32 s25, s13, 0
    s_mov_b32 s26, 10485760
    s_mov_b32 s27, 0x00020000
    v_and_b32 v1, 31, v0
    v_lshlrev_b32 v1, 5, v1
    v_bfe_u32 v2, v0, 5, 1
    v_lshl_add_u32 v7, v2, 4, v1
    s_lshl_b32 s60, s41, 6
    s_lshl_b32 s61, s42, 2
    s_add_u32 s60, s60, s61
    s_add_u32 s60, s60, s40
    s_mul_i32 s60, s60, 40
    s_mul_i32 s61, s43, 10
    s_add_u32 s60, s60, s61
    s_lshl_b32 s60, s60, 10
    s_add_u32 s61, s60, 4096
    s_add_u32 s62, s60, 8192
    s_barrier
    v_add_u32 v18, 0, v17
    v_add_u32 v20, 0, v19
    ds_read_b128 v[24:27], v18 offset:0
    ds_read_b64_tr_b16 v[28:29], v20 offset:0
    ds_read_b64_tr_b16 v[30:31], v20 offset:2560
    ds_read_b64_tr_b16 v[32:33], v20 offset:64
    ds_read_b64_tr_b16 v[34:35], v20 offset:2624
    ds_read_b64_tr_b16 v[36:37], v20 offset:128
    ds_read_b64_tr_b16 v[38:39], v20 offset:2688
    ds_read_b64_tr_b16 v[40:41], v20 offset:192
    ds_read_b64_tr_b16 v[42:43], v20 offset:2752
    ds_read_b64_tr_b16 v[44:45], v20 offset:256
    ds_read_b64_tr_b16 v[46:47], v20 offset:2816
    ds_read_b128 v[48:51], v18 offset:1024
    ds_read_b64_tr_b16 v[52:53], v20 offset:5120
    ds_read_b64_tr_b16 v[54:55], v20 offset:7680
    ds_read_b64_tr_b16 v[56:57], v20 offset:5184
    ds_read_b64_tr_b16 v[58:59], v20 offset:7744
    ds_read_b64_tr_b16 v[60:61], v20 offset:5248
    ds_read_b64_tr_b16 v[62:63], v20 offset:7808
    ds_read_b64_tr_b16 v[64:65], v20 offset:5312
    ds_read_b64_tr_b16 v[66:67], v20 offset:7872
    ds_read_b64_tr_b16 v[68:69], v20 offset:5376
    ds_read_b64_tr_b16 v[70:71], v20 offset:7936
    s_waitcnt lgkmcnt(0)
    v_mfma_f32_32x32x16_bf16 v[120:135], v[28:31], v[24:27], 0
    ds_read_b128 v[72:75], v18 offset:2048
    ds_read_b64_tr_b16 v[76:77], v20 offset:10240
    ds_read_b64_tr_b16 v[78:79], v20 offset:12800
    v_mfma_f32_32x32x16_bf16 v[136:151], v[32:35], v[24:27], 0
    ds_read_b64_tr_b16 v[80:81], v20 offset:10304
    ds_read_b64_tr_b16 v[82:83], v20 offset:12864
    ds_read_b64_tr_b16 v[84:85], v20 offset:10368
    v_mfma_f32_32x32x16_bf16 v[152:167], v[36:39], v[24:27], 0
    ds_read_b64_tr_b16 v[86:87], v20 offset:12928
    ds_read_b64_tr_b16 v[88:89], v20 offset:10432
    ds_read_b64_tr_b16 v[90:91], v20 offset:12992
    v_mfma_f32_32x32x16_bf16 v[168:183], v[40:43], v[24:27], 0
    ds_read_b64_tr_b16 v[92:93], v20 offset:10496
    ds_read_b64_tr_b16 v[94:95], v20 offset:13056
    ds_read_b128 v[96:99], v18 offset:3072
    v_mfma_f32_32x32x16_bf16 v[184:199], v[44:47], v[24:27], 0
    ds_read_b64_tr_b16 v[100:101], v20 offset:15360
    ds_read_b64_tr_b16 v[102:103], v20 offset:17920
    ds_read_b64_tr_b16 v[104:105], v20 offset:15424
    v_mfma_f32_32x32x16_bf16 v[120:135], v[52:55], v[48:51], v[120:135]
    ds_read_b64_tr_b16 v[106:107], v20 offset:17984
    ds_read_b64_tr_b16 v[108:109], v20 offset:15488
    ds_read_b64_tr_b16 v[110:111], v20 offset:18048
    v_mfma_f32_32x32x16_bf16 v[136:151], v[56:59], v[48:51], v[136:151]
    ds_read_b64_tr_b16 v[112:113], v20 offset:15552
    ds_read_b64_tr_b16 v[114:115], v20 offset:18112
    ds_read_b64_tr_b16 v[116:117], v20 offset:15616
    v_mfma_f32_32x32x16_bf16 v[152:167], v[60:63], v[48:51], v[152:167]
    ds_read_b64_tr_b16 v[118:119], v20 offset:18176
    v_mfma_f32_32x32x16_bf16 v[168:183], v[64:67], v[48:51], v[168:183]
    v_mfma_f32_32x32x16_bf16 v[184:199], v[68:71], v[48:51], v[184:199]
    s_waitcnt lgkmcnt(0)
    s_barrier
    v_mfma_f32_32x32x16_bf16 v[120:135], v[76:79], v[72:75], v[120:135]
    v_add_u32 v18, 36864, v17
    v_add_u32 v20, 36864, v19
    ds_read_b128 v[24:27], v18 offset:0
    v_mfma_f32_32x32x16_bf16 v[136:151], v[80:83], v[72:75], v[136:151]
    ds_read_b64_tr_b16 v[28:29], v20 offset:0
    ds_read_b64_tr_b16 v[30:31], v20 offset:2560
    ds_read_b64_tr_b16 v[32:33], v20 offset:64
    v_mfma_f32_32x32x16_bf16 v[152:167], v[84:87], v[72:75], v[152:167]
    ds_read_b64_tr_b16 v[34:35], v20 offset:2624
    ds_read_b64_tr_b16 v[36:37], v20 offset:128
    ds_read_b64_tr_b16 v[38:39], v20 offset:2688
    v_mfma_f32_32x32x16_bf16 v[168:183], v[88:91], v[72:75], v[168:183]
    ds_read_b64_tr_b16 v[40:41], v20 offset:192
    ds_read_b64_tr_b16 v[42:43], v20 offset:2752
    ds_read_b64_tr_b16 v[44:45], v20 offset:256
    v_mfma_f32_32x32x16_bf16 v[184:199], v[92:95], v[72:75], v[184:199]
    ds_read_b64_tr_b16 v[46:47], v20 offset:2816
    ds_read_b128 v[48:51], v18 offset:1024
    ds_read_b64_tr_b16 v[52:53], v20 offset:5120
    v_mfma_f32_32x32x16_bf16 v[120:135], v[100:103], v[96:99], v[120:135]
    ds_read_b64_tr_b16 v[54:55], v20 offset:7680
    ds_read_b64_tr_b16 v[56:57], v20 offset:5184
    ds_read_b64_tr_b16 v[58:59], v20 offset:7744
    v_mfma_f32_32x32x16_bf16 v[136:151], v[104:107], v[96:99], v[136:151]
    ds_read_b64_tr_b16 v[60:61], v20 offset:5248
    ds_read_b64_tr_b16 v[62:63], v20 offset:7808
    ds_read_b64_tr_b16 v[64:65], v20 offset:5312
    v_mfma_f32_32x32x16_bf16 v[152:167], v[108:111], v[96:99], v[152:167]
    ds_read_b64_tr_b16 v[66:67], v20 offset:7872
    ds_read_b64_tr_b16 v[68:69], v20 offset:5376
    ds_read_b64_tr_b16 v[70:71], v20 offset:7936
    v_mfma_f32_32x32x16_bf16 v[168:183], v[112:115], v[96:99], v[168:183]
    v_mfma_f32_32x32x16_bf16 v[184:199], v[116:119], v[96:99], v[184:199]
    s_waitcnt lgkmcnt(0)
    v_mfma_f32_32x32x16_bf16 v[120:135], v[28:31], v[24:27], v[120:135]
    ds_read_b128 v[72:75], v18 offset:2048
    ds_read_b64_tr_b16 v[76:77], v20 offset:10240
    ds_read_b64_tr_b16 v[78:79], v20 offset:12800
    v_mfma_f32_32x32x16_bf16 v[136:151], v[32:35], v[24:27], v[136:151]
    ds_read_b64_tr_b16 v[80:81], v20 offset:10304
    ds_read_b64_tr_b16 v[82:83], v20 offset:12864
    ds_read_b64_tr_b16 v[84:85], v20 offset:10368
    v_mfma_f32_32x32x16_bf16 v[152:167], v[36:39], v[24:27], v[152:167]
    ds_read_b64_tr_b16 v[86:87], v20 offset:12928
    ds_read_b64_tr_b16 v[88:89], v20 offset:10432
    ds_read_b64_tr_b16 v[90:91], v20 offset:12992
    v_mfma_f32_32x32x16_bf16 v[168:183], v[40:43], v[24:27], v[168:183]
    ds_read_b64_tr_b16 v[92:93], v20 offset:10496
    ds_read_b64_tr_b16 v[94:95], v20 offset:13056
    ds_read_b128 v[96:99], v18 offset:3072
    v_mfma_f32_32x32x16_bf16 v[184:199], v[44:47], v[24:27], v[184:199]
    ds_read_b64_tr_b16 v[100:101], v20 offset:15360
    ds_read_b64_tr_b16 v[102:103], v20 offset:17920
    ds_read_b64_tr_b16 v[104:105], v20 offset:15424
    v_mfma_f32_32x32x16_bf16 v[120:135], v[52:55], v[48:51], v[120:135]
    ds_read_b64_tr_b16 v[106:107], v20 offset:17984
    ds_read_b64_tr_b16 v[108:109], v20 offset:15488
    ds_read_b64_tr_b16 v[110:111], v20 offset:18048
    v_mfma_f32_32x32x16_bf16 v[136:151], v[56:59], v[48:51], v[136:151]
    ds_read_b64_tr_b16 v[112:113], v20 offset:15552
    ds_read_b64_tr_b16 v[114:115], v20 offset:18112
    ds_read_b64_tr_b16 v[116:117], v20 offset:15616
    v_mfma_f32_32x32x16_bf16 v[152:167], v[60:63], v[48:51], v[152:167]
    ds_read_b64_tr_b16 v[118:119], v20 offset:18176
    v_mfma_f32_32x32x16_bf16 v[168:183], v[64:67], v[48:51], v[168:183]
    v_mfma_f32_32x32x16_bf16 v[184:199], v[68:71], v[48:51], v[184:199]
    s_waitcnt lgkmcnt(0)
    s_barrier
    v_mfma_f32_32x32x16_bf16 v[120:135], v[76:79], v[72:75], v[120:135]
    v_add_u32 v18, 73728, v17
    v_add_u32 v20, 73728, v19
    ds_read_b128 v[24:27], v18 offset:0
    v_mfma_f32_32x32x16_bf16 v[136:151], v[80:83], v[72:75], v[136:151]
    ds_read_b64_tr_b16 v[28:29], v20 offset:0
    ds_read_b64_tr_b16 v[30:31], v20 offset:2560
    ds_read_b64_tr_b16 v[32:33], v20 offset:64
    v_mfma_f32_32x32x16_bf16 v[152:167], v[84:87], v[72:75], v[152:167]
    ds_read_b64_tr_b16 v[34:35], v20 offset:2624
    ds_read_b64_tr_b16 v[36:37], v20 offset:128
    ds_read_b64_tr_b16 v[38:39], v20 offset:2688
    v_mfma_f32_32x32x16_bf16 v[168:183], v[88:91], v[72:75], v[168:183]
    ds_read_b64_tr_b16 v[40:41], v20 offset:192
    ds_read_b64_tr_b16 v[42:43], v20 offset:2752
    ds_read_b64_tr_b16 v[44:45], v20 offset:256
    v_mfma_f32_32x32x16_bf16 v[184:199], v[92:95], v[72:75], v[184:199]
    ds_read_b64_tr_b16 v[46:47], v20 offset:2816
    ds_read_b128 v[48:51], v18 offset:1024
    ds_read_b64_tr_b16 v[52:53], v20 offset:5120
    v_mfma_f32_32x32x16_bf16 v[120:135], v[100:103], v[96:99], v[120:135]
    ds_read_b64_tr_b16 v[54:55], v20 offset:7680
    ds_read_b64_tr_b16 v[56:57], v20 offset:5184
    ds_read_b64_tr_b16 v[58:59], v20 offset:7744
    v_mfma_f32_32x32x16_bf16 v[136:151], v[104:107], v[96:99], v[136:151]
    ds_read_b64_tr_b16 v[60:61], v20 offset:5248
    ds_read_b64_tr_b16 v[62:63], v20 offset:7808
    ds_read_b64_tr_b16 v[64:65], v20 offset:5312
    v_mfma_f32_32x32x16_bf16 v[152:167], v[108:111], v[96:99], v[152:167]
    ds_read_b64_tr_b16 v[66:67], v20 offset:7872
    ds_read_b64_tr_b16 v[68:69], v20 offset:5376
    ds_read_b64_tr_b16 v[70:71], v20 offset:7936
    v_mfma_f32_32x32x16_bf16 v[168:183], v[112:115], v[96:99], v[168:183]
    v_mfma_f32_32x32x16_bf16 v[184:199], v[116:119], v[96:99], v[184:199]
    s_waitcnt lgkmcnt(0)
    v_mfma_f32_32x32x16_bf16 v[120:135], v[28:31], v[24:27], v[120:135]
    ds_read_b128 v[72:75], v18 offset:2048
    ds_read_b64_tr_b16 v[76:77], v20 offset:10240
    ds_read_b64_tr_b16 v[78:79], v20 offset:12800
    v_mfma_f32_32x32x16_bf16 v[136:151], v[32:35], v[24:27], v[136:151]
    ds_read_b64_tr_b16 v[80:81], v20 offset:10304
    ds_read_b64_tr_b16 v[82:83], v20 offset:12864
    ds_read_b64_tr_b16 v[84:85], v20 offset:10368
    v_mfma_f32_32x32x16_bf16 v[152:167], v[36:39], v[24:27], v[152:167]
    ds_read_b64_tr_b16 v[86:87], v20 offset:12928
    ds_read_b64_tr_b16 v[88:89], v20 offset:10432
    ds_read_b64_tr_b16 v[90:91], v20 offset:12992
    v_mfma_f32_32x32x16_bf16 v[168:183], v[40:43], v[24:27], v[168:183]
    ds_read_b64_tr_b16 v[92:93], v20 offset:10496
    ds_read_b64_tr_b16 v[94:95], v20 offset:13056
    ds_read_b128 v[96:99], v18 offset:3072
    v_mfma_f32_32x32x16_bf16 v[184:199], v[44:47], v[24:27], v[184:199]
    ds_read_b64_tr_b16 v[100:101], v20 offset:15360
    ds_read_b64_tr_b16 v[102:103], v20 offset:17920
    ds_read_b64_tr_b16 v[104:105], v20 offset:15424
    v_mfma_f32_32x32x16_bf16 v[120:135], v[52:55], v[48:51], v[120:135]
    ds_read_b64_tr_b16 v[106:107], v20 offset:17984
    ds_read_b64_tr_b16 v[108:109], v20 offset:15488
    ds_read_b64_tr_b16 v[110:111], v20 offset:18048
    v_mfma_f32_32x32x16_bf16 v[136:151], v[56:59], v[48:51], v[136:151]
    ds_read_b64_tr_b16 v[112:113], v20 offset:15552
    ds_read_b64_tr_b16 v[114:115], v20 offset:18112
    ds_read_b64_tr_b16 v[116:117], v20 offset:15616
    v_mfma_f32_32x32x16_bf16 v[152:167], v[60:63], v[48:51], v[152:167]
    ds_read_b64_tr_b16 v[118:119], v20 offset:18176
    v_mfma_f32_32x32x16_bf16 v[168:183], v[64:67], v[48:51], v[168:183]
    v_mfma_f32_32x32x16_bf16 v[184:199], v[68:71], v[48:51], v[184:199]
    s_waitcnt lgkmcnt(0)
    s_barrier
    v_mfma_f32_32x32x16_bf16 v[120:135], v[76:79], v[72:75], v[120:135]
    v_add_u32 v18, 110592, v17
    v_add_u32 v20, 110592, v19
    ds_read_b128 v[24:27], v18 offset:0
    v_mfma_f32_32x32x16_bf16 v[136:151], v[80:83], v[72:75], v[136:151]
    ds_read_b64_tr_b16 v[28:29], v20 offset:0
    ds_read_b64_tr_b16 v[30:31], v20 offset:2560
    ds_read_b64_tr_b16 v[32:33], v20 offset:64
    v_mfma_f32_32x32x16_bf16 v[152:167], v[84:87], v[72:75], v[152:167]
    ds_read_b64_tr_b16 v[34:35], v20 offset:2624
    ds_read_b64_tr_b16 v[36:37], v20 offset:128
    ds_read_b64_tr_b16 v[38:39], v20 offset:2688
    v_mfma_f32_32x32x16_bf16 v[168:183], v[88:91], v[72:75], v[168:183]
    ds_read_b64_tr_b16 v[40:41], v20 offset:192
    ds_read_b64_tr_b16 v[42:43], v20 offset:2752
    ds_read_b64_tr_b16 v[44:45], v20 offset:256
    v_mfma_f32_32x32x16_bf16 v[184:199], v[92:95], v[72:75], v[184:199]
    ds_read_b64_tr_b16 v[46:47], v20 offset:2816
    ds_read_b128 v[48:51], v18 offset:1024
    ds_read_b64_tr_b16 v[52:53], v20 offset:5120
    v_mfma_f32_32x32x16_bf16 v[120:135], v[100:103], v[96:99], v[120:135]
    ds_read_b64_tr_b16 v[54:55], v20 offset:7680
    ds_read_b64_tr_b16 v[56:57], v20 offset:5184
    ds_read_b64_tr_b16 v[58:59], v20 offset:7744
    v_mfma_f32_32x32x16_bf16 v[136:151], v[104:107], v[96:99], v[136:151]
    ds_read_b64_tr_b16 v[60:61], v20 offset:5248
    ds_read_b64_tr_b16 v[62:63], v20 offset:7808
    ds_read_b64_tr_b16 v[64:65], v20 offset:5312
    v_mfma_f32_32x32x16_bf16 v[152:167], v[108:111], v[96:99], v[152:167]
    ds_read_b64_tr_b16 v[66:67], v20 offset:7872
    ds_read_b64_tr_b16 v[68:69], v20 offset:5376
    ds_read_b64_tr_b16 v[70:71], v20 offset:7936
    v_mfma_f32_32x32x16_bf16 v[168:183], v[112:115], v[96:99], v[168:183]
    v_mfma_f32_32x32x16_bf16 v[184:199], v[116:119], v[96:99], v[184:199]
    s_waitcnt lgkmcnt(0)
    v_mfma_f32_32x32x16_bf16 v[120:135], v[28:31], v[24:27], v[120:135]
    ds_read_b128 v[72:75], v18 offset:2048
    ds_read_b64_tr_b16 v[76:77], v20 offset:10240
    ds_read_b64_tr_b16 v[78:79], v20 offset:12800
    v_mfma_f32_32x32x16_bf16 v[136:151], v[32:35], v[24:27], v[136:151]
    ds_read_b64_tr_b16 v[80:81], v20 offset:10304
    ds_read_b64_tr_b16 v[82:83], v20 offset:12864
    ds_read_b64_tr_b16 v[84:85], v20 offset:10368
    v_mfma_f32_32x32x16_bf16 v[152:167], v[36:39], v[24:27], v[152:167]
    ds_read_b64_tr_b16 v[86:87], v20 offset:12928
    ds_read_b64_tr_b16 v[88:89], v20 offset:10432
    ds_read_b64_tr_b16 v[90:91], v20 offset:12992
    v_mfma_f32_32x32x16_bf16 v[168:183], v[40:43], v[24:27], v[168:183]
    ds_read_b64_tr_b16 v[92:93], v20 offset:10496
    ds_read_b64_tr_b16 v[94:95], v20 offset:13056
    ds_read_b128 v[96:99], v18 offset:3072
    v_mfma_f32_32x32x16_bf16 v[184:199], v[44:47], v[24:27], v[184:199]
    ds_read_b64_tr_b16 v[100:101], v20 offset:15360
    ds_read_b64_tr_b16 v[102:103], v20 offset:17920
    ds_read_b64_tr_b16 v[104:105], v20 offset:15424
    v_mfma_f32_32x32x16_bf16 v[120:135], v[52:55], v[48:51], v[120:135]
    ds_read_b64_tr_b16 v[106:107], v20 offset:17984
    ds_read_b64_tr_b16 v[108:109], v20 offset:15488
    ds_read_b64_tr_b16 v[110:111], v20 offset:18048
    v_mfma_f32_32x32x16_bf16 v[136:151], v[56:59], v[48:51], v[136:151]
    ds_read_b64_tr_b16 v[112:113], v20 offset:15552
    ds_read_b64_tr_b16 v[114:115], v20 offset:18112
    ds_read_b64_tr_b16 v[116:117], v20 offset:15616
    v_mfma_f32_32x32x16_bf16 v[152:167], v[60:63], v[48:51], v[152:167]
    ds_read_b64_tr_b16 v[118:119], v20 offset:18176
    v_mfma_f32_32x32x16_bf16 v[168:183], v[64:67], v[48:51], v[168:183]
    v_mfma_f32_32x32x16_bf16 v[184:199], v[68:71], v[48:51], v[184:199]
    s_waitcnt lgkmcnt(0)
    s_barrier
    v_mfma_f32_32x32x16_bf16 v[120:135], v[76:79], v[72:75], v[120:135]
    v_add_u32 v18, 0, v17
    v_add_u32 v20, 0, v19
    ds_read_b128 v[24:27], v18 offset:0
    v_mfma_f32_32x32x16_bf16 v[136:151], v[80:83], v[72:75], v[136:151]
    ds_read_b64_tr_b16 v[28:29], v20 offset:0
    ds_read_b64_tr_b16 v[30:31], v20 offset:2560
    ds_read_b64_tr_b16 v[32:33], v20 offset:64
    v_mfma_f32_32x32x16_bf16 v[152:167], v[84:87], v[72:75], v[152:167]
    ds_read_b64_tr_b16 v[34:35], v20 offset:2624
    ds_read_b64_tr_b16 v[36:37], v20 offset:128
    ds_read_b64_tr_b16 v[38:39], v20 offset:2688
    v_mfma_f32_32x32x16_bf16 v[168:183], v[88:91], v[72:75], v[168:183]
    ds_read_b64_tr_b16 v[40:41], v20 offset:192
    ds_read_b64_tr_b16 v[42:43], v20 offset:2752
    ds_read_b64_tr_b16 v[44:45], v20 offset:256
    v_mfma_f32_32x32x16_bf16 v[184:199], v[92:95], v[72:75], v[184:199]
    ds_read_b64_tr_b16 v[46:47], v20 offset:2816
    ds_read_b128 v[48:51], v18 offset:1024
    ds_read_b64_tr_b16 v[52:53], v20 offset:5120
    v_mfma_f32_32x32x16_bf16 v[120:135], v[100:103], v[96:99], v[120:135]
    ds_read_b64_tr_b16 v[54:55], v20 offset:7680
    ds_read_b64_tr_b16 v[56:57], v20 offset:5184
    ds_read_b64_tr_b16 v[58:59], v20 offset:7744
    v_mfma_f32_32x32x16_bf16 v[136:151], v[104:107], v[96:99], v[136:151]
    ds_read_b64_tr_b16 v[60:61], v20 offset:5248
    ds_read_b64_tr_b16 v[62:63], v20 offset:7808
    ds_read_b64_tr_b16 v[64:65], v20 offset:5312
    v_mfma_f32_32x32x16_bf16 v[152:167], v[108:111], v[96:99], v[152:167]
    ds_read_b64_tr_b16 v[66:67], v20 offset:7872
    ds_read_b64_tr_b16 v[68:69], v20 offset:5376
    ds_read_b64_tr_b16 v[70:71], v20 offset:7936
    v_mfma_f32_32x32x16_bf16 v[168:183], v[112:115], v[96:99], v[168:183]
    v_mfma_f32_32x32x16_bf16 v[184:199], v[116:119], v[96:99], v[184:199]
    s_waitcnt lgkmcnt(0)
    v_mfma_f32_32x32x16_bf16 v[120:135], v[28:31], v[24:27], v[120:135]
    ds_read_b128 v[72:75], v18 offset:2048
    ds_read_b64_tr_b16 v[76:77], v20 offset:10240
    ds_read_b64_tr_b16 v[78:79], v20 offset:12800
    v_mfma_f32_32x32x16_bf16 v[136:151], v[32:35], v[24:27], v[136:151]
    ds_read_b64_tr_b16 v[80:81], v20 offset:10304
    ds_read_b64_tr_b16 v[82:83], v20 offset:12864
    ds_read_b64_tr_b16 v[84:85], v20 offset:10368
    v_mfma_f32_32x32x16_bf16 v[152:167], v[36:39], v[24:27], v[152:167]
    ds_read_b64_tr_b16 v[86:87], v20 offset:12928
    ds_read_b64_tr_b16 v[88:89], v20 offset:10432
    ds_read_b64_tr_b16 v[90:91], v20 offset:12992
    v_mfma_f32_32x32x16_bf16 v[168:183], v[40:43], v[24:27], v[168:183]
    ds_read_b64_tr_b16 v[92:93], v20 offset:10496
    ds_read_b64_tr_b16 v[94:95], v20 offset:13056
    ds_read_b128 v[96:99], v18 offset:3072
    v_mfma_f32_32x32x16_bf16 v[184:199], v[44:47], v[24:27], v[184:199]
    ds_read_b64_tr_b16 v[100:101], v20 offset:15360
    ds_read_b64_tr_b16 v[102:103], v20 offset:17920
    ds_read_b64_tr_b16 v[104:105], v20 offset:15424
    v_mfma_f32_32x32x16_bf16 v[120:135], v[52:55], v[48:51], v[120:135]
    ds_read_b64_tr_b16 v[106:107], v20 offset:17984
    ds_read_b64_tr_b16 v[108:109], v20 offset:15488
    ds_read_b64_tr_b16 v[110:111], v20 offset:18048
    v_mfma_f32_32x32x16_bf16 v[136:151], v[56:59], v[48:51], v[136:151]
    ds_read_b64_tr_b16 v[112:113], v20 offset:15552
    ds_read_b64_tr_b16 v[114:115], v20 offset:18112
    ds_read_b64_tr_b16 v[116:117], v20 offset:15616
    v_mfma_f32_32x32x16_bf16 v[152:167], v[60:63], v[48:51], v[152:167]
    ds_read_b64_tr_b16 v[118:119], v20 offset:18176
    v_mfma_f32_32x32x16_bf16 v[168:183], v[64:67], v[48:51], v[168:183]
    v_mfma_f32_32x32x16_bf16 v[184:199], v[68:71], v[48:51], v[184:199]
    s_waitcnt lgkmcnt(0)
    s_barrier
    v_mfma_f32_32x32x16_bf16 v[120:135], v[76:79], v[72:75], v[120:135]
    v_add_u32 v18, 36864, v17
    v_add_u32 v20, 36864, v19
    ds_read_b128 v[24:27], v18 offset:0
    v_mfma_f32_32x32x16_bf16 v[136:151], v[80:83], v[72:75], v[136:151]
    ds_read_b64_tr_b16 v[28:29], v20 offset:0
    ds_read_b64_tr_b16 v[30:31], v20 offset:2560
    ds_read_b64_tr_b16 v[32:33], v20 offset:64
    v_mfma_f32_32x32x16_bf16 v[152:167], v[84:87], v[72:75], v[152:167]
    ds_read_b64_tr_b16 v[34:35], v20 offset:2624
    ds_read_b64_tr_b16 v[36:37], v20 offset:128
    ds_read_b64_tr_b16 v[38:39], v20 offset:2688
    v_mfma_f32_32x32x16_bf16 v[168:183], v[88:91], v[72:75], v[168:183]
    ds_read_b64_tr_b16 v[40:41], v20 offset:192
    ds_read_b64_tr_b16 v[42:43], v20 offset:2752
    ds_read_b64_tr_b16 v[44:45], v20 offset:256
    v_mfma_f32_32x32x16_bf16 v[184:199], v[92:95], v[72:75], v[184:199]
    ds_read_b64_tr_b16 v[46:47], v20 offset:2816
    ds_read_b128 v[48:51], v18 offset:1024
    ds_read_b64_tr_b16 v[52:53], v20 offset:5120
    v_mfma_f32_32x32x16_bf16 v[120:135], v[100:103], v[96:99], v[120:135]
    ds_read_b64_tr_b16 v[54:55], v20 offset:7680
    ds_read_b64_tr_b16 v[56:57], v20 offset:5184
    ds_read_b64_tr_b16 v[58:59], v20 offset:7744
    v_mfma_f32_32x32x16_bf16 v[136:151], v[104:107], v[96:99], v[136:151]
    ds_read_b64_tr_b16 v[60:61], v20 offset:5248
    ds_read_b64_tr_b16 v[62:63], v20 offset:7808
    ds_read_b64_tr_b16 v[64:65], v20 offset:5312
    v_mfma_f32_32x32x16_bf16 v[152:167], v[108:111], v[96:99], v[152:167]
    ds_read_b64_tr_b16 v[66:67], v20 offset:7872
    ds_read_b64_tr_b16 v[68:69], v20 offset:5376
    ds_read_b64_tr_b16 v[70:71], v20 offset:7936
    v_mfma_f32_32x32x16_bf16 v[168:183], v[112:115], v[96:99], v[168:183]
    v_mfma_f32_32x32x16_bf16 v[184:199], v[116:119], v[96:99], v[184:199]
    s_waitcnt lgkmcnt(0)
    v_mfma_f32_32x32x16_bf16 v[120:135], v[28:31], v[24:27], v[120:135]
    ds_read_b128 v[72:75], v18 offset:2048
    ds_read_b64_tr_b16 v[76:77], v20 offset:10240
    ds_read_b64_tr_b16 v[78:79], v20 offset:12800
    v_mfma_f32_32x32x16_bf16 v[136:151], v[32:35], v[24:27], v[136:151]
    ds_read_b64_tr_b16 v[80:81], v20 offset:10304
    ds_read_b64_tr_b16 v[82:83], v20 offset:12864
    ds_read_b64_tr_b16 v[84:85], v20 offset:10368
    v_mfma_f32_32x32x16_bf16 v[152:167], v[36:39], v[24:27], v[152:167]
    ds_read_b64_tr_b16 v[86:87], v20 offset:12928
    ds_read_b64_tr_b16 v[88:89], v20 offset:10432
    ds_read_b64_tr_b16 v[90:91], v20 offset:12992
    v_mfma_f32_32x32x16_bf16 v[168:183], v[40:43], v[24:27], v[168:183]
    ds_read_b64_tr_b16 v[92:93], v20 offset:10496
    ds_read_b64_tr_b16 v[94:95], v20 offset:13056
    ds_read_b128 v[96:99], v18 offset:3072
    v_mfma_f32_32x32x16_bf16 v[184:199], v[44:47], v[24:27], v[184:199]
    ds_read_b64_tr_b16 v[100:101], v20 offset:15360
    ds_read_b64_tr_b16 v[102:103], v20 offset:17920
    ds_read_b64_tr_b16 v[104:105], v20 offset:15424
    v_mfma_f32_32x32x16_bf16 v[120:135], v[52:55], v[48:51], v[120:135]
    ds_read_b64_tr_b16 v[106:107], v20 offset:17984
    ds_read_b64_tr_b16 v[108:109], v20 offset:15488
    ds_read_b64_tr_b16 v[110:111], v20 offset:18048
    v_mfma_f32_32x32x16_bf16 v[136:151], v[56:59], v[48:51], v[136:151]
    ds_read_b64_tr_b16 v[112:113], v20 offset:15552
    ds_read_b64_tr_b16 v[114:115], v20 offset:18112
    ds_read_b64_tr_b16 v[116:117], v20 offset:15616
    v_mfma_f32_32x32x16_bf16 v[152:167], v[60:63], v[48:51], v[152:167]
    ds_read_b64_tr_b16 v[118:119], v20 offset:18176
    v_mfma_f32_32x32x16_bf16 v[168:183], v[64:67], v[48:51], v[168:183]
    v_mfma_f32_32x32x16_bf16 v[184:199], v[68:71], v[48:51], v[184:199]
    s_waitcnt lgkmcnt(0)
    s_barrier
    v_mfma_f32_32x32x16_bf16 v[120:135], v[76:79], v[72:75], v[120:135]
    v_add_u32 v18, 73728, v17
    v_add_u32 v20, 73728, v19
    ds_read_b128 v[24:27], v18 offset:0
    v_mfma_f32_32x32x16_bf16 v[136:151], v[80:83], v[72:75], v[136:151]
    ds_read_b64_tr_b16 v[28:29], v20 offset:0
    ds_read_b64_tr_b16 v[30:31], v20 offset:2560
    ds_read_b64_tr_b16 v[32:33], v20 offset:64
    v_mfma_f32_32x32x16_bf16 v[152:167], v[84:87], v[72:75], v[152:167]
    ds_read_b64_tr_b16 v[34:35], v20 offset:2624
    ds_read_b64_tr_b16 v[36:37], v20 offset:128
    ds_read_b64_tr_b16 v[38:39], v20 offset:2688
    v_mfma_f32_32x32x16_bf16 v[168:183], v[88:91], v[72:75], v[168:183]
    ds_read_b64_tr_b16 v[40:41], v20 offset:192
    ds_read_b64_tr_b16 v[42:43], v20 offset:2752
    ds_read_b64_tr_b16 v[44:45], v20 offset:256
    v_mfma_f32_32x32x16_bf16 v[184:199], v[92:95], v[72:75], v[184:199]
    ds_read_b64_tr_b16 v[46:47], v20 offset:2816
    ds_read_b128 v[48:51], v18 offset:1024
    ds_read_b64_tr_b16 v[52:53], v20 offset:5120
    v_mfma_f32_32x32x16_bf16 v[120:135], v[100:103], v[96:99], v[120:135]
    ds_read_b64_tr_b16 v[54:55], v20 offset:7680
    ds_read_b64_tr_b16 v[56:57], v20 offset:5184
    ds_read_b64_tr_b16 v[58:59], v20 offset:7744
    v_mfma_f32_32x32x16_bf16 v[136:151], v[104:107], v[96:99], v[136:151]
    ds_read_b64_tr_b16 v[60:61], v20 offset:5248
    ds_read_b64_tr_b16 v[62:63], v20 offset:7808
    ds_read_b64_tr_b16 v[64:65], v20 offset:5312
    v_mfma_f32_32x32x16_bf16 v[152:167], v[108:111], v[96:99], v[152:167]
    ds_read_b64_tr_b16 v[66:67], v20 offset:7872
    ds_read_b64_tr_b16 v[68:69], v20 offset:5376
    ds_read_b64_tr_b16 v[70:71], v20 offset:7936
    v_mfma_f32_32x32x16_bf16 v[168:183], v[112:115], v[96:99], v[168:183]
    v_mfma_f32_32x32x16_bf16 v[184:199], v[116:119], v[96:99], v[184:199]
    s_waitcnt lgkmcnt(0)
    v_mfma_f32_32x32x16_bf16 v[120:135], v[28:31], v[24:27], v[120:135]
    ds_read_b128 v[72:75], v18 offset:2048
    ds_read_b64_tr_b16 v[76:77], v20 offset:10240
    ds_read_b64_tr_b16 v[78:79], v20 offset:12800
    v_mfma_f32_32x32x16_bf16 v[136:151], v[32:35], v[24:27], v[136:151]
    ds_read_b64_tr_b16 v[80:81], v20 offset:10304
    ds_read_b64_tr_b16 v[82:83], v20 offset:12864
    ds_read_b64_tr_b16 v[84:85], v20 offset:10368
    v_mfma_f32_32x32x16_bf16 v[152:167], v[36:39], v[24:27], v[152:167]
    ds_read_b64_tr_b16 v[86:87], v20 offset:12928
    ds_read_b64_tr_b16 v[88:89], v20 offset:10432
    ds_read_b64_tr_b16 v[90:91], v20 offset:12992
    v_mfma_f32_32x32x16_bf16 v[168:183], v[40:43], v[24:27], v[168:183]
    ds_read_b64_tr_b16 v[92:93], v20 offset:10496
    ds_read_b64_tr_b16 v[94:95], v20 offset:13056
    ds_read_b128 v[96:99], v18 offset:3072
    v_mfma_f32_32x32x16_bf16 v[184:199], v[44:47], v[24:27], v[184:199]
    ds_read_b64_tr_b16 v[100:101], v20 offset:15360
    ds_read_b64_tr_b16 v[102:103], v20 offset:17920
    ds_read_b64_tr_b16 v[104:105], v20 offset:15424
    v_mfma_f32_32x32x16_bf16 v[120:135], v[52:55], v[48:51], v[120:135]
    ds_read_b64_tr_b16 v[106:107], v20 offset:17984
    ds_read_b64_tr_b16 v[108:109], v20 offset:15488
    ds_read_b64_tr_b16 v[110:111], v20 offset:18048
    v_mfma_f32_32x32x16_bf16 v[136:151], v[56:59], v[48:51], v[136:151]
    ds_read_b64_tr_b16 v[112:113], v20 offset:15552
    ds_read_b64_tr_b16 v[114:115], v20 offset:18112
    ds_read_b64_tr_b16 v[116:117], v20 offset:15616
    v_mfma_f32_32x32x16_bf16 v[152:167], v[60:63], v[48:51], v[152:167]
    ds_read_b64_tr_b16 v[118:119], v20 offset:18176
    v_mfma_f32_32x32x16_bf16 v[168:183], v[64:67], v[48:51], v[168:183]
    v_mfma_f32_32x32x16_bf16 v[184:199], v[68:71], v[48:51], v[184:199]
    s_waitcnt lgkmcnt(0)
    s_barrier
    v_mfma_f32_32x32x16_bf16 v[120:135], v[76:79], v[72:75], v[120:135]
    v_add_u32 v18, 110592, v17
    v_add_u32 v20, 110592, v19
    ds_read_b128 v[24:27], v18 offset:0
    v_mfma_f32_32x32x16_bf16 v[136:151], v[80:83], v[72:75], v[136:151]
    ds_read_b64_tr_b16 v[28:29], v20 offset:0
    ds_read_b64_tr_b16 v[30:31], v20 offset:2560
    ds_read_b64_tr_b16 v[32:33], v20 offset:64
    v_mfma_f32_32x32x16_bf16 v[152:167], v[84:87], v[72:75], v[152:167]
    ds_read_b64_tr_b16 v[34:35], v20 offset:2624
    ds_read_b64_tr_b16 v[36:37], v20 offset:128
    ds_read_b64_tr_b16 v[38:39], v20 offset:2688
    v_mfma_f32_32x32x16_bf16 v[168:183], v[88:91], v[72:75], v[168:183]
    ds_read_b64_tr_b16 v[40:41], v20 offset:192
    ds_read_b64_tr_b16 v[42:43], v20 offset:2752
    ds_read_b64_tr_b16 v[44:45], v20 offset:256
    v_mfma_f32_32x32x16_bf16 v[184:199], v[92:95], v[72:75], v[184:199]
    ds_read_b64_tr_b16 v[46:47], v20 offset:2816
    ds_read_b128 v[48:51], v18 offset:1024
    ds_read_b64_tr_b16 v[52:53], v20 offset:5120
    v_mfma_f32_32x32x16_bf16 v[120:135], v[100:103], v[96:99], v[120:135]
    ds_read_b64_tr_b16 v[54:55], v20 offset:7680
    ds_read_b64_tr_b16 v[56:57], v20 offset:5184
    ds_read_b64_tr_b16 v[58:59], v20 offset:7744
    v_mfma_f32_32x32x16_bf16 v[136:151], v[104:107], v[96:99], v[136:151]
    ds_read_b64_tr_b16 v[60:61], v20 offset:5248
    ds_read_b64_tr_b16 v[62:63], v20 offset:7808
    ds_read_b64_tr_b16 v[64:65], v20 offset:5312
    v_mfma_f32_32x32x16_bf16 v[152:167], v[108:111], v[96:99], v[152:167]
    ds_read_b64_tr_b16 v[66:67], v20 offset:7872
    ds_read_b64_tr_b16 v[68:69], v20 offset:5376
    ds_read_b64_tr_b16 v[70:71], v20 offset:7936
    v_mfma_f32_32x32x16_bf16 v[168:183], v[112:115], v[96:99], v[168:183]
    v_mfma_f32_32x32x16_bf16 v[184:199], v[116:119], v[96:99], v[184:199]
    s_waitcnt lgkmcnt(0)
    v_mfma_f32_32x32x16_bf16 v[120:135], v[28:31], v[24:27], v[120:135]
    ds_read_b128 v[72:75], v18 offset:2048
    ds_read_b64_tr_b16 v[76:77], v20 offset:10240
    ds_read_b64_tr_b16 v[78:79], v20 offset:12800
    v_mfma_f32_32x32x16_bf16 v[136:151], v[32:35], v[24:27], v[136:151]
    ds_read_b64_tr_b16 v[80:81], v20 offset:10304
    ds_read_b64_tr_b16 v[82:83], v20 offset:12864
    ds_read_b64_tr_b16 v[84:85], v20 offset:10368
    v_mfma_f32_32x32x16_bf16 v[152:167], v[36:39], v[24:27], v[152:167]
    ds_read_b64_tr_b16 v[86:87], v20 offset:12928
    ds_read_b64_tr_b16 v[88:89], v20 offset:10432
    ds_read_b64_tr_b16 v[90:91], v20 offset:12992
    v_mfma_f32_32x32x16_bf16 v[168:183], v[40:43], v[24:27], v[168:183]
    ds_read_b64_tr_b16 v[92:93], v20 offset:10496
    ds_read_b64_tr_b16 v[94:95], v20 offset:13056
    ds_read_b128 v[96:99], v18 offset:3072
    v_mfma_f32_32x32x16_bf16 v[184:199], v[44:47], v[24:27], v[184:199]
    ds_read_b64_tr_b16 v[100:101], v20 offset:15360
    ds_read_b64_tr_b16 v[102:103], v20 offset:17920
    ds_read_b64_tr_b16 v[104:105], v20 offset:15424
    v_mfma_f32_32x32x16_bf16 v[120:135], v[52:55], v[48:51], v[120:135]
    ds_read_b64_tr_b16 v[106:107], v20 offset:17984
    ds_read_b64_tr_b16 v[108:109], v20 offset:15488
    ds_read_b64_tr_b16 v[110:111], v20 offset:18048
    v_mfma_f32_32x32x16_bf16 v[136:151], v[56:59], v[48:51], v[136:151]
    ds_read_b64_tr_b16 v[112:113], v20 offset:15552
    ds_read_b64_tr_b16 v[114:115], v20 offset:18112
    ds_read_b64_tr_b16 v[116:117], v20 offset:15616
    v_mfma_f32_32x32x16_bf16 v[152:167], v[60:63], v[48:51], v[152:167]
    ds_read_b64_tr_b16 v[118:119], v20 offset:18176
    v_mfma_f32_32x32x16_bf16 v[168:183], v[64:67], v[48:51], v[168:183]
    v_mfma_f32_32x32x16_bf16 v[184:199], v[68:71], v[48:51], v[184:199]
    s_waitcnt lgkmcnt(0)
    s_barrier
    v_mfma_f32_32x32x16_bf16 v[120:135], v[76:79], v[72:75], v[120:135]
    v_add_u32 v18, 0, v17
    v_add_u32 v20, 0, v19
    ds_read_b128 v[24:27], v18 offset:0
    v_mfma_f32_32x32x16_bf16 v[136:151], v[80:83], v[72:75], v[136:151]
    ds_read_b64_tr_b16 v[28:29], v20 offset:0
    ds_read_b64_tr_b16 v[30:31], v20 offset:2560
    ds_read_b64_tr_b16 v[32:33], v20 offset:64
    v_mfma_f32_32x32x16_bf16 v[152:167], v[84:87], v[72:75], v[152:167]
    ds_read_b64_tr_b16 v[34:35], v20 offset:2624
    ds_read_b64_tr_b16 v[36:37], v20 offset:128
    ds_read_b64_tr_b16 v[38:39], v20 offset:2688
    v_mfma_f32_32x32x16_bf16 v[168:183], v[88:91], v[72:75], v[168:183]
    ds_read_b64_tr_b16 v[40:41], v20 offset:192
    ds_read_b64_tr_b16 v[42:43], v20 offset:2752
    ds_read_b64_tr_b16 v[44:45], v20 offset:256
    v_mfma_f32_32x32x16_bf16 v[184:199], v[92:95], v[72:75], v[184:199]
    ds_read_b64_tr_b16 v[46:47], v20 offset:2816
    ds_read_b128 v[48:51], v18 offset:1024
    ds_read_b64_tr_b16 v[52:53], v20 offset:5120
    v_mfma_f32_32x32x16_bf16 v[120:135], v[100:103], v[96:99], v[120:135]
    ds_read_b64_tr_b16 v[54:55], v20 offset:7680
    ds_read_b64_tr_b16 v[56:57], v20 offset:5184
    ds_read_b64_tr_b16 v[58:59], v20 offset:7744
    v_mfma_f32_32x32x16_bf16 v[136:151], v[104:107], v[96:99], v[136:151]
    ds_read_b64_tr_b16 v[60:61], v20 offset:5248
    ds_read_b64_tr_b16 v[62:63], v20 offset:7808
    ds_read_b64_tr_b16 v[64:65], v20 offset:5312
    v_mfma_f32_32x32x16_bf16 v[152:167], v[108:111], v[96:99], v[152:167]
    ds_read_b64_tr_b16 v[66:67], v20 offset:7872
    ds_read_b64_tr_b16 v[68:69], v20 offset:5376
    ds_read_b64_tr_b16 v[70:71], v20 offset:7936
    v_mfma_f32_32x32x16_bf16 v[168:183], v[112:115], v[96:99], v[168:183]
    v_mfma_f32_32x32x16_bf16 v[184:199], v[116:119], v[96:99], v[184:199]
    s_waitcnt lgkmcnt(0)
    v_mfma_f32_32x32x16_bf16 v[120:135], v[28:31], v[24:27], v[120:135]
    ds_read_b128 v[72:75], v18 offset:2048
    ds_read_b64_tr_b16 v[76:77], v20 offset:10240
    ds_read_b64_tr_b16 v[78:79], v20 offset:12800
    v_mfma_f32_32x32x16_bf16 v[136:151], v[32:35], v[24:27], v[136:151]
    ds_read_b64_tr_b16 v[80:81], v20 offset:10304
    ds_read_b64_tr_b16 v[82:83], v20 offset:12864
    ds_read_b64_tr_b16 v[84:85], v20 offset:10368
    v_mfma_f32_32x32x16_bf16 v[152:167], v[36:39], v[24:27], v[152:167]
    ds_read_b64_tr_b16 v[86:87], v20 offset:12928
    ds_read_b64_tr_b16 v[88:89], v20 offset:10432
    ds_read_b64_tr_b16 v[90:91], v20 offset:12992
    v_mfma_f32_32x32x16_bf16 v[168:183], v[40:43], v[24:27], v[168:183]
    ds_read_b64_tr_b16 v[92:93], v20 offset:10496
    ds_read_b64_tr_b16 v[94:95], v20 offset:13056
    ds_read_b128 v[96:99], v18 offset:3072
    v_mfma_f32_32x32x16_bf16 v[184:199], v[44:47], v[24:27], v[184:199]
    ds_read_b64_tr_b16 v[100:101], v20 offset:15360
    ds_read_b64_tr_b16 v[102:103], v20 offset:17920
    ds_read_b64_tr_b16 v[104:105], v20 offset:15424
    v_mfma_f32_32x32x16_bf16 v[120:135], v[52:55], v[48:51], v[120:135]
    ds_read_b64_tr_b16 v[106:107], v20 offset:17984
    ds_read_b64_tr_b16 v[108:109], v20 offset:15488
    ds_read_b64_tr_b16 v[110:111], v20 offset:18048
    v_mfma_f32_32x32x16_bf16 v[136:151], v[56:59], v[48:51], v[136:151]
    ds_read_b64_tr_b16 v[112:113], v20 offset:15552
    ds_read_b64_tr_b16 v[114:115], v20 offset:18112
    ds_read_b64_tr_b16 v[116:117], v20 offset:15616
    v_mfma_f32_32x32x16_bf16 v[152:167], v[60:63], v[48:51], v[152:167]
    ds_read_b64_tr_b16 v[118:119], v20 offset:18176
    v_mfma_f32_32x32x16_bf16 v[168:183], v[64:67], v[48:51], v[168:183]
    v_mfma_f32_32x32x16_bf16 v[184:199], v[68:71], v[48:51], v[184:199]
    s_waitcnt lgkmcnt(0)
    s_barrier
    v_mfma_f32_32x32x16_bf16 v[120:135], v[76:79], v[72:75], v[120:135]
    v_add_u32 v18, 36864, v17
    v_add_u32 v20, 36864, v19
    ds_read_b128 v[24:27], v18 offset:0
    v_mfma_f32_32x32x16_bf16 v[136:151], v[80:83], v[72:75], v[136:151]
    ds_read_b64_tr_b16 v[28:29], v20 offset:0
    ds_read_b64_tr_b16 v[30:31], v20 offset:2560
    ds_read_b64_tr_b16 v[32:33], v20 offset:64
    v_mfma_f32_32x32x16_bf16 v[152:167], v[84:87], v[72:75], v[152:167]
    ds_read_b64_tr_b16 v[34:35], v20 offset:2624
    ds_read_b64_tr_b16 v[36:37], v20 offset:128
    ds_read_b64_tr_b16 v[38:39], v20 offset:2688
    v_mfma_f32_32x32x16_bf16 v[168:183], v[88:91], v[72:75], v[168:183]
    ds_read_b64_tr_b16 v[40:41], v20 offset:192
    ds_read_b64_tr_b16 v[42:43], v20 offset:2752
    ds_read_b64_tr_b16 v[44:45], v20 offset:256
    v_mfma_f32_32x32x16_bf16 v[184:199], v[92:95], v[72:75], v[184:199]
    ds_read_b64_tr_b16 v[46:47], v20 offset:2816
    ds_read_b128 v[48:51], v18 offset:1024
    ds_read_b64_tr_b16 v[52:53], v20 offset:5120
    v_mfma_f32_32x32x16_bf16 v[120:135], v[100:103], v[96:99], v[120:135]
    ds_read_b64_tr_b16 v[54:55], v20 offset:7680
    ds_read_b64_tr_b16 v[56:57], v20 offset:5184
    ds_read_b64_tr_b16 v[58:59], v20 offset:7744
    v_mfma_f32_32x32x16_bf16 v[136:151], v[104:107], v[96:99], v[136:151]
    ds_read_b64_tr_b16 v[60:61], v20 offset:5248
    ds_read_b64_tr_b16 v[62:63], v20 offset:7808
    ds_read_b64_tr_b16 v[64:65], v20 offset:5312
    v_mfma_f32_32x32x16_bf16 v[152:167], v[108:111], v[96:99], v[152:167]
    ds_read_b64_tr_b16 v[66:67], v20 offset:7872
    ds_read_b64_tr_b16 v[68:69], v20 offset:5376
    ds_read_b64_tr_b16 v[70:71], v20 offset:7936
    v_mfma_f32_32x32x16_bf16 v[168:183], v[112:115], v[96:99], v[168:183]
    v_mfma_f32_32x32x16_bf16 v[184:199], v[116:119], v[96:99], v[184:199]
    s_waitcnt lgkmcnt(0)
    v_mfma_f32_32x32x16_bf16 v[120:135], v[28:31], v[24:27], v[120:135]
    ds_read_b128 v[72:75], v18 offset:2048
    ds_read_b64_tr_b16 v[76:77], v20 offset:10240
    ds_read_b64_tr_b16 v[78:79], v20 offset:12800
    v_mfma_f32_32x32x16_bf16 v[136:151], v[32:35], v[24:27], v[136:151]
    ds_read_b64_tr_b16 v[80:81], v20 offset:10304
    ds_read_b64_tr_b16 v[82:83], v20 offset:12864
    ds_read_b64_tr_b16 v[84:85], v20 offset:10368
    v_mfma_f32_32x32x16_bf16 v[152:167], v[36:39], v[24:27], v[152:167]
    ds_read_b64_tr_b16 v[86:87], v20 offset:12928
    ds_read_b64_tr_b16 v[88:89], v20 offset:10432
    ds_read_b64_tr_b16 v[90:91], v20 offset:12992
    v_mfma_f32_32x32x16_bf16 v[168:183], v[40:43], v[24:27], v[168:183]
    ds_read_b64_tr_b16 v[92:93], v20 offset:10496
    ds_read_b64_tr_b16 v[94:95], v20 offset:13056
    ds_read_b128 v[96:99], v18 offset:3072
    v_mfma_f32_32x32x16_bf16 v[184:199], v[44:47], v[24:27], v[184:199]
    ds_read_b64_tr_b16 v[100:101], v20 offset:15360
    ds_read_b64_tr_b16 v[102:103], v20 offset:17920
    ds_read_b64_tr_b16 v[104:105], v20 offset:15424
    v_mfma_f32_32x32x16_bf16 v[120:135], v[52:55], v[48:51], v[120:135]
    ds_read_b64_tr_b16 v[106:107], v20 offset:17984
    ds_read_b64_tr_b16 v[108:109], v20 offset:15488
    ds_read_b64_tr_b16 v[110:111], v20 offset:18048
    v_mfma_f32_32x32x16_bf16 v[136:151], v[56:59], v[48:51], v[136:151]
    ds_read_b64_tr_b16 v[112:113], v20 offset:15552
    ds_read_b64_tr_b16 v[114:115], v20 offset:18112
    ds_read_b64_tr_b16 v[116:117], v20 offset:15616
    v_mfma_f32_32x32x16_bf16 v[152:167], v[60:63], v[48:51], v[152:167]
    ds_read_b64_tr_b16 v[118:119], v20 offset:18176
    v_mfma_f32_32x32x16_bf16 v[168:183], v[64:67], v[48:51], v[168:183]
    v_mfma_f32_32x32x16_bf16 v[184:199], v[68:71], v[48:51], v[184:199]
    s_waitcnt lgkmcnt(0)
    s_barrier
    v_mfma_f32_32x32x16_bf16 v[120:135], v[76:79], v[72:75], v[120:135]
    v_add_u32 v18, 73728, v17
    v_add_u32 v20, 73728, v19
    ds_read_b128 v[24:27], v18 offset:0
    v_mfma_f32_32x32x16_bf16 v[136:151], v[80:83], v[72:75], v[136:151]
    ds_read_b64_tr_b16 v[28:29], v20 offset:0
    ds_read_b64_tr_b16 v[30:31], v20 offset:2560
    ds_read_b64_tr_b16 v[32:33], v20 offset:64
    v_mfma_f32_32x32x16_bf16 v[152:167], v[84:87], v[72:75], v[152:167]
    ds_read_b64_tr_b16 v[34:35], v20 offset:2624
    ds_read_b64_tr_b16 v[36:37], v20 offset:128
    ds_read_b64_tr_b16 v[38:39], v20 offset:2688
    v_mfma_f32_32x32x16_bf16 v[168:183], v[88:91], v[72:75], v[168:183]
    ds_read_b64_tr_b16 v[40:41], v20 offset:192
    ds_read_b64_tr_b16 v[42:43], v20 offset:2752
    ds_read_b64_tr_b16 v[44:45], v20 offset:256
    v_mfma_f32_32x32x16_bf16 v[184:199], v[92:95], v[72:75], v[184:199]
    ds_read_b64_tr_b16 v[46:47], v20 offset:2816
    ds_read_b128 v[48:51], v18 offset:1024
    ds_read_b64_tr_b16 v[52:53], v20 offset:5120
    v_mfma_f32_32x32x16_bf16 v[120:135], v[100:103], v[96:99], v[120:135]
    ds_read_b64_tr_b16 v[54:55], v20 offset:7680
    ds_read_b64_tr_b16 v[56:57], v20 offset:5184
    ds_read_b64_tr_b16 v[58:59], v20 offset:7744
    v_mfma_f32_32x32x16_bf16 v[136:151], v[104:107], v[96:99], v[136:151]
    ds_read_b64_tr_b16 v[60:61], v20 offset:5248
    ds_read_b64_tr_b16 v[62:63], v20 offset:7808
    ds_read_b64_tr_b16 v[64:65], v20 offset:5312
    v_mfma_f32_32x32x16_bf16 v[152:167], v[108:111], v[96:99], v[152:167]
    ds_read_b64_tr_b16 v[66:67], v20 offset:7872
    ds_read_b64_tr_b16 v[68:69], v20 offset:5376
    ds_read_b64_tr_b16 v[70:71], v20 offset:7936
    v_mfma_f32_32x32x16_bf16 v[168:183], v[112:115], v[96:99], v[168:183]
    v_mfma_f32_32x32x16_bf16 v[184:199], v[116:119], v[96:99], v[184:199]
    s_waitcnt lgkmcnt(0)
    v_mfma_f32_32x32x16_bf16 v[120:135], v[28:31], v[24:27], v[120:135]
    ds_read_b128 v[72:75], v18 offset:2048
    ds_read_b64_tr_b16 v[76:77], v20 offset:10240
    ds_read_b64_tr_b16 v[78:79], v20 offset:12800
    v_mfma_f32_32x32x16_bf16 v[136:151], v[32:35], v[24:27], v[136:151]
    ds_read_b64_tr_b16 v[80:81], v20 offset:10304
    ds_read_b64_tr_b16 v[82:83], v20 offset:12864
    ds_read_b64_tr_b16 v[84:85], v20 offset:10368
    v_mfma_f32_32x32x16_bf16 v[152:167], v[36:39], v[24:27], v[152:167]
    ds_read_b64_tr_b16 v[86:87], v20 offset:12928
    ds_read_b64_tr_b16 v[88:89], v20 offset:10432
    ds_read_b64_tr_b16 v[90:91], v20 offset:12992
    v_mfma_f32_32x32x16_bf16 v[168:183], v[40:43], v[24:27], v[168:183]
    ds_read_b64_tr_b16 v[92:93], v20 offset:10496
    ds_read_b64_tr_b16 v[94:95], v20 offset:13056
    ds_read_b128 v[96:99], v18 offset:3072
    v_mfma_f32_32x32x16_bf16 v[184:199], v[44:47], v[24:27], v[184:199]
    ds_read_b64_tr_b16 v[100:101], v20 offset:15360
    ds_read_b64_tr_b16 v[102:103], v20 offset:17920
    ds_read_b64_tr_b16 v[104:105], v20 offset:15424
    v_mfma_f32_32x32x16_bf16 v[120:135], v[52:55], v[48:51], v[120:135]
    ds_read_b64_tr_b16 v[106:107], v20 offset:17984
    ds_read_b64_tr_b16 v[108:109], v20 offset:15488
    ds_read_b64_tr_b16 v[110:111], v20 offset:18048
    v_mfma_f32_32x32x16_bf16 v[136:151], v[56:59], v[48:51], v[136:151]
    ds_read_b64_tr_b16 v[112:113], v20 offset:15552
    ds_read_b64_tr_b16 v[114:115], v20 offset:18112
    ds_read_b64_tr_b16 v[116:117], v20 offset:15616
    v_mfma_f32_32x32x16_bf16 v[152:167], v[60:63], v[48:51], v[152:167]
    ds_read_b64_tr_b16 v[118:119], v20 offset:18176
    v_mfma_f32_32x32x16_bf16 v[168:183], v[64:67], v[48:51], v[168:183]
    v_mfma_f32_32x32x16_bf16 v[184:199], v[68:71], v[48:51], v[184:199]
    s_waitcnt lgkmcnt(0)
    s_barrier
    v_mfma_f32_32x32x16_bf16 v[120:135], v[76:79], v[72:75], v[120:135]
    v_add_u32 v18, 110592, v17
    v_add_u32 v20, 110592, v19
    ds_read_b128 v[24:27], v18 offset:0
    v_mfma_f32_32x32x16_bf16 v[136:151], v[80:83], v[72:75], v[136:151]
    ds_read_b64_tr_b16 v[28:29], v20 offset:0
    ds_read_b64_tr_b16 v[30:31], v20 offset:2560
    ds_read_b64_tr_b16 v[32:33], v20 offset:64
    v_mfma_f32_32x32x16_bf16 v[152:167], v[84:87], v[72:75], v[152:167]
    ds_read_b64_tr_b16 v[34:35], v20 offset:2624
    ds_read_b64_tr_b16 v[36:37], v20 offset:128
    ds_read_b64_tr_b16 v[38:39], v20 offset:2688
    v_mfma_f32_32x32x16_bf16 v[168:183], v[88:91], v[72:75], v[168:183]
    ds_read_b64_tr_b16 v[40:41], v20 offset:192
    ds_read_b64_tr_b16 v[42:43], v20 offset:2752
    ds_read_b64_tr_b16 v[44:45], v20 offset:256
    v_mfma_f32_32x32x16_bf16 v[184:199], v[92:95], v[72:75], v[184:199]
    ds_read_b64_tr_b16 v[46:47], v20 offset:2816
    ds_read_b128 v[48:51], v18 offset:1024
    ds_read_b64_tr_b16 v[52:53], v20 offset:5120
    v_mfma_f32_32x32x16_bf16 v[120:135], v[100:103], v[96:99], v[120:135]
    ds_read_b64_tr_b16 v[54:55], v20 offset:7680
    ds_read_b64_tr_b16 v[56:57], v20 offset:5184
    ds_read_b64_tr_b16 v[58:59], v20 offset:7744
    v_mfma_f32_32x32x16_bf16 v[136:151], v[104:107], v[96:99], v[136:151]
    ds_read_b64_tr_b16 v[60:61], v20 offset:5248
    ds_read_b64_tr_b16 v[62:63], v20 offset:7808
    ds_read_b64_tr_b16 v[64:65], v20 offset:5312
    v_mfma_f32_32x32x16_bf16 v[152:167], v[108:111], v[96:99], v[152:167]
    ds_read_b64_tr_b16 v[66:67], v20 offset:7872
    ds_read_b64_tr_b16 v[68:69], v20 offset:5376
    ds_read_b64_tr_b16 v[70:71], v20 offset:7936
    v_mfma_f32_32x32x16_bf16 v[168:183], v[112:115], v[96:99], v[168:183]
    v_mfma_f32_32x32x16_bf16 v[184:199], v[116:119], v[96:99], v[184:199]
    s_waitcnt lgkmcnt(0)
    v_mfma_f32_32x32x16_bf16 v[120:135], v[28:31], v[24:27], v[120:135]
    ds_read_b128 v[72:75], v18 offset:2048
    ds_read_b64_tr_b16 v[76:77], v20 offset:10240
    ds_read_b64_tr_b16 v[78:79], v20 offset:12800
    v_mfma_f32_32x32x16_bf16 v[136:151], v[32:35], v[24:27], v[136:151]
    ds_read_b64_tr_b16 v[80:81], v20 offset:10304
    ds_read_b64_tr_b16 v[82:83], v20 offset:12864
    ds_read_b64_tr_b16 v[84:85], v20 offset:10368
    v_mfma_f32_32x32x16_bf16 v[152:167], v[36:39], v[24:27], v[152:167]
    ds_read_b64_tr_b16 v[86:87], v20 offset:12928
    ds_read_b64_tr_b16 v[88:89], v20 offset:10432
    ds_read_b64_tr_b16 v[90:91], v20 offset:12992
    v_mfma_f32_32x32x16_bf16 v[168:183], v[40:43], v[24:27], v[168:183]
    ds_read_b64_tr_b16 v[92:93], v20 offset:10496
    ds_read_b64_tr_b16 v[94:95], v20 offset:13056
    ds_read_b128 v[96:99], v18 offset:3072
    v_mfma_f32_32x32x16_bf16 v[184:199], v[44:47], v[24:27], v[184:199]
    ds_read_b64_tr_b16 v[100:101], v20 offset:15360
    ds_read_b64_tr_b16 v[102:103], v20 offset:17920
    ds_read_b64_tr_b16 v[104:105], v20 offset:15424
    v_mfma_f32_32x32x16_bf16 v[120:135], v[52:55], v[48:51], v[120:135]
    ds_read_b64_tr_b16 v[106:107], v20 offset:17984
    ds_read_b64_tr_b16 v[108:109], v20 offset:15488
    ds_read_b64_tr_b16 v[110:111], v20 offset:18048
    v_mfma_f32_32x32x16_bf16 v[136:151], v[56:59], v[48:51], v[136:151]
    ds_read_b64_tr_b16 v[112:113], v20 offset:15552
    ds_read_b64_tr_b16 v[114:115], v20 offset:18112
    ds_read_b64_tr_b16 v[116:117], v20 offset:15616
    v_mfma_f32_32x32x16_bf16 v[152:167], v[60:63], v[48:51], v[152:167]
    ds_read_b64_tr_b16 v[118:119], v20 offset:18176
    v_mfma_f32_32x32x16_bf16 v[168:183], v[64:67], v[48:51], v[168:183]
    v_mfma_f32_32x32x16_bf16 v[184:199], v[68:71], v[48:51], v[184:199]
    s_waitcnt lgkmcnt(0)
    s_barrier
    v_mfma_f32_32x32x16_bf16 v[120:135], v[76:79], v[72:75], v[120:135]
    v_add_u32 v18, 0, v17
    v_add_u32 v20, 0, v19
    ds_read_b128 v[24:27], v18 offset:0
    v_mfma_f32_32x32x16_bf16 v[136:151], v[80:83], v[72:75], v[136:151]
    ds_read_b64_tr_b16 v[28:29], v20 offset:0
    ds_read_b64_tr_b16 v[30:31], v20 offset:2560
    ds_read_b64_tr_b16 v[32:33], v20 offset:64
    v_mfma_f32_32x32x16_bf16 v[152:167], v[84:87], v[72:75], v[152:167]
    ds_read_b64_tr_b16 v[34:35], v20 offset:2624
    ds_read_b64_tr_b16 v[36:37], v20 offset:128
    ds_read_b64_tr_b16 v[38:39], v20 offset:2688
    v_mfma_f32_32x32x16_bf16 v[168:183], v[88:91], v[72:75], v[168:183]
    ds_read_b64_tr_b16 v[40:41], v20 offset:192
    ds_read_b64_tr_b16 v[42:43], v20 offset:2752
    ds_read_b64_tr_b16 v[44:45], v20 offset:256
    v_mfma_f32_32x32x16_bf16 v[184:199], v[92:95], v[72:75], v[184:199]
    ds_read_b64_tr_b16 v[46:47], v20 offset:2816
    ds_read_b128 v[48:51], v18 offset:1024
    ds_read_b64_tr_b16 v[52:53], v20 offset:5120
    v_mfma_f32_32x32x16_bf16 v[120:135], v[100:103], v[96:99], v[120:135]
    ds_read_b64_tr_b16 v[54:55], v20 offset:7680
    ds_read_b64_tr_b16 v[56:57], v20 offset:5184
    ds_read_b64_tr_b16 v[58:59], v20 offset:7744
    v_mfma_f32_32x32x16_bf16 v[136:151], v[104:107], v[96:99], v[136:151]
    ds_read_b64_tr_b16 v[60:61], v20 offset:5248
    ds_read_b64_tr_b16 v[62:63], v20 offset:7808
    ds_read_b64_tr_b16 v[64:65], v20 offset:5312
    v_mfma_f32_32x32x16_bf16 v[152:167], v[108:111], v[96:99], v[152:167]
    ds_read_b64_tr_b16 v[66:67], v20 offset:7872
    ds_read_b64_tr_b16 v[68:69], v20 offset:5376
    ds_read_b64_tr_b16 v[70:71], v20 offset:7936
    v_mfma_f32_32x32x16_bf16 v[168:183], v[112:115], v[96:99], v[168:183]
    v_mfma_f32_32x32x16_bf16 v[184:199], v[116:119], v[96:99], v[184:199]
    s_waitcnt lgkmcnt(0)
    v_mfma_f32_32x32x16_bf16 v[120:135], v[28:31], v[24:27], v[120:135]
    ds_read_b128 v[72:75], v18 offset:2048
    ds_read_b64_tr_b16 v[76:77], v20 offset:10240
    ds_read_b64_tr_b16 v[78:79], v20 offset:12800
    v_mfma_f32_32x32x16_bf16 v[136:151], v[32:35], v[24:27], v[136:151]
    ds_read_b64_tr_b16 v[80:81], v20 offset:10304
    ds_read_b64_tr_b16 v[82:83], v20 offset:12864
    ds_read_b64_tr_b16 v[84:85], v20 offset:10368
    v_mfma_f32_32x32x16_bf16 v[152:167], v[36:39], v[24:27], v[152:167]
    ds_read_b64_tr_b16 v[86:87], v20 offset:12928
    ds_read_b64_tr_b16 v[88:89], v20 offset:10432
    ds_read_b64_tr_b16 v[90:91], v20 offset:12992
    v_mfma_f32_32x32x16_bf16 v[168:183], v[40:43], v[24:27], v[168:183]
    ds_read_b64_tr_b16 v[92:93], v20 offset:10496
    ds_read_b64_tr_b16 v[94:95], v20 offset:13056
    ds_read_b128 v[96:99], v18 offset:3072
    v_mfma_f32_32x32x16_bf16 v[184:199], v[44:47], v[24:27], v[184:199]
    ds_read_b64_tr_b16 v[100:101], v20 offset:15360
    ds_read_b64_tr_b16 v[102:103], v20 offset:17920
    ds_read_b64_tr_b16 v[104:105], v20 offset:15424
    v_mfma_f32_32x32x16_bf16 v[120:135], v[52:55], v[48:51], v[120:135]
    ds_read_b64_tr_b16 v[106:107], v20 offset:17984
    ds_read_b64_tr_b16 v[108:109], v20 offset:15488
    ds_read_b64_tr_b16 v[110:111], v20 offset:18048
    v_mfma_f32_32x32x16_bf16 v[136:151], v[56:59], v[48:51], v[136:151]
    ds_read_b64_tr_b16 v[112:113], v20 offset:15552
    ds_read_b64_tr_b16 v[114:115], v20 offset:18112
    ds_read_b64_tr_b16 v[116:117], v20 offset:15616
    v_mfma_f32_32x32x16_bf16 v[152:167], v[60:63], v[48:51], v[152:167]
    ds_read_b64_tr_b16 v[118:119], v20 offset:18176
    v_mfma_f32_32x32x16_bf16 v[168:183], v[64:67], v[48:51], v[168:183]
    v_mfma_f32_32x32x16_bf16 v[184:199], v[68:71], v[48:51], v[184:199]
    s_waitcnt lgkmcnt(0)
    s_barrier
    v_mfma_f32_32x32x16_bf16 v[120:135], v[76:79], v[72:75], v[120:135]
    v_add_u32 v18, 36864, v17
    v_add_u32 v20, 36864, v19
    ds_read_b128 v[24:27], v18 offset:0
    v_mfma_f32_32x32x16_bf16 v[136:151], v[80:83], v[72:75], v[136:151]
    ds_read_b64_tr_b16 v[28:29], v20 offset:0
    ds_read_b64_tr_b16 v[30:31], v20 offset:2560
    ds_read_b64_tr_b16 v[32:33], v20 offset:64
    v_mfma_f32_32x32x16_bf16 v[152:167], v[84:87], v[72:75], v[152:167]
    ds_read_b64_tr_b16 v[34:35], v20 offset:2624
    ds_read_b64_tr_b16 v[36:37], v20 offset:128
    ds_read_b64_tr_b16 v[38:39], v20 offset:2688
    v_mfma_f32_32x32x16_bf16 v[168:183], v[88:91], v[72:75], v[168:183]
    ds_read_b64_tr_b16 v[40:41], v20 offset:192
    ds_read_b64_tr_b16 v[42:43], v20 offset:2752
    ds_read_b64_tr_b16 v[44:45], v20 offset:256
    v_mfma_f32_32x32x16_bf16 v[184:199], v[92:95], v[72:75], v[184:199]
    ds_read_b64_tr_b16 v[46:47], v20 offset:2816
    ds_read_b128 v[48:51], v18 offset:1024
    ds_read_b64_tr_b16 v[52:53], v20 offset:5120
    v_mfma_f32_32x32x16_bf16 v[120:135], v[100:103], v[96:99], v[120:135]
    ds_read_b64_tr_b16 v[54:55], v20 offset:7680
    ds_read_b64_tr_b16 v[56:57], v20 offset:5184
    ds_read_b64_tr_b16 v[58:59], v20 offset:7744
    v_mfma_f32_32x32x16_bf16 v[136:151], v[104:107], v[96:99], v[136:151]
    ds_read_b64_tr_b16 v[60:61], v20 offset:5248
    ds_read_b64_tr_b16 v[62:63], v20 offset:7808
    ds_read_b64_tr_b16 v[64:65], v20 offset:5312
    v_mfma_f32_32x32x16_bf16 v[152:167], v[108:111], v[96:99], v[152:167]
    ds_read_b64_tr_b16 v[66:67], v20 offset:7872
    ds_read_b64_tr_b16 v[68:69], v20 offset:5376
    ds_read_b64_tr_b16 v[70:71], v20 offset:7936
    v_mfma_f32_32x32x16_bf16 v[168:183], v[112:115], v[96:99], v[168:183]
    v_mfma_f32_32x32x16_bf16 v[184:199], v[116:119], v[96:99], v[184:199]
    s_waitcnt lgkmcnt(0)
    v_mfma_f32_32x32x16_bf16 v[120:135], v[28:31], v[24:27], v[120:135]
    ds_read_b128 v[72:75], v18 offset:2048
    ds_read_b64_tr_b16 v[76:77], v20 offset:10240
    ds_read_b64_tr_b16 v[78:79], v20 offset:12800
    v_mfma_f32_32x32x16_bf16 v[136:151], v[32:35], v[24:27], v[136:151]
    ds_read_b64_tr_b16 v[80:81], v20 offset:10304
    ds_read_b64_tr_b16 v[82:83], v20 offset:12864
    ds_read_b64_tr_b16 v[84:85], v20 offset:10368
    v_mfma_f32_32x32x16_bf16 v[152:167], v[36:39], v[24:27], v[152:167]
    ds_read_b64_tr_b16 v[86:87], v20 offset:12928
    ds_read_b64_tr_b16 v[88:89], v20 offset:10432
    ds_read_b64_tr_b16 v[90:91], v20 offset:12992
    v_mfma_f32_32x32x16_bf16 v[168:183], v[40:43], v[24:27], v[168:183]
    ds_read_b64_tr_b16 v[92:93], v20 offset:10496
    ds_read_b64_tr_b16 v[94:95], v20 offset:13056
    ds_read_b128 v[96:99], v18 offset:3072
    v_mfma_f32_32x32x16_bf16 v[184:199], v[44:47], v[24:27], v[184:199]
    ds_read_b64_tr_b16 v[100:101], v20 offset:15360
    ds_read_b64_tr_b16 v[102:103], v20 offset:17920
    ds_read_b64_tr_b16 v[104:105], v20 offset:15424
    v_mfma_f32_32x32x16_bf16 v[120:135], v[52:55], v[48:51], v[120:135]
    ds_read_b64_tr_b16 v[106:107], v20 offset:17984
    ds_read_b64_tr_b16 v[108:109], v20 offset:15488
    ds_read_b64_tr_b16 v[110:111], v20 offset:18048
    v_mfma_f32_32x32x16_bf16 v[136:151], v[56:59], v[48:51], v[136:151]
    ds_read_b64_tr_b16 v[112:113], v20 offset:15552
    ds_read_b64_tr_b16 v[114:115], v20 offset:18112
    ds_read_b64_tr_b16 v[116:117], v20 offset:15616
    v_mfma_f32_32x32x16_bf16 v[152:167], v[60:63], v[48:51], v[152:167]
    ds_read_b64_tr_b16 v[118:119], v20 offset:18176
    v_mfma_f32_32x32x16_bf16 v[168:183], v[64:67], v[48:51], v[168:183]
    v_mfma_f32_32x32x16_bf16 v[184:199], v[68:71], v[48:51], v[184:199]
    s_waitcnt lgkmcnt(0)
    s_barrier
    v_mfma_f32_32x32x16_bf16 v[120:135], v[76:79], v[72:75], v[120:135]
    v_add_u32 v18, 73728, v17
    v_add_u32 v20, 73728, v19
    ds_read_b128 v[24:27], v18 offset:0
    v_mfma_f32_32x32x16_bf16 v[136:151], v[80:83], v[72:75], v[136:151]
    ds_read_b64_tr_b16 v[28:29], v20 offset:0
    ds_read_b64_tr_b16 v[30:31], v20 offset:2560
    ds_read_b64_tr_b16 v[32:33], v20 offset:64
    v_mfma_f32_32x32x16_bf16 v[152:167], v[84:87], v[72:75], v[152:167]
    ds_read_b64_tr_b16 v[34:35], v20 offset:2624
    ds_read_b64_tr_b16 v[36:37], v20 offset:128
    ds_read_b64_tr_b16 v[38:39], v20 offset:2688
    v_mfma_f32_32x32x16_bf16 v[168:183], v[88:91], v[72:75], v[168:183]
    ds_read_b64_tr_b16 v[40:41], v20 offset:192
    ds_read_b64_tr_b16 v[42:43], v20 offset:2752
    ds_read_b64_tr_b16 v[44:45], v20 offset:256
    v_mfma_f32_32x32x16_bf16 v[184:199], v[92:95], v[72:75], v[184:199]
    ds_read_b64_tr_b16 v[46:47], v20 offset:2816
    ds_read_b128 v[48:51], v18 offset:1024
    ds_read_b64_tr_b16 v[52:53], v20 offset:5120
    v_mfma_f32_32x32x16_bf16 v[120:135], v[100:103], v[96:99], v[120:135]
    ds_read_b64_tr_b16 v[54:55], v20 offset:7680
    ds_read_b64_tr_b16 v[56:57], v20 offset:5184
    ds_read_b64_tr_b16 v[58:59], v20 offset:7744
    v_mfma_f32_32x32x16_bf16 v[136:151], v[104:107], v[96:99], v[136:151]
    ds_read_b64_tr_b16 v[60:61], v20 offset:5248
    ds_read_b64_tr_b16 v[62:63], v20 offset:7808
    ds_read_b64_tr_b16 v[64:65], v20 offset:5312
    v_mfma_f32_32x32x16_bf16 v[152:167], v[108:111], v[96:99], v[152:167]
    ds_read_b64_tr_b16 v[66:67], v20 offset:7872
    ds_read_b64_tr_b16 v[68:69], v20 offset:5376
    ds_read_b64_tr_b16 v[70:71], v20 offset:7936
    v_mfma_f32_32x32x16_bf16 v[168:183], v[112:115], v[96:99], v[168:183]
    v_mfma_f32_32x32x16_bf16 v[184:199], v[116:119], v[96:99], v[184:199]
    s_waitcnt lgkmcnt(0)
    v_mfma_f32_32x32x16_bf16 v[120:135], v[28:31], v[24:27], v[120:135]
    ds_read_b128 v[72:75], v18 offset:2048
    ds_read_b64_tr_b16 v[76:77], v20 offset:10240
    ds_read_b64_tr_b16 v[78:79], v20 offset:12800
    v_mfma_f32_32x32x16_bf16 v[136:151], v[32:35], v[24:27], v[136:151]
    ds_read_b64_tr_b16 v[80:81], v20 offset:10304
    ds_read_b64_tr_b16 v[82:83], v20 offset:12864
    ds_read_b64_tr_b16 v[84:85], v20 offset:10368
    v_mfma_f32_32x32x16_bf16 v[152:167], v[36:39], v[24:27], v[152:167]
    ds_read_b64_tr_b16 v[86:87], v20 offset:12928
    ds_read_b64_tr_b16 v[88:89], v20 offset:10432
    ds_read_b64_tr_b16 v[90:91], v20 offset:12992
    v_mfma_f32_32x32x16_bf16 v[168:183], v[40:43], v[24:27], v[168:183]
    ds_read_b64_tr_b16 v[92:93], v20 offset:10496
    ds_read_b64_tr_b16 v[94:95], v20 offset:13056
    ds_read_b128 v[96:99], v18 offset:3072
    v_mfma_f32_32x32x16_bf16 v[184:199], v[44:47], v[24:27], v[184:199]
    ds_read_b64_tr_b16 v[100:101], v20 offset:15360
    ds_read_b64_tr_b16 v[102:103], v20 offset:17920
    ds_read_b64_tr_b16 v[104:105], v20 offset:15424
    v_mfma_f32_32x32x16_bf16 v[120:135], v[52:55], v[48:51], v[120:135]
    ds_read_b64_tr_b16 v[106:107], v20 offset:17984
    ds_read_b64_tr_b16 v[108:109], v20 offset:15488
    ds_read_b64_tr_b16 v[110:111], v20 offset:18048
    v_mfma_f32_32x32x16_bf16 v[136:151], v[56:59], v[48:51], v[136:151]
    ds_read_b64_tr_b16 v[112:113], v20 offset:15552
    ds_read_b64_tr_b16 v[114:115], v20 offset:18112
    ds_read_b64_tr_b16 v[116:117], v20 offset:15616
    v_mfma_f32_32x32x16_bf16 v[152:167], v[60:63], v[48:51], v[152:167]
    ds_read_b64_tr_b16 v[118:119], v20 offset:18176
    v_mfma_f32_32x32x16_bf16 v[168:183], v[64:67], v[48:51], v[168:183]
    v_mfma_f32_32x32x16_bf16 v[184:199], v[68:71], v[48:51], v[184:199]
    s_waitcnt lgkmcnt(0)
    s_barrier
    v_mfma_f32_32x32x16_bf16 v[120:135], v[76:79], v[72:75], v[120:135]
    v_add_u32 v18, 110592, v17
    v_add_u32 v20, 110592, v19
    ds_read_b128 v[24:27], v18 offset:0
    v_mfma_f32_32x32x16_bf16 v[136:151], v[80:83], v[72:75], v[136:151]
    ds_read_b64_tr_b16 v[28:29], v20 offset:0
    ds_read_b64_tr_b16 v[30:31], v20 offset:2560
    ds_read_b64_tr_b16 v[32:33], v20 offset:64
    v_mfma_f32_32x32x16_bf16 v[152:167], v[84:87], v[72:75], v[152:167]
    ds_read_b64_tr_b16 v[34:35], v20 offset:2624
    ds_read_b64_tr_b16 v[36:37], v20 offset:128
    ds_read_b64_tr_b16 v[38:39], v20 offset:2688
    v_mfma_f32_32x32x16_bf16 v[168:183], v[88:91], v[72:75], v[168:183]
    ds_read_b64_tr_b16 v[40:41], v20 offset:192
    ds_read_b64_tr_b16 v[42:43], v20 offset:2752
    ds_read_b64_tr_b16 v[44:45], v20 offset:256
    v_mfma_f32_32x32x16_bf16 v[184:199], v[92:95], v[72:75], v[184:199]
    ds_read_b64_tr_b16 v[46:47], v20 offset:2816
    ds_read_b128 v[48:51], v18 offset:1024
    ds_read_b64_tr_b16 v[52:53], v20 offset:5120
    v_mfma_f32_32x32x16_bf16 v[120:135], v[100:103], v[96:99], v[120:135]
    ds_read_b64_tr_b16 v[54:55], v20 offset:7680
    ds_read_b64_tr_b16 v[56:57], v20 offset:5184
    ds_read_b64_tr_b16 v[58:59], v20 offset:7744
    v_mfma_f32_32x32x16_bf16 v[136:151], v[104:107], v[96:99], v[136:151]
    ds_read_b64_tr_b16 v[60:61], v20 offset:5248
    ds_read_b64_tr_b16 v[62:63], v20 offset:7808
    ds_read_b64_tr_b16 v[64:65], v20 offset:5312
    v_mfma_f32_32x32x16_bf16 v[152:167], v[108:111], v[96:99], v[152:167]
    ds_read_b64_tr_b16 v[66:67], v20 offset:7872
    ds_read_b64_tr_b16 v[68:69], v20 offset:5376
    ds_read_b64_tr_b16 v[70:71], v20 offset:7936
    v_mfma_f32_32x32x16_bf16 v[168:183], v[112:115], v[96:99], v[168:183]
    v_mfma_f32_32x32x16_bf16 v[184:199], v[116:119], v[96:99], v[184:199]
    s_waitcnt lgkmcnt(0)
    v_mfma_f32_32x32x16_bf16 v[120:135], v[28:31], v[24:27], v[120:135]
    ds_read_b128 v[72:75], v18 offset:2048
    ds_read_b64_tr_b16 v[76:77], v20 offset:10240
    ds_read_b64_tr_b16 v[78:79], v20 offset:12800
    v_mfma_f32_32x32x16_bf16 v[136:151], v[32:35], v[24:27], v[136:151]
    ds_read_b64_tr_b16 v[80:81], v20 offset:10304
    ds_read_b64_tr_b16 v[82:83], v20 offset:12864
    ds_read_b64_tr_b16 v[84:85], v20 offset:10368
    v_mfma_f32_32x32x16_bf16 v[152:167], v[36:39], v[24:27], v[152:167]
    ds_read_b64_tr_b16 v[86:87], v20 offset:12928
    ds_read_b64_tr_b16 v[88:89], v20 offset:10432
    ds_read_b64_tr_b16 v[90:91], v20 offset:12992
    v_mfma_f32_32x32x16_bf16 v[168:183], v[40:43], v[24:27], v[168:183]
    ds_read_b64_tr_b16 v[92:93], v20 offset:10496
    ds_read_b64_tr_b16 v[94:95], v20 offset:13056
    ds_read_b128 v[96:99], v18 offset:3072
    v_mfma_f32_32x32x16_bf16 v[184:199], v[44:47], v[24:27], v[184:199]
    ds_read_b64_tr_b16 v[100:101], v20 offset:15360
    ds_read_b64_tr_b16 v[102:103], v20 offset:17920
    ds_read_b64_tr_b16 v[104:105], v20 offset:15424
    v_mfma_f32_32x32x16_bf16 v[120:135], v[52:55], v[48:51], v[120:135]
    ds_read_b64_tr_b16 v[106:107], v20 offset:17984
    ds_read_b64_tr_b16 v[108:109], v20 offset:15488
    ds_read_b64_tr_b16 v[110:111], v20 offset:18048
    v_mfma_f32_32x32x16_bf16 v[136:151], v[56:59], v[48:51], v[136:151]
    ds_read_b64_tr_b16 v[112:113], v20 offset:15552
    ds_read_b64_tr_b16 v[114:115], v20 offset:18112
    ds_read_b64_tr_b16 v[116:117], v20 offset:15616
    v_mfma_f32_32x32x16_bf16 v[152:167], v[60:63], v[48:51], v[152:167]
    ds_read_b64_tr_b16 v[118:119], v20 offset:18176
    v_mfma_f32_32x32x16_bf16 v[168:183], v[64:67], v[48:51], v[168:183]
    v_mfma_f32_32x32x16_bf16 v[184:199], v[68:71], v[48:51], v[184:199]
    s_waitcnt lgkmcnt(0)
    v_mfma_f32_32x32x16_bf16 v[120:135], v[76:79], v[72:75], v[120:135]
    v_mfma_f32_32x32x16_bf16 v[136:151], v[80:83], v[72:75], v[136:151]
    v_mfma_f32_32x32x16_bf16 v[152:167], v[84:87], v[72:75], v[152:167]
    v_mfma_f32_32x32x16_bf16 v[168:183], v[88:91], v[72:75], v[168:183]
    v_mfma_f32_32x32x16_bf16 v[184:199], v[92:95], v[72:75], v[184:199]
    v_mfma_f32_32x32x16_bf16 v[120:135], v[100:103], v[96:99], v[120:135]
    v_mfma_f32_32x32x16_bf16 v[136:151], v[104:107], v[96:99], v[136:151]
    v_mfma_f32_32x32x16_bf16 v[152:167], v[108:111], v[96:99], v[152:167]
    v_mfma_f32_32x32x16_bf16 v[168:183], v[112:115], v[96:99], v[168:183]
    v_mfma_f32_32x32x16_bf16 v[184:199], v[116:119], v[96:99], v[184:199]
    s_nop 7
    s_nop 7
    v_cvt_pk_bf16_f32 v120, v120, v121
    v_cvt_pk_bf16_f32 v121, v122, v123
    v_cvt_pk_bf16_f32 v122, v124, v125
    v_cvt_pk_bf16_f32 v123, v126, v127
    buffer_store_dwordx4 v[120:123], v7, s[24:27], s60 offen offset:0
    v_cvt_pk_bf16_f32 v128, v128, v129
    v_cvt_pk_bf16_f32 v129, v130, v131
    v_cvt_pk_bf16_f32 v130, v132, v133
    v_cvt_pk_bf16_f32 v131, v134, v135
    buffer_store_dwordx4 v[128:131], v7, s[24:27], s60 offen offset:1024
    v_cvt_pk_bf16_f32 v136, v136, v137
    v_cvt_pk_bf16_f32 v137, v138, v139
    v_cvt_pk_bf16_f32 v138, v140, v141
    v_cvt_pk_bf16_f32 v139, v142, v143
    buffer_store_dwordx4 v[136:139], v7, s[24:27], s60 offen offset:2048
    v_cvt_pk_bf16_f32 v144, v144, v145
    v_cvt_pk_bf16_f32 v145, v146, v147
    v_cvt_pk_bf16_f32 v146, v148, v149
    v_cvt_pk_bf16_f32 v147, v150, v151
    buffer_store_dwordx4 v[144:147], v7, s[24:27], s60 offen offset:3072
    v_cvt_pk_bf16_f32 v152, v152, v153
    v_cvt_pk_bf16_f32 v153, v154, v155
    v_cvt_pk_bf16_f32 v154, v156, v157
    v_cvt_pk_bf16_f32 v155, v158, v159
    buffer_store_dwordx4 v[152:155], v7, s[24:27], s61 offen offset:0
    v_cvt_pk_bf16_f32 v160, v160, v161
    v_cvt_pk_bf16_f32 v161, v162, v163
    v_cvt_pk_bf16_f32 v162, v164, v165
    v_cvt_pk_bf16_f32 v163, v166, v167
    buffer_store_dwordx4 v[160:163], v7, s[24:27], s61 offen offset:1024
    v_cvt_pk_bf16_f32 v168, v168, v169
    v_cvt_pk_bf16_f32 v169, v170, v171
    v_cvt_pk_bf16_f32 v170, v172, v173
    v_cvt_pk_bf16_f32 v171, v174, v175
    buffer_store_dwordx4 v[168:171], v7, s[24:27], s61 offen offset:2048
    v_cvt_pk_bf16_f32 v176, v176, v177
    v_cvt_pk_bf16_f32 v177, v178, v179
    v_cvt_pk_bf16_f32 v178, v180, v181
    v_cvt_pk_bf16_f32 v179, v182, v183
    buffer_store_dwordx4 v[176:179], v7, s[24:27], s61 offen offset:3072
    v_cvt_pk_bf16_f32 v184, v184, v185
    v_cvt_pk_bf16_f32 v185, v186, v187
    v_cvt_pk_bf16_f32 v186, v188, v189
    v_cvt_pk_bf16_f32 v187, v190, v191
    buffer_store_dwordx4 v[184:187], v7, s[24:27], s62 offen offset:0
    v_cvt_pk_bf16_f32 v192, v192, v193
    v_cvt_pk_bf16_f32 v193, v194, v195
    v_cvt_pk_bf16_f32 v194, v196, v197
    v_cvt_pk_bf16_f32 v195, v198, v199
    buffer_store_dwordx4 v[192:195], v7, s[24:27], s62 offen offset:1024
Lop_end:
    s_endpgm
.globl ln2_kernel
.p2align 8
.type ln2_kernel,@function
ln2_kernel:
    s_cmp_ge_u32 s2, 256
    s_cbranch_scc1 Lln_end
    s_load_dwordx2 s[4:5], s[0:1], 0
    s_load_dwordx2 s[12:13], s[0:1], 104
    v_lshrrev_b32 v1, 6, v0
    s_nop 0
    v_readfirstlane_b32 s40, v1
    s_lshl_b32 s3, s2, 2
    s_add_u32 s3, s3, s40
    v_and_b32 v1, 7, v0
    v_bfe_u32 v2, v0, 3, 3
    v_lshlrev_b32 v3, 3, v1
    v_lshl_add_u32 v3, v2, 10, v3
    s_lshr_b32 s41, s3, 4
    s_mul_i32 s41, s41, 40960
    s_and_b32 s42, s3, 15
    s_lshl_b32 s42, s42, 6
    s_add_u32 s41, s41, s42
    v_bfe_u32 v5, v0, 1, 1
    v_lshlrev_b32 v5, 3, v5
    v_and_b32 v4, 1, v0
    v_lshl_add_u32 v5, v4, 4, v5
    v_lshrrev_b32 v1, 2, v1
    v_mul_u32_u24 v4, 1280, v1
    v_add_u32 v4, v4, v5
    v_lshl_add_u32 v4, v2, 5, v4
    s_mul_i32 s43, s3, 2560
    s_waitcnt lgkmcnt(0)
    s_add_u32 s16, s12, 67108864
    s_addc_u32 s17, s13, 0
    s_mov_b32 s18, 10485760
    s_mov_b32 s19, 0x00020000
    s_mov_b32 s20, s4
    s_mov_b32 s21, s5
    s_mov_b32 s22, 2621440
    s_mov_b32 s23, 0x00020000
    s_add_u32 s44, s41, 0
    buffer_load_dwordx2 v[28:29], v3, s[16:19], s44 offen
    s_add_u32 s44, s41, 8192
    buffer_load_dwordx2 v[30:31], v3, s[16:19], s44 offen
    s_add_u32 s44, s41, 16384
    buffer_load_dwordx2 v[32:33], v3, s[16:19], s44 offen
    s_add_u32 s44, s41, 24576
    buffer_load_dwordx2 v[34:35], v3, s[16:19], s44 offen
    s_add_u32 s44, s41, 32768
    buffer_load_dwordx2 v[36:37], v3, s[16:19], s44 offen
    s_add_u32 s44, s41, 2621440
    buffer_load_dwordx2 v[38:39], v3, s[16:19], s44 offen
    s_add_u32 s44, s41, 2629632
    buffer_load_dwordx2 v[40:41], v3, s[16:19], s44 offen
    s_add_u32 s44, s41, 2637824
    buffer_load_dwordx2 v[42:43], v3, s[16:19], s44 offen
    s_add_u32 s44, s41, 2646016
    buffer_load_dwordx2 v[44:45], v3, s[16:19], s44 offen
    s_add_u32 s44, s41, 2654208
    buffer_load_dwordx2 v[46:47], v3, s[16:19], s44 offen
    s_add_u32 s44, s41, 5242880
    buffer_load_dwordx2 v[48:49], v3, s[16:19], s44 offen
    s_add_u32 s44, s41, 5251072
    buffer_load_dwordx2 v[50:51], v3, s[16:19], s44 offen
    s_add_u32 s44, s41, 5259264
    buffer_load_dwordx2 v[52:53], v3, s[16:19], s44 offen
    s_add_u32 s44, s41, 5267456
    buffer_load_dwordx2 v[54:55], v3, s[16:19], s44 offen
    s_add_u32 s44, s41, 5275648
    buffer_load_dwordx2 v[56:57], v3, s[16:19], s44 offen
    s_add_u32 s44, s41, 7864320
    buffer_load_dwordx2 v[58:59], v3, s[16:19], s44 offen
    s_add_u32 s44, s41, 7872512
    buffer_load_dwordx2 v[60:61], v3, s[16:19], s44 offen
    s_add_u32 s44, s41, 7880704
    buffer_load_dwordx2 v[62:63], v3, s[16:19], s44 offen
    s_add_u32 s44, s41, 7888896
    buffer_load_dwordx2 v[64:65], v3, s[16:19], s44 offen
    s_add_u32 s44, s41, 7897088
    buffer_load_dwordx2 v[66:67], v3, s[16:19], s44 offen
    buffer_load_dwordx2 v[68:69], v4, s[20:23], s43 offen offset:0
    buffer_load_dwordx2 v[70:71], v4, s[20:23], s43 offen offset:256
    buffer_load_dwordx2 v[72:73], v4, s[20:23], s43 offen offset:512
    buffer_load_dwordx2 v[74:75], v4, s[20:23], s43 offen offset:768
    buffer_load_dwordx2 v[76:77], v4, s[20:23], s43 offen offset:1024
    s_add_u32 s24, s12, 117440512
    s_addc_u32 s25, s13, 0
    s_mov_b32 s26, 2621440
    s_mov_b32 s27, 0x00020000
    s_add_u32 s28, s12, 121634816
    s_addc_u32 s29, s13, 0
    s_mov_b32 s30, 2621440
    s_mov_b32 s31, 0x00020000
    v_mul_u32_u24 v6, 160, v1
    v_add_u32 v6, v6, v5
    s_mul_i32 s45, s3, 320
    s_mov_b32 s46, 327520
    v_add_u32 v7, 0, v2
    v_lshl_add_u32 v90, v7, 5, v6
    v_mul_u32_u24 v7, 52, v7
    v_lshrrev_b32 v7, 8, v7
    v_mad_u32_u24 v90, v7, s46, v90
    v_add_u32 v7, 8, v2
    v_lshl_add_u32 v91, v7, 5, v6
    v_mul_u32_u24 v7, 52, v7
    v_lshrrev_b32 v7, 8, v7
    v_mad_u32_u24 v91, v7, s46, v91
    v_add_u32 v7, 16, v2
    v_lshl_add_u32 v92, v7, 5, v6
    v_mul_u32_u24 v7, 52, v7
    v_lshrrev_b32 v7, 8, v7
    v_mad_u32_u24 v92, v7, s46, v92
    v_add_u32 v7, 24, v2
    v_lshl_add_u32 v93, v7, 5, v6
    v_mul_u32_u24 v7, 52, v7
    v_lshrrev_b32 v7, 8, v7
    v_mad_u32_u24 v93, v7, s46, v93
    v_add_u32 v7, 32, v2
    v_lshl_add_u32 v94, v7, 5, v6
    v_mul_u32_u24 v7, 52, v7
    v_lshrrev_b32 v7, 8, v7
    v_mad_u32_u24 v94, v7, s46, v94
    s_waitcnt vmcnt(20)
    v_lshlrev_b32 v8, 16, v28
    v_and_b32 v9, 0xffff0000, v28
    v_lshlrev_b32 v10, 16, v29
    v_and_b32 v11, 0xffff0000, v29
    v_lshlrev_b32 v12, 16, v30
    v_and_b32 v13, 0xffff0000, v30
    v_lshlrev_b32 v14, 16, v31
    v_and_b32 v15, 0xffff0000, v31
    v_lshlrev_b32 v16, 16, v32
    v_and_b32 v17, 0xffff0000, v32
    v_lshlrev_b32 v18, 16, v33
    v_and_b32 v19, 0xffff0000, v33
    v_lshlrev_b32 v20, 16, v34
    v_and_b32 v21, 0xffff0000, v34
    v_lshlrev_b32 v22, 16, v35
    v_and_b32 v23, 0xffff0000, v35
    v_lshlrev_b32 v24, 16, v36
    v_and_b32 v25, 0xffff0000, v36
    v_lshlrev_b32 v26, 16, v37
    v_and_b32 v27, 0xffff0000, v37
    s_waitcnt vmcnt(15)
    v_lshlrev_b32 v88, 16, v38
    v_and_b32 v89, 0xffff0000, v38
    v_pk_add_f32 v[8:9], v[8:9], v[88:89]
    v_lshlrev_b32 v6, 16, v39
    v_and_b32 v7, 0xffff0000, v39
    v_pk_add_f32 v[10:11], v[10:11], v[6:7]
    v_lshlrev_b32 v88, 16, v40
    v_and_b32 v89, 0xffff0000, v40
    v_pk_add_f32 v[12:13], v[12:13], v[88:89]
    v_lshlrev_b32 v6, 16, v41
    v_and_b32 v7, 0xffff0000, v41
    v_pk_add_f32 v[14:15], v[14:15], v[6:7]
    v_lshlrev_b32 v88, 16, v42
    v_and_b32 v89, 0xffff0000, v42
    v_pk_add_f32 v[16:17], v[16:17], v[88:89]
    v_lshlrev_b32 v6, 16, v43
    v_and_b32 v7, 0xffff0000, v43
    v_pk_add_f32 v[18:19], v[18:19], v[6:7]
    v_lshlrev_b32 v88, 16, v44
    v_and_b32 v89, 0xffff0000, v44
    v_pk_add_f32 v[20:21], v[20:21], v[88:89]
    v_lshlrev_b32 v6, 16, v45
    v_and_b32 v7, 0xffff0000, v45
    v_pk_add_f32 v[22:23], v[22:23], v[6:7]
    v_lshlrev_b32 v88, 16, v46
    v_and_b32 v89, 0xffff0000, v46
    v_pk_add_f32 v[24:25], v[24:25], v[88:89]
    v_lshlrev_b32 v6, 16, v47
    v_and_b32 v7, 0xffff0000, v47
    v_pk_add_f32 v[26:27], v[26:27], v[6:7]
    s_waitcnt vmcnt(10)
    v_lshlrev_b32 v88, 16, v48
    v_and_b32 v89, 0xffff0000, v48
    v_pk_add_f32 v[8:9], v[8:9], v[88:89]
    v_lshlrev_b32 v6, 16, v49
    v_and_b32 v7, 0xffff0000, v49
    v_pk_add_f32 v[10:11], v[10:11], v[6:7]
    v_lshlrev_b32 v88, 16, v50
    v_and_b32 v89, 0xffff0000, v50
    v_pk_add_f32 v[12:13], v[12:13], v[88:89]
    v_lshlrev_b32 v6, 16, v51
    v_and_b32 v7, 0xffff0000, v51
    v_pk_add_f32 v[14:15], v[14:15], v[6:7]
    v_lshlrev_b32 v88, 16, v52
    v_and_b32 v89, 0xffff0000, v52
    v_pk_add_f32 v[16:17], v[16:17], v[88:89]
    v_lshlrev_b32 v6, 16, v53
    v_and_b32 v7, 0xffff0000, v53
    v_pk_add_f32 v[18:19], v[18:19], v[6:7]
    v_lshlrev_b32 v88, 16, v54
    v_and_b32 v89, 0xffff0000, v54
    v_pk_add_f32 v[20:21], v[20:21], v[88:89]
    v_lshlrev_b32 v6, 16, v55
    v_and_b32 v7, 0xffff0000, v55
    v_pk_add_f32 v[22:23], v[22:23], v[6:7]
    v_lshlrev_b32 v88, 16, v56
    v_and_b32 v89, 0xffff0000, v56
    v_pk_add_f32 v[24:25], v[24:25], v[88:89]
    v_lshlrev_b32 v6, 16, v57
    v_and_b32 v7, 0xffff0000, v57
    v_pk_add_f32 v[26:27], v[26:27], v[6:7]
    s_waitcnt vmcnt(5)
    v_lshlrev_b32 v88, 16, v58
    v_and_b32 v89, 0xffff0000, v58
    v_pk_add_f32 v[8:9], v[8:9], v[88:89]
    v_lshlrev_b32 v6, 16, v59
    v_and_b32 v7, 0xffff0000, v59
    v_pk_add_f32 v[10:11], v[10:11], v[6:7]
    v_lshlrev_b32 v88, 16, v60
    v_and_b32 v89, 0xffff0000, v60
    v_pk_add_f32 v[12:13], v[12:13], v[88:89]
    v_lshlrev_b32 v6, 16, v61
    v_and_b32 v7, 0xffff0000, v61
    v_pk_add_f32 v[14:15], v[14:15], v[6:7]
    v_lshlrev_b32 v88, 16, v62
    v_and_b32 v89, 0xffff0000, v62
    v_pk_add_f32 v[16:17], v[16:17], v[88:89]
    v_lshlrev_b32 v6, 16, v63
    v_and_b32 v7, 0xffff0000, v63
    v_pk_add_f32 v[18:19], v[18:19], v[6:7]
    v_lshlrev_b32 v88, 16, v64
    v_and_b32 v89, 0xffff0000, v64
    v_pk_add_f32 v[20:21], v[20:21], v[88:89]
    v_lshlrev_b32 v6, 16, v65
    v_and_b32 v7, 0xffff0000, v65
    v_pk_add_f32 v[22:23], v[22:23], v[6:7]
    v_lshlrev_b32 v88, 16, v66
    v_and_b32 v89, 0xffff0000, v66
    v_pk_add_f32 v[24:25], v[24:25], v[88:89]
    v_lshlrev_b32 v6, 16, v67
    v_and_b32 v7, 0xffff0000, v67
    v_pk_add_f32 v[26:27], v[26:27], v[6:7]
    s_waitcnt vmcnt(0)
    v_cvt_pk_bf16_f32 v78, v8, v9
    v_cvt_pk_bf16_f32 v79, v10, v11
    v_cvt_pk_bf16_f32 v80, v12, v13
    v_cvt_pk_bf16_f32 v81, v14, v15
    v_cvt_pk_bf16_f32 v82, v16, v17
    v_cvt_pk_bf16_f32 v83, v18, v19
    v_cvt_pk_bf16_f32 v84, v20, v21
    v_cvt_pk_bf16_f32 v85, v22, v23
    v_cvt_pk_bf16_f32 v86, v24, v25
    v_cvt_pk_bf16_f32 v87, v26, v27
    v_lshlrev_b32 v8, 16, v78
    v_and_b32 v9, 0xffff0000, v78
    v_lshlrev_b32 v10, 16, v79
    v_and_b32 v11, 0xffff0000, v79
    v_lshlrev_b32 v12, 16, v80
    v_and_b32 v13, 0xffff0000, v80
    v_lshlrev_b32 v14, 16, v81
    v_and_b32 v15, 0xffff0000, v81
    v_lshlrev_b32 v16, 16, v82
    v_and_b32 v17, 0xffff0000, v82
    v_lshlrev_b32 v18, 16, v83
    v_and_b32 v19, 0xffff0000, v83
    v_lshlrev_b32 v20, 16, v84
    v_and_b32 v21, 0xffff0000, v84
    v_lshlrev_b32 v22, 16, v85
    v_and_b32 v23, 0xffff0000, v85
    v_lshlrev_b32 v24, 16, v86
    v_and_b32 v25, 0xffff0000, v86
    v_lshlrev_b32 v26, 16, v87
    v_and_b32 v27, 0xffff0000, v87
    v_lshlrev_b32 v88, 16, v68
    v_and_b32 v89, 0xffff0000, v68
    v_pk_add_f32 v[8:9], v[8:9], v[88:89]
    v_lshlrev_b32 v6, 16, v69
    v_and_b32 v7, 0xffff0000, v69
    v_pk_add_f32 v[10:11], v[10:11], v[6:7]
    v_lshlrev_b32 v88, 16, v70
    v_and_b32 v89, 0xffff0000, v70
    v_pk_add_f32 v[12:13], v[12:13], v[88:89]
    v_lshlrev_b32 v6, 16, v71
    v_and_b32 v7, 0xffff0000, v71
    v_pk_add_f32 v[14:15], v[14:15], v[6:7]
    v_lshlrev_b32 v88, 16, v72
    v_and_b32 v89, 0xffff0000, v72
    v_pk_add_f32 v[16:17], v[16:17], v[88:89]
    v_lshlrev_b32 v6, 16, v73
    v_and_b32 v7, 0xffff0000, v73
    v_pk_add_f32 v[18:19], v[18:19], v[6:7]
    v_lshlrev_b32 v88, 16, v74
    v_and_b32 v89, 0xffff0000, v74
    v_pk_add_f32 v[20:21], v[20:21], v[88:89]
    v_lshlrev_b32 v6, 16, v75
    v_and_b32 v7, 0xffff0000, v75
    v_pk_add_f32 v[22:23], v[22:23], v[6:7]
    v_lshlrev_b32 v88, 16, v76
    v_and_b32 v89, 0xffff0000, v76
    v_pk_add_f32 v[24:25], v[24:25], v[88:89]
    v_lshlrev_b32 v6, 16, v77
    v_and_b32 v7, 0xffff0000, v77
    v_pk_add_f32 v[26:27], v[26:27], v[6:7]
    v_cvt_pk_bf16_f32 v78, v8, v9
    v_cvt_pk_bf16_f32 v79, v10, v11
    v_cvt_pk_bf16_f32 v80, v12, v13
    v_cvt_pk_bf16_f32 v81, v14, v15
    v_cvt_pk_bf16_f32 v82, v16, v17
    v_cvt_pk_bf16_f32 v83, v18, v19
    v_cvt_pk_bf16_f32 v84, v20, v21
    v_cvt_pk_bf16_f32 v85, v22, v23
    v_cvt_pk_bf16_f32 v86, v24, v25
    v_cvt_pk_bf16_f32 v87, v26, v27
    v_lshlrev_b32 v8, 16, v78
    v_and_b32 v9, 0xffff0000, v78
    v_lshlrev_b32 v10, 16, v79
    v_and_b32 v11, 0xffff0000, v79
    v_lshlrev_b32 v12, 16, v80
    v_and_b32 v13, 0xffff0000, v80
    v_lshlrev_b32 v14, 16, v81
    v_and_b32 v15, 0xffff0000, v81
    v_lshlrev_b32 v16, 16, v82
    v_and_b32 v17, 0xffff0000, v82
    v_lshlrev_b32 v18, 16, v83
    v_and_b32 v19, 0xffff0000, v83
    v_lshlrev_b32 v20, 16, v84
    v_and_b32 v21, 0xffff0000, v84
    v_lshlrev_b32 v22, 16, v85
    v_and_b32 v23, 0xffff0000, v85
    v_lshlrev_b32 v24, 16, v86
    v_and_b32 v25, 0xffff0000, v86
    v_lshlrev_b32 v26, 16, v87
    v_and_b32 v27, 0xffff0000, v87
    buffer_store_dwordx2 v[78:79], v4, s[24:27], s43 offen offset:0
    buffer_store_dwordx2 v[80:81], v4, s[24:27], s43 offen offset:256
    buffer_store_dwordx2 v[82:83], v4, s[24:27], s43 offen offset:512
    buffer_store_dwordx2 v[84:85], v4, s[24:27], s43 offen offset:768
    buffer_store_dwordx2 v[86:87], v4, s[24:27], s43 offen offset:1024
    v_add_f32 v6, v8, v9
    v_add_f32 v7, v10, v11
    v_add_f32 v6, v6, v12
    v_add_f32 v7, v7, v13
    v_add_f32 v6, v6, v14
    v_add_f32 v7, v7, v15
    v_add_f32 v6, v6, v16
    v_add_f32 v7, v7, v17
    v_add_f32 v6, v6, v18
    v_add_f32 v7, v7, v19
    v_add_f32 v6, v6, v20
    v_add_f32 v7, v7, v21
    v_add_f32 v6, v6, v22
    v_add_f32 v7, v7, v23
    v_add_f32 v6, v6, v24
    v_add_f32 v7, v7, v25
    v_add_f32 v6, v6, v26
    v_add_f32 v7, v7, v27
    v_add_f32 v6, v6, v7
    s_nop 1
    v_add_f32_dpp v6, v6, v6 quad_perm:[1,0,3,2] row_mask:0xf bank_mask:0xf
    s_nop 1
    v_add_f32_dpp v6, v6, v6 quad_perm:[2,3,0,1] row_mask:0xf bank_mask:0xf
    s_nop 1
    v_add_f32_dpp v6, v6, v6 row_ror:8 row_mask:0xf bank_mask:0xf
    v_mov_b32 v7, v6
    s_nop 1
    v_permlane16_swap_b32 v7, v6
    s_nop 1
    v_add_f32 v6, v6, v7
    v_mov_b32 v7, v6
    s_nop 1
    v_permlane32_swap_b32 v7, v6
    s_nop 1
    v_add_f32 v6, v6, v7
    v_mul_f32 v6, -0.0015625, v6
    v_mov_b32 v7, v6
    v_pk_add_f32 v[8:9], v[8:9], v[6:7]
    v_pk_add_f32 v[10:11], v[10:11], v[6:7]
    v_pk_add_f32 v[12:13], v[12:13], v[6:7]
    v_pk_add_f32 v[14:15], v[14:15], v[6:7]
    v_pk_add_f32 v[16:17], v[16:17], v[6:7]
    v_pk_add_f32 v[18:19], v[18:19], v[6:7]
    v_pk_add_f32 v[20:21], v[20:21], v[6:7]
    v_pk_add_f32 v[22:23], v[22:23], v[6:7]
    v_pk_add_f32 v[24:25], v[24:25], v[6:7]
    v_pk_add_f32 v[26:27], v[26:27], v[6:7]
    v_pk_mul_f32 v[6:7], v[8:9], v[8:9]
    v_pk_fma_f32 v[6:7], v[10:11], v[10:11], v[6:7]
    v_pk_fma_f32 v[6:7], v[12:13], v[12:13], v[6:7]
    v_pk_fma_f32 v[6:7], v[14:15], v[14:15], v[6:7]
    v_pk_fma_f32 v[6:7], v[16:17], v[16:17], v[6:7]
    v_pk_fma_f32 v[6:7], v[18:19], v[18:19], v[6:7]
    v_pk_fma_f32 v[6:7], v[20:21], v[20:21], v[6:7]
    v_pk_fma_f32 v[6:7], v[22:23], v[22:23], v[6:7]
    v_pk_fma_f32 v[6:7], v[24:25], v[24:25], v[6:7]
    v_pk_fma_f32 v[6:7], v[26:27], v[26:27], v[6:7]
    v_add_f32 v6, v6, v7
    s_nop 1
    v_add_f32_dpp v6, v6, v6 quad_perm:[1,0,3,2] row_mask:0xf bank_mask:0xf
    s_nop 1
    v_add_f32_dpp v6, v6, v6 quad_perm:[2,3,0,1] row_mask:0xf bank_mask:0xf
    s_nop 1
    v_add_f32_dpp v6, v6, v6 row_ror:8 row_mask:0xf bank_mask:0xf
    v_mov_b32 v7, v6
    s_nop 1
    v_permlane16_swap_b32 v7, v6
    s_nop 1
    v_add_f32 v6, v6, v7
    v_mov_b32 v7, v6
    s_nop 1
    v_permlane32_swap_b32 v7, v6
    s_nop 1
    v_add_f32 v6, v6, v7
    v_mov_b32 v7, 0x3727c5ac
    v_fmac_f32 v7, 0.0015625, v6
    v_rsq_f32 v7, v7
    s_nop 0
    v_mov_b32 v6, v7
    v_pk_mul_f32 v[8:9], v[8:9], v[6:7]
    v_pk_mul_f32 v[10:11], v[10:11], v[6:7]
    v_pk_mul_f32 v[12:13], v[12:13], v[6:7]
    v_pk_mul_f32 v[14:15], v[14:15], v[6:7]
    v_pk_mul_f32 v[16:17], v[16:17], v[6:7]
    v_pk_mul_f32 v[18:19], v[18:19], v[6:7]
    v_pk_mul_f32 v[20:21], v[20:21], v[6:7]
    v_pk_mul_f32 v[22:23], v[22:23], v[6:7]
    v_pk_mul_f32 v[24:25], v[24:25], v[6:7]
    v_pk_mul_f32 v[26:27], v[26:27], v[6:7]
    v_cvt_pk_bf16_f32 v28, v8, v9
    v_cvt_pk_bf16_f32 v29, v10, v11
    v_cvt_pk_bf16_f32 v30, v12, v13
    v_cvt_pk_bf16_f32 v31, v14, v15
    v_cvt_pk_bf16_f32 v32, v16, v17
    v_cvt_pk_bf16_f32 v33, v18, v19
    v_cvt_pk_bf16_f32 v34, v20, v21
    v_cvt_pk_bf16_f32 v35, v22, v23
    v_cvt_pk_bf16_f32 v36, v24, v25
    v_cvt_pk_bf16_f32 v37, v26, v27
    v_lshlrev_b32 v8, 16, v28
    v_and_b32 v9, 0xffff0000, v28
    v_lshlrev_b32 v10, 16, v29
    v_and_b32 v11, 0xffff0000, v29
    v_lshlrev_b32 v12, 16, v30
    v_and_b32 v13, 0xffff0000, v30
    v_lshlrev_b32 v14, 16, v31
    v_and_b32 v15, 0xffff0000, v31
    v_lshlrev_b32 v16, 16, v32
    v_and_b32 v17, 0xffff0000, v32
    v_lshlrev_b32 v18, 16, v33
    v_and_b32 v19, 0xffff0000, v33
    v_lshlrev_b32 v20, 16, v34
    v_and_b32 v21, 0xffff0000, v34
    v_lshlrev_b32 v22, 16, v35
    v_and_b32 v23, 0xffff0000, v35
    v_lshlrev_b32 v24, 16, v36
    v_and_b32 v25, 0xffff0000, v36
    v_lshlrev_b32 v26, 16, v37
    v_and_b32 v27, 0xffff0000, v37
    v_add_f32 v6, v8, v9
    v_add_f32 v7, v10, v11
    v_add_f32 v6, v6, v12
    v_add_f32 v7, v7, v13
    v_add_f32 v6, v6, v14
    v_add_f32 v7, v7, v15
    v_add_f32 v6, v6, v16
    v_add_f32 v7, v7, v17
    v_add_f32 v6, v6, v18
    v_add_f32 v7, v7, v19
    v_add_f32 v6, v6, v20
    v_add_f32 v7, v7, v21
    v_add_f32 v6, v6, v22
    v_add_f32 v7, v7, v23
    v_add_f32 v6, v6, v24
    v_add_f32 v7, v7, v25
    v_add_f32 v6, v6, v26
    v_add_f32 v7, v7, v27
    v_add_f32 v6, v6, v7
    s_nop 1
    v_add_f32_dpp v6, v6, v6 quad_perm:[1,0,3,2] row_mask:0xf bank_mask:0xf
    s_nop 1
    v_add_f32_dpp v6, v6, v6 quad_perm:[2,3,0,1] row_mask:0xf bank_mask:0xf
    s_nop 1
    v_add_f32_dpp v6, v6, v6 row_ror:8 row_mask:0xf bank_mask:0xf
    v_mov_b32 v7, v6
    s_nop 1
    v_permlane16_swap_b32 v7, v6
    s_nop 1
    v_add_f32 v6, v6, v7
    v_mov_b32 v7, v6
    s_nop 1
    v_permlane32_swap_b32 v7, v6
    s_nop 1
    v_add_f32 v6, v6, v7
    v_mul_f32 v6, -0.0015625, v6
    v_mov_b32 v7, v6
    v_pk_add_f32 v[8:9], v[8:9], v[6:7]
    v_pk_add_f32 v[10:11], v[10:11], v[6:7]
    v_pk_add_f32 v[12:13], v[12:13], v[6:7]
    v_pk_add_f32 v[14:15], v[14:15], v[6:7]
    v_pk_add_f32 v[16:17], v[16:17], v[6:7]
    v_pk_add_f32 v[18:19], v[18:19], v[6:7]
    v_pk_add_f32 v[20:21], v[20:21], v[6:7]
    v_pk_add_f32 v[22:23], v[22:23], v[6:7]
    v_pk_add_f32 v[24:25], v[24:25], v[6:7]
    v_pk_add_f32 v[26:27], v[26:27], v[6:7]
    v_pk_mul_f32 v[6:7], v[8:9], v[8:9]
    v_pk_fma_f32 v[6:7], v[10:11], v[10:11], v[6:7]
    v_pk_fma_f32 v[6:7], v[12:13], v[12:13], v[6:7]
    v_pk_fma_f32 v[6:7], v[14:15], v[14:15], v[6:7]
    v_pk_fma_f32 v[6:7], v[16:17], v[16:17], v[6:7]
    v_pk_fma_f32 v[6:7], v[18:19], v[18:19], v[6:7]
    v_pk_fma_f32 v[6:7], v[20:21], v[20:21], v[6:7]
    v_pk_fma_f32 v[6:7], v[22:23], v[22:23], v[6:7]
    v_pk_fma_f32 v[6:7], v[24:25], v[24:25], v[6:7]
    v_pk_fma_f32 v[6:7], v[26:27], v[26:27], v[6:7]
    v_add_f32 v6, v6, v7
    s_nop 1
    v_add_f32_dpp v6, v6, v6 quad_perm:[1,0,3,2] row_mask:0xf bank_mask:0xf
    s_nop 1
    v_add_f32_dpp v6, v6, v6 quad_perm:[2,3,0,1] row_mask:0xf bank_mask:0xf
    s_nop 1
    v_add_f32_dpp v6, v6, v6 row_ror:8 row_mask:0xf bank_mask:0xf
    v_mov_b32 v7, v6
    s_nop 1
    v_permlane16_swap_b32 v7, v6
    s_nop 1
    v_add_f32 v6, v6, v7
    v_mov_b32 v7, v6
    s_nop 1
    v_permlane32_swap_b32 v7, v6
    s_nop 1
    v_add_f32 v6, v6, v7
    v_mov_b32 v7, 0x3727c5ac
    v_fmac_f32 v7, 0.0015625, v6
    v_rsq_f32 v7, v7
    s_nop 0
    v_mov_b32 v6, v7
    v_pk_mul_f32 v[8:9], v[8:9], v[6:7]
    v_pk_mul_f32 v[10:11], v[10:11], v[6:7]
    v_pk_mul_f32 v[12:13], v[12:13], v[6:7]
    v_pk_mul_f32 v[14:15], v[14:15], v[6:7]
    v_pk_mul_f32 v[16:17], v[16:17], v[6:7]
    v_pk_mul_f32 v[18:19], v[18:19], v[6:7]
    v_pk_mul_f32 v[20:21], v[20:21], v[6:7]
    v_pk_mul_f32 v[22:23], v[22:23], v[6:7]
    v_pk_mul_f32 v[24:25], v[24:25], v[6:7]
    v_pk_mul_f32 v[26:27], v[26:27], v[6:7]
    v_cvt_pk_bf16_f32 v28, v8, v9
    v_cvt_pk_bf16_f32 v29, v10, v11
    v_cvt_pk_bf16_f32 v30, v12, v13
    v_cvt_pk_bf16_f32 v31, v14, v15
    v_cvt_pk_bf16_f32 v32, v16, v17
    v_cvt_pk_bf16_f32 v33, v18, v19
    v_cvt_pk_bf16_f32 v34, v20, v21
    v_cvt_pk_bf16_f32 v35, v22, v23
    v_cvt_pk_bf16_f32 v36, v24, v25
    v_cvt_pk_bf16_f32 v37, v26, v27
    buffer_store_dwordx2 v[28:29], v90, s[28:31], s45 offen
    buffer_store_dwordx2 v[30:31], v91, s[28:31], s45 offen
    buffer_store_dwordx2 v[32:33], v92, s[28:31], s45 offen
    buffer_store_dwordx2 v[34:35], v93, s[28:31], s45 offen
    buffer_store_dwordx2 v[36:37], v94, s[28:31], s45 offen
Lln_end:
    s_endpgm
.globl mlp1_kernel
.p2align 8
.type mlp1_kernel,@function
mlp1_kernel:
    s_cmp_ge_u32 s2, 216
    s_cbranch_scc1 Lm1_end
    s_load_dwordx4 s[4:7], s[0:1], 56
    s_load_dwordx2 s[12:13], s[0:1], 104
    v_lshrrev_b32 v1, 6, v0
    s_nop 0
    v_readfirstlane_b32 s45, v1
    s_and_b32 s40, s45, 3
    s_bfe_u32 s41, s2, 0x20001
    s_lshr_b32 s42, s2, 3
    s_mul_i32 s41, s41, 27
    s_add_u32 s41, s41, s42
    s_and_b32 s42, s41, 3
    s_lshr_b32 s43, s41, 2
    s_and_b32 s41, s2, 1
    s_lshl_b32 s41, s41, 2
    s_add_u32 s42, s42, s41
    s_mul_i32 s49, s42, 327680
    s_lshl_b32 s51, s43, 7
    s_cmp_lt_u32 s45, 4
    s_cbranch_scc1 Lm1_cons
    v_and_b32 v1, 63, v0
    s_mul_i32 s48, s40, 5120
    s_lshr_b32 s52, s48, 4
    v_add_u32 v2, s52, v1
    v_mul_u32_u24 v3, 6554, v2
    v_lshrrev_b32 v3, 16, v3
    v_mul_u32_u24 v4, 10, v3
    v_sub_u32 v4, v2, v4
    s_mov_b32 s53, 160
    v_mul_lo_u32 v3, v3, s53
    v_lshl_add_u32 v8, v4, 4, v3
    v_add_u32 v2, s52, v1
    v_add_u32 v2, 64, v2
    v_mul_u32_u24 v3, 6554, v2
    v_lshrrev_b32 v3, 16, v3
    v_mul_u32_u24 v4, 10, v3
    v_sub_u32 v4, v2, v4
    s_mov_b32 s53, 160
    v_mul_lo_u32 v3, v3, s53
    v_lshl_add_u32 v9, v4, 4, v3
    v_add_u32 v2, s52, v1
    v_add_u32 v2, 128, v2
    v_mul_u32_u24 v3, 6554, v2
    v_lshrrev_b32 v3, 16, v3
    v_mul_u32_u24 v4, 10, v3
    v_sub_u32 v4, v2, v4
    s_mov_b32 s53, 160
    v_mul_lo_u32 v3, v3, s53
    v_lshl_add_u32 v10, v4, 4, v3
    v_add_u32 v2, s52, v1
    v_add_u32 v2, 192, v2
    v_mul_u32_u24 v3, 6554, v2
    v_lshrrev_b32 v3, 16, v3
    v_mul_u32_u24 v4, 10, v3
    v_sub_u32 v4, v2, v4
    s_mov_b32 s53, 160
    v_mul_lo_u32 v3, v3, s53
    v_lshl_add_u32 v11, v4, 4, v3
    v_add_u32 v2, s52, v1
    v_add_u32 v2, 256, v2
    v_mul_u32_u24 v3, 6554, v2
    v_lshrrev_b32 v3, 16, v3
    v_mul_u32_u24 v4, 10, v3
    v_sub_u32 v4, v2, v4
    s_mov_b32 s53, 160
    v_mul_lo_u32 v3, v3, s53
    v_lshl_add_u32 v12, v4, 4, v3
    s_mul_i32 s50, s40, 4096
    s_lshr_b32 s52, s50, 4
    v_add_u32 v2, s52, v1
    v_lshrrev_b32 v3, 3, v2
    v_and_b32 v4, 7, v2
    v_and_b32 v5, 6, v3
    v_xor_b32 v4, v4, v5
    s_mov_b32 s53, 3456
    v_mul_lo_u32 v3, v3, s53
    v_lshl_add_u32 v13, v4, 4, v3
    v_add_u32 v2, s52, v1
    v_add_u32 v2, 64, v2
    v_lshrrev_b32 v3, 3, v2
    v_and_b32 v4, 7, v2
    v_and_b32 v5, 6, v3
    v_xor_b32 v4, v4, v5
    s_mov_b32 s53, 3456
    v_mul_lo_u32 v3, v3, s53
    v_lshl_add_u32 v14, v4, 4, v3
    v_add_u32 v2, s52, v1
    v_add_u32 v2, 128, v2
    v_lshrrev_b32 v3, 3, v2
    v_and_b32 v4, 7, v2
    v_and_b32 v5, 6, v3
    v_xor_b32 v4, v4, v5
    s_mov_b32 s53, 3456
    v_mul_lo_u32 v3, v3, s53
    v_lshl_add_u32 v15, v4, 4, v3
    v_add_u32 v2, s52, v1
    v_add_u32 v2, 192, v2
    v_lshrrev_b32 v3, 3, v2
    v_and_b32 v4, 7, v2
    v_and_b32 v5, 6, v3
    v_xor_b32 v4, v4, v5
    s_mov_b32 s53, 3456
    v_mul_lo_u32 v3, v3, s53
    v_lshl_add_u32 v16, v4, 4, v3
    s_waitcnt lgkmcnt(0)
    s_add_u32 s16, s12, 121634816
    s_addc_u32 s17, s13, 0
    s_mov_b32 s18, 2621440
    s_mov_b32 s19, 0x00020000
    s_mov_b32 s20, s4
    s_mov_b32 s21, s5
    s_mov_b32 s22, 7077888
    s_mov_b32 s23, 0x00020000
    s_add_u32 m0, s48, 0
    s_nop 0
    buffer_load_dwordx4 v8, s[16:19], s49 offen lds
    s_add_u32 m0, s48, 1024
    s_nop 0
    buffer_load_dwordx4 v9, s[16:19], s49 offen lds
    s_add_u32 m0, s48, 2048
    s_nop 0
    buffer_load_dwordx4 v10, s[16:19], s49 offen lds
    s_add_u32 m0, s48, 3072
    s_nop 0
    buffer_load_dwordx4 v11, s[16:19], s49 offen lds
    s_add_u32 m0, s48, 4096
    s_nop 0
    buffer_load_dwordx4 v12, s[16:19], s49 offen lds
    s_add_u32 s49, s49, 20480
    s_add_u32 m0, s50, 20480
    s_nop 0
    buffer_load_dwordx4 v13, s[20:23], s51 offen lds
    s_add_u32 m0, s50, 21504
    s_nop 0
    buffer_load_dwordx4 v14, s[20:23], s51 offen lds
    s_add_u32 m0, s50, 22528
    s_nop 0
    buffer_load_dwordx4 v15, s[20:23], s51 offen lds
    s_add_u32 m0, s50, 23552
    s_nop 0
    buffer_load_dwordx4 v16, s[20:23], s51 offen lds
    s_add_u32 s51, s51, 442368
    s_add_u32 m0, s48, 36864
    s_nop 0
    buffer_load_dwordx4 v8, s[16:19], s49 offen lds
    s_add_u32 m0, s48, 37888
    s_nop 0
    buffer_load_dwordx4 v9, s[16:19], s49 offen lds
    s_add_u32 m0, s48, 38912
    s_nop 0
    buffer_load_dwordx4 v10, s[16:19], s49 offen lds
    s_add_u32 m0, s48, 39936
    s_nop 0
    buffer_load_dwordx4 v11, s[16:19], s49 offen lds
    s_add_u32 m0, s48, 40960
    s_nop 0
    buffer_load_dwordx4 v12, s[16:19], s49 offen lds
    s_add_u32 s49, s49, 20480
    s_add_u32 m0, s50, 57344
    s_nop 0
    buffer_load_dwordx4 v13, s[20:23], s51 offen lds
    s_add_u32 m0, s50, 58368
    s_nop 0
    buffer_load_dwordx4 v14, s[20:23], s51 offen lds
    s_add_u32 m0, s50, 59392
    s_nop 0
    buffer_load_dwordx4 v15, s[20:23], s51 offen lds
    s_add_u32 m0, s50, 60416
    s_nop 0
    buffer_load_dwordx4 v16, s[20:23], s51 offen lds
    s_add_u32 s51, s51, 442368
    s_add_u32 m0, s48, 73728
    s_nop 0
    buffer_load_dwordx4 v8, s[16:19], s49 offen lds
    s_add_u32 m0, s48, 74752
    s_nop 0
    buffer_load_dwordx4 v9, s[16:19], s49 offen lds
    s_add_u32 m0, s48, 75776
    s_nop 0
    buffer_load_dwordx4 v10, s[16:19], s49 offen lds
    s_add_u32 m0, s48, 76800
    s_nop 0
    buffer_load_dwordx4 v11, s[16:19], s49 offen lds
    s_add_u32 m0, s48, 77824
    s_nop 0
    buffer_load_dwordx4 v12, s[16:19], s49 offen lds
    s_add_u32 s49, s49, 20480
    s_add_u32 m0, s50, 94208
    s_nop 0
    buffer_load_dwordx4 v13, s[20:23], s51 offen lds
    s_add_u32 m0, s50, 95232
    s_nop 0
    buffer_load_dwordx4 v14, s[20:23], s51 offen lds
    s_add_u32 m0, s50, 96256
    s_nop 0
    buffer_load_dwordx4 v15, s[20:23], s51 offen lds
    s_add_u32 m0, s50, 97280
    s_nop 0
    buffer_load_dwordx4 v16, s[20:23], s51 offen lds
    s_add_u32 s51, s51, 442368
    s_add_u32 m0, s48, 110592
    s_nop 0
    buffer_load_dwordx4 v8, s[16:19], s49 offen lds
    s_add_u32 m0, s48, 111616
    s_nop 0
    buffer_load_dwordx4 v9, s[16:19], s49 offen lds
    s_add_u32 m0, s48, 112640
    s_nop 0
    buffer_load_dwordx4 v10, s[16:19], s49 offen lds
    s_add_u32 m0, s48, 113664
    s_nop 0
    buffer_load_dwordx4 v11, s[16:19], s49 offen lds
    s_add_u32 m0, s48, 114688
    s_nop 0
    buffer_load_dwordx4 v12, s[16:19], s49 offen lds
    s_add_u32 s49, s49, 20480
    s_add_u32 m0, s50, 131072
    s_nop 0
    buffer_load_dwordx4 v13, s[20:23], s51 offen lds
    s_add_u32 m0, s50, 132096
    s_nop 0
    buffer_load_dwordx4 v14, s[20:23], s51 offen lds
    s_add_u32 m0, s50, 133120
    s_nop 0
    buffer_load_dwordx4 v15, s[20:23], s51 offen lds
    s_add_u32 m0, s50, 134144
    s_nop 0
    buffer_load_dwordx4 v16, s[20:23], s51 offen lds
    s_add_u32 s51, s51, 442368
    s_waitcnt vmcnt(27)
    s_barrier
    s_waitcnt vmcnt(18)
    s_barrier
    s_add_u32 m0, s48, 0
    s_nop 0
    buffer_load_dwordx4 v8, s[16:19], s49 offen lds
    s_add_u32 m0, s48, 1024
    s_nop 0
    buffer_load_dwordx4 v9, s[16:19], s49 offen lds
    s_add_u32 m0, s48, 2048
    s_nop 0
    buffer_load_dwordx4 v10, s[16:19], s49 offen lds
    s_add_u32 m0, s48, 3072
    s_nop 0
    buffer_load_dwordx4 v11, s[16:19], s49 offen lds
    s_add_u32 m0, s48, 4096
    s_nop 0
    buffer_load_dwordx4 v12, s[16:19], s49 offen lds
    s_add_u32 s49, s49, 20480
    s_add_u32 m0, s50, 20480
    s_nop 0
    buffer_load_dwordx4 v13, s[20:23], s51 offen lds
    s_add_u32 m0, s50, 21504
    s_nop 0
    buffer_load_dwordx4 v14, s[20:23], s51 offen lds
    s_add_u32 m0, s50, 22528
    s_nop 0
    buffer_load_dwordx4 v15, s[20:23], s51 offen lds
    s_add_u32 m0, s50, 23552
    s_nop 0
    buffer_load_dwordx4 v16, s[20:23], s51 offen lds
    s_add_u32 s51, s51, 442368
    s_waitcnt vmcnt(18)
    s_barrier
    s_add_u32 m0, s48, 36864
    s_nop 0
    buffer_load_dwordx4 v8, s[16:19], s49 offen lds
    s_add_u32 m0, s48, 37888
    s_nop 0
    buffer_load_dwordx4 v9, s[16:19], s49 offen lds
    s_add_u32 m0, s48, 38912
    s_nop 0
    buffer_load_dwordx4 v10, s[16:19], s49 offen lds
    s_add_u32 m0, s48, 39936
    s_nop 0
    buffer_load_dwordx4 v11, s[16:19], s49 offen lds
    s_add_u32 m0, s48, 40960
    s_nop 0
    buffer_load_dwordx4 v12, s[16:19], s49 offen lds
    s_add_u32 s49, s49, 20480
    s_add_u32 m0, s50, 57344
    s_nop 0
    buffer_load_dwordx4 v13, s[20:23], s51 offen lds
    s_add_u32 m0, s50, 58368
    s_nop 0
    buffer_load_dwordx4 v14, s[20:23], s51 offen lds
    s_add_u32 m0, s50, 59392
    s_nop 0
    buffer_load_dwordx4 v15, s[20:23], s51 offen lds
    s_add_u32 m0, s50, 60416
    s_nop 0
    buffer_load_dwordx4 v16, s[20:23], s51 offen lds
    s_add_u32 s51, s51, 442368
    s_waitcnt vmcnt(18)
    s_barrier
    s_add_u32 m0, s48, 73728
    s_nop 0
    buffer_load_dwordx4 v8, s[16:19], s49 offen lds
    s_add_u32 m0, s48, 74752
    s_nop 0
    buffer_load_dwordx4 v9, s[16:19], s49 offen lds
    s_add_u32 m0, s48, 75776
    s_nop 0
    buffer_load_dwordx4 v10, s[16:19], s49 offen lds
    s_add_u32 m0, s48, 76800
    s_nop 0
    buffer_load_dwordx4 v11, s[16:19], s49 offen lds
    s_add_u32 m0, s48, 77824
    s_nop 0
    buffer_load_dwordx4 v12, s[16:19], s49 offen lds
    s_add_u32 s49, s49, 20480
    s_add_u32 m0, s50, 94208
    s_nop 0
    buffer_load_dwordx4 v13, s[20:23], s51 offen lds
    s_add_u32 m0, s50, 95232
    s_nop 0
    buffer_load_dwordx4 v14, s[20:23], s51 offen lds
    s_add_u32 m0, s50, 96256
    s_nop 0
    buffer_load_dwordx4 v15, s[20:23], s51 offen lds
    s_add_u32 m0, s50, 97280
    s_nop 0
    buffer_load_dwordx4 v16, s[20:23], s51 offen lds
    s_add_u32 s51, s51, 442368
    s_waitcnt vmcnt(18)
    s_barrier
    s_add_u32 m0, s48, 110592
    s_nop 0
    buffer_load_dwordx4 v8, s[16:19], s49 offen lds
    s_add_u32 m0, s48, 111616
    s_nop 0
    buffer_load_dwordx4 v9, s[16:19], s49 offen lds
    s_add_u32 m0, s48, 112640
    s_nop 0
    buffer_load_dwordx4 v10, s[16:19], s49 offen lds
    s_add_u32 m0, s48, 113664
    s_nop 0
    buffer_load_dwordx4 v11, s[16:19], s49 offen lds
    s_add_u32 m0, s48, 114688
    s_nop 0
    buffer_load_dwordx4 v12, s[16:19], s49 offen lds
    s_add_u32 s49, s49, 20480
    s_add_u32 m0, s50, 131072
    s_nop 0
    buffer_load_dwordx4 v13, s[20:23], s51 offen lds
    s_add_u32 m0, s50, 132096
    s_nop 0
    buffer_load_dwordx4 v14, s[20:23], s51 offen lds
    s_add_u32 m0, s50, 133120
    s_nop 0
    buffer_load_dwordx4 v15, s[20:23], s51 offen lds
    s_add_u32 m0, s50, 134144
    s_nop 0
    buffer_load_dwordx4 v16, s[20:23], s51 offen lds
    s_add_u32 s51, s51, 442368
    s_waitcnt vmcnt(18)
    s_barrier
    s_add_u32 m0, s48, 0
    s_nop 0
    buffer_load_dwordx4 v8, s[16:19], s49 offen lds
    s_add_u32 m0, s48, 1024
    s_nop 0
    buffer_load_dwordx4 v9, s[16:19], s49 offen lds
    s_add_u32 m0, s48, 2048
    s_nop 0
    buffer_load_dwordx4 v10, s[16:19], s49 offen lds
    s_add_u32 m0, s48, 3072
    s_nop 0
    buffer_load_dwordx4 v11, s[16:19], s49 offen lds
    s_add_u32 m0, s48, 4096
    s_nop 0
    buffer_load_dwordx4 v12, s[16:19], s49 offen lds
    s_add_u32 s49, s49, 20480
    s_add_u32 m0, s50, 20480
    s_nop 0
    buffer_load_dwordx4 v13, s[20:23], s51 offen lds
    s_add_u32 m0, s50, 21504
    s_nop 0
    buffer_load_dwordx4 v14, s[20:23], s51 offen lds
    s_add_u32 m0, s50, 22528
    s_nop 0
    buffer_load_dwordx4 v15, s[20:23], s51 offen lds
    s_add_u32 m0, s50, 23552
    s_nop 0
    buffer_load_dwordx4 v16, s[20:23], s51 offen lds
    s_add_u32 s51, s51, 442368
    s_waitcnt vmcnt(18)
    s_barrier
    s_add_u32 m0, s48, 36864
    s_nop 0
    buffer_load_dwordx4 v8, s[16:19], s49 offen lds
    s_add_u32 m0, s48, 37888
    s_nop 0
    buffer_load_dwordx4 v9, s[16:19], s49 offen lds
    s_add_u32 m0, s48, 38912
    s_nop 0
    buffer_load_dwordx4 v10, s[16:19], s49 offen lds
    s_add_u32 m0, s48, 39936
    s_nop 0
    buffer_load_dwordx4 v11, s[16:19], s49 offen lds
    s_add_u32 m0, s48, 40960
    s_nop 0
    buffer_load_dwordx4 v12, s[16:19], s49 offen lds
    s_add_u32 s49, s49, 20480
    s_add_u32 m0, s50, 57344
    s_nop 0
    buffer_load_dwordx4 v13, s[20:23], s51 offen lds
    s_add_u32 m0, s50, 58368
    s_nop 0
    buffer_load_dwordx4 v14, s[20:23], s51 offen lds
    s_add_u32 m0, s50, 59392
    s_nop 0
    buffer_load_dwordx4 v15, s[20:23], s51 offen lds
    s_add_u32 m0, s50, 60416
    s_nop 0
    buffer_load_dwordx4 v16, s[20:23], s51 offen lds
    s_add_u32 s51, s51, 442368
    s_waitcnt vmcnt(18)
    s_barrier
    s_add_u32 m0, s48, 73728
    s_nop 0
    buffer_load_dwordx4 v8, s[16:19], s49 offen lds
    s_add_u32 m0, s48, 74752
    s_nop 0
    buffer_load_dwordx4 v9, s[16:19], s49 offen lds
    s_add_u32 m0, s48, 75776
    s_nop 0
    buffer_load_dwordx4 v10, s[16:19], s49 offen lds
    s_add_u32 m0, s48, 76800
    s_nop 0
    buffer_load_dwordx4 v11, s[16:19], s49 offen lds
    s_add_u32 m0, s48, 77824
    s_nop 0
    buffer_load_dwordx4 v12, s[16:19], s49 offen lds
    s_add_u32 s49, s49, 20480
    s_add_u32 m0, s50, 94208
    s_nop 0
    buffer_load_dwordx4 v13, s[20:23], s51 offen lds
    s_add_u32 m0, s50, 95232
    s_nop 0
    buffer_load_dwordx4 v14, s[20:23], s51 offen lds
    s_add_u32 m0, s50, 96256
    s_nop 0
    buffer_load_dwordx4 v15, s[20:23], s51 offen lds
    s_add_u32 m0, s50, 97280
    s_nop 0
    buffer_load_dwordx4 v16, s[20:23], s51 offen lds
    s_add_u32 s51, s51, 442368
    s_waitcnt vmcnt(18)
    s_barrier
    s_add_u32 m0, s48, 110592
    s_nop 0
    buffer_load_dwordx4 v8, s[16:19], s49 offen lds
    s_add_u32 m0, s48, 111616
    s_nop 0
    buffer_load_dwordx4 v9, s[16:19], s49 offen lds
    s_add_u32 m0, s48, 112640
    s_nop 0
    buffer_load_dwordx4 v10, s[16:19], s49 offen lds
    s_add_u32 m0, s48, 113664
    s_nop 0
    buffer_load_dwordx4 v11, s[16:19], s49 offen lds
    s_add_u32 m0, s48, 114688
    s_nop 0
    buffer_load_dwordx4 v12, s[16:19], s49 offen lds
    s_add_u32 s49, s49, 20480
    s_add_u32 m0, s50, 131072
    s_nop 0
    buffer_load_dwordx4 v13, s[20:23], s51 offen lds
    s_add_u32 m0, s50, 132096
    s_nop 0
    buffer_load_dwordx4 v14, s[20:23], s51 offen lds
    s_add_u32 m0, s50, 133120
    s_nop 0
    buffer_load_dwordx4 v15, s[20:23], s51 offen lds
    s_add_u32 m0, s50, 134144
    s_nop 0
    buffer_load_dwordx4 v16, s[20:23], s51 offen lds
    s_add_u32 s51, s51, 442368
    s_waitcnt vmcnt(18)
    s_barrier
    s_add_u32 m0, s48, 0
    s_nop 0
    buffer_load_dwordx4 v8, s[16:19], s49 offen lds
    s_add_u32 m0, s48, 1024
    s_nop 0
    buffer_load_dwordx4 v9, s[16:19], s49 offen lds
    s_add_u32 m0, s48, 2048
    s_nop 0
    buffer_load_dwordx4 v10, s[16:19], s49 offen lds
    s_add_u32 m0, s48, 3072
    s_nop 0
    buffer_load_dwordx4 v11, s[16:19], s49 offen lds
    s_add_u32 m0, s48, 4096
    s_nop 0
    buffer_load_dwordx4 v12, s[16:19], s49 offen lds
    s_add_u32 s49, s49, 20480
    s_add_u32 m0, s50, 20480
    s_nop 0
    buffer_load_dwordx4 v13, s[20:23], s51 offen lds
    s_add_u32 m0, s50, 21504
    s_nop 0
    buffer_load_dwordx4 v14, s[20:23], s51 offen lds
    s_add_u32 m0, s50, 22528
    s_nop 0
    buffer_load_dwordx4 v15, s[20:23], s51 offen lds
    s_add_u32 m0, s50, 23552
    s_nop 0
    buffer_load_dwordx4 v16, s[20:23], s51 offen lds
    s_add_u32 s51, s51, 442368
    s_waitcnt vmcnt(18)
    s_barrier
    s_add_u32 m0, s48, 36864
    s_nop 0
    buffer_load_dwordx4 v8, s[16:19], s49 offen lds
    s_add_u32 m0, s48, 37888
    s_nop 0
    buffer_load_dwordx4 v9, s[16:19], s49 offen lds
    s_add_u32 m0, s48, 38912
    s_nop 0
    buffer_load_dwordx4 v10, s[16:19], s49 offen lds
    s_add_u32 m0, s48, 39936
    s_nop 0
    buffer_load_dwordx4 v11, s[16:19], s49 offen lds
    s_add_u32 m0, s48, 40960
    s_nop 0
    buffer_load_dwordx4 v12, s[16:19], s49 offen lds
    s_add_u32 s49, s49, 20480
    s_add_u32 m0, s50, 57344
    s_nop 0
    buffer_load_dwordx4 v13, s[20:23], s51 offen lds
    s_add_u32 m0, s50, 58368
    s_nop 0
    buffer_load_dwordx4 v14, s[20:23], s51 offen lds
    s_add_u32 m0, s50, 59392
    s_nop 0
    buffer_load_dwordx4 v15, s[20:23], s51 offen lds
    s_add_u32 m0, s50, 60416
    s_nop 0
    buffer_load_dwordx4 v16, s[20:23], s51 offen lds
    s_add_u32 s51, s51, 442368
    s_waitcnt vmcnt(18)
    s_barrier
    s_add_u32 m0, s48, 73728
    s_nop 0
    buffer_load_dwordx4 v8, s[16:19], s49 offen lds
    s_add_u32 m0, s48, 74752
    s_nop 0
    buffer_load_dwordx4 v9, s[16:19], s49 offen lds
    s_add_u32 m0, s48, 75776
    s_nop 0
    buffer_load_dwordx4 v10, s[16:19], s49 offen lds
    s_add_u32 m0, s48, 76800
    s_nop 0
    buffer_load_dwordx4 v11, s[16:19], s49 offen lds
    s_add_u32 m0, s48, 77824
    s_nop 0
    buffer_load_dwordx4 v12, s[16:19], s49 offen lds
    s_add_u32 s49, s49, 20480
    s_add_u32 m0, s50, 94208
    s_nop 0
    buffer_load_dwordx4 v13, s[20:23], s51 offen lds
    s_add_u32 m0, s50, 95232
    s_nop 0
    buffer_load_dwordx4 v14, s[20:23], s51 offen lds
    s_add_u32 m0, s50, 96256
    s_nop 0
    buffer_load_dwordx4 v15, s[20:23], s51 offen lds
    s_add_u32 m0, s50, 97280
    s_nop 0
    buffer_load_dwordx4 v16, s[20:23], s51 offen lds
    s_add_u32 s51, s51, 442368
    s_waitcnt vmcnt(18)
    s_barrier
    s_add_u32 m0, s48, 110592
    s_nop 0
    buffer_load_dwordx4 v8, s[16:19], s49 offen lds
    s_add_u32 m0, s48, 111616
    s_nop 0
    buffer_load_dwordx4 v9, s[16:19], s49 offen lds
    s_add_u32 m0, s48, 112640
    s_nop 0
    buffer_load_dwordx4 v10, s[16:19], s49 offen lds
    s_add_u32 m0, s48, 113664
    s_nop 0
    buffer_load_dwordx4 v11, s[16:19], s49 offen lds
    s_add_u32 m0, s48, 114688
    s_nop 0
    buffer_load_dwordx4 v12, s[16:19], s49 offen lds
    s_add_u32 s49, s49, 20480
    s_add_u32 m0, s50, 131072
    s_nop 0
    buffer_load_dwordx4 v13, s[20:23], s51 offen lds
    s_add_u32 m0, s50, 132096
    s_nop 0
    buffer_load_dwordx4 v14, s[20:23], s51 offen lds
    s_add_u32 m0, s50, 133120
    s_nop 0
    buffer_load_dwordx4 v15, s[20:23], s51 offen lds
    s_add_u32 m0, s50, 134144
    s_nop 0
    buffer_load_dwordx4 v16, s[20:23], s51 offen lds
    s_add_u32 s51, s51, 442368
    s_waitcnt vmcnt(18)
    s_barrier
    s_waitcnt vmcnt(9)
    s_barrier
    s_waitcnt vmcnt(0)
    s_barrier
    s_endpgm
Lm1_cons:
    s_lshr_b32 s46, s2, 3
    s_lshl_b32 s46, s46, 2
    s_add_u32 s46, s46, s40
    s_and_b32 s47, s2, 7
    s_mul_i32 s47, s47, 27
    s_lshr_b32 s47, s47, 3
    s_lshl_b32 s47, s47, 7
    v_and_b32 v1, 63, v0
    s_waitcnt lgkmcnt(0)
    s_add_u32 s16, s12, 121634816
    s_addc_u32 s17, s13, 0
    s_mov_b32 s18, 2621440
    s_mov_b32 s19, 0x00020000
    s_mov_b32 s20, s4
    s_mov_b32 s21, s5
    s_mov_b32 s22, 7077888
    s_mov_b32 s23, 0x00020000
    s_mov_b32 s28, s6
    s_mov_b32 s29, s7
    s_mov_b32 s30, 3456
    s_mov_b32 s31, 0x00020000
    v_bfe_u32 v1, v0, 4, 2
    v_lshlrev_b32 v1, 3, v1
    s_lshl_b32 s60, s43, 7
    s_lshl_b32 s61, s40, 5
    s_add_u32 s60, s60, s61
    buffer_load_dwordx2 v[208:209], v1, s[28:31], s60 offen
    s_add_u32 s24, s12, 125829120
    s_addc_u32 s25, s13, 0
    s_mov_b32 s26, 2211840
    s_mov_b32 s27, 0x00020000
    v_and_b32 v1, 63, v0
    v_bfe_u32 v2, v1, 2, 2
    v_lshrrev_b32 v3, 4, v1
    v_mad_u32_u24 v3, v3, 4, v2
    v_mul_u32_u24 v4, 160, v3
    v_and_b32 v5, 3, v1
    v_lshl_add_u32 v4, v5, 3, v4
    v_add_u32 v4, 0, v4
    v_mov_b32 v17, v4
    v_bfe_u32 v2, v1, 2, 2
    v_lshrrev_b32 v3, 4, v1
    v_mad_u32_u24 v3, v3, 4, v2
    v_mul_u32_u24 v4, 128, v3
    v_and_b32 v5, 3, v1
    v_lshl_add_u32 v4, v5, 3, v4
    v_add_u32 v4, 20480, v4
    v_bfe_u32 v5, v3, 1, 2
    s_mul_i32 s52, s40, 1
    s_add_u32 s52, s52, 0
    v_xor_b32 v2, s52, v5
    v_mad_u32_u24 v19, v2, 32, v4
    s_barrier
    v_add_u32 v18, 0, v17
    v_add_u32 v20, 0, v19
    ds_read_b64_tr_b16 v[24:25], v18 offset:0
    ds_read_b64_tr_b16 v[26:27], v18 offset:2560
    ds_read_b64_tr_b16 v[28:29], v18 offset:32
    ds_read_b64_tr_b16 v[30:31], v18 offset:2592
    ds_read_b64_tr_b16 v[32:33], v18 offset:64
    ds_read_b64_tr_b16 v[34:35], v18 offset:2624
    ds_read_b64_tr_b16 v[36:37], v18 offset:96
    ds_read_b64_tr_b16 v[38:39], v18 offset:2656
    ds_read_b64_tr_b16 v[40:41], v18 offset:128
    ds_read_b64_tr_b16 v[42:43], v18 offset:2688
    ds_read_b64_tr_b16 v[44:45], v20 offset:0
    ds_read_b64_tr_b16 v[46:47], v20 offset:2048
    ds_read_b64_tr_b16 v[48:49], v18 offset:5120
    ds_read_b64_tr_b16 v[50:51], v18 offset:7680
    ds_read_b64_tr_b16 v[52:53], v18 offset:5152
    ds_read_b64_tr_b16 v[54:55], v18 offset:7712
    ds_read_b64_tr_b16 v[56:57], v18 offset:5184
    ds_read_b64_tr_b16 v[58:59], v18 offset:7744
    ds_read_b64_tr_b16 v[60:61], v18 offset:5216
    ds_read_b64_tr_b16 v[62:63], v18 offset:7776
    ds_read_b64_tr_b16 v[64:65], v18 offset:5248
    ds_read_b64_tr_b16 v[66:67], v18 offset:7808
    ds_read_b64_tr_b16 v[68:69], v20 offset:4096
    ds_read_b64_tr_b16 v[70:71], v20 offset:6144
    s_waitcnt lgkmcnt(0)
    v_mfma_f32_16x16x32_bf16 v[128:131], v[44:47], v[24:27], 0
    ds_read_b64_tr_b16 v[72:73], v18 offset:10240
    ds_read_b64_tr_b16 v[74:75], v18 offset:12800
    ds_read_b64_tr_b16 v[76:77], v18 offset:10272
    v_mfma_f32_16x16x32_bf16 v[132:135], v[44:47], v[28:31], 0
    ds_read_b64_tr_b16 v[78:79], v18 offset:12832
    ds_read_b64_tr_b16 v[80:81], v18 offset:10304
    ds_read_b64_tr_b16 v[82:83], v18 offset:12864
    v_mfma_f32_16x16x32_bf16 v[136:139], v[44:47], v[32:35], 0
    ds_read_b64_tr_b16 v[84:85], v18 offset:10336
    ds_read_b64_tr_b16 v[86:87], v18 offset:12896
    ds_read_b64_tr_b16 v[88:89], v18 offset:10368
    v_mfma_f32_16x16x32_bf16 v[140:143], v[44:47], v[36:39], 0
    ds_read_b64_tr_b16 v[90:91], v18 offset:12928
    ds_read_b64_tr_b16 v[92:93], v20 offset:8192
    ds_read_b64_tr_b16 v[94:95], v20 offset:10240
    v_mfma_f32_16x16x32_bf16 v[144:147], v[44:47], v[40:43], 0
    ds_read_b64_tr_b16 v[96:97], v18 offset:15360
    ds_read_b64_tr_b16 v[98:99], v18 offset:17920
    ds_read_b64_tr_b16 v[100:101], v18 offset:15392
    v_mfma_f32_16x16x32_bf16 v[128:131], v[68:71], v[48:51], v[128:131]
    ds_read_b64_tr_b16 v[102:103], v18 offset:17952
    ds_read_b64_tr_b16 v[104:105], v18 offset:15424
    ds_read_b64_tr_b16 v[106:107], v18 offset:17984
    v_mfma_f32_16x16x32_bf16 v[132:135], v[68:71], v[52:55], v[132:135]
    ds_read_b64_tr_b16 v[108:109], v18 offset:15456
    ds_read_b64_tr_b16 v[110:111], v18 offset:18016
    ds_read_b64_tr_b16 v[112:113], v18 offset:15488
    v_mfma_f32_16x16x32_bf16 v[136:139], v[68:71], v[56:59], v[136:139]
    ds_read_b64_tr_b16 v[114:115], v18 offset:18048
    ds_read_b64_tr_b16 v[116:117], v20 offset:12288
    ds_read_b64_tr_b16 v[118:119], v20 offset:14336
    v_mfma_f32_16x16x32_bf16 v[140:143], v[68:71], v[60:63], v[140:143]
    v_mfma_f32_16x16x32_bf16 v[144:147], v[68:71], v[64:67], v[144:147]
    s_waitcnt lgkmcnt(0)
    s_barrier
    v_mfma_f32_16x16x32_bf16 v[128:131], v[92:95], v[72:75], v[128:131]
    v_add_u32 v18, 36864, v17
    v_add_u32 v20, 36864, v19
    ds_read_b64_tr_b16 v[24:25], v18 offset:0
    v_mfma_f32_16x16x32_bf16 v[132:135], v[92:95], v[76:79], v[132:135]
    ds_read_b64_tr_b16 v[26:27], v18 offset:2560
    ds_read_b64_tr_b16 v[28:29], v18 offset:32
    ds_read_b64_tr_b16 v[30:31], v18 offset:2592
    v_mfma_f32_16x16x32_bf16 v[136:139], v[92:95], v[80:83], v[136:139]
    ds_read_b64_tr_b16 v[32:33], v18 offset:64
    ds_read_b64_tr_b16 v[34:35], v18 offset:2624
    ds_read_b64_tr_b16 v[36:37], v18 offset:96
    v_mfma_f32_16x16x32_bf16 v[140:143], v[92:95], v[84:87], v[140:143]
    ds_read_b64_tr_b16 v[38:39], v18 offset:2656
    ds_read_b64_tr_b16 v[40:41], v18 offset:128
    ds_read_b64_tr_b16 v[42:43], v18 offset:2688
    v_mfma_f32_16x16x32_bf16 v[144:147], v[92:95], v[88:91], v[144:147]
    ds_read_b64_tr_b16 v[44:45], v20 offset:0
    ds_read_b64_tr_b16 v[46:47], v20 offset:2048
    ds_read_b64_tr_b16 v[48:49], v18 offset:5120
    v_mfma_f32_16x16x32_bf16 v[128:131], v[116:119], v[96:99], v[128:131]
    ds_read_b64_tr_b16 v[50:51], v18 offset:7680
    ds_read_b64_tr_b16 v[52:53], v18 offset:5152
    ds_read_b64_tr_b16 v[54:55], v18 offset:7712
    v_mfma_f32_16x16x32_bf16 v[132:135], v[116:119], v[100:103], v[132:135]
    ds_read_b64_tr_b16 v[56:57], v18 offset:5184
    ds_read_b64_tr_b16 v[58:59], v18 offset:7744
    ds_read_b64_tr_b16 v[60:61], v18 offset:5216
    v_mfma_f32_16x16x32_bf16 v[136:139], v[116:119], v[104:107], v[136:139]
    ds_read_b64_tr_b16 v[62:63], v18 offset:7776
    ds_read_b64_tr_b16 v[64:65], v18 offset:5248
    ds_read_b64_tr_b16 v[66:67], v18 offset:7808
    v_mfma_f32_16x16x32_bf16 v[140:143], v[116:119], v[108:111], v[140:143]
    ds_read_b64_tr_b16 v[68:69], v20 offset:4096
    ds_read_b64_tr_b16 v[70:71], v20 offset:6144
    v_mfma_f32_16x16x32_bf16 v[144:147], v[116:119], v[112:115], v[144:147]
    s_waitcnt lgkmcnt(0)
    v_mfma_f32_16x16x32_bf16 v[128:131], v[44:47], v[24:27], v[128:131]
    ds_read_b64_tr_b16 v[72:73], v18 offset:10240
    ds_read_b64_tr_b16 v[74:75], v18 offset:12800
    ds_read_b64_tr_b16 v[76:77], v18 offset:10272
    v_mfma_f32_16x16x32_bf16 v[132:135], v[44:47], v[28:31], v[132:135]
    ds_read_b64_tr_b16 v[78:79], v18 offset:12832
    ds_read_b64_tr_b16 v[80:81], v18 offset:10304
    ds_read_b64_tr_b16 v[82:83], v18 offset:12864
    v_mfma_f32_16x16x32_bf16 v[136:139], v[44:47], v[32:35], v[136:139]
    ds_read_b64_tr_b16 v[84:85], v18 offset:10336
    ds_read_b64_tr_b16 v[86:87], v18 offset:12896
    ds_read_b64_tr_b16 v[88:89], v18 offset:10368
    v_mfma_f32_16x16x32_bf16 v[140:143], v[44:47], v[36:39], v[140:143]
    ds_read_b64_tr_b16 v[90:91], v18 offset:12928
    ds_read_b64_tr_b16 v[92:93], v20 offset:8192
    ds_read_b64_tr_b16 v[94:95], v20 offset:10240
    v_mfma_f32_16x16x32_bf16 v[144:147], v[44:47], v[40:43], v[144:147]
    ds_read_b64_tr_b16 v[96:97], v18 offset:15360
    ds_read_b64_tr_b16 v[98:99], v18 offset:17920
    ds_read_b64_tr_b16 v[100:101], v18 offset:15392
    v_mfma_f32_16x16x32_bf16 v[128:131], v[68:71], v[48:51], v[128:131]
    ds_read_b64_tr_b16 v[102:103], v18 offset:17952
    ds_read_b64_tr_b16 v[104:105], v18 offset:15424
    ds_read_b64_tr_b16 v[106:107], v18 offset:17984
    v_mfma_f32_16x16x32_bf16 v[132:135], v[68:71], v[52:55], v[132:135]
    ds_read_b64_tr_b16 v[108:109], v18 offset:15456
    ds_read_b64_tr_b16 v[110:111], v18 offset:18016
    ds_read_b64_tr_b16 v[112:113], v18 offset:15488
    v_mfma_f32_16x16x32_bf16 v[136:139], v[68:71], v[56:59], v[136:139]
    ds_read_b64_tr_b16 v[114:115], v18 offset:18048
    ds_read_b64_tr_b16 v[116:117], v20 offset:12288
    ds_read_b64_tr_b16 v[118:119], v20 offset:14336
    v_mfma_f32_16x16x32_bf16 v[140:143], v[68:71], v[60:63], v[140:143]
    v_mfma_f32_16x16x32_bf16 v[144:147], v[68:71], v[64:67], v[144:147]
    s_waitcnt lgkmcnt(0)
    s_barrier
    v_mfma_f32_16x16x32_bf16 v[128:131], v[92:95], v[72:75], v[128:131]
    v_add_u32 v18, 73728, v17
    v_add_u32 v20, 73728, v19
    ds_read_b64_tr_b16 v[24:25], v18 offset:0
    v_mfma_f32_16x16x32_bf16 v[132:135], v[92:95], v[76:79], v[132:135]
    ds_read_b64_tr_b16 v[26:27], v18 offset:2560
    ds_read_b64_tr_b16 v[28:29], v18 offset:32
    ds_read_b64_tr_b16 v[30:31], v18 offset:2592
    v_mfma_f32_16x16x32_bf16 v[136:139], v[92:95], v[80:83], v[136:139]
    ds_read_b64_tr_b16 v[32:33], v18 offset:64
    ds_read_b64_tr_b16 v[34:35], v18 offset:2624
    ds_read_b64_tr_b16 v[36:37], v18 offset:96
    v_mfma_f32_16x16x32_bf16 v[140:143], v[92:95], v[84:87], v[140:143]
    ds_read_b64_tr_b16 v[38:39], v18 offset:2656
    ds_read_b64_tr_b16 v[40:41], v18 offset:128
    ds_read_b64_tr_b16 v[42:43], v18 offset:2688
    v_mfma_f32_16x16x32_bf16 v[144:147], v[92:95], v[88:91], v[144:147]
    ds_read_b64_tr_b16 v[44:45], v20 offset:0
    ds_read_b64_tr_b16 v[46:47], v20 offset:2048
    ds_read_b64_tr_b16 v[48:49], v18 offset:5120
    v_mfma_f32_16x16x32_bf16 v[128:131], v[116:119], v[96:99], v[128:131]
    ds_read_b64_tr_b16 v[50:51], v18 offset:7680
    ds_read_b64_tr_b16 v[52:53], v18 offset:5152
    ds_read_b64_tr_b16 v[54:55], v18 offset:7712
    v_mfma_f32_16x16x32_bf16 v[132:135], v[116:119], v[100:103], v[132:135]
    ds_read_b64_tr_b16 v[56:57], v18 offset:5184
    ds_read_b64_tr_b16 v[58:59], v18 offset:7744
    ds_read_b64_tr_b16 v[60:61], v18 offset:5216
    v_mfma_f32_16x16x32_bf16 v[136:139], v[116:119], v[104:107], v[136:139]
    ds_read_b64_tr_b16 v[62:63], v18 offset:7776
    ds_read_b64_tr_b16 v[64:65], v18 offset:5248
    ds_read_b64_tr_b16 v[66:67], v18 offset:7808
    v_mfma_f32_16x16x32_bf16 v[140:143], v[116:119], v[108:111], v[140:143]
    ds_read_b64_tr_b16 v[68:69], v20 offset:4096
    ds_read_b64_tr_b16 v[70:71], v20 offset:6144
    v_mfma_f32_16x16x32_bf16 v[144:147], v[116:119], v[112:115], v[144:147]
    s_waitcnt lgkmcnt(0)
    v_mfma_f32_16x16x32_bf16 v[128:131], v[44:47], v[24:27], v[128:131]
    ds_read_b64_tr_b16 v[72:73], v18 offset:10240
    ds_read_b64_tr_b16 v[74:75], v18 offset:12800
    ds_read_b64_tr_b16 v[76:77], v18 offset:10272
    v_mfma_f32_16x16x32_bf16 v[132:135], v[44:47], v[28:31], v[132:135]
    ds_read_b64_tr_b16 v[78:79], v18 offset:12832
    ds_read_b64_tr_b16 v[80:81], v18 offset:10304
    ds_read_b64_tr_b16 v[82:83], v18 offset:12864
    v_mfma_f32_16x16x32_bf16 v[136:139], v[44:47], v[32:35], v[136:139]
    ds_read_b64_tr_b16 v[84:85], v18 offset:10336
    ds_read_b64_tr_b16 v[86:87], v18 offset:12896
    ds_read_b64_tr_b16 v[88:89], v18 offset:10368
    v_mfma_f32_16x16x32_bf16 v[140:143], v[44:47], v[36:39], v[140:143]
    ds_read_b64_tr_b16 v[90:91], v18 offset:12928
    ds_read_b64_tr_b16 v[92:93], v20 offset:8192
    ds_read_b64_tr_b16 v[94:95], v20 offset:10240
    v_mfma_f32_16x16x32_bf16 v[144:147], v[44:47], v[40:43], v[144:147]
    ds_read_b64_tr_b16 v[96:97], v18 offset:15360
    ds_read_b64_tr_b16 v[98:99], v18 offset:17920
    ds_read_b64_tr_b16 v[100:101], v18 offset:15392
    v_mfma_f32_16x16x32_bf16 v[128:131], v[68:71], v[48:51], v[128:131]
    ds_read_b64_tr_b16 v[102:103], v18 offset:17952
    ds_read_b64_tr_b16 v[104:105], v18 offset:15424
    ds_read_b64_tr_b16 v[106:107], v18 offset:17984
    v_mfma_f32_16x16x32_bf16 v[132:135], v[68:71], v[52:55], v[132:135]
    ds_read_b64_tr_b16 v[108:109], v18 offset:15456
    ds_read_b64_tr_b16 v[110:111], v18 offset:18016
    ds_read_b64_tr_b16 v[112:113], v18 offset:15488
    v_mfma_f32_16x16x32_bf16 v[136:139], v[68:71], v[56:59], v[136:139]
    ds_read_b64_tr_b16 v[114:115], v18 offset:18048
    ds_read_b64_tr_b16 v[116:117], v20 offset:12288
    ds_read_b64_tr_b16 v[118:119], v20 offset:14336
    v_mfma_f32_16x16x32_bf16 v[140:143], v[68:71], v[60:63], v[140:143]
    v_mfma_f32_16x16x32_bf16 v[144:147], v[68:71], v[64:67], v[144:147]
    s_waitcnt lgkmcnt(0)
    s_barrier
    v_mfma_f32_16x16x32_bf16 v[128:131], v[92:95], v[72:75], v[128:131]
    v_add_u32 v18, 110592, v17
    v_add_u32 v20, 110592, v19
    ds_read_b64_tr_b16 v[24:25], v18 offset:0
    v_mfma_f32_16x16x32_bf16 v[132:135], v[92:95], v[76:79], v[132:135]
    ds_read_b64_tr_b16 v[26:27], v18 offset:2560
    ds_read_b64_tr_b16 v[28:29], v18 offset:32
    ds_read_b64_tr_b16 v[30:31], v18 offset:2592
    v_mfma_f32_16x16x32_bf16 v[136:139], v[92:95], v[80:83], v[136:139]
    ds_read_b64_tr_b16 v[32:33], v18 offset:64
    ds_read_b64_tr_b16 v[34:35], v18 offset:2624
    ds_read_b64_tr_b16 v[36:37], v18 offset:96
    v_mfma_f32_16x16x32_bf16 v[140:143], v[92:95], v[84:87], v[140:143]
    ds_read_b64_tr_b16 v[38:39], v18 offset:2656
    ds_read_b64_tr_b16 v[40:41], v18 offset:128
    ds_read_b64_tr_b16 v[42:43], v18 offset:2688
    v_mfma_f32_16x16x32_bf16 v[144:147], v[92:95], v[88:91], v[144:147]
    ds_read_b64_tr_b16 v[44:45], v20 offset:0
    ds_read_b64_tr_b16 v[46:47], v20 offset:2048
    ds_read_b64_tr_b16 v[48:49], v18 offset:5120
    v_mfma_f32_16x16x32_bf16 v[128:131], v[116:119], v[96:99], v[128:131]
    ds_read_b64_tr_b16 v[50:51], v18 offset:7680
    ds_read_b64_tr_b16 v[52:53], v18 offset:5152
    ds_read_b64_tr_b16 v[54:55], v18 offset:7712
    v_mfma_f32_16x16x32_bf16 v[132:135], v[116:119], v[100:103], v[132:135]
    ds_read_b64_tr_b16 v[56:57], v18 offset:5184
    ds_read_b64_tr_b16 v[58:59], v18 offset:7744
    ds_read_b64_tr_b16 v[60:61], v18 offset:5216
    v_mfma_f32_16x16x32_bf16 v[136:139], v[116:119], v[104:107], v[136:139]
    ds_read_b64_tr_b16 v[62:63], v18 offset:7776
    ds_read_b64_tr_b16 v[64:65], v18 offset:5248
    ds_read_b64_tr_b16 v[66:67], v18 offset:7808
    v_mfma_f32_16x16x32_bf16 v[140:143], v[116:119], v[108:111], v[140:143]
    ds_read_b64_tr_b16 v[68:69], v20 offset:4096
    ds_read_b64_tr_b16 v[70:71], v20 offset:6144
    v_mfma_f32_16x16x32_bf16 v[144:147], v[116:119], v[112:115], v[144:147]
    s_waitcnt lgkmcnt(0)
    v_mfma_f32_16x16x32_bf16 v[128:131], v[44:47], v[24:27], v[128:131]
    ds_read_b64_tr_b16 v[72:73], v18 offset:10240
    ds_read_b64_tr_b16 v[74:75], v18 offset:12800
    ds_read_b64_tr_b16 v[76:77], v18 offset:10272
    v_mfma_f32_16x16x32_bf16 v[132:135], v[44:47], v[28:31], v[132:135]
    ds_read_b64_tr_b16 v[78:79], v18 offset:12832
    ds_read_b64_tr_b16 v[80:81], v18 offset:10304
    ds_read_b64_tr_b16 v[82:83], v18 offset:12864
    v_mfma_f32_16x16x32_bf16 v[136:139], v[44:47], v[32:35], v[136:139]
    ds_read_b64_tr_b16 v[84:85], v18 offset:10336
    ds_read_b64_tr_b16 v[86:87], v18 offset:12896
    ds_read_b64_tr_b16 v[88:89], v18 offset:10368
    v_mfma_f32_16x16x32_bf16 v[140:143], v[44:47], v[36:39], v[140:143]
    ds_read_b64_tr_b16 v[90:91], v18 offset:12928
    ds_read_b64_tr_b16 v[92:93], v20 offset:8192
    ds_read_b64_tr_b16 v[94:95], v20 offset:10240
    v_mfma_f32_16x16x32_bf16 v[144:147], v[44:47], v[40:43], v[144:147]
    ds_read_b64_tr_b16 v[96:97], v18 offset:15360
    ds_read_b64_tr_b16 v[98:99], v18 offset:17920
    ds_read_b64_tr_b16 v[100:101], v18 offset:15392
    v_mfma_f32_16x16x32_bf16 v[128:131], v[68:71], v[48:51], v[128:131]
    ds_read_b64_tr_b16 v[102:103], v18 offset:17952
    ds_read_b64_tr_b16 v[104:105], v18 offset:15424
    ds_read_b64_tr_b16 v[106:107], v18 offset:17984
    v_mfma_f32_16x16x32_bf16 v[132:135], v[68:71], v[52:55], v[132:135]
    ds_read_b64_tr_b16 v[108:109], v18 offset:15456
    ds_read_b64_tr_b16 v[110:111], v18 offset:18016
    ds_read_b64_tr_b16 v[112:113], v18 offset:15488
    v_mfma_f32_16x16x32_bf16 v[136:139], v[68:71], v[56:59], v[136:139]
    ds_read_b64_tr_b16 v[114:115], v18 offset:18048
    ds_read_b64_tr_b16 v[116:117], v20 offset:12288
    ds_read_b64_tr_b16 v[118:119], v20 offset:14336
    v_mfma_f32_16x16x32_bf16 v[140:143], v[68:71], v[60:63], v[140:143]
    v_mfma_f32_16x16x32_bf16 v[144:147], v[68:71], v[64:67], v[144:147]
    s_waitcnt lgkmcnt(0)
    s_barrier
    v_mfma_f32_16x16x32_bf16 v[128:131], v[92:95], v[72:75], v[128:131]
    v_add_u32 v18, 0, v17
    v_add_u32 v20, 0, v19
    ds_read_b64_tr_b16 v[24:25], v18 offset:0
    v_mfma_f32_16x16x32_bf16 v[132:135], v[92:95], v[76:79], v[132:135]
    ds_read_b64_tr_b16 v[26:27], v18 offset:2560
    ds_read_b64_tr_b16 v[28:29], v18 offset:32
    ds_read_b64_tr_b16 v[30:31], v18 offset:2592
    v_mfma_f32_16x16x32_bf16 v[136:139], v[92:95], v[80:83], v[136:139]
    ds_read_b64_tr_b16 v[32:33], v18 offset:64
    ds_read_b64_tr_b16 v[34:35], v18 offset:2624
    ds_read_b64_tr_b16 v[36:37], v18 offset:96
    v_mfma_f32_16x16x32_bf16 v[140:143], v[92:95], v[84:87], v[140:143]
    ds_read_b64_tr_b16 v[38:39], v18 offset:2656
    ds_read_b64_tr_b16 v[40:41], v18 offset:128
    ds_read_b64_tr_b16 v[42:43], v18 offset:2688
    v_mfma_f32_16x16x32_bf16 v[144:147], v[92:95], v[88:91], v[144:147]
    ds_read_b64_tr_b16 v[44:45], v20 offset:0
    ds_read_b64_tr_b16 v[46:47], v20 offset:2048
    ds_read_b64_tr_b16 v[48:49], v18 offset:5120
    v_mfma_f32_16x16x32_bf16 v[128:131], v[116:119], v[96:99], v[128:131]
    ds_read_b64_tr_b16 v[50:51], v18 offset:7680
    ds_read_b64_tr_b16 v[52:53], v18 offset:5152
    ds_read_b64_tr_b16 v[54:55], v18 offset:7712
    v_mfma_f32_16x16x32_bf16 v[132:135], v[116:119], v[100:103], v[132:135]
    ds_read_b64_tr_b16 v[56:57], v18 offset:5184
    ds_read_b64_tr_b16 v[58:59], v18 offset:7744
    ds_read_b64_tr_b16 v[60:61], v18 offset:5216
    v_mfma_f32_16x16x32_bf16 v[136:139], v[116:119], v[104:107], v[136:139]
    ds_read_b64_tr_b16 v[62:63], v18 offset:7776
    ds_read_b64_tr_b16 v[64:65], v18 offset:5248
    ds_read_b64_tr_b16 v[66:67], v18 offset:7808
    v_mfma_f32_16x16x32_bf16 v[140:143], v[116:119], v[108:111], v[140:143]
    ds_read_b64_tr_b16 v[68:69], v20 offset:4096
    ds_read_b64_tr_b16 v[70:71], v20 offset:6144
    v_mfma_f32_16x16x32_bf16 v[144:147], v[116:119], v[112:115], v[144:147]
    s_waitcnt lgkmcnt(0)
    v_mfma_f32_16x16x32_bf16 v[128:131], v[44:47], v[24:27], v[128:131]
    ds_read_b64_tr_b16 v[72:73], v18 offset:10240
    ds_read_b64_tr_b16 v[74:75], v18 offset:12800
    ds_read_b64_tr_b16 v[76:77], v18 offset:10272
    v_mfma_f32_16x16x32_bf16 v[132:135], v[44:47], v[28:31], v[132:135]
    ds_read_b64_tr_b16 v[78:79], v18 offset:12832
    ds_read_b64_tr_b16 v[80:81], v18 offset:10304
    ds_read_b64_tr_b16 v[82:83], v18 offset:12864
    v_mfma_f32_16x16x32_bf16 v[136:139], v[44:47], v[32:35], v[136:139]
    ds_read_b64_tr_b16 v[84:85], v18 offset:10336
    ds_read_b64_tr_b16 v[86:87], v18 offset:12896
    ds_read_b64_tr_b16 v[88:89], v18 offset:10368
    v_mfma_f32_16x16x32_bf16 v[140:143], v[44:47], v[36:39], v[140:143]
    ds_read_b64_tr_b16 v[90:91], v18 offset:12928
    ds_read_b64_tr_b16 v[92:93], v20 offset:8192
    ds_read_b64_tr_b16 v[94:95], v20 offset:10240
    v_mfma_f32_16x16x32_bf16 v[144:147], v[44:47], v[40:43], v[144:147]
    ds_read_b64_tr_b16 v[96:97], v18 offset:15360
    ds_read_b64_tr_b16 v[98:99], v18 offset:17920
    ds_read_b64_tr_b16 v[100:101], v18 offset:15392
    v_mfma_f32_16x16x32_bf16 v[128:131], v[68:71], v[48:51], v[128:131]
    ds_read_b64_tr_b16 v[102:103], v18 offset:17952
    ds_read_b64_tr_b16 v[104:105], v18 offset:15424
    ds_read_b64_tr_b16 v[106:107], v18 offset:17984
    v_mfma_f32_16x16x32_bf16 v[132:135], v[68:71], v[52:55], v[132:135]
    ds_read_b64_tr_b16 v[108:109], v18 offset:15456
    ds_read_b64_tr_b16 v[110:111], v18 offset:18016
    ds_read_b64_tr_b16 v[112:113], v18 offset:15488
    v_mfma_f32_16x16x32_bf16 v[136:139], v[68:71], v[56:59], v[136:139]
    ds_read_b64_tr_b16 v[114:115], v18 offset:18048
    ds_read_b64_tr_b16 v[116:117], v20 offset:12288
    ds_read_b64_tr_b16 v[118:119], v20 offset:14336
    v_mfma_f32_16x16x32_bf16 v[140:143], v[68:71], v[60:63], v[140:143]
    v_mfma_f32_16x16x32_bf16 v[144:147], v[68:71], v[64:67], v[144:147]
    s_waitcnt lgkmcnt(0)
    s_barrier
    v_mfma_f32_16x16x32_bf16 v[128:131], v[92:95], v[72:75], v[128:131]
    v_add_u32 v18, 36864, v17
    v_add_u32 v20, 36864, v19
    ds_read_b64_tr_b16 v[24:25], v18 offset:0
    v_mfma_f32_16x16x32_bf16 v[132:135], v[92:95], v[76:79], v[132:135]
    ds_read_b64_tr_b16 v[26:27], v18 offset:2560
    ds_read_b64_tr_b16 v[28:29], v18 offset:32
    ds_read_b64_tr_b16 v[30:31], v18 offset:2592
    v_mfma_f32_16x16x32_bf16 v[136:139], v[92:95], v[80:83], v[136:139]
    ds_read_b64_tr_b16 v[32:33], v18 offset:64
    ds_read_b64_tr_b16 v[34:35], v18 offset:2624
    ds_read_b64_tr_b16 v[36:37], v18 offset:96
    v_mfma_f32_16x16x32_bf16 v[140:143], v[92:95], v[84:87], v[140:143]
    ds_read_b64_tr_b16 v[38:39], v18 offset:2656
    ds_read_b64_tr_b16 v[40:41], v18 offset:128
    ds_read_b64_tr_b16 v[42:43], v18 offset:2688
    v_mfma_f32_16x16x32_bf16 v[144:147], v[92:95], v[88:91], v[144:147]
    ds_read_b64_tr_b16 v[44:45], v20 offset:0
    ds_read_b64_tr_b16 v[46:47], v20 offset:2048
    ds_read_b64_tr_b16 v[48:49], v18 offset:5120
    v_mfma_f32_16x16x32_bf16 v[128:131], v[116:119], v[96:99], v[128:131]
    ds_read_b64_tr_b16 v[50:51], v18 offset:7680
    ds_read_b64_tr_b16 v[52:53], v18 offset:5152
    ds_read_b64_tr_b16 v[54:55], v18 offset:7712
    v_mfma_f32_16x16x32_bf16 v[132:135], v[116:119], v[100:103], v[132:135]
    ds_read_b64_tr_b16 v[56:57], v18 offset:5184
    ds_read_b64_tr_b16 v[58:59], v18 offset:7744
    ds_read_b64_tr_b16 v[60:61], v18 offset:5216
    v_mfma_f32_16x16x32_bf16 v[136:139], v[116:119], v[104:107], v[136:139]
    ds_read_b64_tr_b16 v[62:63], v18 offset:7776
    ds_read_b64_tr_b16 v[64:65], v18 offset:5248
    ds_read_b64_tr_b16 v[66:67], v18 offset:7808
    v_mfma_f32_16x16x32_bf16 v[140:143], v[116:119], v[108:111], v[140:143]
    ds_read_b64_tr_b16 v[68:69], v20 offset:4096
    ds_read_b64_tr_b16 v[70:71], v20 offset:6144
    v_mfma_f32_16x16x32_bf16 v[144:147], v[116:119], v[112:115], v[144:147]
    s_waitcnt lgkmcnt(0)
    v_mfma_f32_16x16x32_bf16 v[128:131], v[44:47], v[24:27], v[128:131]
    ds_read_b64_tr_b16 v[72:73], v18 offset:10240
    ds_read_b64_tr_b16 v[74:75], v18 offset:12800
    ds_read_b64_tr_b16 v[76:77], v18 offset:10272
    v_mfma_f32_16x16x32_bf16 v[132:135], v[44:47], v[28:31], v[132:135]
    ds_read_b64_tr_b16 v[78:79], v18 offset:12832
    ds_read_b64_tr_b16 v[80:81], v18 offset:10304
    ds_read_b64_tr_b16 v[82:83], v18 offset:12864
    v_mfma_f32_16x16x32_bf16 v[136:139], v[44:47], v[32:35], v[136:139]
    ds_read_b64_tr_b16 v[84:85], v18 offset:10336
    ds_read_b64_tr_b16 v[86:87], v18 offset:12896
    ds_read_b64_tr_b16 v[88:89], v18 offset:10368
    v_mfma_f32_16x16x32_bf16 v[140:143], v[44:47], v[36:39], v[140:143]
    ds_read_b64_tr_b16 v[90:91], v18 offset:12928
    ds_read_b64_tr_b16 v[92:93], v20 offset:8192
    ds_read_b64_tr_b16 v[94:95], v20 offset:10240
    v_mfma_f32_16x16x32_bf16 v[144:147], v[44:47], v[40:43], v[144:147]
    ds_read_b64_tr_b16 v[96:97], v18 offset:15360
    ds_read_b64_tr_b16 v[98:99], v18 offset:17920
    ds_read_b64_tr_b16 v[100:101], v18 offset:15392
    v_mfma_f32_16x16x32_bf16 v[128:131], v[68:71], v[48:51], v[128:131]
    ds_read_b64_tr_b16 v[102:103], v18 offset:17952
    ds_read_b64_tr_b16 v[104:105], v18 offset:15424
    ds_read_b64_tr_b16 v[106:107], v18 offset:17984
    v_mfma_f32_16x16x32_bf16 v[132:135], v[68:71], v[52:55], v[132:135]
    ds_read_b64_tr_b16 v[108:109], v18 offset:15456
    ds_read_b64_tr_b16 v[110:111], v18 offset:18016
    ds_read_b64_tr_b16 v[112:113], v18 offset:15488
    v_mfma_f32_16x16x32_bf16 v[136:139], v[68:71], v[56:59], v[136:139]
    ds_read_b64_tr_b16 v[114:115], v18 offset:18048
    ds_read_b64_tr_b16 v[116:117], v20 offset:12288
    ds_read_b64_tr_b16 v[118:119], v20 offset:14336
    v_mfma_f32_16x16x32_bf16 v[140:143], v[68:71], v[60:63], v[140:143]
    v_mfma_f32_16x16x32_bf16 v[144:147], v[68:71], v[64:67], v[144:147]
    s_waitcnt lgkmcnt(0)
    s_barrier
    v_mfma_f32_16x16x32_bf16 v[128:131], v[92:95], v[72:75], v[128:131]
    v_add_u32 v18, 73728, v17
    v_add_u32 v20, 73728, v19
    ds_read_b64_tr_b16 v[24:25], v18 offset:0
    v_mfma_f32_16x16x32_bf16 v[132:135], v[92:95], v[76:79], v[132:135]
    ds_read_b64_tr_b16 v[26:27], v18 offset:2560
    ds_read_b64_tr_b16 v[28:29], v18 offset:32
    ds_read_b64_tr_b16 v[30:31], v18 offset:2592
    v_mfma_f32_16x16x32_bf16 v[136:139], v[92:95], v[80:83], v[136:139]
    ds_read_b64_tr_b16 v[32:33], v18 offset:64
    ds_read_b64_tr_b16 v[34:35], v18 offset:2624
    ds_read_b64_tr_b16 v[36:37], v18 offset:96
    v_mfma_f32_16x16x32_bf16 v[140:143], v[92:95], v[84:87], v[140:143]
    ds_read_b64_tr_b16 v[38:39], v18 offset:2656
    ds_read_b64_tr_b16 v[40:41], v18 offset:128
    ds_read_b64_tr_b16 v[42:43], v18 offset:2688
    v_mfma_f32_16x16x32_bf16 v[144:147], v[92:95], v[88:91], v[144:147]
    ds_read_b64_tr_b16 v[44:45], v20 offset:0
    ds_read_b64_tr_b16 v[46:47], v20 offset:2048
    ds_read_b64_tr_b16 v[48:49], v18 offset:5120
    v_mfma_f32_16x16x32_bf16 v[128:131], v[116:119], v[96:99], v[128:131]
    ds_read_b64_tr_b16 v[50:51], v18 offset:7680
    ds_read_b64_tr_b16 v[52:53], v18 offset:5152
    ds_read_b64_tr_b16 v[54:55], v18 offset:7712
    v_mfma_f32_16x16x32_bf16 v[132:135], v[116:119], v[100:103], v[132:135]
    ds_read_b64_tr_b16 v[56:57], v18 offset:5184
    ds_read_b64_tr_b16 v[58:59], v18 offset:7744
    ds_read_b64_tr_b16 v[60:61], v18 offset:5216
    v_mfma_f32_16x16x32_bf16 v[136:139], v[116:119], v[104:107], v[136:139]
    ds_read_b64_tr_b16 v[62:63], v18 offset:7776
    ds_read_b64_tr_b16 v[64:65], v18 offset:5248
    ds_read_b64_tr_b16 v[66:67], v18 offset:7808
    v_mfma_f32_16x16x32_bf16 v[140:143], v[116:119], v[108:111], v[140:143]
    ds_read_b64_tr_b16 v[68:69], v20 offset:4096
    ds_read_b64_tr_b16 v[70:71], v20 offset:6144
    v_mfma_f32_16x16x32_bf16 v[144:147], v[116:119], v[112:115], v[144:147]
    s_waitcnt lgkmcnt(0)
    v_mfma_f32_16x16x32_bf16 v[128:131], v[44:47], v[24:27], v[128:131]
    ds_read_b64_tr_b16 v[72:73], v18 offset:10240
    ds_read_b64_tr_b16 v[74:75], v18 offset:12800
    ds_read_b64_tr_b16 v[76:77], v18 offset:10272
    v_mfma_f32_16x16x32_bf16 v[132:135], v[44:47], v[28:31], v[132:135]
    ds_read_b64_tr_b16 v[78:79], v18 offset:12832
    ds_read_b64_tr_b16 v[80:81], v18 offset:10304
    ds_read_b64_tr_b16 v[82:83], v18 offset:12864
    v_mfma_f32_16x16x32_bf16 v[136:139], v[44:47], v[32:35], v[136:139]
    ds_read_b64_tr_b16 v[84:85], v18 offset:10336
    ds_read_b64_tr_b16 v[86:87], v18 offset:12896
    ds_read_b64_tr_b16 v[88:89], v18 offset:10368
    v_mfma_f32_16x16x32_bf16 v[140:143], v[44:47], v[36:39], v[140:143]
    ds_read_b64_tr_b16 v[90:91], v18 offset:12928
    ds_read_b64_tr_b16 v[92:93], v20 offset:8192
    ds_read_b64_tr_b16 v[94:95], v20 offset:10240
    v_mfma_f32_16x16x32_bf16 v[144:147], v[44:47], v[40:43], v[144:147]
    ds_read_b64_tr_b16 v[96:97], v18 offset:15360
    ds_read_b64_tr_b16 v[98:99], v18 offset:17920
    ds_read_b64_tr_b16 v[100:101], v18 offset:15392
    v_mfma_f32_16x16x32_bf16 v[128:131], v[68:71], v[48:51], v[128:131]
    ds_read_b64_tr_b16 v[102:103], v18 offset:17952
    ds_read_b64_tr_b16 v[104:105], v18 offset:15424
    ds_read_b64_tr_b16 v[106:107], v18 offset:17984
    v_mfma_f32_16x16x32_bf16 v[132:135], v[68:71], v[52:55], v[132:135]
    ds_read_b64_tr_b16 v[108:109], v18 offset:15456
    ds_read_b64_tr_b16 v[110:111], v18 offset:18016
    ds_read_b64_tr_b16 v[112:113], v18 offset:15488
    v_mfma_f32_16x16x32_bf16 v[136:139], v[68:71], v[56:59], v[136:139]
    ds_read_b64_tr_b16 v[114:115], v18 offset:18048
    ds_read_b64_tr_b16 v[116:117], v20 offset:12288
    ds_read_b64_tr_b16 v[118:119], v20 offset:14336
    v_mfma_f32_16x16x32_bf16 v[140:143], v[68:71], v[60:63], v[140:143]
    v_mfma_f32_16x16x32_bf16 v[144:147], v[68:71], v[64:67], v[144:147]
    s_waitcnt lgkmcnt(0)
    s_barrier
    v_mfma_f32_16x16x32_bf16 v[128:131], v[92:95], v[72:75], v[128:131]
    v_add_u32 v18, 110592, v17
    v_add_u32 v20, 110592, v19
    ds_read_b64_tr_b16 v[24:25], v18 offset:0
    v_mfma_f32_16x16x32_bf16 v[132:135], v[92:95], v[76:79], v[132:135]
    ds_read_b64_tr_b16 v[26:27], v18 offset:2560
    ds_read_b64_tr_b16 v[28:29], v18 offset:32
    ds_read_b64_tr_b16 v[30:31], v18 offset:2592
    v_mfma_f32_16x16x32_bf16 v[136:139], v[92:95], v[80:83], v[136:139]
    ds_read_b64_tr_b16 v[32:33], v18 offset:64
    ds_read_b64_tr_b16 v[34:35], v18 offset:2624
    ds_read_b64_tr_b16 v[36:37], v18 offset:96
    v_mfma_f32_16x16x32_bf16 v[140:143], v[92:95], v[84:87], v[140:143]
    ds_read_b64_tr_b16 v[38:39], v18 offset:2656
    ds_read_b64_tr_b16 v[40:41], v18 offset:128
    ds_read_b64_tr_b16 v[42:43], v18 offset:2688
    v_mfma_f32_16x16x32_bf16 v[144:147], v[92:95], v[88:91], v[144:147]
    ds_read_b64_tr_b16 v[44:45], v20 offset:0
    ds_read_b64_tr_b16 v[46:47], v20 offset:2048
    ds_read_b64_tr_b16 v[48:49], v18 offset:5120
    v_mfma_f32_16x16x32_bf16 v[128:131], v[116:119], v[96:99], v[128:131]
    ds_read_b64_tr_b16 v[50:51], v18 offset:7680
    ds_read_b64_tr_b16 v[52:53], v18 offset:5152
    ds_read_b64_tr_b16 v[54:55], v18 offset:7712
    v_mfma_f32_16x16x32_bf16 v[132:135], v[116:119], v[100:103], v[132:135]
    ds_read_b64_tr_b16 v[56:57], v18 offset:5184
    ds_read_b64_tr_b16 v[58:59], v18 offset:7744
    ds_read_b64_tr_b16 v[60:61], v18 offset:5216
    v_mfma_f32_16x16x32_bf16 v[136:139], v[116:119], v[104:107], v[136:139]
    ds_read_b64_tr_b16 v[62:63], v18 offset:7776
    ds_read_b64_tr_b16 v[64:65], v18 offset:5248
    ds_read_b64_tr_b16 v[66:67], v18 offset:7808
    v_mfma_f32_16x16x32_bf16 v[140:143], v[116:119], v[108:111], v[140:143]
    ds_read_b64_tr_b16 v[68:69], v20 offset:4096
    ds_read_b64_tr_b16 v[70:71], v20 offset:6144
    v_mfma_f32_16x16x32_bf16 v[144:147], v[116:119], v[112:115], v[144:147]
    s_waitcnt lgkmcnt(0)
    v_mfma_f32_16x16x32_bf16 v[128:131], v[44:47], v[24:27], v[128:131]
    ds_read_b64_tr_b16 v[72:73], v18 offset:10240
    ds_read_b64_tr_b16 v[74:75], v18 offset:12800
    ds_read_b64_tr_b16 v[76:77], v18 offset:10272
    v_mfma_f32_16x16x32_bf16 v[132:135], v[44:47], v[28:31], v[132:135]
    ds_read_b64_tr_b16 v[78:79], v18 offset:12832
    ds_read_b64_tr_b16 v[80:81], v18 offset:10304
    ds_read_b64_tr_b16 v[82:83], v18 offset:12864
    v_mfma_f32_16x16x32_bf16 v[136:139], v[44:47], v[32:35], v[136:139]
    ds_read_b64_tr_b16 v[84:85], v18 offset:10336
    ds_read_b64_tr_b16 v[86:87], v18 offset:12896
    ds_read_b64_tr_b16 v[88:89], v18 offset:10368
    v_mfma_f32_16x16x32_bf16 v[140:143], v[44:47], v[36:39], v[140:143]
    ds_read_b64_tr_b16 v[90:91], v18 offset:12928
    ds_read_b64_tr_b16 v[92:93], v20 offset:8192
    ds_read_b64_tr_b16 v[94:95], v20 offset:10240
    v_mfma_f32_16x16x32_bf16 v[144:147], v[44:47], v[40:43], v[144:147]
    ds_read_b64_tr_b16 v[96:97], v18 offset:15360
    ds_read_b64_tr_b16 v[98:99], v18 offset:17920
    ds_read_b64_tr_b16 v[100:101], v18 offset:15392
    v_mfma_f32_16x16x32_bf16 v[128:131], v[68:71], v[48:51], v[128:131]
    ds_read_b64_tr_b16 v[102:103], v18 offset:17952
    ds_read_b64_tr_b16 v[104:105], v18 offset:15424
    ds_read_b64_tr_b16 v[106:107], v18 offset:17984
    v_mfma_f32_16x16x32_bf16 v[132:135], v[68:71], v[52:55], v[132:135]
    ds_read_b64_tr_b16 v[108:109], v18 offset:15456
    ds_read_b64_tr_b16 v[110:111], v18 offset:18016
    ds_read_b64_tr_b16 v[112:113], v18 offset:15488
    v_mfma_f32_16x16x32_bf16 v[136:139], v[68:71], v[56:59], v[136:139]
    ds_read_b64_tr_b16 v[114:115], v18 offset:18048
    ds_read_b64_tr_b16 v[116:117], v20 offset:12288
    ds_read_b64_tr_b16 v[118:119], v20 offset:14336
    v_mfma_f32_16x16x32_bf16 v[140:143], v[68:71], v[60:63], v[140:143]
    v_mfma_f32_16x16x32_bf16 v[144:147], v[68:71], v[64:67], v[144:147]
    s_waitcnt lgkmcnt(0)
    s_barrier
    v_mfma_f32_16x16x32_bf16 v[128:131], v[92:95], v[72:75], v[128:131]
    v_add_u32 v18, 0, v17
    v_add_u32 v20, 0, v19
    ds_read_b64_tr_b16 v[24:25], v18 offset:0
    v_mfma_f32_16x16x32_bf16 v[132:135], v[92:95], v[76:79], v[132:135]
    ds_read_b64_tr_b16 v[26:27], v18 offset:2560
    ds_read_b64_tr_b16 v[28:29], v18 offset:32
    ds_read_b64_tr_b16 v[30:31], v18 offset:2592
    v_mfma_f32_16x16x32_bf16 v[136:139], v[92:95], v[80:83], v[136:139]
    ds_read_b64_tr_b16 v[32:33], v18 offset:64
    ds_read_b64_tr_b16 v[34:35], v18 offset:2624
    ds_read_b64_tr_b16 v[36:37], v18 offset:96
    v_mfma_f32_16x16x32_bf16 v[140:143], v[92:95], v[84:87], v[140:143]
    ds_read_b64_tr_b16 v[38:39], v18 offset:2656
    ds_read_b64_tr_b16 v[40:41], v18 offset:128
    ds_read_b64_tr_b16 v[42:43], v18 offset:2688
    v_mfma_f32_16x16x32_bf16 v[144:147], v[92:95], v[88:91], v[144:147]
    ds_read_b64_tr_b16 v[44:45], v20 offset:0
    ds_read_b64_tr_b16 v[46:47], v20 offset:2048
    ds_read_b64_tr_b16 v[48:49], v18 offset:5120
    v_mfma_f32_16x16x32_bf16 v[128:131], v[116:119], v[96:99], v[128:131]
    ds_read_b64_tr_b16 v[50:51], v18 offset:7680
    ds_read_b64_tr_b16 v[52:53], v18 offset:5152
    ds_read_b64_tr_b16 v[54:55], v18 offset:7712
    v_mfma_f32_16x16x32_bf16 v[132:135], v[116:119], v[100:103], v[132:135]
    ds_read_b64_tr_b16 v[56:57], v18 offset:5184
    ds_read_b64_tr_b16 v[58:59], v18 offset:7744
    ds_read_b64_tr_b16 v[60:61], v18 offset:5216
    v_mfma_f32_16x16x32_bf16 v[136:139], v[116:119], v[104:107], v[136:139]
    ds_read_b64_tr_b16 v[62:63], v18 offset:7776
    ds_read_b64_tr_b16 v[64:65], v18 offset:5248
    ds_read_b64_tr_b16 v[66:67], v18 offset:7808
    v_mfma_f32_16x16x32_bf16 v[140:143], v[116:119], v[108:111], v[140:143]
    ds_read_b64_tr_b16 v[68:69], v20 offset:4096
    ds_read_b64_tr_b16 v[70:71], v20 offset:6144
    v_mfma_f32_16x16x32_bf16 v[144:147], v[116:119], v[112:115], v[144:147]
    s_waitcnt lgkmcnt(0)
    v_mfma_f32_16x16x32_bf16 v[128:131], v[44:47], v[24:27], v[128:131]
    ds_read_b64_tr_b16 v[72:73], v18 offset:10240
    ds_read_b64_tr_b16 v[74:75], v18 offset:12800
    ds_read_b64_tr_b16 v[76:77], v18 offset:10272
    v_mfma_f32_16x16x32_bf16 v[132:135], v[44:47], v[28:31], v[132:135]
    ds_read_b64_tr_b16 v[78:79], v18 offset:12832
    ds_read_b64_tr_b16 v[80:81], v18 offset:10304
    ds_read_b64_tr_b16 v[82:83], v18 offset:12864
    v_mfma_f32_16x16x32_bf16 v[136:139], v[44:47], v[32:35], v[136:139]
    ds_read_b64_tr_b16 v[84:85], v18 offset:10336
    ds_read_b64_tr_b16 v[86:87], v18 offset:12896
    ds_read_b64_tr_b16 v[88:89], v18 offset:10368
    v_mfma_f32_16x16x32_bf16 v[140:143], v[44:47], v[36:39], v[140:143]
    ds_read_b64_tr_b16 v[90:91], v18 offset:12928
    ds_read_b64_tr_b16 v[92:93], v20 offset:8192
    ds_read_b64_tr_b16 v[94:95], v20 offset:10240
    v_mfma_f32_16x16x32_bf16 v[144:147], v[44:47], v[40:43], v[144:147]
    ds_read_b64_tr_b16 v[96:97], v18 offset:15360
    ds_read_b64_tr_b16 v[98:99], v18 offset:17920
    ds_read_b64_tr_b16 v[100:101], v18 offset:15392
    v_mfma_f32_16x16x32_bf16 v[128:131], v[68:71], v[48:51], v[128:131]
    ds_read_b64_tr_b16 v[102:103], v18 offset:17952
    ds_read_b64_tr_b16 v[104:105], v18 offset:15424
    ds_read_b64_tr_b16 v[106:107], v18 offset:17984
    v_mfma_f32_16x16x32_bf16 v[132:135], v[68:71], v[52:55], v[132:135]
    ds_read_b64_tr_b16 v[108:109], v18 offset:15456
    ds_read_b64_tr_b16 v[110:111], v18 offset:18016
    ds_read_b64_tr_b16 v[112:113], v18 offset:15488
    v_mfma_f32_16x16x32_bf16 v[136:139], v[68:71], v[56:59], v[136:139]
    ds_read_b64_tr_b16 v[114:115], v18 offset:18048
    ds_read_b64_tr_b16 v[116:117], v20 offset:12288
    ds_read_b64_tr_b16 v[118:119], v20 offset:14336
    v_mfma_f32_16x16x32_bf16 v[140:143], v[68:71], v[60:63], v[140:143]
    v_mfma_f32_16x16x32_bf16 v[144:147], v[68:71], v[64:67], v[144:147]
    s_waitcnt lgkmcnt(0)
    s_barrier
    v_mfma_f32_16x16x32_bf16 v[128:131], v[92:95], v[72:75], v[128:131]
    v_add_u32 v18, 36864, v17
    v_add_u32 v20, 36864, v19
    ds_read_b64_tr_b16 v[24:25], v18 offset:0
    v_mfma_f32_16x16x32_bf16 v[132:135], v[92:95], v[76:79], v[132:135]
    ds_read_b64_tr_b16 v[26:27], v18 offset:2560
    ds_read_b64_tr_b16 v[28:29], v18 offset:32
    ds_read_b64_tr_b16 v[30:31], v18 offset:2592
    v_mfma_f32_16x16x32_bf16 v[136:139], v[92:95], v[80:83], v[136:139]
    ds_read_b64_tr_b16 v[32:33], v18 offset:64
    ds_read_b64_tr_b16 v[34:35], v18 offset:2624
    ds_read_b64_tr_b16 v[36:37], v18 offset:96
    v_mfma_f32_16x16x32_bf16 v[140:143], v[92:95], v[84:87], v[140:143]
    ds_read_b64_tr_b16 v[38:39], v18 offset:2656
    ds_read_b64_tr_b16 v[40:41], v18 offset:128
    ds_read_b64_tr_b16 v[42:43], v18 offset:2688
    v_mfma_f32_16x16x32_bf16 v[144:147], v[92:95], v[88:91], v[144:147]
    ds_read_b64_tr_b16 v[44:45], v20 offset:0
    ds_read_b64_tr_b16 v[46:47], v20 offset:2048
    ds_read_b64_tr_b16 v[48:49], v18 offset:5120
    v_mfma_f32_16x16x32_bf16 v[128:131], v[116:119], v[96:99], v[128:131]
    ds_read_b64_tr_b16 v[50:51], v18 offset:7680
    ds_read_b64_tr_b16 v[52:53], v18 offset:5152
    ds_read_b64_tr_b16 v[54:55], v18 offset:7712
    v_mfma_f32_16x16x32_bf16 v[132:135], v[116:119], v[100:103], v[132:135]
    ds_read_b64_tr_b16 v[56:57], v18 offset:5184
    ds_read_b64_tr_b16 v[58:59], v18 offset:7744
    ds_read_b64_tr_b16 v[60:61], v18 offset:5216
    v_mfma_f32_16x16x32_bf16 v[136:139], v[116:119], v[104:107], v[136:139]
    ds_read_b64_tr_b16 v[62:63], v18 offset:7776
    ds_read_b64_tr_b16 v[64:65], v18 offset:5248
    ds_read_b64_tr_b16 v[66:67], v18 offset:7808
    v_mfma_f32_16x16x32_bf16 v[140:143], v[116:119], v[108:111], v[140:143]
    ds_read_b64_tr_b16 v[68:69], v20 offset:4096
    ds_read_b64_tr_b16 v[70:71], v20 offset:6144
    v_mfma_f32_16x16x32_bf16 v[144:147], v[116:119], v[112:115], v[144:147]
    s_waitcnt lgkmcnt(0)
    v_mfma_f32_16x16x32_bf16 v[128:131], v[44:47], v[24:27], v[128:131]
    ds_read_b64_tr_b16 v[72:73], v18 offset:10240
    ds_read_b64_tr_b16 v[74:75], v18 offset:12800
    ds_read_b64_tr_b16 v[76:77], v18 offset:10272
    v_mfma_f32_16x16x32_bf16 v[132:135], v[44:47], v[28:31], v[132:135]
    ds_read_b64_tr_b16 v[78:79], v18 offset:12832
    ds_read_b64_tr_b16 v[80:81], v18 offset:10304
    ds_read_b64_tr_b16 v[82:83], v18 offset:12864
    v_mfma_f32_16x16x32_bf16 v[136:139], v[44:47], v[32:35], v[136:139]
    ds_read_b64_tr_b16 v[84:85], v18 offset:10336
    ds_read_b64_tr_b16 v[86:87], v18 offset:12896
    ds_read_b64_tr_b16 v[88:89], v18 offset:10368
    v_mfma_f32_16x16x32_bf16 v[140:143], v[44:47], v[36:39], v[140:143]
    ds_read_b64_tr_b16 v[90:91], v18 offset:12928
    ds_read_b64_tr_b16 v[92:93], v20 offset:8192
    ds_read_b64_tr_b16 v[94:95], v20 offset:10240
    v_mfma_f32_16x16x32_bf16 v[144:147], v[44:47], v[40:43], v[144:147]
    ds_read_b64_tr_b16 v[96:97], v18 offset:15360
    ds_read_b64_tr_b16 v[98:99], v18 offset:17920
    ds_read_b64_tr_b16 v[100:101], v18 offset:15392
    v_mfma_f32_16x16x32_bf16 v[128:131], v[68:71], v[48:51], v[128:131]
    ds_read_b64_tr_b16 v[102:103], v18 offset:17952
    ds_read_b64_tr_b16 v[104:105], v18 offset:15424
    ds_read_b64_tr_b16 v[106:107], v18 offset:17984
    v_mfma_f32_16x16x32_bf16 v[132:135], v[68:71], v[52:55], v[132:135]
    ds_read_b64_tr_b16 v[108:109], v18 offset:15456
    ds_read_b64_tr_b16 v[110:111], v18 offset:18016
    ds_read_b64_tr_b16 v[112:113], v18 offset:15488
    v_mfma_f32_16x16x32_bf16 v[136:139], v[68:71], v[56:59], v[136:139]
    ds_read_b64_tr_b16 v[114:115], v18 offset:18048
    ds_read_b64_tr_b16 v[116:117], v20 offset:12288
    ds_read_b64_tr_b16 v[118:119], v20 offset:14336
    v_mfma_f32_16x16x32_bf16 v[140:143], v[68:71], v[60:63], v[140:143]
    v_mfma_f32_16x16x32_bf16 v[144:147], v[68:71], v[64:67], v[144:147]
    s_waitcnt lgkmcnt(0)
    s_barrier
    v_mfma_f32_16x16x32_bf16 v[128:131], v[92:95], v[72:75], v[128:131]
    v_add_u32 v18, 73728, v17
    v_add_u32 v20, 73728, v19
    ds_read_b64_tr_b16 v[24:25], v18 offset:0
    v_mfma_f32_16x16x32_bf16 v[132:135], v[92:95], v[76:79], v[132:135]
    ds_read_b64_tr_b16 v[26:27], v18 offset:2560
    ds_read_b64_tr_b16 v[28:29], v18 offset:32
    ds_read_b64_tr_b16 v[30:31], v18 offset:2592
    v_mfma_f32_16x16x32_bf16 v[136:139], v[92:95], v[80:83], v[136:139]
    ds_read_b64_tr_b16 v[32:33], v18 offset:64
    ds_read_b64_tr_b16 v[34:35], v18 offset:2624
    ds_read_b64_tr_b16 v[36:37], v18 offset:96
    v_mfma_f32_16x16x32_bf16 v[140:143], v[92:95], v[84:87], v[140:143]
    ds_read_b64_tr_b16 v[38:39], v18 offset:2656
    ds_read_b64_tr_b16 v[40:41], v18 offset:128
    ds_read_b64_tr_b16 v[42:43], v18 offset:2688
    v_mfma_f32_16x16x32_bf16 v[144:147], v[92:95], v[88:91], v[144:147]
    ds_read_b64_tr_b16 v[44:45], v20 offset:0
    ds_read_b64_tr_b16 v[46:47], v20 offset:2048
    ds_read_b64_tr_b16 v[48:49], v18 offset:5120
    v_mfma_f32_16x16x32_bf16 v[128:131], v[116:119], v[96:99], v[128:131]
    ds_read_b64_tr_b16 v[50:51], v18 offset:7680
    ds_read_b64_tr_b16 v[52:53], v18 offset:5152
    ds_read_b64_tr_b16 v[54:55], v18 offset:7712
    v_mfma_f32_16x16x32_bf16 v[132:135], v[116:119], v[100:103], v[132:135]
    ds_read_b64_tr_b16 v[56:57], v18 offset:5184
    ds_read_b64_tr_b16 v[58:59], v18 offset:7744
    ds_read_b64_tr_b16 v[60:61], v18 offset:5216
    v_mfma_f32_16x16x32_bf16 v[136:139], v[116:119], v[104:107], v[136:139]
    ds_read_b64_tr_b16 v[62:63], v18 offset:7776
    ds_read_b64_tr_b16 v[64:65], v18 offset:5248
    ds_read_b64_tr_b16 v[66:67], v18 offset:7808
    v_mfma_f32_16x16x32_bf16 v[140:143], v[116:119], v[108:111], v[140:143]
    ds_read_b64_tr_b16 v[68:69], v20 offset:4096
    ds_read_b64_tr_b16 v[70:71], v20 offset:6144
    v_mfma_f32_16x16x32_bf16 v[144:147], v[116:119], v[112:115], v[144:147]
    s_waitcnt lgkmcnt(0)
    v_mfma_f32_16x16x32_bf16 v[128:131], v[44:47], v[24:27], v[128:131]
    ds_read_b64_tr_b16 v[72:73], v18 offset:10240
    ds_read_b64_tr_b16 v[74:75], v18 offset:12800
    ds_read_b64_tr_b16 v[76:77], v18 offset:10272
    v_mfma_f32_16x16x32_bf16 v[132:135], v[44:47], v[28:31], v[132:135]
    ds_read_b64_tr_b16 v[78:79], v18 offset:12832
    ds_read_b64_tr_b16 v[80:81], v18 offset:10304
    ds_read_b64_tr_b16 v[82:83], v18 offset:12864
    v_mfma_f32_16x16x32_bf16 v[136:139], v[44:47], v[32:35], v[136:139]
    ds_read_b64_tr_b16 v[84:85], v18 offset:10336
    ds_read_b64_tr_b16 v[86:87], v18 offset:12896
    ds_read_b64_tr_b16 v[88:89], v18 offset:10368
    v_mfma_f32_16x16x32_bf16 v[140:143], v[44:47], v[36:39], v[140:143]
    ds_read_b64_tr_b16 v[90:91], v18 offset:12928
    ds_read_b64_tr_b16 v[92:93], v20 offset:8192
    ds_read_b64_tr_b16 v[94:95], v20 offset:10240
    v_mfma_f32_16x16x32_bf16 v[144:147], v[44:47], v[40:43], v[144:147]
    ds_read_b64_tr_b16 v[96:97], v18 offset:15360
    ds_read_b64_tr_b16 v[98:99], v18 offset:17920
    ds_read_b64_tr_b16 v[100:101], v18 offset:15392
    v_mfma_f32_16x16x32_bf16 v[128:131], v[68:71], v[48:51], v[128:131]
    ds_read_b64_tr_b16 v[102:103], v18 offset:17952
    ds_read_b64_tr_b16 v[104:105], v18 offset:15424
    ds_read_b64_tr_b16 v[106:107], v18 offset:17984
    v_mfma_f32_16x16x32_bf16 v[132:135], v[68:71], v[52:55], v[132:135]
    ds_read_b64_tr_b16 v[108:109], v18 offset:15456
    ds_read_b64_tr_b16 v[110:111], v18 offset:18016
    ds_read_b64_tr_b16 v[112:113], v18 offset:15488
    v_mfma_f32_16x16x32_bf16 v[136:139], v[68:71], v[56:59], v[136:139]
    ds_read_b64_tr_b16 v[114:115], v18 offset:18048
    ds_read_b64_tr_b16 v[116:117], v20 offset:12288
    ds_read_b64_tr_b16 v[118:119], v20 offset:14336
    v_mfma_f32_16x16x32_bf16 v[140:143], v[68:71], v[60:63], v[140:143]
    v_mfma_f32_16x16x32_bf16 v[144:147], v[68:71], v[64:67], v[144:147]
    s_waitcnt lgkmcnt(0)
    s_barrier
    v_mfma_f32_16x16x32_bf16 v[128:131], v[92:95], v[72:75], v[128:131]
    v_add_u32 v18, 110592, v17
    v_add_u32 v20, 110592, v19
    ds_read_b64_tr_b16 v[24:25], v18 offset:0
    v_mfma_f32_16x16x32_bf16 v[132:135], v[92:95], v[76:79], v[132:135]
    ds_read_b64_tr_b16 v[26:27], v18 offset:2560
    ds_read_b64_tr_b16 v[28:29], v18 offset:32
    ds_read_b64_tr_b16 v[30:31], v18 offset:2592
    v_mfma_f32_16x16x32_bf16 v[136:139], v[92:95], v[80:83], v[136:139]
    ds_read_b64_tr_b16 v[32:33], v18 offset:64
    ds_read_b64_tr_b16 v[34:35], v18 offset:2624
    ds_read_b64_tr_b16 v[36:37], v18 offset:96
    v_mfma_f32_16x16x32_bf16 v[140:143], v[92:95], v[84:87], v[140:143]
    ds_read_b64_tr_b16 v[38:39], v18 offset:2656
    ds_read_b64_tr_b16 v[40:41], v18 offset:128
    ds_read_b64_tr_b16 v[42:43], v18 offset:2688
    v_mfma_f32_16x16x32_bf16 v[144:147], v[92:95], v[88:91], v[144:147]
    ds_read_b64_tr_b16 v[44:45], v20 offset:0
    ds_read_b64_tr_b16 v[46:47], v20 offset:2048
    ds_read_b64_tr_b16 v[48:49], v18 offset:5120
    v_mfma_f32_16x16x32_bf16 v[128:131], v[116:119], v[96:99], v[128:131]
    ds_read_b64_tr_b16 v[50:51], v18 offset:7680
    ds_read_b64_tr_b16 v[52:53], v18 offset:5152
    ds_read_b64_tr_b16 v[54:55], v18 offset:7712
    v_mfma_f32_16x16x32_bf16 v[132:135], v[116:119], v[100:103], v[132:135]
    ds_read_b64_tr_b16 v[56:57], v18 offset:5184
    ds_read_b64_tr_b16 v[58:59], v18 offset:7744
    ds_read_b64_tr_b16 v[60:61], v18 offset:5216
    v_mfma_f32_16x16x32_bf16 v[136:139], v[116:119], v[104:107], v[136:139]
    ds_read_b64_tr_b16 v[62:63], v18 offset:7776
    ds_read_b64_tr_b16 v[64:65], v18 offset:5248
    ds_read_b64_tr_b16 v[66:67], v18 offset:7808
    v_mfma_f32_16x16x32_bf16 v[140:143], v[116:119], v[108:111], v[140:143]
    ds_read_b64_tr_b16 v[68:69], v20 offset:4096
    ds_read_b64_tr_b16 v[70:71], v20 offset:6144
    v_mfma_f32_16x16x32_bf16 v[144:147], v[116:119], v[112:115], v[144:147]
    s_waitcnt lgkmcnt(0)
    v_mfma_f32_16x16x32_bf16 v[128:131], v[44:47], v[24:27], v[128:131]
    ds_read_b64_tr_b16 v[72:73], v18 offset:10240
    ds_read_b64_tr_b16 v[74:75], v18 offset:12800
    ds_read_b64_tr_b16 v[76:77], v18 offset:10272
    v_mfma_f32_16x16x32_bf16 v[132:135], v[44:47], v[28:31], v[132:135]
    ds_read_b64_tr_b16 v[78:79], v18 offset:12832
    ds_read_b64_tr_b16 v[80:81], v18 offset:10304
    ds_read_b64_tr_b16 v[82:83], v18 offset:12864
    v_mfma_f32_16x16x32_bf16 v[136:139], v[44:47], v[32:35], v[136:139]
    ds_read_b64_tr_b16 v[84:85], v18 offset:10336
    ds_read_b64_tr_b16 v[86:87], v18 offset:12896
    ds_read_b64_tr_b16 v[88:89], v18 offset:10368
    v_mfma_f32_16x16x32_bf16 v[140:143], v[44:47], v[36:39], v[140:143]
    ds_read_b64_tr_b16 v[90:91], v18 offset:12928
    ds_read_b64_tr_b16 v[92:93], v20 offset:8192
    ds_read_b64_tr_b16 v[94:95], v20 offset:10240
    v_mfma_f32_16x16x32_bf16 v[144:147], v[44:47], v[40:43], v[144:147]
    ds_read_b64_tr_b16 v[96:97], v18 offset:15360
    ds_read_b64_tr_b16 v[98:99], v18 offset:17920
    ds_read_b64_tr_b16 v[100:101], v18 offset:15392
    v_mfma_f32_16x16x32_bf16 v[128:131], v[68:71], v[48:51], v[128:131]
    ds_read_b64_tr_b16 v[102:103], v18 offset:17952
    ds_read_b64_tr_b16 v[104:105], v18 offset:15424
    ds_read_b64_tr_b16 v[106:107], v18 offset:17984
    v_mfma_f32_16x16x32_bf16 v[132:135], v[68:71], v[52:55], v[132:135]
    ds_read_b64_tr_b16 v[108:109], v18 offset:15456
    ds_read_b64_tr_b16 v[110:111], v18 offset:18016
    ds_read_b64_tr_b16 v[112:113], v18 offset:15488
    v_mfma_f32_16x16x32_bf16 v[136:139], v[68:71], v[56:59], v[136:139]
    ds_read_b64_tr_b16 v[114:115], v18 offset:18048
    ds_read_b64_tr_b16 v[116:117], v20 offset:12288
    ds_read_b64_tr_b16 v[118:119], v20 offset:14336
    v_mfma_f32_16x16x32_bf16 v[140:143], v[68:71], v[60:63], v[140:143]
    v_mfma_f32_16x16x32_bf16 v[144:147], v[68:71], v[64:67], v[144:147]
    s_waitcnt lgkmcnt(0)
    s_barrier
    v_mfma_f32_16x16x32_bf16 v[128:131], v[92:95], v[72:75], v[128:131]
    v_add_u32 v18, 0, v17
    v_add_u32 v20, 0, v19
    ds_read_b64_tr_b16 v[24:25], v18 offset:0
    v_mfma_f32_16x16x32_bf16 v[132:135], v[92:95], v[76:79], v[132:135]
    ds_read_b64_tr_b16 v[26:27], v18 offset:2560
    ds_read_b64_tr_b16 v[28:29], v18 offset:32
    ds_read_b64_tr_b16 v[30:31], v18 offset:2592
    v_mfma_f32_16x16x32_bf16 v[136:139], v[92:95], v[80:83], v[136:139]
    ds_read_b64_tr_b16 v[32:33], v18 offset:64
    ds_read_b64_tr_b16 v[34:35], v18 offset:2624
    ds_read_b64_tr_b16 v[36:37], v18 offset:96
    v_mfma_f32_16x16x32_bf16 v[140:143], v[92:95], v[84:87], v[140:143]
    ds_read_b64_tr_b16 v[38:39], v18 offset:2656
    ds_read_b64_tr_b16 v[40:41], v18 offset:128
    ds_read_b64_tr_b16 v[42:43], v18 offset:2688
    v_mfma_f32_16x16x32_bf16 v[144:147], v[92:95], v[88:91], v[144:147]
    ds_read_b64_tr_b16 v[44:45], v20 offset:0
    ds_read_b64_tr_b16 v[46:47], v20 offset:2048
    ds_read_b64_tr_b16 v[48:49], v18 offset:5120
    v_mfma_f32_16x16x32_bf16 v[128:131], v[116:119], v[96:99], v[128:131]
    ds_read_b64_tr_b16 v[50:51], v18 offset:7680
    ds_read_b64_tr_b16 v[52:53], v18 offset:5152
    ds_read_b64_tr_b16 v[54:55], v18 offset:7712
    v_mfma_f32_16x16x32_bf16 v[132:135], v[116:119], v[100:103], v[132:135]
    ds_read_b64_tr_b16 v[56:57], v18 offset:5184
    ds_read_b64_tr_b16 v[58:59], v18 offset:7744
    ds_read_b64_tr_b16 v[60:61], v18 offset:5216
    v_mfma_f32_16x16x32_bf16 v[136:139], v[116:119], v[104:107], v[136:139]
    ds_read_b64_tr_b16 v[62:63], v18 offset:7776
    ds_read_b64_tr_b16 v[64:65], v18 offset:5248
    ds_read_b64_tr_b16 v[66:67], v18 offset:7808
    v_mfma_f32_16x16x32_bf16 v[140:143], v[116:119], v[108:111], v[140:143]
    ds_read_b64_tr_b16 v[68:69], v20 offset:4096
    ds_read_b64_tr_b16 v[70:71], v20 offset:6144
    v_mfma_f32_16x16x32_bf16 v[144:147], v[116:119], v[112:115], v[144:147]
    s_waitcnt lgkmcnt(0)
    v_mfma_f32_16x16x32_bf16 v[128:131], v[44:47], v[24:27], v[128:131]
    ds_read_b64_tr_b16 v[72:73], v18 offset:10240
    ds_read_b64_tr_b16 v[74:75], v18 offset:12800
    ds_read_b64_tr_b16 v[76:77], v18 offset:10272
    v_mfma_f32_16x16x32_bf16 v[132:135], v[44:47], v[28:31], v[132:135]
    ds_read_b64_tr_b16 v[78:79], v18 offset:12832
    ds_read_b64_tr_b16 v[80:81], v18 offset:10304
    ds_read_b64_tr_b16 v[82:83], v18 offset:12864
    v_mfma_f32_16x16x32_bf16 v[136:139], v[44:47], v[32:35], v[136:139]
    ds_read_b64_tr_b16 v[84:85], v18 offset:10336
    ds_read_b64_tr_b16 v[86:87], v18 offset:12896
    ds_read_b64_tr_b16 v[88:89], v18 offset:10368
    v_mfma_f32_16x16x32_bf16 v[140:143], v[44:47], v[36:39], v[140:143]
    ds_read_b64_tr_b16 v[90:91], v18 offset:12928
    ds_read_b64_tr_b16 v[92:93], v20 offset:8192
    ds_read_b64_tr_b16 v[94:95], v20 offset:10240
    v_mfma_f32_16x16x32_bf16 v[144:147], v[44:47], v[40:43], v[144:147]
    ds_read_b64_tr_b16 v[96:97], v18 offset:15360
    ds_read_b64_tr_b16 v[98:99], v18 offset:17920
    ds_read_b64_tr_b16 v[100:101], v18 offset:15392
    v_mfma_f32_16x16x32_bf16 v[128:131], v[68:71], v[48:51], v[128:131]
    ds_read_b64_tr_b16 v[102:103], v18 offset:17952
    ds_read_b64_tr_b16 v[104:105], v18 offset:15424
    ds_read_b64_tr_b16 v[106:107], v18 offset:17984
    v_mfma_f32_16x16x32_bf16 v[132:135], v[68:71], v[52:55], v[132:135]
    ds_read_b64_tr_b16 v[108:109], v18 offset:15456
    ds_read_b64_tr_b16 v[110:111], v18 offset:18016
    ds_read_b64_tr_b16 v[112:113], v18 offset:15488
    v_mfma_f32_16x16x32_bf16 v[136:139], v[68:71], v[56:59], v[136:139]
    ds_read_b64_tr_b16 v[114:115], v18 offset:18048
    ds_read_b64_tr_b16 v[116:117], v20 offset:12288
    ds_read_b64_tr_b16 v[118:119], v20 offset:14336
    v_mfma_f32_16x16x32_bf16 v[140:143], v[68:71], v[60:63], v[140:143]
    v_mfma_f32_16x16x32_bf16 v[144:147], v[68:71], v[64:67], v[144:147]
    s_waitcnt lgkmcnt(0)
    s_barrier
    v_mfma_f32_16x16x32_bf16 v[128:131], v[92:95], v[72:75], v[128:131]
    v_add_u32 v18, 36864, v17
    v_add_u32 v20, 36864, v19
    ds_read_b64_tr_b16 v[24:25], v18 offset:0
    v_mfma_f32_16x16x32_bf16 v[132:135], v[92:95], v[76:79], v[132:135]
    ds_read_b64_tr_b16 v[26:27], v18 offset:2560
    ds_read_b64_tr_b16 v[28:29], v18 offset:32
    ds_read_b64_tr_b16 v[30:31], v18 offset:2592
    v_mfma_f32_16x16x32_bf16 v[136:139], v[92:95], v[80:83], v[136:139]
    ds_read_b64_tr_b16 v[32:33], v18 offset:64
    ds_read_b64_tr_b16 v[34:35], v18 offset:2624
    ds_read_b64_tr_b16 v[36:37], v18 offset:96
    v_mfma_f32_16x16x32_bf16 v[140:143], v[92:95], v[84:87], v[140:143]
    ds_read_b64_tr_b16 v[38:39], v18 offset:2656
    ds_read_b64_tr_b16 v[40:41], v18 offset:128
    ds_read_b64_tr_b16 v[42:43], v18 offset:2688
    v_mfma_f32_16x16x32_bf16 v[144:147], v[92:95], v[88:91], v[144:147]
    ds_read_b64_tr_b16 v[44:45], v20 offset:0
    ds_read_b64_tr_b16 v[46:47], v20 offset:2048
    ds_read_b64_tr_b16 v[48:49], v18 offset:5120
    v_mfma_f32_16x16x32_bf16 v[128:131], v[116:119], v[96:99], v[128:131]
    ds_read_b64_tr_b16 v[50:51], v18 offset:7680
    ds_read_b64_tr_b16 v[52:53], v18 offset:5152
    ds_read_b64_tr_b16 v[54:55], v18 offset:7712
    v_mfma_f32_16x16x32_bf16 v[132:135], v[116:119], v[100:103], v[132:135]
    ds_read_b64_tr_b16 v[56:57], v18 offset:5184
    ds_read_b64_tr_b16 v[58:59], v18 offset:7744
    ds_read_b64_tr_b16 v[60:61], v18 offset:5216
    v_mfma_f32_16x16x32_bf16 v[136:139], v[116:119], v[104:107], v[136:139]
    ds_read_b64_tr_b16 v[62:63], v18 offset:7776
    ds_read_b64_tr_b16 v[64:65], v18 offset:5248
    ds_read_b64_tr_b16 v[66:67], v18 offset:7808
    v_mfma_f32_16x16x32_bf16 v[140:143], v[116:119], v[108:111], v[140:143]
    ds_read_b64_tr_b16 v[68:69], v20 offset:4096
    ds_read_b64_tr_b16 v[70:71], v20 offset:6144
    v_mfma_f32_16x16x32_bf16 v[144:147], v[116:119], v[112:115], v[144:147]
    s_waitcnt lgkmcnt(0)
    v_mfma_f32_16x16x32_bf16 v[128:131], v[44:47], v[24:27], v[128:131]
    ds_read_b64_tr_b16 v[72:73], v18 offset:10240
    ds_read_b64_tr_b16 v[74:75], v18 offset:12800
    ds_read_b64_tr_b16 v[76:77], v18 offset:10272
    v_mfma_f32_16x16x32_bf16 v[132:135], v[44:47], v[28:31], v[132:135]
    ds_read_b64_tr_b16 v[78:79], v18 offset:12832
    ds_read_b64_tr_b16 v[80:81], v18 offset:10304
    ds_read_b64_tr_b16 v[82:83], v18 offset:12864
    v_mfma_f32_16x16x32_bf16 v[136:139], v[44:47], v[32:35], v[136:139]
    ds_read_b64_tr_b16 v[84:85], v18 offset:10336
    ds_read_b64_tr_b16 v[86:87], v18 offset:12896
    ds_read_b64_tr_b16 v[88:89], v18 offset:10368
    v_mfma_f32_16x16x32_bf16 v[140:143], v[44:47], v[36:39], v[140:143]
    ds_read_b64_tr_b16 v[90:91], v18 offset:12928
    ds_read_b64_tr_b16 v[92:93], v20 offset:8192
    ds_read_b64_tr_b16 v[94:95], v20 offset:10240
    v_mfma_f32_16x16x32_bf16 v[144:147], v[44:47], v[40:43], v[144:147]
    ds_read_b64_tr_b16 v[96:97], v18 offset:15360
    ds_read_b64_tr_b16 v[98:99], v18 offset:17920
    ds_read_b64_tr_b16 v[100:101], v18 offset:15392
    v_mfma_f32_16x16x32_bf16 v[128:131], v[68:71], v[48:51], v[128:131]
    ds_read_b64_tr_b16 v[102:103], v18 offset:17952
    ds_read_b64_tr_b16 v[104:105], v18 offset:15424
    ds_read_b64_tr_b16 v[106:107], v18 offset:17984
    v_mfma_f32_16x16x32_bf16 v[132:135], v[68:71], v[52:55], v[132:135]
    ds_read_b64_tr_b16 v[108:109], v18 offset:15456
    ds_read_b64_tr_b16 v[110:111], v18 offset:18016
    ds_read_b64_tr_b16 v[112:113], v18 offset:15488
    v_mfma_f32_16x16x32_bf16 v[136:139], v[68:71], v[56:59], v[136:139]
    ds_read_b64_tr_b16 v[114:115], v18 offset:18048
    ds_read_b64_tr_b16 v[116:117], v20 offset:12288
    ds_read_b64_tr_b16 v[118:119], v20 offset:14336
    v_mfma_f32_16x16x32_bf16 v[140:143], v[68:71], v[60:63], v[140:143]
    v_mfma_f32_16x16x32_bf16 v[144:147], v[68:71], v[64:67], v[144:147]
    s_waitcnt lgkmcnt(0)
    s_barrier
    v_mfma_f32_16x16x32_bf16 v[128:131], v[92:95], v[72:75], v[128:131]
    v_add_u32 v18, 73728, v17
    v_add_u32 v20, 73728, v19
    ds_read_b64_tr_b16 v[24:25], v18 offset:0
    v_mfma_f32_16x16x32_bf16 v[132:135], v[92:95], v[76:79], v[132:135]
    ds_read_b64_tr_b16 v[26:27], v18 offset:2560
    ds_read_b64_tr_b16 v[28:29], v18 offset:32
    ds_read_b64_tr_b16 v[30:31], v18 offset:2592
    v_mfma_f32_16x16x32_bf16 v[136:139], v[92:95], v[80:83], v[136:139]
    ds_read_b64_tr_b16 v[32:33], v18 offset:64
    ds_read_b64_tr_b16 v[34:35], v18 offset:2624
    ds_read_b64_tr_b16 v[36:37], v18 offset:96
    v_mfma_f32_16x16x32_bf16 v[140:143], v[92:95], v[84:87], v[140:143]
    ds_read_b64_tr_b16 v[38:39], v18 offset:2656
    ds_read_b64_tr_b16 v[40:41], v18 offset:128
    ds_read_b64_tr_b16 v[42:43], v18 offset:2688
    v_mfma_f32_16x16x32_bf16 v[144:147], v[92:95], v[88:91], v[144:147]
    ds_read_b64_tr_b16 v[44:45], v20 offset:0
    ds_read_b64_tr_b16 v[46:47], v20 offset:2048
    ds_read_b64_tr_b16 v[48:49], v18 offset:5120
    v_mfma_f32_16x16x32_bf16 v[128:131], v[116:119], v[96:99], v[128:131]
    ds_read_b64_tr_b16 v[50:51], v18 offset:7680
    ds_read_b64_tr_b16 v[52:53], v18 offset:5152
    ds_read_b64_tr_b16 v[54:55], v18 offset:7712
    v_mfma_f32_16x16x32_bf16 v[132:135], v[116:119], v[100:103], v[132:135]
    ds_read_b64_tr_b16 v[56:57], v18 offset:5184
    ds_read_b64_tr_b16 v[58:59], v18 offset:7744
    ds_read_b64_tr_b16 v[60:61], v18 offset:5216
    v_mfma_f32_16x16x32_bf16 v[136:139], v[116:119], v[104:107], v[136:139]
    ds_read_b64_tr_b16 v[62:63], v18 offset:7776
    ds_read_b64_tr_b16 v[64:65], v18 offset:5248
    ds_read_b64_tr_b16 v[66:67], v18 offset:7808
    v_mfma_f32_16x16x32_bf16 v[140:143], v[116:119], v[108:111], v[140:143]
    ds_read_b64_tr_b16 v[68:69], v20 offset:4096
    ds_read_b64_tr_b16 v[70:71], v20 offset:6144
    v_mfma_f32_16x16x32_bf16 v[144:147], v[116:119], v[112:115], v[144:147]
    s_waitcnt lgkmcnt(0)
    v_mfma_f32_16x16x32_bf16 v[128:131], v[44:47], v[24:27], v[128:131]
    ds_read_b64_tr_b16 v[72:73], v18 offset:10240
    ds_read_b64_tr_b16 v[74:75], v18 offset:12800
    ds_read_b64_tr_b16 v[76:77], v18 offset:10272
    v_mfma_f32_16x16x32_bf16 v[132:135], v[44:47], v[28:31], v[132:135]
    ds_read_b64_tr_b16 v[78:79], v18 offset:12832
    ds_read_b64_tr_b16 v[80:81], v18 offset:10304
    ds_read_b64_tr_b16 v[82:83], v18 offset:12864
    v_mfma_f32_16x16x32_bf16 v[136:139], v[44:47], v[32:35], v[136:139]
    ds_read_b64_tr_b16 v[84:85], v18 offset:10336
    ds_read_b64_tr_b16 v[86:87], v18 offset:12896
    ds_read_b64_tr_b16 v[88:89], v18 offset:10368
    v_mfma_f32_16x16x32_bf16 v[140:143], v[44:47], v[36:39], v[140:143]
    ds_read_b64_tr_b16 v[90:91], v18 offset:12928
    ds_read_b64_tr_b16 v[92:93], v20 offset:8192
    ds_read_b64_tr_b16 v[94:95], v20 offset:10240
    v_mfma_f32_16x16x32_bf16 v[144:147], v[44:47], v[40:43], v[144:147]
    ds_read_b64_tr_b16 v[96:97], v18 offset:15360
    ds_read_b64_tr_b16 v[98:99], v18 offset:17920
    ds_read_b64_tr_b16 v[100:101], v18 offset:15392
    v_mfma_f32_16x16x32_bf16 v[128:131], v[68:71], v[48:51], v[128:131]
    ds_read_b64_tr_b16 v[102:103], v18 offset:17952
    ds_read_b64_tr_b16 v[104:105], v18 offset:15424
    ds_read_b64_tr_b16 v[106:107], v18 offset:17984
    v_mfma_f32_16x16x32_bf16 v[132:135], v[68:71], v[52:55], v[132:135]
    ds_read_b64_tr_b16 v[108:109], v18 offset:15456
    ds_read_b64_tr_b16 v[110:111], v18 offset:18016
    ds_read_b64_tr_b16 v[112:113], v18 offset:15488
    v_mfma_f32_16x16x32_bf16 v[136:139], v[68:71], v[56:59], v[136:139]
    ds_read_b64_tr_b16 v[114:115], v18 offset:18048
    ds_read_b64_tr_b16 v[116:117], v20 offset:12288
    ds_read_b64_tr_b16 v[118:119], v20 offset:14336
    v_mfma_f32_16x16x32_bf16 v[140:143], v[68:71], v[60:63], v[140:143]
    v_mfma_f32_16x16x32_bf16 v[144:147], v[68:71], v[64:67], v[144:147]
    s_waitcnt lgkmcnt(0)
    s_barrier
    v_mfma_f32_16x16x32_bf16 v[128:131], v[92:95], v[72:75], v[128:131]
    v_add_u32 v18, 110592, v17
    v_add_u32 v20, 110592, v19
    ds_read_b64_tr_b16 v[24:25], v18 offset:0
    v_mfma_f32_16x16x32_bf16 v[132:135], v[92:95], v[76:79], v[132:135]
    ds_read_b64_tr_b16 v[26:27], v18 offset:2560
    ds_read_b64_tr_b16 v[28:29], v18 offset:32
    ds_read_b64_tr_b16 v[30:31], v18 offset:2592
    v_mfma_f32_16x16x32_bf16 v[136:139], v[92:95], v[80:83], v[136:139]
    ds_read_b64_tr_b16 v[32:33], v18 offset:64
    ds_read_b64_tr_b16 v[34:35], v18 offset:2624
    ds_read_b64_tr_b16 v[36:37], v18 offset:96
    v_mfma_f32_16x16x32_bf16 v[140:143], v[92:95], v[84:87], v[140:143]
    ds_read_b64_tr_b16 v[38:39], v18 offset:2656
    ds_read_b64_tr_b16 v[40:41], v18 offset:128
    ds_read_b64_tr_b16 v[42:43], v18 offset:2688
    v_mfma_f32_16x16x32_bf16 v[144:147], v[92:95], v[88:91], v[144:147]
    ds_read_b64_tr_b16 v[44:45], v20 offset:0
    ds_read_b64_tr_b16 v[46:47], v20 offset:2048
    ds_read_b64_tr_b16 v[48:49], v18 offset:5120
    v_mfma_f32_16x16x32_bf16 v[128:131], v[116:119], v[96:99], v[128:131]
    ds_read_b64_tr_b16 v[50:51], v18 offset:7680
    ds_read_b64_tr_b16 v[52:53], v18 offset:5152
    ds_read_b64_tr_b16 v[54:55], v18 offset:7712
    v_mfma_f32_16x16x32_bf16 v[132:135], v[116:119], v[100:103], v[132:135]
    ds_read_b64_tr_b16 v[56:57], v18 offset:5184
    ds_read_b64_tr_b16 v[58:59], v18 offset:7744
    ds_read_b64_tr_b16 v[60:61], v18 offset:5216
    v_mfma_f32_16x16x32_bf16 v[136:139], v[116:119], v[104:107], v[136:139]
    ds_read_b64_tr_b16 v[62:63], v18 offset:7776
    ds_read_b64_tr_b16 v[64:65], v18 offset:5248
    ds_read_b64_tr_b16 v[66:67], v18 offset:7808
    v_mfma_f32_16x16x32_bf16 v[140:143], v[116:119], v[108:111], v[140:143]
    ds_read_b64_tr_b16 v[68:69], v20 offset:4096
    ds_read_b64_tr_b16 v[70:71], v20 offset:6144
    v_mfma_f32_16x16x32_bf16 v[144:147], v[116:119], v[112:115], v[144:147]
    s_waitcnt lgkmcnt(0)
    v_mfma_f32_16x16x32_bf16 v[128:131], v[44:47], v[24:27], v[128:131]
    ds_read_b64_tr_b16 v[72:73], v18 offset:10240
    ds_read_b64_tr_b16 v[74:75], v18 offset:12800
    ds_read_b64_tr_b16 v[76:77], v18 offset:10272
    v_mfma_f32_16x16x32_bf16 v[132:135], v[44:47], v[28:31], v[132:135]
    ds_read_b64_tr_b16 v[78:79], v18 offset:12832
    ds_read_b64_tr_b16 v[80:81], v18 offset:10304
    ds_read_b64_tr_b16 v[82:83], v18 offset:12864
    v_mfma_f32_16x16x32_bf16 v[136:139], v[44:47], v[32:35], v[136:139]
    ds_read_b64_tr_b16 v[84:85], v18 offset:10336
    ds_read_b64_tr_b16 v[86:87], v18 offset:12896
    ds_read_b64_tr_b16 v[88:89], v18 offset:10368
    v_mfma_f32_16x16x32_bf16 v[140:143], v[44:47], v[36:39], v[140:143]
    ds_read_b64_tr_b16 v[90:91], v18 offset:12928
    ds_read_b64_tr_b16 v[92:93], v20 offset:8192
    ds_read_b64_tr_b16 v[94:95], v20 offset:10240
    v_mfma_f32_16x16x32_bf16 v[144:147], v[44:47], v[40:43], v[144:147]
    ds_read_b64_tr_b16 v[96:97], v18 offset:15360
    ds_read_b64_tr_b16 v[98:99], v18 offset:17920
    ds_read_b64_tr_b16 v[100:101], v18 offset:15392
    v_mfma_f32_16x16x32_bf16 v[128:131], v[68:71], v[48:51], v[128:131]
    ds_read_b64_tr_b16 v[102:103], v18 offset:17952
    ds_read_b64_tr_b16 v[104:105], v18 offset:15424
    ds_read_b64_tr_b16 v[106:107], v18 offset:17984
    v_mfma_f32_16x16x32_bf16 v[132:135], v[68:71], v[52:55], v[132:135]
    ds_read_b64_tr_b16 v[108:109], v18 offset:15456
    ds_read_b64_tr_b16 v[110:111], v18 offset:18016
    ds_read_b64_tr_b16 v[112:113], v18 offset:15488
    v_mfma_f32_16x16x32_bf16 v[136:139], v[68:71], v[56:59], v[136:139]
    ds_read_b64_tr_b16 v[114:115], v18 offset:18048
    ds_read_b64_tr_b16 v[116:117], v20 offset:12288
    ds_read_b64_tr_b16 v[118:119], v20 offset:14336
    v_mfma_f32_16x16x32_bf16 v[140:143], v[68:71], v[60:63], v[140:143]
    v_mfma_f32_16x16x32_bf16 v[144:147], v[68:71], v[64:67], v[144:147]
    s_waitcnt lgkmcnt(0)
    v_mfma_f32_16x16x32_bf16 v[128:131], v[92:95], v[72:75], v[128:131]
    v_mfma_f32_16x16x32_bf16 v[132:135], v[92:95], v[76:79], v[132:135]
    v_mfma_f32_16x16x32_bf16 v[136:139], v[92:95], v[80:83], v[136:139]
    v_mfma_f32_16x16x32_bf16 v[140:143], v[92:95], v[84:87], v[140:143]
    v_mfma_f32_16x16x32_bf16 v[144:147], v[92:95], v[88:91], v[144:147]
    v_mfma_f32_16x16x32_bf16 v[128:131], v[116:119], v[96:99], v[128:131]
    v_mfma_f32_16x16x32_bf16 v[132:135], v[116:119], v[100:103], v[132:135]
    v_mfma_f32_16x16x32_bf16 v[136:139], v[116:119], v[104:107], v[136:139]
    v_mfma_f32_16x16x32_bf16 v[140:143], v[116:119], v[108:111], v[140:143]
    v_mfma_f32_16x16x32_bf16 v[144:147], v[116:119], v[112:115], v[144:147]
    s_nop 7
    s_waitcnt vmcnt(0)
    v_lshlrev_b32 v210, 16, v208
    v_and_b32 v211, 0xffff0000, v208
    v_lshlrev_b32 v212, 16, v209
    v_and_b32 v213, 0xffff0000, v209
    s_mov_b32 s62, -2.302208198144325
    s_mov_b32 s63, -0.1029432395800235
    v_add_f32 v128, v128, v210
    v_mul_f32 v40, v128, v128
    v_mov_b32 v60, s62
    v_fmac_f32 v60, s63, v40
    v_mul_f32 v40, v60, v128
    v_exp_f32 v40, v40
    v_add_f32 v129, v129, v211
    v_mul_f32 v41, v129, v129
    v_mov_b32 v61, s62
    v_fmac_f32 v61, s63, v41
    v_mul_f32 v41, v61, v129
    v_exp_f32 v41, v41
    v_add_f32 v130, v130, v212
    v_mul_f32 v42, v130, v130
    v_mov_b32 v62, s62
    v_fmac_f32 v62, s63, v42
    v_mul_f32 v42, v62, v130
    v_exp_f32 v42, v42
    v_add_f32 v131, v131, v213
    v_mul_f32 v43, v131, v131
    v_mov_b32 v63, s62
    v_fmac_f32 v63, s63, v43
    v_mul_f32 v43, v63, v131
    v_exp_f32 v43, v43
    v_add_f32 v132, v132, v210
    v_mul_f32 v44, v132, v132
    v_mov_b32 v64, s62
    v_fmac_f32 v64, s63, v44
    v_mul_f32 v44, v64, v132
    v_exp_f32 v44, v44
    v_add_f32 v133, v133, v211
    v_mul_f32 v45, v133, v133
    v_mov_b32 v65, s62
    v_fmac_f32 v65, s63, v45
    v_mul_f32 v45, v65, v133
    v_exp_f32 v45, v45
    v_add_f32 v134, v134, v212
    v_mul_f32 v46, v134, v134
    v_mov_b32 v66, s62
    v_fmac_f32 v66, s63, v46
    v_mul_f32 v46, v66, v134
    v_exp_f32 v46, v46
    v_add_f32 v135, v135, v213
    v_mul_f32 v47, v135, v135
    v_mov_b32 v67, s62
    v_fmac_f32 v67, s63, v47
    v_mul_f32 v47, v67, v135
    v_exp_f32 v47, v47
    v_add_f32 v136, v136, v210
    v_mul_f32 v48, v136, v136
    v_mov_b32 v68, s62
    v_fmac_f32 v68, s63, v48
    v_mul_f32 v48, v68, v136
    v_exp_f32 v48, v48
    v_add_f32 v137, v137, v211
    v_mul_f32 v49, v137, v137
    v_mov_b32 v69, s62
    v_fmac_f32 v69, s63, v49
    v_mul_f32 v49, v69, v137
    v_exp_f32 v49, v49
    v_add_f32 v138, v138, v212
    v_mul_f32 v50, v138, v138
    v_mov_b32 v70, s62
    v_fmac_f32 v70, s63, v50
    v_mul_f32 v50, v70, v138
    v_exp_f32 v50, v50
    v_add_f32 v139, v139, v213
    v_mul_f32 v51, v139, v139
    v_mov_b32 v71, s62
    v_fmac_f32 v71, s63, v51
    v_mul_f32 v51, v71, v139
    v_exp_f32 v51, v51
    v_add_f32 v140, v140, v210
    v_mul_f32 v52, v140, v140
    v_mov_b32 v72, s62
    v_fmac_f32 v72, s63, v52
    v_mul_f32 v52, v72, v140
    v_exp_f32 v52, v52
    v_add_f32 v141, v141, v211
    v_mul_f32 v53, v141, v141
    v_mov_b32 v73, s62
    v_fmac_f32 v73, s63, v53
    v_mul_f32 v53, v73, v141
    v_exp_f32 v53, v53
    v_add_f32 v142, v142, v212
    v_mul_f32 v54, v142, v142
    v_mov_b32 v74, s62
    v_fmac_f32 v74, s63, v54
    v_mul_f32 v54, v74, v142
    v_exp_f32 v54, v54
    v_add_f32 v143, v143, v213
    v_mul_f32 v55, v143, v143
    v_mov_b32 v75, s62
    v_fmac_f32 v75, s63, v55
    v_mul_f32 v55, v75, v143
    v_exp_f32 v55, v55
    v_add_f32 v144, v144, v210
    v_mul_f32 v56, v144, v144
    v_mov_b32 v76, s62
    v_fmac_f32 v76, s63, v56
    v_mul_f32 v56, v76, v144
    v_exp_f32 v56, v56
    v_add_f32 v145, v145, v211
    v_mul_f32 v57, v145, v145
    v_mov_b32 v77, s62
    v_fmac_f32 v77, s63, v57
    v_mul_f32 v57, v77, v145
    v_exp_f32 v57, v57
    v_add_f32 v146, v146, v212
    v_mul_f32 v58, v146, v146
    v_mov_b32 v78, s62
    v_fmac_f32 v78, s63, v58
    v_mul_f32 v58, v78, v146
    v_exp_f32 v58, v58
    v_add_f32 v147, v147, v213
    v_mul_f32 v59, v147, v147
    v_mov_b32 v79, s62
    v_fmac_f32 v79, s63, v59
    v_mul_f32 v59, v79, v147
    v_exp_f32 v59, v59
    v_add_f32 v40, 1.0, v40
    v_rcp_f32 v40, v40
    v_add_f32 v41, 1.0, v41
    v_rcp_f32 v41, v41
    v_add_f32 v42, 1.0, v42
    v_rcp_f32 v42, v42
    v_add_f32 v43, 1.0, v43
    v_rcp_f32 v43, v43
    v_add_f32 v44, 1.0, v44
    v_rcp_f32 v44, v44
    v_add_f32 v45, 1.0, v45
    v_rcp_f32 v45, v45
    v_add_f32 v46, 1.0, v46
    v_rcp_f32 v46, v46
    v_add_f32 v47, 1.0, v47
    v_rcp_f32 v47, v47
    v_add_f32 v48, 1.0, v48
    v_rcp_f32 v48, v48
    v_add_f32 v49, 1.0, v49
    v_rcp_f32 v49, v49
    v_add_f32 v50, 1.0, v50
    v_rcp_f32 v50, v50
    v_add_f32 v51, 1.0, v51
    v_rcp_f32 v51, v51
    v_add_f32 v52, 1.0, v52
    v_rcp_f32 v52, v52
    v_add_f32 v53, 1.0, v53
    v_rcp_f32 v53, v53
    v_add_f32 v54, 1.0, v54
    v_rcp_f32 v54, v54
    v_add_f32 v55, 1.0, v55
    v_rcp_f32 v55, v55
    v_add_f32 v56, 1.0, v56
    v_rcp_f32 v56, v56
    v_add_f32 v57, 1.0, v57
    v_rcp_f32 v57, v57
    v_add_f32 v58, 1.0, v58
    v_rcp_f32 v58, v58
    v_add_f32 v59, 1.0, v59
    v_rcp_f32 v59, v59
    v_mul_f32 v128, v128, v40
    v_mul_f32 v129, v129, v41
    v_mul_f32 v130, v130, v42
    v_mul_f32 v131, v131, v43
    v_mul_f32 v132, v132, v44
    v_mul_f32 v133, v133, v45
    v_mul_f32 v134, v134, v46
    v_mul_f32 v135, v135, v47
    v_mul_f32 v136, v136, v48
    v_mul_f32 v137, v137, v49
    v_mul_f32 v138, v138, v50
    v_mul_f32 v139, v139, v51
    v_mul_f32 v140, v140, v52
    v_mul_f32 v141, v141, v53
    v_mul_f32 v142, v142, v54
    v_mul_f32 v143, v143, v55
    v_mul_f32 v144, v144, v56
    v_mul_f32 v145, v145, v57
    v_mul_f32 v146, v146, v58
    v_mul_f32 v147, v147, v59
    v_cvt_pk_bf16_f32 v80, v128, v129
    v_cvt_pk_bf16_f32 v81, v130, v131
    v_cvt_pk_bf16_f32 v82, v132, v133
    v_cvt_pk_bf16_f32 v83, v134, v135
    v_cvt_pk_bf16_f32 v84, v136, v137
    v_cvt_pk_bf16_f32 v85, v138, v139
    v_cvt_pk_bf16_f32 v86, v140, v141
    v_cvt_pk_bf16_f32 v87, v142, v143
    v_cvt_pk_bf16_f32 v88, v144, v145
    v_cvt_pk_bf16_f32 v89, v146, v147
    v_and_b32 v1, 63, v0
    v_lshlrev_b32 v1, 4, v1
    s_mul_i32 s60, s42, 276480
    s_lshl_b32 s61, s43, 11
    s_add_u32 s60, s60, s61
    s_lshr_b32 s61, s40, 1
    s_lshl_b32 s61, s61, 10
    s_add_u32 s60, s60, s61
    s_and_b32 s61, s40, 1
    s_lshl_b32 s61, s61, 3
    s_add_u32 s60, s60, s61
    buffer_store_dwordx2 v[80:81], v1, s[24:27], s60 offen
    s_add_u32 s60, s60, 55296
    buffer_store_dwordx2 v[82:83], v1, s[24:27], s60 offen
    s_add_u32 s60, s60, 55296
    buffer_store_dwordx2 v[84:85], v1, s[24:27], s60 offen
    s_add_u32 s60, s60, 55296
    buffer_store_dwordx2 v[86:87], v1, s[24:27], s60 offen
    s_add_u32 s60, s60, 55296
    buffer_store_dwordx2 v[88:89], v1, s[24:27], s60 offen
    s_add_u32 s60, s60, 55296
Lm1_end:
    s_endpgm
.globl mlp2_kernel
.p2align 8
.type mlp2_kernel,@function
mlp2_kernel:
    s_cmp_ge_u32 s2, 256
    s_cbranch_scc1 Lm2_end
    s_load_dwordx4 s[4:7], s[0:1], 72
    s_load_dwordx2 s[8:9], s[0:1], 88
    s_load_dwordx2 s[12:13], s[0:1], 104
    v_lshrrev_b32 v1, 6, v0
    s_nop 0
    v_readfirstlane_b32 s45, v1
    s_and_b32 s40, s45, 3
    s_bfe_u32 s41, s2, 0x20001
    s_lshr_b32 s42, s2, 3
    s_lshr_b32 s43, s42, 2
    s_and_b32 s42, s42, 3
    s_lshl_b32 s41, s41, 3
    s_add_u32 s43, s43, s41
    s_and_b32 s41, s2, 1
    s_lshl_b32 s41, s41, 2
    s_add_u32 s42, s42, s41
    s_mul_i32 s49, s42, 276480
    s_lshl_b32 s51, s43, 7
    s_cmp_lt_u32 s45, 4
    s_cbranch_scc1 Lm2_cons
    v_and_b32 v1, 63, v0
    s_mul_i32 s48, s40, 5120
    v_lshlrev_b32 v2, 4, v1
    s_mul_i32 s52, s40, 5
    s_add_u32 s52, s52, 0
    s_and_b32 s53, s52, 3
    s_lshl_b32 s53, s53, 10
    s_lshr_b32 s52, s52, 2
    s_mul_i32 s52, s52, 55296
    s_add_u32 s52, s52, s53
    v_add_u32 v8, s52, v2
    s_mul_i32 s52, s40, 5
    s_add_u32 s52, s52, 1
    s_and_b32 s53, s52, 3
    s_lshl_b32 s53, s53, 10
    s_lshr_b32 s52, s52, 2
    s_mul_i32 s52, s52, 55296
    s_add_u32 s52, s52, s53
    v_add_u32 v9, s52, v2
    s_mul_i32 s52, s40, 5
    s_add_u32 s52, s52, 2
    s_and_b32 s53, s52, 3
    s_lshl_b32 s53, s53, 10
    s_lshr_b32 s52, s52, 2
    s_mul_i32 s52, s52, 55296
    s_add_u32 s52, s52, s53
    v_add_u32 v10, s52, v2
    s_mul_i32 s52, s40, 5
    s_add_u32 s52, s52, 3
    s_and_b32 s53, s52, 3
    s_lshl_b32 s53, s53, 10
    s_lshr_b32 s52, s52, 2
    s_mul_i32 s52, s52, 55296
    s_add_u32 s52, s52, s53
    v_add_u32 v11, s52, v2
    s_mul_i32 s52, s40, 5
    s_add_u32 s52, s52, 4
    s_and_b32 s53, s52, 3
    s_lshl_b32 s53, s53, 10
    s_lshr_b32 s52, s52, 2
    s_mul_i32 s52, s52, 55296
    s_add_u32 s52, s52, s53
    v_add_u32 v12, s52, v2
    s_mul_i32 s50, s40, 4096
    s_lshr_b32 s52, s50, 4
    v_add_u32 v2, s52, v1
    v_lshrrev_b32 v3, 3, v2
    v_and_b32 v4, 7, v2
    v_and_b32 v5, 6, v3
    v_xor_b32 v4, v4, v5
    s_mov_b32 s53, 4096
    v_mul_lo_u32 v3, v3, s53
    v_lshl_add_u32 v13, v4, 4, v3
    v_add_u32 v2, s52, v1
    v_add_u32 v2, 64, v2
    v_lshrrev_b32 v3, 3, v2
    v_and_b32 v4, 7, v2
    v_and_b32 v5, 6, v3
    v_xor_b32 v4, v4, v5
    s_mov_b32 s53, 4096
    v_mul_lo_u32 v3, v3, s53
    v_lshl_add_u32 v14, v4, 4, v3
    v_add_u32 v2, s52, v1
    v_add_u32 v2, 128, v2
    v_lshrrev_b32 v3, 3, v2
    v_and_b32 v4, 7, v2
    v_and_b32 v5, 6, v3
    v_xor_b32 v4, v4, v5
    s_mov_b32 s53, 4096
    v_mul_lo_u32 v3, v3, s53
    v_lshl_add_u32 v15, v4, 4, v3
    v_add_u32 v2, s52, v1
    v_add_u32 v2, 192, v2
    v_lshrrev_b32 v3, 3, v2
    v_and_b32 v4, 7, v2
    v_and_b32 v5, 6, v3
    v_xor_b32 v4, v4, v5
    s_mov_b32 s53, 4096
    v_mul_lo_u32 v3, v3, s53
    v_lshl_add_u32 v16, v4, 4, v3
    s_waitcnt lgkmcnt(0)
    s_add_u32 s16, s12, 125829120
    s_addc_u32 s17, s13, 0
    s_mov_b32 s18, 2211840
    s_mov_b32 s19, 0x00020000
    s_mov_b32 s20, s4
    s_mov_b32 s21, s5
    s_mov_b32 s22, 7077888
    s_mov_b32 s23, 0x00020000
    s_add_u32 m0, s48, 0
    s_nop 0
    buffer_load_dwordx4 v8, s[16:19], s49 offen lds
    s_add_u32 m0, s48, 1024
    s_nop 0
    buffer_load_dwordx4 v9, s[16:19], s49 offen lds
    s_add_u32 m0, s48, 2048
    s_nop 0
    buffer_load_dwordx4 v10, s[16:19], s49 offen lds
    s_add_u32 m0, s48, 3072
    s_nop 0
    buffer_load_dwordx4 v11, s[16:19], s49 offen lds
    s_add_u32 m0, s48, 4096
    s_nop 0
    buffer_load_dwordx4 v12, s[16:19], s49 offen lds
    s_add_u32 s49, s49, 4096
    s_add_u32 m0, s50, 20480
    s_nop 0
    buffer_load_dwordx4 v13, s[20:23], s51 offen lds
    s_add_u32 m0, s50, 21504
    s_nop 0
    buffer_load_dwordx4 v14, s[20:23], s51 offen lds
    s_add_u32 m0, s50, 22528
    s_nop 0
    buffer_load_dwordx4 v15, s[20:23], s51 offen lds
    s_add_u32 m0, s50, 23552
    s_nop 0
    buffer_load_dwordx4 v16, s[20:23], s51 offen lds
    s_add_u32 s51, s51, 524288
    s_add_u32 m0, s48, 36864
    s_nop 0
    buffer_load_dwordx4 v8, s[16:19], s49 offen lds
    s_add_u32 m0, s48, 37888
    s_nop 0
    buffer_load_dwordx4 v9, s[16:19], s49 offen lds
    s_add_u32 m0, s48, 38912
    s_nop 0
    buffer_load_dwordx4 v10, s[16:19], s49 offen lds
    s_add_u32 m0, s48, 39936
    s_nop 0
    buffer_load_dwordx4 v11, s[16:19], s49 offen lds
    s_add_u32 m0, s48, 40960
    s_nop 0
    buffer_load_dwordx4 v12, s[16:19], s49 offen lds
    s_add_u32 s49, s49, 4096
    s_add_u32 m0, s50, 57344
    s_nop 0
    buffer_load_dwordx4 v13, s[20:23], s51 offen lds
    s_add_u32 m0, s50, 58368
    s_nop 0
    buffer_load_dwordx4 v14, s[20:23], s51 offen lds
    s_add_u32 m0, s50, 59392
    s_nop 0
    buffer_load_dwordx4 v15, s[20:23], s51 offen lds
    s_add_u32 m0, s50, 60416
    s_nop 0
    buffer_load_dwordx4 v16, s[20:23], s51 offen lds
    s_add_u32 s51, s51, 524288
    s_add_u32 m0, s48, 73728
    s_nop 0
    buffer_load_dwordx4 v8, s[16:19], s49 offen lds
    s_add_u32 m0, s48, 74752
    s_nop 0
    buffer_load_dwordx4 v9, s[16:19], s49 offen lds
    s_add_u32 m0, s48, 75776
    s_nop 0
    buffer_load_dwordx4 v10, s[16:19], s49 offen lds
    s_add_u32 m0, s48, 76800
    s_nop 0
    buffer_load_dwordx4 v11, s[16:19], s49 offen lds
    s_add_u32 m0, s48, 77824
    s_nop 0
    buffer_load_dwordx4 v12, s[16:19], s49 offen lds
    s_add_u32 s49, s49, 4096
    s_add_u32 m0, s50, 94208
    s_nop 0
    buffer_load_dwordx4 v13, s[20:23], s51 offen lds
    s_add_u32 m0, s50, 95232
    s_nop 0
    buffer_load_dwordx4 v14, s[20:23], s51 offen lds
    s_add_u32 m0, s50, 96256
    s_nop 0
    buffer_load_dwordx4 v15, s[20:23], s51 offen lds
    s_add_u32 m0, s50, 97280
    s_nop 0
    buffer_load_dwordx4 v16, s[20:23], s51 offen lds
    s_add_u32 s51, s51, 524288
    s_add_u32 m0, s48, 110592
    s_nop 0
    buffer_load_dwordx4 v8, s[16:19], s49 offen lds
    s_add_u32 m0, s48, 111616
    s_nop 0
    buffer_load_dwordx4 v9, s[16:19], s49 offen lds
    s_add_u32 m0, s48, 112640
    s_nop 0
    buffer_load_dwordx4 v10, s[16:19], s49 offen lds
    s_add_u32 m0, s48, 113664
    s_nop 0
    buffer_load_dwordx4 v11, s[16:19], s49 offen lds
    s_add_u32 m0, s48, 114688
    s_nop 0
    buffer_load_dwordx4 v12, s[16:19], s49 offen lds
    s_add_u32 s49, s49, 4096
    s_add_u32 m0, s50, 131072
    s_nop 0
    buffer_load_dwordx4 v13, s[20:23], s51 offen lds
    s_add_u32 m0, s50, 132096
    s_nop 0
    buffer_load_dwordx4 v14, s[20:23], s51 offen lds
    s_add_u32 m0, s50, 133120
    s_nop 0
    buffer_load_dwordx4 v15, s[20:23], s51 offen lds
    s_add_u32 m0, s50, 134144
    s_nop 0
    buffer_load_dwordx4 v16, s[20:23], s51 offen lds
    s_add_u32 s51, s51, 524288
    s_waitcnt vmcnt(27)
    s_barrier
    s_waitcnt vmcnt(18)
    s_barrier
    s_add_u32 m0, s48, 0
    s_nop 0
    buffer_load_dwordx4 v8, s[16:19], s49 offen lds
    s_add_u32 m0, s48, 1024
    s_nop 0
    buffer_load_dwordx4 v9, s[16:19], s49 offen lds
    s_add_u32 m0, s48, 2048
    s_nop 0
    buffer_load_dwordx4 v10, s[16:19], s49 offen lds
    s_add_u32 m0, s48, 3072
    s_nop 0
    buffer_load_dwordx4 v11, s[16:19], s49 offen lds
    s_add_u32 m0, s48, 4096
    s_nop 0
    buffer_load_dwordx4 v12, s[16:19], s49 offen lds
    s_add_u32 s49, s49, 4096
    s_add_u32 m0, s50, 20480
    s_nop 0
    buffer_load_dwordx4 v13, s[20:23], s51 offen lds
    s_add_u32 m0, s50, 21504
    s_nop 0
    buffer_load_dwordx4 v14, s[20:23], s51 offen lds
    s_add_u32 m0, s50, 22528
    s_nop 0
    buffer_load_dwordx4 v15, s[20:23], s51 offen lds
    s_add_u32 m0, s50, 23552
    s_nop 0
    buffer_load_dwordx4 v16, s[20:23], s51 offen lds
    s_add_u32 s51, s51, 524288
    s_waitcnt vmcnt(18)
    s_barrier
    s_add_u32 m0, s48, 36864
    s_nop 0
    buffer_load_dwordx4 v8, s[16:19], s49 offen lds
    s_add_u32 m0, s48, 37888
    s_nop 0
    buffer_load_dwordx4 v9, s[16:19], s49 offen lds
    s_add_u32 m0, s48, 38912
    s_nop 0
    buffer_load_dwordx4 v10, s[16:19], s49 offen lds
    s_add_u32 m0, s48, 39936
    s_nop 0
    buffer_load_dwordx4 v11, s[16:19], s49 offen lds
    s_add_u32 m0, s48, 40960
    s_nop 0
    buffer_load_dwordx4 v12, s[16:19], s49 offen lds
    s_add_u32 s49, s49, 4096
    s_add_u32 m0, s50, 57344
    s_nop 0
    buffer_load_dwordx4 v13, s[20:23], s51 offen lds
    s_add_u32 m0, s50, 58368
    s_nop 0
    buffer_load_dwordx4 v14, s[20:23], s51 offen lds
    s_add_u32 m0, s50, 59392
    s_nop 0
    buffer_load_dwordx4 v15, s[20:23], s51 offen lds
    s_add_u32 m0, s50, 60416
    s_nop 0
    buffer_load_dwordx4 v16, s[20:23], s51 offen lds
    s_add_u32 s51, s51, 524288
    s_waitcnt vmcnt(18)
    s_barrier
    s_add_u32 m0, s48, 73728
    s_nop 0
    buffer_load_dwordx4 v8, s[16:19], s49 offen lds
    s_add_u32 m0, s48, 74752
    s_nop 0
    buffer_load_dwordx4 v9, s[16:19], s49 offen lds
    s_add_u32 m0, s48, 75776
    s_nop 0
    buffer_load_dwordx4 v10, s[16:19], s49 offen lds
    s_add_u32 m0, s48, 76800
    s_nop 0
    buffer_load_dwordx4 v11, s[16:19], s49 offen lds
    s_add_u32 m0, s48, 77824
    s_nop 0
    buffer_load_dwordx4 v12, s[16:19], s49 offen lds
    s_add_u32 s49, s49, 4096
    s_add_u32 m0, s50, 94208
    s_nop 0
    buffer_load_dwordx4 v13, s[20:23], s51 offen lds
    s_add_u32 m0, s50, 95232
    s_nop 0
    buffer_load_dwordx4 v14, s[20:23], s51 offen lds
    s_add_u32 m0, s50, 96256
    s_nop 0
    buffer_load_dwordx4 v15, s[20:23], s51 offen lds
    s_add_u32 m0, s50, 97280
    s_nop 0
    buffer_load_dwordx4 v16, s[20:23], s51 offen lds
    s_add_u32 s51, s51, 524288
    s_waitcnt vmcnt(18)
    s_barrier
    s_add_u32 m0, s48, 110592
    s_nop 0
    buffer_load_dwordx4 v8, s[16:19], s49 offen lds
    s_add_u32 m0, s48, 111616
    s_nop 0
    buffer_load_dwordx4 v9, s[16:19], s49 offen lds
    s_add_u32 m0, s48, 112640
    s_nop 0
    buffer_load_dwordx4 v10, s[16:19], s49 offen lds
    s_add_u32 m0, s48, 113664
    s_nop 0
    buffer_load_dwordx4 v11, s[16:19], s49 offen lds
    s_add_u32 m0, s48, 114688
    s_nop 0
    buffer_load_dwordx4 v12, s[16:19], s49 offen lds
    s_add_u32 s49, s49, 4096
    s_add_u32 m0, s50, 131072
    s_nop 0
    buffer_load_dwordx4 v13, s[20:23], s51 offen lds
    s_add_u32 m0, s50, 132096
    s_nop 0
    buffer_load_dwordx4 v14, s[20:23], s51 offen lds
    s_add_u32 m0, s50, 133120
    s_nop 0
    buffer_load_dwordx4 v15, s[20:23], s51 offen lds
    s_add_u32 m0, s50, 134144
    s_nop 0
    buffer_load_dwordx4 v16, s[20:23], s51 offen lds
    s_add_u32 s51, s51, 524288
    s_waitcnt vmcnt(18)
    s_barrier
    s_add_u32 m0, s48, 0
    s_nop 0
    buffer_load_dwordx4 v8, s[16:19], s49 offen lds
    s_add_u32 m0, s48, 1024
    s_nop 0
    buffer_load_dwordx4 v9, s[16:19], s49 offen lds
    s_add_u32 m0, s48, 2048
    s_nop 0
    buffer_load_dwordx4 v10, s[16:19], s49 offen lds
    s_add_u32 m0, s48, 3072
    s_nop 0
    buffer_load_dwordx4 v11, s[16:19], s49 offen lds
    s_add_u32 m0, s48, 4096
    s_nop 0
    buffer_load_dwordx4 v12, s[16:19], s49 offen lds
    s_add_u32 s49, s49, 4096
    s_add_u32 m0, s50, 20480
    s_nop 0
    buffer_load_dwordx4 v13, s[20:23], s51 offen lds
    s_add_u32 m0, s50, 21504
    s_nop 0
    buffer_load_dwordx4 v14, s[20:23], s51 offen lds
    s_add_u32 m0, s50, 22528
    s_nop 0
    buffer_load_dwordx4 v15, s[20:23], s51 offen lds
    s_add_u32 m0, s50, 23552
    s_nop 0
    buffer_load_dwordx4 v16, s[20:23], s51 offen lds
    s_add_u32 s51, s51, 524288
    s_waitcnt vmcnt(18)
    s_barrier
    s_add_u32 m0, s48, 36864
    s_nop 0
    buffer_load_dwordx4 v8, s[16:19], s49 offen lds
    s_add_u32 m0, s48, 37888
    s_nop 0
    buffer_load_dwordx4 v9, s[16:19], s49 offen lds
    s_add_u32 m0, s48, 38912
    s_nop 0
    buffer_load_dwordx4 v10, s[16:19], s49 offen lds
    s_add_u32 m0, s48, 39936
    s_nop 0
    buffer_load_dwordx4 v11, s[16:19], s49 offen lds
    s_add_u32 m0, s48, 40960
    s_nop 0
    buffer_load_dwordx4 v12, s[16:19], s49 offen lds
    s_add_u32 s49, s49, 4096
    s_add_u32 m0, s50, 57344
    s_nop 0
    buffer_load_dwordx4 v13, s[20:23], s51 offen lds
    s_add_u32 m0, s50, 58368
    s_nop 0
    buffer_load_dwordx4 v14, s[20:23], s51 offen lds
    s_add_u32 m0, s50, 59392
    s_nop 0
    buffer_load_dwordx4 v15, s[20:23], s51 offen lds
    s_add_u32 m0, s50, 60416
    s_nop 0
    buffer_load_dwordx4 v16, s[20:23], s51 offen lds
    s_add_u32 s51, s51, 524288
    s_waitcnt vmcnt(18)
    s_barrier
    s_add_u32 m0, s48, 73728
    s_nop 0
    buffer_load_dwordx4 v8, s[16:19], s49 offen lds
    s_add_u32 m0, s48, 74752
    s_nop 0
    buffer_load_dwordx4 v9, s[16:19], s49 offen lds
    s_add_u32 m0, s48, 75776
    s_nop 0
    buffer_load_dwordx4 v10, s[16:19], s49 offen lds
    s_add_u32 m0, s48, 76800
    s_nop 0
    buffer_load_dwordx4 v11, s[16:19], s49 offen lds
    s_add_u32 m0, s48, 77824
    s_nop 0
    buffer_load_dwordx4 v12, s[16:19], s49 offen lds
    s_add_u32 s49, s49, 4096
    s_add_u32 m0, s50, 94208
    s_nop 0
    buffer_load_dwordx4 v13, s[20:23], s51 offen lds
    s_add_u32 m0, s50, 95232
    s_nop 0
    buffer_load_dwordx4 v14, s[20:23], s51 offen lds
    s_add_u32 m0, s50, 96256
    s_nop 0
    buffer_load_dwordx4 v15, s[20:23], s51 offen lds
    s_add_u32 m0, s50, 97280
    s_nop 0
    buffer_load_dwordx4 v16, s[20:23], s51 offen lds
    s_add_u32 s51, s51, 524288
    s_waitcnt vmcnt(18)
    s_barrier
    s_add_u32 m0, s48, 110592
    s_nop 0
    buffer_load_dwordx4 v8, s[16:19], s49 offen lds
    s_add_u32 m0, s48, 111616
    s_nop 0
    buffer_load_dwordx4 v9, s[16:19], s49 offen lds
    s_add_u32 m0, s48, 112640
    s_nop 0
    buffer_load_dwordx4 v10, s[16:19], s49 offen lds
    s_add_u32 m0, s48, 113664
    s_nop 0
    buffer_load_dwordx4 v11, s[16:19], s49 offen lds
    s_add_u32 m0, s48, 114688
    s_nop 0
    buffer_load_dwordx4 v12, s[16:19], s49 offen lds
    s_add_u32 s49, s49, 4096
    s_add_u32 m0, s50, 131072
    s_nop 0
    buffer_load_dwordx4 v13, s[20:23], s51 offen lds
    s_add_u32 m0, s50, 132096
    s_nop 0
    buffer_load_dwordx4 v14, s[20:23], s51 offen lds
    s_add_u32 m0, s50, 133120
    s_nop 0
    buffer_load_dwordx4 v15, s[20:23], s51 offen lds
    s_add_u32 m0, s50, 134144
    s_nop 0
    buffer_load_dwordx4 v16, s[20:23], s51 offen lds
    s_add_u32 s51, s51, 524288
    s_waitcnt vmcnt(18)
    s_barrier
    s_add_u32 m0, s48, 0
    s_nop 0
    buffer_load_dwordx4 v8, s[16:19], s49 offen lds
    s_add_u32 m0, s48, 1024
    s_nop 0
    buffer_load_dwordx4 v9, s[16:19], s49 offen lds
    s_add_u32 m0, s48, 2048
    s_nop 0
    buffer_load_dwordx4 v10, s[16:19], s49 offen lds
    s_add_u32 m0, s48, 3072
    s_nop 0
    buffer_load_dwordx4 v11, s[16:19], s49 offen lds
    s_add_u32 m0, s48, 4096
    s_nop 0
    buffer_load_dwordx4 v12, s[16:19], s49 offen lds
    s_add_u32 s49, s49, 4096
    s_add_u32 m0, s50, 20480
    s_nop 0
    buffer_load_dwordx4 v13, s[20:23], s51 offen lds
    s_add_u32 m0, s50, 21504
    s_nop 0
    buffer_load_dwordx4 v14, s[20:23], s51 offen lds
    s_add_u32 m0, s50, 22528
    s_nop 0
    buffer_load_dwordx4 v15, s[20:23], s51 offen lds
    s_add_u32 m0, s50, 23552
    s_nop 0
    buffer_load_dwordx4 v16, s[20:23], s51 offen lds
    s_add_u32 s51, s51, 524288
    s_waitcnt vmcnt(18)
    s_barrier
    s_add_u32 m0, s48, 36864
    s_nop 0
    buffer_load_dwordx4 v8, s[16:19], s49 offen lds
    s_add_u32 m0, s48, 37888
    s_nop 0
    buffer_load_dwordx4 v9, s[16:19], s49 offen lds
    s_add_u32 m0, s48, 38912
    s_nop 0
    buffer_load_dwordx4 v10, s[16:19], s49 offen lds
    s_add_u32 m0, s48, 39936
    s_nop 0
    buffer_load_dwordx4 v11, s[16:19], s49 offen lds
    s_add_u32 m0, s48, 40960
    s_nop 0
    buffer_load_dwordx4 v12, s[16:19], s49 offen lds
    s_add_u32 s49, s49, 4096
    s_add_u32 m0, s50, 57344
    s_nop 0
    buffer_load_dwordx4 v13, s[20:23], s51 offen lds
    s_add_u32 m0, s50, 58368
    s_nop 0
    buffer_load_dwordx4 v14, s[20:23], s51 offen lds
    s_add_u32 m0, s50, 59392
    s_nop 0
    buffer_load_dwordx4 v15, s[20:23], s51 offen lds
    s_add_u32 m0, s50, 60416
    s_nop 0
    buffer_load_dwordx4 v16, s[20:23], s51 offen lds
    s_add_u32 s51, s51, 524288
    s_waitcnt vmcnt(18)
    s_barrier
    s_waitcnt vmcnt(9)
    s_barrier
    s_waitcnt vmcnt(0)
    s_barrier
    s_endpgm
Lm2_cons:
    s_lshr_b32 s46, s2, 3
    s_lshl_b32 s46, s46, 2
    s_add_u32 s46, s46, s40
    s_and_b32 s47, s2, 7
    s_lshl_b32 s47, s47, 9
    v_and_b32 v1, 63, v0
    s_waitcnt lgkmcnt(0)
    s_add_u32 s16, s12, 125829120
    s_addc_u32 s17, s13, 0
    s_mov_b32 s18, 2211840
    s_mov_b32 s19, 0x00020000
    s_mov_b32 s20, s4
    s_mov_b32 s21, s5
    s_mov_b32 s22, 7077888
    s_mov_b32 s23, 0x00020000
    s_mov_b32 s28, s6
    s_mov_b32 s29, s7
    s_mov_b32 s30, 4096
    s_mov_b32 s31, 0x00020000
    s_add_u32 s32, s12, 117440512
    s_addc_u32 s33, s13, 0
    s_mov_b32 s34, 2621440
    s_mov_b32 s35, 0x00020000
    s_mov_b32 s24, s8
    s_mov_b32 s25, s9
    s_mov_b32 s26, 2621440
    s_mov_b32 s27, 0x00020000
    v_and_b32 v1, 15, v0
    s_lshl_b32 s60, s43, 6
    s_lshl_b32 s61, s40, 4
    s_add_u32 s60, s60, s61
    v_add_u32 v1, s60, v1
    v_lshlrev_b32 v2, 1, v1
    buffer_load_ushort v208, v2, s[28:31], 0 offen
    v_mul_u32_u24 v1, 1280, v1
    v_bfe_u32 v2, v0, 4, 2
    v_lshl_add_u32 v220, v2, 3, v1
    s_mul_i32 s64, s42, 160
    buffer_load_dwordx2 v[210:211], v220, s[32:35], s64 offen offset:0
    buffer_load_dwordx2 v[212:213], v220, s[32:35], s64 offen offset:32
    buffer_load_dwordx2 v[214:215], v220, s[32:35], s64 offen offset:64
    buffer_load_dwordx2 v[216:217], v220, s[32:35], s64 offen offset:96
    buffer_load_dwordx2 v[218:219], v220, s[32:35], s64 offen offset:128
    v_and_b32 v1, 63, v0
    v_lshlrev_b32 v2, 4, v1
    v_add_u32 v17, 0, v2
    v_bfe_u32 v2, v1, 2, 2
    v_lshrrev_b32 v3, 4, v1
    v_mad_u32_u24 v3, v3, 4, v2
    v_mul_u32_u24 v4, 128, v3
    v_and_b32 v5, 3, v1
    v_lshl_add_u32 v4, v5, 3, v4
    v_add_u32 v4, 20480, v4
    v_bfe_u32 v5, v3, 1, 2
    s_mul_i32 s52, s40, 1
    s_add_u32 s52, s52, 0
    v_xor_b32 v2, s52, v5
    v_mad_u32_u24 v19, v2, 32, v4
    s_barrier
    v_add_u32 v18, 0, v17
    v_add_u32 v20, 0, v19
    ds_read_b128 v[24:27], v18 offset:0
    ds_read_b128 v[28:31], v18 offset:4096
    ds_read_b128 v[32:35], v18 offset:8192
    ds_read_b128 v[36:39], v18 offset:12288
    ds_read_b128 v[40:43], v18 offset:16384
    ds_read_b64_tr_b16 v[44:45], v20 offset:0
    ds_read_b64_tr_b16 v[46:47], v20 offset:2048
    ds_read_b128 v[48:51], v18 offset:1024
    ds_read_b128 v[52:55], v18 offset:5120
    ds_read_b128 v[56:59], v18 offset:9216
    ds_read_b128 v[60:63], v18 offset:13312
    ds_read_b128 v[64:67], v18 offset:17408
    ds_read_b64_tr_b16 v[68:69], v20 offset:4096
    ds_read_b64_tr_b16 v[70:71], v20 offset:6144
    s_waitcnt lgkmcnt(0)
    v_mfma_f32_16x16x32_bf16 v[128:131], v[24:27], v[44:47], 0
    ds_read_b128 v[72:75], v18 offset:2048
    ds_read_b128 v[76:79], v18 offset:6144
    ds_read_b128 v[80:83], v18 offset:10240
    v_mfma_f32_16x16x32_bf16 v[132:135], v[28:31], v[44:47], 0
    ds_read_b128 v[84:87], v18 offset:14336
    ds_read_b128 v[88:91], v18 offset:18432
    ds_read_b64_tr_b16 v[92:93], v20 offset:8192
    v_mfma_f32_16x16x32_bf16 v[136:139], v[32:35], v[44:47], 0
    ds_read_b64_tr_b16 v[94:95], v20 offset:10240
    ds_read_b128 v[96:99], v18 offset:3072
    ds_read_b128 v[100:103], v18 offset:7168
    v_mfma_f32_16x16x32_bf16 v[140:143], v[36:39], v[44:47], 0
    ds_read_b128 v[104:107], v18 offset:11264
    ds_read_b128 v[108:111], v18 offset:15360
    ds_read_b128 v[112:115], v18 offset:19456
    v_mfma_f32_16x16x32_bf16 v[144:147], v[40:43], v[44:47], 0
    ds_read_b64_tr_b16 v[116:117], v20 offset:12288
    ds_read_b64_tr_b16 v[118:119], v20 offset:14336
    v_mfma_f32_16x16x32_bf16 v[128:131], v[48:51], v[68:71], v[128:131]
    v_mfma_f32_16x16x32_bf16 v[132:135], v[52:55], v[68:71], v[132:135]
    v_mfma_f32_16x16x32_bf16 v[136:139], v[56:59], v[68:71], v[136:139]
    v_mfma_f32_16x16x32_bf16 v[140:143], v[60:63], v[68:71], v[140:143]
    v_mfma_f32_16x16x32_bf16 v[144:147], v[64:67], v[68:71], v[144:147]
    s_waitcnt lgkmcnt(0)
    s_barrier
    v_mfma_f32_16x16x32_bf16 v[128:131], v[72:75], v[92:95], v[128:131]
    v_add_u32 v18, 36864, v17
    v_add_u32 v20, 36864, v19
    ds_read_b128 v[24:27], v18 offset:0
    v_mfma_f32_16x16x32_bf16 v[132:135], v[76:79], v[92:95], v[132:135]
    ds_read_b128 v[28:31], v18 offset:4096
    ds_read_b128 v[32:35], v18 offset:8192
    ds_read_b128 v[36:39], v18 offset:12288
    v_mfma_f32_16x16x32_bf16 v[136:139], v[80:83], v[92:95], v[136:139]
    ds_read_b128 v[40:43], v18 offset:16384
    ds_read_b64_tr_b16 v[44:45], v20 offset:0
    ds_read_b64_tr_b16 v[46:47], v20 offset:2048
    v_mfma_f32_16x16x32_bf16 v[140:143], v[84:87], v[92:95], v[140:143]
    ds_read_b128 v[48:51], v18 offset:1024
    ds_read_b128 v[52:55], v18 offset:5120
    ds_read_b128 v[56:59], v18 offset:9216
    v_mfma_f32_16x16x32_bf16 v[144:147], v[88:91], v[92:95], v[144:147]
    ds_read_b128 v[60:63], v18 offset:13312
    ds_read_b128 v[64:67], v18 offset:17408
    ds_read_b64_tr_b16 v[68:69], v20 offset:4096
    v_mfma_f32_16x16x32_bf16 v[128:131], v[96:99], v[116:119], v[128:131]
    ds_read_b64_tr_b16 v[70:71], v20 offset:6144
    v_mfma_f32_16x16x32_bf16 v[132:135], v[100:103], v[116:119], v[132:135]
    v_mfma_f32_16x16x32_bf16 v[136:139], v[104:107], v[116:119], v[136:139]
    v_mfma_f32_16x16x32_bf16 v[140:143], v[108:111], v[116:119], v[140:143]
    v_mfma_f32_16x16x32_bf16 v[144:147], v[112:115], v[116:119], v[144:147]
    s_waitcnt lgkmcnt(0)
    v_mfma_f32_16x16x32_bf16 v[128:131], v[24:27], v[44:47], v[128:131]
    ds_read_b128 v[72:75], v18 offset:2048
    ds_read_b128 v[76:79], v18 offset:6144
    ds_read_b128 v[80:83], v18 offset:10240
    v_mfma_f32_16x16x32_bf16 v[132:135], v[28:31], v[44:47], v[132:135]
    ds_read_b128 v[84:87], v18 offset:14336
    ds_read_b128 v[88:91], v18 offset:18432
    ds_read_b64_tr_b16 v[92:93], v20 offset:8192
    v_mfma_f32_16x16x32_bf16 v[136:139], v[32:35], v[44:47], v[136:139]
    ds_read_b64_tr_b16 v[94:95], v20 offset:10240
    ds_read_b128 v[96:99], v18 offset:3072
    ds_read_b128 v[100:103], v18 offset:7168
    v_mfma_f32_16x16x32_bf16 v[140:143], v[36:39], v[44:47], v[140:143]
    ds_read_b128 v[104:107], v18 offset:11264
    ds_read_b128 v[108:111], v18 offset:15360
    ds_read_b128 v[112:115], v18 offset:19456
    v_mfma_f32_16x16x32_bf16 v[144:147], v[40:43], v[44:47], v[144:147]
    ds_read_b64_tr_b16 v[116:117], v20 offset:12288
    ds_read_b64_tr_b16 v[118:119], v20 offset:14336
    v_mfma_f32_16x16x32_bf16 v[128:131], v[48:51], v[68:71], v[128:131]
    v_mfma_f32_16x16x32_bf16 v[132:135], v[52:55], v[68:71], v[132:135]
    v_mfma_f32_16x16x32_bf16 v[136:139], v[56:59], v[68:71], v[136:139]
    v_mfma_f32_16x16x32_bf16 v[140:143], v[60:63], v[68:71], v[140:143]
    v_mfma_f32_16x16x32_bf16 v[144:147], v[64:67], v[68:71], v[144:147]
    s_waitcnt lgkmcnt(0)
    s_barrier
    v_mfma_f32_16x16x32_bf16 v[128:131], v[72:75], v[92:95], v[128:131]
    v_add_u32 v18, 73728, v17
    v_add_u32 v20, 73728, v19
    ds_read_b128 v[24:27], v18 offset:0
    v_mfma_f32_16x16x32_bf16 v[132:135], v[76:79], v[92:95], v[132:135]
    ds_read_b128 v[28:31], v18 offset:4096
    ds_read_b128 v[32:35], v18 offset:8192
    ds_read_b128 v[36:39], v18 offset:12288
    v_mfma_f32_16x16x32_bf16 v[136:139], v[80:83], v[92:95], v[136:139]
    ds_read_b128 v[40:43], v18 offset:16384
    ds_read_b64_tr_b16 v[44:45], v20 offset:0
    ds_read_b64_tr_b16 v[46:47], v20 offset:2048
    v_mfma_f32_16x16x32_bf16 v[140:143], v[84:87], v[92:95], v[140:143]
    ds_read_b128 v[48:51], v18 offset:1024
    ds_read_b128 v[52:55], v18 offset:5120
    ds_read_b128 v[56:59], v18 offset:9216
    v_mfma_f32_16x16x32_bf16 v[144:147], v[88:91], v[92:95], v[144:147]
    ds_read_b128 v[60:63], v18 offset:13312
    ds_read_b128 v[64:67], v18 offset:17408
    ds_read_b64_tr_b16 v[68:69], v20 offset:4096
    v_mfma_f32_16x16x32_bf16 v[128:131], v[96:99], v[116:119], v[128:131]
    ds_read_b64_tr_b16 v[70:71], v20 offset:6144
    v_mfma_f32_16x16x32_bf16 v[132:135], v[100:103], v[116:119], v[132:135]
    v_mfma_f32_16x16x32_bf16 v[136:139], v[104:107], v[116:119], v[136:139]
    v_mfma_f32_16x16x32_bf16 v[140:143], v[108:111], v[116:119], v[140:143]
    v_mfma_f32_16x16x32_bf16 v[144:147], v[112:115], v[116:119], v[144:147]
    s_waitcnt lgkmcnt(0)
    v_mfma_f32_16x16x32_bf16 v[128:131], v[24:27], v[44:47], v[128:131]
    ds_read_b128 v[72:75], v18 offset:2048
    ds_read_b128 v[76:79], v18 offset:6144
    ds_read_b128 v[80:83], v18 offset:10240
    v_mfma_f32_16x16x32_bf16 v[132:135], v[28:31], v[44:47], v[132:135]
    ds_read_b128 v[84:87], v18 offset:14336
    ds_read_b128 v[88:91], v18 offset:18432
    ds_read_b64_tr_b16 v[92:93], v20 offset:8192
    v_mfma_f32_16x16x32_bf16 v[136:139], v[32:35], v[44:47], v[136:139]
    ds_read_b64_tr_b16 v[94:95], v20 offset:10240
    ds_read_b128 v[96:99], v18 offset:3072
    ds_read_b128 v[100:103], v18 offset:7168
    v_mfma_f32_16x16x32_bf16 v[140:143], v[36:39], v[44:47], v[140:143]
    ds_read_b128 v[104:107], v18 offset:11264
    ds_read_b128 v[108:111], v18 offset:15360
    ds_read_b128 v[112:115], v18 offset:19456
    v_mfma_f32_16x16x32_bf16 v[144:147], v[40:43], v[44:47], v[144:147]
    ds_read_b64_tr_b16 v[116:117], v20 offset:12288
    ds_read_b64_tr_b16 v[118:119], v20 offset:14336
    v_mfma_f32_16x16x32_bf16 v[128:131], v[48:51], v[68:71], v[128:131]
    v_mfma_f32_16x16x32_bf16 v[132:135], v[52:55], v[68:71], v[132:135]
    v_mfma_f32_16x16x32_bf16 v[136:139], v[56:59], v[68:71], v[136:139]
    v_mfma_f32_16x16x32_bf16 v[140:143], v[60:63], v[68:71], v[140:143]
    v_mfma_f32_16x16x32_bf16 v[144:147], v[64:67], v[68:71], v[144:147]
    s_waitcnt lgkmcnt(0)
    s_barrier
    v_mfma_f32_16x16x32_bf16 v[128:131], v[72:75], v[92:95], v[128:131]
    v_add_u32 v18, 110592, v17
    v_add_u32 v20, 110592, v19
    ds_read_b128 v[24:27], v18 offset:0
    v_mfma_f32_16x16x32_bf16 v[132:135], v[76:79], v[92:95], v[132:135]
    ds_read_b128 v[28:31], v18 offset:4096
    ds_read_b128 v[32:35], v18 offset:8192
    ds_read_b128 v[36:39], v18 offset:12288
    v_mfma_f32_16x16x32_bf16 v[136:139], v[80:83], v[92:95], v[136:139]
    ds_read_b128 v[40:43], v18 offset:16384
    ds_read_b64_tr_b16 v[44:45], v20 offset:0
    ds_read_b64_tr_b16 v[46:47], v20 offset:2048
    v_mfma_f32_16x16x32_bf16 v[140:143], v[84:87], v[92:95], v[140:143]
    ds_read_b128 v[48:51], v18 offset:1024
    ds_read_b128 v[52:55], v18 offset:5120
    ds_read_b128 v[56:59], v18 offset:9216
    v_mfma_f32_16x16x32_bf16 v[144:147], v[88:91], v[92:95], v[144:147]
    ds_read_b128 v[60:63], v18 offset:13312
    ds_read_b128 v[64:67], v18 offset:17408
    ds_read_b64_tr_b16 v[68:69], v20 offset:4096
    v_mfma_f32_16x16x32_bf16 v[128:131], v[96:99], v[116:119], v[128:131]
    ds_read_b64_tr_b16 v[70:71], v20 offset:6144
    v_mfma_f32_16x16x32_bf16 v[132:135], v[100:103], v[116:119], v[132:135]
    v_mfma_f32_16x16x32_bf16 v[136:139], v[104:107], v[116:119], v[136:139]
    v_mfma_f32_16x16x32_bf16 v[140:143], v[108:111], v[116:119], v[140:143]
    v_mfma_f32_16x16x32_bf16 v[144:147], v[112:115], v[116:119], v[144:147]
    s_waitcnt lgkmcnt(0)
    v_mfma_f32_16x16x32_bf16 v[128:131], v[24:27], v[44:47], v[128:131]
    ds_read_b128 v[72:75], v18 offset:2048
    ds_read_b128 v[76:79], v18 offset:6144
    ds_read_b128 v[80:83], v18 offset:10240
    v_mfma_f32_16x16x32_bf16 v[132:135], v[28:31], v[44:47], v[132:135]
    ds_read_b128 v[84:87], v18 offset:14336
    ds_read_b128 v[88:91], v18 offset:18432
    ds_read_b64_tr_b16 v[92:93], v20 offset:8192
    v_mfma_f32_16x16x32_bf16 v[136:139], v[32:35], v[44:47], v[136:139]
    ds_read_b64_tr_b16 v[94:95], v20 offset:10240
    ds_read_b128 v[96:99], v18 offset:3072
    ds_read_b128 v[100:103], v18 offset:7168
    v_mfma_f32_16x16x32_bf16 v[140:143], v[36:39], v[44:47], v[140:143]
    ds_read_b128 v[104:107], v18 offset:11264
    ds_read_b128 v[108:111], v18 offset:15360
    ds_read_b128 v[112:115], v18 offset:19456
    v_mfma_f32_16x16x32_bf16 v[144:147], v[40:43], v[44:47], v[144:147]
    ds_read_b64_tr_b16 v[116:117], v20 offset:12288
    ds_read_b64_tr_b16 v[118:119], v20 offset:14336
    v_mfma_f32_16x16x32_bf16 v[128:131], v[48:51], v[68:71], v[128:131]
    v_mfma_f32_16x16x32_bf16 v[132:135], v[52:55], v[68:71], v[132:135]
    v_mfma_f32_16x16x32_bf16 v[136:139], v[56:59], v[68:71], v[136:139]
    v_mfma_f32_16x16x32_bf16 v[140:143], v[60:63], v[68:71], v[140:143]
    v_mfma_f32_16x16x32_bf16 v[144:147], v[64:67], v[68:71], v[144:147]
    s_waitcnt lgkmcnt(0)
    s_barrier
    v_mfma_f32_16x16x32_bf16 v[128:131], v[72:75], v[92:95], v[128:131]
    v_add_u32 v18, 0, v17
    v_add_u32 v20, 0, v19
    ds_read_b128 v[24:27], v18 offset:0
    v_mfma_f32_16x16x32_bf16 v[132:135], v[76:79], v[92:95], v[132:135]
    ds_read_b128 v[28:31], v18 offset:4096
    ds_read_b128 v[32:35], v18 offset:8192
    ds_read_b128 v[36:39], v18 offset:12288
    v_mfma_f32_16x16x32_bf16 v[136:139], v[80:83], v[92:95], v[136:139]
    ds_read_b128 v[40:43], v18 offset:16384
    ds_read_b64_tr_b16 v[44:45], v20 offset:0
    ds_read_b64_tr_b16 v[46:47], v20 offset:2048
    v_mfma_f32_16x16x32_bf16 v[140:143], v[84:87], v[92:95], v[140:143]
    ds_read_b128 v[48:51], v18 offset:1024
    ds_read_b128 v[52:55], v18 offset:5120
    ds_read_b128 v[56:59], v18 offset:9216
    v_mfma_f32_16x16x32_bf16 v[144:147], v[88:91], v[92:95], v[144:147]
    ds_read_b128 v[60:63], v18 offset:13312
    ds_read_b128 v[64:67], v18 offset:17408
    ds_read_b64_tr_b16 v[68:69], v20 offset:4096
    v_mfma_f32_16x16x32_bf16 v[128:131], v[96:99], v[116:119], v[128:131]
    ds_read_b64_tr_b16 v[70:71], v20 offset:6144
    v_mfma_f32_16x16x32_bf16 v[132:135], v[100:103], v[116:119], v[132:135]
    v_mfma_f32_16x16x32_bf16 v[136:139], v[104:107], v[116:119], v[136:139]
    v_mfma_f32_16x16x32_bf16 v[140:143], v[108:111], v[116:119], v[140:143]
    v_mfma_f32_16x16x32_bf16 v[144:147], v[112:115], v[116:119], v[144:147]
    s_waitcnt lgkmcnt(0)
    v_mfma_f32_16x16x32_bf16 v[128:131], v[24:27], v[44:47], v[128:131]
    ds_read_b128 v[72:75], v18 offset:2048
    ds_read_b128 v[76:79], v18 offset:6144
    ds_read_b128 v[80:83], v18 offset:10240
    v_mfma_f32_16x16x32_bf16 v[132:135], v[28:31], v[44:47], v[132:135]
    ds_read_b128 v[84:87], v18 offset:14336
    ds_read_b128 v[88:91], v18 offset:18432
    ds_read_b64_tr_b16 v[92:93], v20 offset:8192
    v_mfma_f32_16x16x32_bf16 v[136:139], v[32:35], v[44:47], v[136:139]
    ds_read_b64_tr_b16 v[94:95], v20 offset:10240
    ds_read_b128 v[96:99], v18 offset:3072
    ds_read_b128 v[100:103], v18 offset:7168
    v_mfma_f32_16x16x32_bf16 v[140:143], v[36:39], v[44:47], v[140:143]
    ds_read_b128 v[104:107], v18 offset:11264
    ds_read_b128 v[108:111], v18 offset:15360
    ds_read_b128 v[112:115], v18 offset:19456
    v_mfma_f32_16x16x32_bf16 v[144:147], v[40:43], v[44:47], v[144:147]
    ds_read_b64_tr_b16 v[116:117], v20 offset:12288
    ds_read_b64_tr_b16 v[118:119], v20 offset:14336
    v_mfma_f32_16x16x32_bf16 v[128:131], v[48:51], v[68:71], v[128:131]
    v_mfma_f32_16x16x32_bf16 v[132:135], v[52:55], v[68:71], v[132:135]
    v_mfma_f32_16x16x32_bf16 v[136:139], v[56:59], v[68:71], v[136:139]
    v_mfma_f32_16x16x32_bf16 v[140:143], v[60:63], v[68:71], v[140:143]
    v_mfma_f32_16x16x32_bf16 v[144:147], v[64:67], v[68:71], v[144:147]
    s_waitcnt lgkmcnt(0)
    s_barrier
    v_mfma_f32_16x16x32_bf16 v[128:131], v[72:75], v[92:95], v[128:131]
    v_add_u32 v18, 36864, v17
    v_add_u32 v20, 36864, v19
    ds_read_b128 v[24:27], v18 offset:0
    v_mfma_f32_16x16x32_bf16 v[132:135], v[76:79], v[92:95], v[132:135]
    ds_read_b128 v[28:31], v18 offset:4096
    ds_read_b128 v[32:35], v18 offset:8192
    ds_read_b128 v[36:39], v18 offset:12288
    v_mfma_f32_16x16x32_bf16 v[136:139], v[80:83], v[92:95], v[136:139]
    ds_read_b128 v[40:43], v18 offset:16384
    ds_read_b64_tr_b16 v[44:45], v20 offset:0
    ds_read_b64_tr_b16 v[46:47], v20 offset:2048
    v_mfma_f32_16x16x32_bf16 v[140:143], v[84:87], v[92:95], v[140:143]
    ds_read_b128 v[48:51], v18 offset:1024
    ds_read_b128 v[52:55], v18 offset:5120
    ds_read_b128 v[56:59], v18 offset:9216
    v_mfma_f32_16x16x32_bf16 v[144:147], v[88:91], v[92:95], v[144:147]
    ds_read_b128 v[60:63], v18 offset:13312
    ds_read_b128 v[64:67], v18 offset:17408
    ds_read_b64_tr_b16 v[68:69], v20 offset:4096
    v_mfma_f32_16x16x32_bf16 v[128:131], v[96:99], v[116:119], v[128:131]
    ds_read_b64_tr_b16 v[70:71], v20 offset:6144
    v_mfma_f32_16x16x32_bf16 v[132:135], v[100:103], v[116:119], v[132:135]
    v_mfma_f32_16x16x32_bf16 v[136:139], v[104:107], v[116:119], v[136:139]
    v_mfma_f32_16x16x32_bf16 v[140:143], v[108:111], v[116:119], v[140:143]
    v_mfma_f32_16x16x32_bf16 v[144:147], v[112:115], v[116:119], v[144:147]
    s_waitcnt lgkmcnt(0)
    v_mfma_f32_16x16x32_bf16 v[128:131], v[24:27], v[44:47], v[128:131]
    ds_read_b128 v[72:75], v18 offset:2048
    ds_read_b128 v[76:79], v18 offset:6144
    ds_read_b128 v[80:83], v18 offset:10240
    v_mfma_f32_16x16x32_bf16 v[132:135], v[28:31], v[44:47], v[132:135]
    ds_read_b128 v[84:87], v18 offset:14336
    ds_read_b128 v[88:91], v18 offset:18432
    ds_read_b64_tr_b16 v[92:93], v20 offset:8192
    v_mfma_f32_16x16x32_bf16 v[136:139], v[32:35], v[44:47], v[136:139]
    ds_read_b64_tr_b16 v[94:95], v20 offset:10240
    ds_read_b128 v[96:99], v18 offset:3072
    ds_read_b128 v[100:103], v18 offset:7168
    v_mfma_f32_16x16x32_bf16 v[140:143], v[36:39], v[44:47], v[140:143]
    ds_read_b128 v[104:107], v18 offset:11264
    ds_read_b128 v[108:111], v18 offset:15360
    ds_read_b128 v[112:115], v18 offset:19456
    v_mfma_f32_16x16x32_bf16 v[144:147], v[40:43], v[44:47], v[144:147]
    ds_read_b64_tr_b16 v[116:117], v20 offset:12288
    ds_read_b64_tr_b16 v[118:119], v20 offset:14336
    v_mfma_f32_16x16x32_bf16 v[128:131], v[48:51], v[68:71], v[128:131]
    v_mfma_f32_16x16x32_bf16 v[132:135], v[52:55], v[68:71], v[132:135]
    v_mfma_f32_16x16x32_bf16 v[136:139], v[56:59], v[68:71], v[136:139]
    v_mfma_f32_16x16x32_bf16 v[140:143], v[60:63], v[68:71], v[140:143]
    v_mfma_f32_16x16x32_bf16 v[144:147], v[64:67], v[68:71], v[144:147]
    s_waitcnt lgkmcnt(0)
    s_barrier
    v_mfma_f32_16x16x32_bf16 v[128:131], v[72:75], v[92:95], v[128:131]
    v_add_u32 v18, 73728, v17
    v_add_u32 v20, 73728, v19
    ds_read_b128 v[24:27], v18 offset:0
    v_mfma_f32_16x16x32_bf16 v[132:135], v[76:79], v[92:95], v[132:135]
    ds_read_b128 v[28:31], v18 offset:4096
    ds_read_b128 v[32:35], v18 offset:8192
    ds_read_b128 v[36:39], v18 offset:12288
    v_mfma_f32_16x16x32_bf16 v[136:139], v[80:83], v[92:95], v[136:139]
    ds_read_b128 v[40:43], v18 offset:16384
    ds_read_b64_tr_b16 v[44:45], v20 offset:0
    ds_read_b64_tr_b16 v[46:47], v20 offset:2048
    v_mfma_f32_16x16x32_bf16 v[140:143], v[84:87], v[92:95], v[140:143]
    ds_read_b128 v[48:51], v18 offset:1024
    ds_read_b128 v[52:55], v18 offset:5120
    ds_read_b128 v[56:59], v18 offset:9216
    v_mfma_f32_16x16x32_bf16 v[144:147], v[88:91], v[92:95], v[144:147]
    ds_read_b128 v[60:63], v18 offset:13312
    ds_read_b128 v[64:67], v18 offset:17408
    ds_read_b64_tr_b16 v[68:69], v20 offset:4096
    v_mfma_f32_16x16x32_bf16 v[128:131], v[96:99], v[116:119], v[128:131]
    ds_read_b64_tr_b16 v[70:71], v20 offset:6144
    v_mfma_f32_16x16x32_bf16 v[132:135], v[100:103], v[116:119], v[132:135]
    v_mfma_f32_16x16x32_bf16 v[136:139], v[104:107], v[116:119], v[136:139]
    v_mfma_f32_16x16x32_bf16 v[140:143], v[108:111], v[116:119], v[140:143]
    v_mfma_f32_16x16x32_bf16 v[144:147], v[112:115], v[116:119], v[144:147]
    s_waitcnt lgkmcnt(0)
    v_mfma_f32_16x16x32_bf16 v[128:131], v[24:27], v[44:47], v[128:131]
    ds_read_b128 v[72:75], v18 offset:2048
    ds_read_b128 v[76:79], v18 offset:6144
    ds_read_b128 v[80:83], v18 offset:10240
    v_mfma_f32_16x16x32_bf16 v[132:135], v[28:31], v[44:47], v[132:135]
    ds_read_b128 v[84:87], v18 offset:14336
    ds_read_b128 v[88:91], v18 offset:18432
    ds_read_b64_tr_b16 v[92:93], v20 offset:8192
    v_mfma_f32_16x16x32_bf16 v[136:139], v[32:35], v[44:47], v[136:139]
    ds_read_b64_tr_b16 v[94:95], v20 offset:10240
    ds_read_b128 v[96:99], v18 offset:3072
    ds_read_b128 v[100:103], v18 offset:7168
    v_mfma_f32_16x16x32_bf16 v[140:143], v[36:39], v[44:47], v[140:143]
    ds_read_b128 v[104:107], v18 offset:11264
    ds_read_b128 v[108:111], v18 offset:15360
    ds_read_b128 v[112:115], v18 offset:19456
    v_mfma_f32_16x16x32_bf16 v[144:147], v[40:43], v[44:47], v[144:147]
    ds_read_b64_tr_b16 v[116:117], v20 offset:12288
    ds_read_b64_tr_b16 v[118:119], v20 offset:14336
    v_mfma_f32_16x16x32_bf16 v[128:131], v[48:51], v[68:71], v[128:131]
    v_mfma_f32_16x16x32_bf16 v[132:135], v[52:55], v[68:71], v[132:135]
    v_mfma_f32_16x16x32_bf16 v[136:139], v[56:59], v[68:71], v[136:139]
    v_mfma_f32_16x16x32_bf16 v[140:143], v[60:63], v[68:71], v[140:143]
    v_mfma_f32_16x16x32_bf16 v[144:147], v[64:67], v[68:71], v[144:147]
    s_waitcnt lgkmcnt(0)
    s_barrier
    v_mfma_f32_16x16x32_bf16 v[128:131], v[72:75], v[92:95], v[128:131]
    v_add_u32 v18, 110592, v17
    v_add_u32 v20, 110592, v19
    ds_read_b128 v[24:27], v18 offset:0
    v_mfma_f32_16x16x32_bf16 v[132:135], v[76:79], v[92:95], v[132:135]
    ds_read_b128 v[28:31], v18 offset:4096
    ds_read_b128 v[32:35], v18 offset:8192
    ds_read_b128 v[36:39], v18 offset:12288
    v_mfma_f32_16x16x32_bf16 v[136:139], v[80:83], v[92:95], v[136:139]
    ds_read_b128 v[40:43], v18 offset:16384
    ds_read_b64_tr_b16 v[44:45], v20 offset:0
    ds_read_b64_tr_b16 v[46:47], v20 offset:2048
    v_mfma_f32_16x16x32_bf16 v[140:143], v[84:87], v[92:95], v[140:143]
    ds_read_b128 v[48:51], v18 offset:1024
    ds_read_b128 v[52:55], v18 offset:5120
    ds_read_b128 v[56:59], v18 offset:9216
    v_mfma_f32_16x16x32_bf16 v[144:147], v[88:91], v[92:95], v[144:147]
    ds_read_b128 v[60:63], v18 offset:13312
    ds_read_b128 v[64:67], v18 offset:17408
    ds_read_b64_tr_b16 v[68:69], v20 offset:4096
    v_mfma_f32_16x16x32_bf16 v[128:131], v[96:99], v[116:119], v[128:131]
    ds_read_b64_tr_b16 v[70:71], v20 offset:6144
    v_mfma_f32_16x16x32_bf16 v[132:135], v[100:103], v[116:119], v[132:135]
    v_mfma_f32_16x16x32_bf16 v[136:139], v[104:107], v[116:119], v[136:139]
    v_mfma_f32_16x16x32_bf16 v[140:143], v[108:111], v[116:119], v[140:143]
    v_mfma_f32_16x16x32_bf16 v[144:147], v[112:115], v[116:119], v[144:147]
    s_waitcnt lgkmcnt(0)
    v_mfma_f32_16x16x32_bf16 v[128:131], v[24:27], v[44:47], v[128:131]
    ds_read_b128 v[72:75], v18 offset:2048
    ds_read_b128 v[76:79], v18 offset:6144
    ds_read_b128 v[80:83], v18 offset:10240
    v_mfma_f32_16x16x32_bf16 v[132:135], v[28:31], v[44:47], v[132:135]
    ds_read_b128 v[84:87], v18 offset:14336
    ds_read_b128 v[88:91], v18 offset:18432
    ds_read_b64_tr_b16 v[92:93], v20 offset:8192
    v_mfma_f32_16x16x32_bf16 v[136:139], v[32:35], v[44:47], v[136:139]
    ds_read_b64_tr_b16 v[94:95], v20 offset:10240
    ds_read_b128 v[96:99], v18 offset:3072
    ds_read_b128 v[100:103], v18 offset:7168
    v_mfma_f32_16x16x32_bf16 v[140:143], v[36:39], v[44:47], v[140:143]
    ds_read_b128 v[104:107], v18 offset:11264
    ds_read_b128 v[108:111], v18 offset:15360
    ds_read_b128 v[112:115], v18 offset:19456
    v_mfma_f32_16x16x32_bf16 v[144:147], v[40:43], v[44:47], v[144:147]
    ds_read_b64_tr_b16 v[116:117], v20 offset:12288
    ds_read_b64_tr_b16 v[118:119], v20 offset:14336
    v_mfma_f32_16x16x32_bf16 v[128:131], v[48:51], v[68:71], v[128:131]
    v_mfma_f32_16x16x32_bf16 v[132:135], v[52:55], v[68:71], v[132:135]
    v_mfma_f32_16x16x32_bf16 v[136:139], v[56:59], v[68:71], v[136:139]
    v_mfma_f32_16x16x32_bf16 v[140:143], v[60:63], v[68:71], v[140:143]
    v_mfma_f32_16x16x32_bf16 v[144:147], v[64:67], v[68:71], v[144:147]
    s_waitcnt lgkmcnt(0)
    s_barrier
    v_mfma_f32_16x16x32_bf16 v[128:131], v[72:75], v[92:95], v[128:131]
    v_add_u32 v18, 0, v17
    v_add_u32 v20, 0, v19
    ds_read_b128 v[24:27], v18 offset:0
    v_mfma_f32_16x16x32_bf16 v[132:135], v[76:79], v[92:95], v[132:135]
    ds_read_b128 v[28:31], v18 offset:4096
    ds_read_b128 v[32:35], v18 offset:8192
    ds_read_b128 v[36:39], v18 offset:12288
    v_mfma_f32_16x16x32_bf16 v[136:139], v[80:83], v[92:95], v[136:139]
    ds_read_b128 v[40:43], v18 offset:16384
    ds_read_b64_tr_b16 v[44:45], v20 offset:0
    ds_read_b64_tr_b16 v[46:47], v20 offset:2048
    v_mfma_f32_16x16x32_bf16 v[140:143], v[84:87], v[92:95], v[140:143]
    ds_read_b128 v[48:51], v18 offset:1024
    ds_read_b128 v[52:55], v18 offset:5120
    ds_read_b128 v[56:59], v18 offset:9216
    v_mfma_f32_16x16x32_bf16 v[144:147], v[88:91], v[92:95], v[144:147]
    ds_read_b128 v[60:63], v18 offset:13312
    ds_read_b128 v[64:67], v18 offset:17408
    ds_read_b64_tr_b16 v[68:69], v20 offset:4096
    v_mfma_f32_16x16x32_bf16 v[128:131], v[96:99], v[116:119], v[128:131]
    ds_read_b64_tr_b16 v[70:71], v20 offset:6144
    v_mfma_f32_16x16x32_bf16 v[132:135], v[100:103], v[116:119], v[132:135]
    v_mfma_f32_16x16x32_bf16 v[136:139], v[104:107], v[116:119], v[136:139]
    v_mfma_f32_16x16x32_bf16 v[140:143], v[108:111], v[116:119], v[140:143]
    v_mfma_f32_16x16x32_bf16 v[144:147], v[112:115], v[116:119], v[144:147]
    s_waitcnt lgkmcnt(0)
    v_mfma_f32_16x16x32_bf16 v[128:131], v[24:27], v[44:47], v[128:131]
    ds_read_b128 v[72:75], v18 offset:2048
    ds_read_b128 v[76:79], v18 offset:6144
    ds_read_b128 v[80:83], v18 offset:10240
    v_mfma_f32_16x16x32_bf16 v[132:135], v[28:31], v[44:47], v[132:135]
    ds_read_b128 v[84:87], v18 offset:14336
    ds_read_b128 v[88:91], v18 offset:18432
    ds_read_b64_tr_b16 v[92:93], v20 offset:8192
    v_mfma_f32_16x16x32_bf16 v[136:139], v[32:35], v[44:47], v[136:139]
    ds_read_b64_tr_b16 v[94:95], v20 offset:10240
    ds_read_b128 v[96:99], v18 offset:3072
    ds_read_b128 v[100:103], v18 offset:7168
    v_mfma_f32_16x16x32_bf16 v[140:143], v[36:39], v[44:47], v[140:143]
    ds_read_b128 v[104:107], v18 offset:11264
    ds_read_b128 v[108:111], v18 offset:15360
    ds_read_b128 v[112:115], v18 offset:19456
    v_mfma_f32_16x16x32_bf16 v[144:147], v[40:43], v[44:47], v[144:147]
    ds_read_b64_tr_b16 v[116:117], v20 offset:12288
    ds_read_b64_tr_b16 v[118:119], v20 offset:14336
    v_mfma_f32_16x16x32_bf16 v[128:131], v[48:51], v[68:71], v[128:131]
    v_mfma_f32_16x16x32_bf16 v[132:135], v[52:55], v[68:71], v[132:135]
    v_mfma_f32_16x16x32_bf16 v[136:139], v[56:59], v[68:71], v[136:139]
    v_mfma_f32_16x16x32_bf16 v[140:143], v[60:63], v[68:71], v[140:143]
    v_mfma_f32_16x16x32_bf16 v[144:147], v[64:67], v[68:71], v[144:147]
    s_waitcnt lgkmcnt(0)
    s_barrier
    v_mfma_f32_16x16x32_bf16 v[128:131], v[72:75], v[92:95], v[128:131]
    v_add_u32 v18, 36864, v17
    v_add_u32 v20, 36864, v19
    ds_read_b128 v[24:27], v18 offset:0
    v_mfma_f32_16x16x32_bf16 v[132:135], v[76:79], v[92:95], v[132:135]
    ds_read_b128 v[28:31], v18 offset:4096
    ds_read_b128 v[32:35], v18 offset:8192
    ds_read_b128 v[36:39], v18 offset:12288
    v_mfma_f32_16x16x32_bf16 v[136:139], v[80:83], v[92:95], v[136:139]
    ds_read_b128 v[40:43], v18 offset:16384
    ds_read_b64_tr_b16 v[44:45], v20 offset:0
    ds_read_b64_tr_b16 v[46:47], v20 offset:2048
    v_mfma_f32_16x16x32_bf16 v[140:143], v[84:87], v[92:95], v[140:143]
    ds_read_b128 v[48:51], v18 offset:1024
    ds_read_b128 v[52:55], v18 offset:5120
    ds_read_b128 v[56:59], v18 offset:9216
    v_mfma_f32_16x16x32_bf16 v[144:147], v[88:91], v[92:95], v[144:147]
    ds_read_b128 v[60:63], v18 offset:13312
    ds_read_b128 v[64:67], v18 offset:17408
    ds_read_b64_tr_b16 v[68:69], v20 offset:4096
    v_mfma_f32_16x16x32_bf16 v[128:131], v[96:99], v[116:119], v[128:131]
    ds_read_b64_tr_b16 v[70:71], v20 offset:6144
    v_mfma_f32_16x16x32_bf16 v[132:135], v[100:103], v[116:119], v[132:135]
    v_mfma_f32_16x16x32_bf16 v[136:139], v[104:107], v[116:119], v[136:139]
    v_mfma_f32_16x16x32_bf16 v[140:143], v[108:111], v[116:119], v[140:143]
    v_mfma_f32_16x16x32_bf16 v[144:147], v[112:115], v[116:119], v[144:147]
    s_waitcnt lgkmcnt(0)
    v_mfma_f32_16x16x32_bf16 v[128:131], v[24:27], v[44:47], v[128:131]
    ds_read_b128 v[72:75], v18 offset:2048
    ds_read_b128 v[76:79], v18 offset:6144
    ds_read_b128 v[80:83], v18 offset:10240
    v_mfma_f32_16x16x32_bf16 v[132:135], v[28:31], v[44:47], v[132:135]
    ds_read_b128 v[84:87], v18 offset:14336
    ds_read_b128 v[88:91], v18 offset:18432
    ds_read_b64_tr_b16 v[92:93], v20 offset:8192
    v_mfma_f32_16x16x32_bf16 v[136:139], v[32:35], v[44:47], v[136:139]
    ds_read_b64_tr_b16 v[94:95], v20 offset:10240
    ds_read_b128 v[96:99], v18 offset:3072
    ds_read_b128 v[100:103], v18 offset:7168
    v_mfma_f32_16x16x32_bf16 v[140:143], v[36:39], v[44:47], v[140:143]
    ds_read_b128 v[104:107], v18 offset:11264
    ds_read_b128 v[108:111], v18 offset:15360
    ds_read_b128 v[112:115], v18 offset:19456
    v_mfma_f32_16x16x32_bf16 v[144:147], v[40:43], v[44:47], v[144:147]
    ds_read_b64_tr_b16 v[116:117], v20 offset:12288
    ds_read_b64_tr_b16 v[118:119], v20 offset:14336
    v_mfma_f32_16x16x32_bf16 v[128:131], v[48:51], v[68:71], v[128:131]
    v_mfma_f32_16x16x32_bf16 v[132:135], v[52:55], v[68:71], v[132:135]
    v_mfma_f32_16x16x32_bf16 v[136:139], v[56:59], v[68:71], v[136:139]
    v_mfma_f32_16x16x32_bf16 v[140:143], v[60:63], v[68:71], v[140:143]
    v_mfma_f32_16x16x32_bf16 v[144:147], v[64:67], v[68:71], v[144:147]
    s_waitcnt lgkmcnt(0)
    s_barrier
    v_mfma_f32_16x16x32_bf16 v[128:131], v[72:75], v[92:95], v[128:131]
    v_add_u32 v18, 73728, v17
    v_add_u32 v20, 73728, v19
    ds_read_b128 v[24:27], v18 offset:0
    v_mfma_f32_16x16x32_bf16 v[132:135], v[76:79], v[92:95], v[132:135]
    ds_read_b128 v[28:31], v18 offset:4096
    ds_read_b128 v[32:35], v18 offset:8192
    ds_read_b128 v[36:39], v18 offset:12288
    v_mfma_f32_16x16x32_bf16 v[136:139], v[80:83], v[92:95], v[136:139]
    ds_read_b128 v[40:43], v18 offset:16384
    ds_read_b64_tr_b16 v[44:45], v20 offset:0
    ds_read_b64_tr_b16 v[46:47], v20 offset:2048
    v_mfma_f32_16x16x32_bf16 v[140:143], v[84:87], v[92:95], v[140:143]
    ds_read_b128 v[48:51], v18 offset:1024
    ds_read_b128 v[52:55], v18 offset:5120
    ds_read_b128 v[56:59], v18 offset:9216
    v_mfma_f32_16x16x32_bf16 v[144:147], v[88:91], v[92:95], v[144:147]
    ds_read_b128 v[60:63], v18 offset:13312
    ds_read_b128 v[64:67], v18 offset:17408
    ds_read_b64_tr_b16 v[68:69], v20 offset:4096
    v_mfma_f32_16x16x32_bf16 v[128:131], v[96:99], v[116:119], v[128:131]
    ds_read_b64_tr_b16 v[70:71], v20 offset:6144
    v_mfma_f32_16x16x32_bf16 v[132:135], v[100:103], v[116:119], v[132:135]
    v_mfma_f32_16x16x32_bf16 v[136:139], v[104:107], v[116:119], v[136:139]
    v_mfma_f32_16x16x32_bf16 v[140:143], v[108:111], v[116:119], v[140:143]
    v_mfma_f32_16x16x32_bf16 v[144:147], v[112:115], v[116:119], v[144:147]
    s_waitcnt lgkmcnt(0)
    v_mfma_f32_16x16x32_bf16 v[128:131], v[24:27], v[44:47], v[128:131]
    ds_read_b128 v[72:75], v18 offset:2048
    ds_read_b128 v[76:79], v18 offset:6144
    ds_read_b128 v[80:83], v18 offset:10240
    v_mfma_f32_16x16x32_bf16 v[132:135], v[28:31], v[44:47], v[132:135]
    ds_read_b128 v[84:87], v18 offset:14336
    ds_read_b128 v[88:91], v18 offset:18432
    ds_read_b64_tr_b16 v[92:93], v20 offset:8192
    v_mfma_f32_16x16x32_bf16 v[136:139], v[32:35], v[44:47], v[136:139]
    ds_read_b64_tr_b16 v[94:95], v20 offset:10240
    ds_read_b128 v[96:99], v18 offset:3072
    ds_read_b128 v[100:103], v18 offset:7168
    v_mfma_f32_16x16x32_bf16 v[140:143], v[36:39], v[44:47], v[140:143]
    ds_read_b128 v[104:107], v18 offset:11264
    ds_read_b128 v[108:111], v18 offset:15360
    ds_read_b128 v[112:115], v18 offset:19456
    v_mfma_f32_16x16x32_bf16 v[144:147], v[40:43], v[44:47], v[144:147]
    ds_read_b64_tr_b16 v[116:117], v20 offset:12288
    ds_read_b64_tr_b16 v[118:119], v20 offset:14336
    v_mfma_f32_16x16x32_bf16 v[128:131], v[48:51], v[68:71], v[128:131]
    v_mfma_f32_16x16x32_bf16 v[132:135], v[52:55], v[68:71], v[132:135]
    v_mfma_f32_16x16x32_bf16 v[136:139], v[56:59], v[68:71], v[136:139]
    v_mfma_f32_16x16x32_bf16 v[140:143], v[60:63], v[68:71], v[140:143]
    v_mfma_f32_16x16x32_bf16 v[144:147], v[64:67], v[68:71], v[144:147]
    s_waitcnt lgkmcnt(0)
    s_barrier
    v_mfma_f32_16x16x32_bf16 v[128:131], v[72:75], v[92:95], v[128:131]
    v_add_u32 v18, 110592, v17
    v_add_u32 v20, 110592, v19
    ds_read_b128 v[24:27], v18 offset:0
    v_mfma_f32_16x16x32_bf16 v[132:135], v[76:79], v[92:95], v[132:135]
    ds_read_b128 v[28:31], v18 offset:4096
    ds_read_b128 v[32:35], v18 offset:8192
    ds_read_b128 v[36:39], v18 offset:12288
    v_mfma_f32_16x16x32_bf16 v[136:139], v[80:83], v[92:95], v[136:139]
    ds_read_b128 v[40:43], v18 offset:16384
    ds_read_b64_tr_b16 v[44:45], v20 offset:0
    ds_read_b64_tr_b16 v[46:47], v20 offset:2048
    v_mfma_f32_16x16x32_bf16 v[140:143], v[84:87], v[92:95], v[140:143]
    ds_read_b128 v[48:51], v18 offset:1024
    ds_read_b128 v[52:55], v18 offset:5120
    ds_read_b128 v[56:59], v18 offset:9216
    v_mfma_f32_16x16x32_bf16 v[144:147], v[88:91], v[92:95], v[144:147]
    ds_read_b128 v[60:63], v18 offset:13312
    ds_read_b128 v[64:67], v18 offset:17408
    ds_read_b64_tr_b16 v[68:69], v20 offset:4096
    v_mfma_f32_16x16x32_bf16 v[128:131], v[96:99], v[116:119], v[128:131]
    ds_read_b64_tr_b16 v[70:71], v20 offset:6144
    v_mfma_f32_16x16x32_bf16 v[132:135], v[100:103], v[116:119], v[132:135]
    v_mfma_f32_16x16x32_bf16 v[136:139], v[104:107], v[116:119], v[136:139]
    v_mfma_f32_16x16x32_bf16 v[140:143], v[108:111], v[116:119], v[140:143]
    v_mfma_f32_16x16x32_bf16 v[144:147], v[112:115], v[116:119], v[144:147]
    s_waitcnt lgkmcnt(0)
    v_mfma_f32_16x16x32_bf16 v[128:131], v[24:27], v[44:47], v[128:131]
    ds_read_b128 v[72:75], v18 offset:2048
    ds_read_b128 v[76:79], v18 offset:6144
    ds_read_b128 v[80:83], v18 offset:10240
    v_mfma_f32_16x16x32_bf16 v[132:135], v[28:31], v[44:47], v[132:135]
    ds_read_b128 v[84:87], v18 offset:14336
    ds_read_b128 v[88:91], v18 offset:18432
    ds_read_b64_tr_b16 v[92:93], v20 offset:8192
    v_mfma_f32_16x16x32_bf16 v[136:139], v[32:35], v[44:47], v[136:139]
    ds_read_b64_tr_b16 v[94:95], v20 offset:10240
    ds_read_b128 v[96:99], v18 offset:3072
    ds_read_b128 v[100:103], v18 offset:7168
    v_mfma_f32_16x16x32_bf16 v[140:143], v[36:39], v[44:47], v[140:143]
    ds_read_b128 v[104:107], v18 offset:11264
    ds_read_b128 v[108:111], v18 offset:15360
    ds_read_b128 v[112:115], v18 offset:19456
    v_mfma_f32_16x16x32_bf16 v[144:147], v[40:43], v[44:47], v[144:147]
    ds_read_b64_tr_b16 v[116:117], v20 offset:12288
    ds_read_b64_tr_b16 v[118:119], v20 offset:14336
    v_mfma_f32_16x16x32_bf16 v[128:131], v[48:51], v[68:71], v[128:131]
    v_mfma_f32_16x16x32_bf16 v[132:135], v[52:55], v[68:71], v[132:135]
    v_mfma_f32_16x16x32_bf16 v[136:139], v[56:59], v[68:71], v[136:139]
    v_mfma_f32_16x16x32_bf16 v[140:143], v[60:63], v[68:71], v[140:143]
    v_mfma_f32_16x16x32_bf16 v[144:147], v[64:67], v[68:71], v[144:147]
    s_waitcnt lgkmcnt(0)
    s_barrier
    v_mfma_f32_16x16x32_bf16 v[128:131], v[72:75], v[92:95], v[128:131]
    v_add_u32 v18, 0, v17
    v_add_u32 v20, 0, v19
    ds_read_b128 v[24:27], v18 offset:0
    v_mfma_f32_16x16x32_bf16 v[132:135], v[76:79], v[92:95], v[132:135]
    ds_read_b128 v[28:31], v18 offset:4096
    ds_read_b128 v[32:35], v18 offset:8192
    ds_read_b128 v[36:39], v18 offset:12288
    v_mfma_f32_16x16x32_bf16 v[136:139], v[80:83], v[92:95], v[136:139]
    ds_read_b128 v[40:43], v18 offset:16384
    ds_read_b64_tr_b16 v[44:45], v20 offset:0
    ds_read_b64_tr_b16 v[46:47], v20 offset:2048
    v_mfma_f32_16x16x32_bf16 v[140:143], v[84:87], v[92:95], v[140:143]
    ds_read_b128 v[48:51], v18 offset:1024
    ds_read_b128 v[52:55], v18 offset:5120
    ds_read_b128 v[56:59], v18 offset:9216
    v_mfma_f32_16x16x32_bf16 v[144:147], v[88:91], v[92:95], v[144:147]
    ds_read_b128 v[60:63], v18 offset:13312
    ds_read_b128 v[64:67], v18 offset:17408
    ds_read_b64_tr_b16 v[68:69], v20 offset:4096
    v_mfma_f32_16x16x32_bf16 v[128:131], v[96:99], v[116:119], v[128:131]
    ds_read_b64_tr_b16 v[70:71], v20 offset:6144
    v_mfma_f32_16x16x32_bf16 v[132:135], v[100:103], v[116:119], v[132:135]
    v_mfma_f32_16x16x32_bf16 v[136:139], v[104:107], v[116:119], v[136:139]
    v_mfma_f32_16x16x32_bf16 v[140:143], v[108:111], v[116:119], v[140:143]
    v_mfma_f32_16x16x32_bf16 v[144:147], v[112:115], v[116:119], v[144:147]
    s_waitcnt lgkmcnt(0)
    v_mfma_f32_16x16x32_bf16 v[128:131], v[24:27], v[44:47], v[128:131]
    ds_read_b128 v[72:75], v18 offset:2048
    ds_read_b128 v[76:79], v18 offset:6144
    ds_read_b128 v[80:83], v18 offset:10240
    v_mfma_f32_16x16x32_bf16 v[132:135], v[28:31], v[44:47], v[132:135]
    ds_read_b128 v[84:87], v18 offset:14336
    ds_read_b128 v[88:91], v18 offset:18432
    ds_read_b64_tr_b16 v[92:93], v20 offset:8192
    v_mfma_f32_16x16x32_bf16 v[136:139], v[32:35], v[44:47], v[136:139]
    ds_read_b64_tr_b16 v[94:95], v20 offset:10240
    ds_read_b128 v[96:99], v18 offset:3072
    ds_read_b128 v[100:103], v18 offset:7168
    v_mfma_f32_16x16x32_bf16 v[140:143], v[36:39], v[44:47], v[140:143]
    ds_read_b128 v[104:107], v18 offset:11264
    ds_read_b128 v[108:111], v18 offset:15360
    ds_read_b128 v[112:115], v18 offset:19456
    v_mfma_f32_16x16x32_bf16 v[144:147], v[40:43], v[44:47], v[144:147]
    ds_read_b64_tr_b16 v[116:117], v20 offset:12288
    ds_read_b64_tr_b16 v[118:119], v20 offset:14336
    v_mfma_f32_16x16x32_bf16 v[128:131], v[48:51], v[68:71], v[128:131]
    v_mfma_f32_16x16x32_bf16 v[132:135], v[52:55], v[68:71], v[132:135]
    v_mfma_f32_16x16x32_bf16 v[136:139], v[56:59], v[68:71], v[136:139]
    v_mfma_f32_16x16x32_bf16 v[140:143], v[60:63], v[68:71], v[140:143]
    v_mfma_f32_16x16x32_bf16 v[144:147], v[64:67], v[68:71], v[144:147]
    s_waitcnt lgkmcnt(0)
    s_barrier
    v_mfma_f32_16x16x32_bf16 v[128:131], v[72:75], v[92:95], v[128:131]
    v_add_u32 v18, 36864, v17
    v_add_u32 v20, 36864, v19
    ds_read_b128 v[24:27], v18 offset:0
    v_mfma_f32_16x16x32_bf16 v[132:135], v[76:79], v[92:95], v[132:135]
    ds_read_b128 v[28:31], v18 offset:4096
    ds_read_b128 v[32:35], v18 offset:8192
    ds_read_b128 v[36:39], v18 offset:12288
    v_mfma_f32_16x16x32_bf16 v[136:139], v[80:83], v[92:95], v[136:139]
    ds_read_b128 v[40:43], v18 offset:16384
    ds_read_b64_tr_b16 v[44:45], v20 offset:0
    ds_read_b64_tr_b16 v[46:47], v20 offset:2048
    v_mfma_f32_16x16x32_bf16 v[140:143], v[84:87], v[92:95], v[140:143]
    ds_read_b128 v[48:51], v18 offset:1024
    ds_read_b128 v[52:55], v18 offset:5120
    ds_read_b128 v[56:59], v18 offset:9216
    v_mfma_f32_16x16x32_bf16 v[144:147], v[88:91], v[92:95], v[144:147]
    ds_read_b128 v[60:63], v18 offset:13312
    ds_read_b128 v[64:67], v18 offset:17408
    ds_read_b64_tr_b16 v[68:69], v20 offset:4096
    v_mfma_f32_16x16x32_bf16 v[128:131], v[96:99], v[116:119], v[128:131]
    ds_read_b64_tr_b16 v[70:71], v20 offset:6144
    v_mfma_f32_16x16x32_bf16 v[132:135], v[100:103], v[116:119], v[132:135]
    v_mfma_f32_16x16x32_bf16 v[136:139], v[104:107], v[116:119], v[136:139]
    v_mfma_f32_16x16x32_bf16 v[140:143], v[108:111], v[116:119], v[140:143]
    v_mfma_f32_16x16x32_bf16 v[144:147], v[112:115], v[116:119], v[144:147]
    s_waitcnt lgkmcnt(0)
    v_mfma_f32_16x16x32_bf16 v[128:131], v[24:27], v[44:47], v[128:131]
    ds_read_b128 v[72:75], v18 offset:2048
    ds_read_b128 v[76:79], v18 offset:6144
    ds_read_b128 v[80:83], v18 offset:10240
    v_mfma_f32_16x16x32_bf16 v[132:135], v[28:31], v[44:47], v[132:135]
    ds_read_b128 v[84:87], v18 offset:14336
    ds_read_b128 v[88:91], v18 offset:18432
    ds_read_b64_tr_b16 v[92:93], v20 offset:8192
    v_mfma_f32_16x16x32_bf16 v[136:139], v[32:35], v[44:47], v[136:139]
    ds_read_b64_tr_b16 v[94:95], v20 offset:10240
    ds_read_b128 v[96:99], v18 offset:3072
    ds_read_b128 v[100:103], v18 offset:7168
    v_mfma_f32_16x16x32_bf16 v[140:143], v[36:39], v[44:47], v[140:143]
    ds_read_b128 v[104:107], v18 offset:11264
    ds_read_b128 v[108:111], v18 offset:15360
    ds_read_b128 v[112:115], v18 offset:19456
    v_mfma_f32_16x16x32_bf16 v[144:147], v[40:43], v[44:47], v[144:147]
    ds_read_b64_tr_b16 v[116:117], v20 offset:12288
    ds_read_b64_tr_b16 v[118:119], v20 offset:14336
    v_mfma_f32_16x16x32_bf16 v[128:131], v[48:51], v[68:71], v[128:131]
    v_mfma_f32_16x16x32_bf16 v[132:135], v[52:55], v[68:71], v[132:135]
    v_mfma_f32_16x16x32_bf16 v[136:139], v[56:59], v[68:71], v[136:139]
    v_mfma_f32_16x16x32_bf16 v[140:143], v[60:63], v[68:71], v[140:143]
    v_mfma_f32_16x16x32_bf16 v[144:147], v[64:67], v[68:71], v[144:147]
    s_waitcnt lgkmcnt(0)
    v_mfma_f32_16x16x32_bf16 v[128:131], v[72:75], v[92:95], v[128:131]
    v_mfma_f32_16x16x32_bf16 v[132:135], v[76:79], v[92:95], v[132:135]
    v_mfma_f32_16x16x32_bf16 v[136:139], v[80:83], v[92:95], v[136:139]
    v_mfma_f32_16x16x32_bf16 v[140:143], v[84:87], v[92:95], v[140:143]
    v_mfma_f32_16x16x32_bf16 v[144:147], v[88:91], v[92:95], v[144:147]
    v_mfma_f32_16x16x32_bf16 v[128:131], v[96:99], v[116:119], v[128:131]
    v_mfma_f32_16x16x32_bf16 v[132:135], v[100:103], v[116:119], v[132:135]
    v_mfma_f32_16x16x32_bf16 v[136:139], v[104:107], v[116:119], v[136:139]
    v_mfma_f32_16x16x32_bf16 v[140:143], v[108:111], v[116:119], v[140:143]
    v_mfma_f32_16x16x32_bf16 v[144:147], v[112:115], v[116:119], v[144:147]
    s_nop 7
    s_waitcnt vmcnt(0)
    v_lshlrev_b32 v208, 16, v208
    v_lshlrev_b32 v40, 16, v210
    v_and_b32 v41, 0xffff0000, v210
    v_add_f32 v128, v128, v208
    v_add_f32 v129, v129, v208
    v_add_f32 v128, v128, v40
    v_add_f32 v129, v129, v41
    v_cvt_pk_bf16_f32 v80, v128, v129
    v_lshlrev_b32 v40, 16, v211
    v_and_b32 v41, 0xffff0000, v211
    v_add_f32 v130, v130, v208
    v_add_f32 v131, v131, v208
    v_add_f32 v130, v130, v40
    v_add_f32 v131, v131, v41
    v_cvt_pk_bf16_f32 v81, v130, v131
    v_lshlrev_b32 v40, 16, v212
    v_and_b32 v41, 0xffff0000, v212
    v_add_f32 v132, v132, v208
    v_add_f32 v133, v133, v208
    v_add_f32 v132, v132, v40
    v_add_f32 v133, v133, v41
    v_cvt_pk_bf16_f32 v82, v132, v133
    v_lshlrev_b32 v40, 16, v213
    v_and_b32 v41, 0xffff0000, v213
    v_add_f32 v134, v134, v208
    v_add_f32 v135, v135, v208
    v_add_f32 v134, v134, v40
    v_add_f32 v135, v135, v41
    v_cvt_pk_bf16_f32 v83, v134, v135
    v_lshlrev_b32 v40, 16, v214
    v_and_b32 v41, 0xffff0000, v214
    v_add_f32 v136, v136, v208
    v_add_f32 v137, v137, v208
    v_add_f32 v136, v136, v40
    v_add_f32 v137, v137, v41
    v_cvt_pk_bf16_f32 v84, v136, v137
    v_lshlrev_b32 v40, 16, v215
    v_and_b32 v41, 0xffff0000, v215
    v_add_f32 v138, v138, v208
    v_add_f32 v139, v139, v208
    v_add_f32 v138, v138, v40
    v_add_f32 v139, v139, v41
    v_cvt_pk_bf16_f32 v85, v138, v139
    v_lshlrev_b32 v40, 16, v216
    v_and_b32 v41, 0xffff0000, v216
    v_add_f32 v140, v140, v208
    v_add_f32 v141, v141, v208
    v_add_f32 v140, v140, v40
    v_add_f32 v141, v141, v41
    v_cvt_pk_bf16_f32 v86, v140, v141
    v_lshlrev_b32 v40, 16, v217
    v_and_b32 v41, 0xffff0000, v217
    v_add_f32 v142, v142, v208
    v_add_f32 v143, v143, v208
    v_add_f32 v142, v142, v40
    v_add_f32 v143, v143, v41
    v_cvt_pk_bf16_f32 v87, v142, v143
    v_lshlrev_b32 v40, 16, v218
    v_and_b32 v41, 0xffff0000, v218
    v_add_f32 v144, v144, v208
    v_add_f32 v145, v145, v208
    v_add_f32 v144, v144, v40
    v_add_f32 v145, v145, v41
    v_cvt_pk_bf16_f32 v88, v144, v145
    v_lshlrev_b32 v40, 16, v219
    v_and_b32 v41, 0xffff0000, v219
    v_add_f32 v146, v146, v208
    v_add_f32 v147, v147, v208
    v_add_f32 v146, v146, v40
    v_add_f32 v147, v147, v41
    v_cvt_pk_bf16_f32 v89, v146, v147
    buffer_store_dwordx2 v[80:81], v220, s[24:27], s64 offen offset:0
    buffer_store_dwordx2 v[82:83], v220, s[24:27], s64 offen offset:32
    buffer_store_dwordx2 v[84:85], v220, s[24:27], s64 offen offset:64
    buffer_store_dwordx2 v[86:87], v220, s[24:27], s64 offen offset:96
    buffer_store_dwordx2 v[88:89], v220, s[24:27], s64 offen offset:128
Lm2_end:
    s_endpgm
.section .rodata,"a"
.p2align 6
.amdhsa_kernel kv_kernel
  .amdhsa_next_free_vgpr 440
  .amdhsa_next_free_sgpr 102
  .amdhsa_accum_offset 184
  .amdhsa_group_segment_fixed_size 0
  .amdhsa_kernarg_size 112
  .amdhsa_user_sgpr_count 2
  .amdhsa_user_sgpr_kernarg_segment_ptr 1
  .amdhsa_system_sgpr_workgroup_id_x 1
.end_amdhsa_kernel
.p2align 6
.amdhsa_kernel attn_kernel
  .amdhsa_next_free_vgpr 256
  .amdhsa_next_free_sgpr 102
  .amdhsa_accum_offset 128
  .amdhsa_group_segment_fixed_size 0
  .amdhsa_kernarg_size 112
  .amdhsa_user_sgpr_count 2
  .amdhsa_user_sgpr_kernarg_segment_ptr 1
  .amdhsa_system_sgpr_workgroup_id_x 1
.end_amdhsa_kernel
.p2align 6
.amdhsa_kernel oproj_kernel
  .amdhsa_next_free_vgpr 204
  .amdhsa_next_free_sgpr 102
  .amdhsa_accum_offset 204
  .amdhsa_group_segment_fixed_size 0
  .amdhsa_kernarg_size 112
  .amdhsa_user_sgpr_count 2
  .amdhsa_user_sgpr_kernarg_segment_ptr 1
  .amdhsa_system_sgpr_workgroup_id_x 1
.end_amdhsa_kernel
.p2align 6
.amdhsa_kernel ln2_kernel
  .amdhsa_next_free_vgpr 96
  .amdhsa_next_free_sgpr 102
  .amdhsa_accum_offset 96
  .amdhsa_group_segment_fixed_size 0
  .amdhsa_kernarg_size 112
  .amdhsa_user_sgpr_count 2
  .amdhsa_user_sgpr_kernarg_segment_ptr 1
  .amdhsa_system_sgpr_workgroup_id_x 1
.end_amdhsa_kernel
.p2align 6
.amdhsa_kernel mlp1_kernel
  .amdhsa_next_free_vgpr 216
  .amdhsa_next_free_sgpr 102
  .amdhsa_accum_offset 216
  .amdhsa_group_segment_fixed_size 0
  .amdhsa_kernarg_size 112
  .amdhsa_user_sgpr_count 2
  .amdhsa_user_sgpr_kernarg_segment_ptr 1
  .amdhsa_system_sgpr_workgroup_id_x 1
.end_amdhsa_kernel
.p2align 6
.amdhsa_kernel mlp2_kernel
  .amdhsa_next_free_vgpr 224
  .amdhsa_next_free_sgpr 102
  .amdhsa_accum_offset 224
  .amdhsa_group_segment_fixed_size 0
  .amdhsa_kernarg_size 112
  .amdhsa_user_sgpr_count 2
  .amdhsa_user_sgpr_kernarg_segment_ptr 1
  .amdhsa_system_sgpr_workgroup_id_x 1
.end_amdhsa_kernel
```
